```python
import torch

def _softmax(x, axis=-1):
    return torch.softmax(x, dim=axis)
def _gelu(x):
    return torch.nn.functional.gelu(x, approximate="tanh")
def _silu(x):
    return torch.nn.functional.silu(x)
def _sigmoid(x):
    return torch.sigmoid(x)
def _layernorm(x, axis=-1, eps=1e-5):
    m = x.mean(dim=axis, keepdim=True)
    v = x.var(dim=axis, keepdim=True, unbiased=False)
    return (x - m) / torch.sqrt(v + eps)
def _scatter_add(tgt, idx, src, axis=0):
    return tgt.clone().index_add_(axis, idx, src)
def _segment_sum(src, seg, n):
    out = torch.zeros((n,) + src.shape[1:], dtype=src.dtype)
    return out.index_add_(0, seg, src)
def _pad(x, pw):
    flat = tuple(v for pair in reversed(pw) for v in pair)
    return torch.nn.functional.pad(x, flat)

kernel_name = 'concat_heads__gqa_block_cached__mha_block_cached__near_ridge'

def setup_inputs():

    _w = (lambda a: (lambda t: t.to(torch.bfloat16) if t.is_floating_point() else t)(torch.as_tensor(a)))
    def _A_setup():
        B, Sq, D = 16, 96, 448
        Hq, Hkv, Sk, Dh = 16, 8, 1024, 256
        assert Hq % Hkv == 0, (Hq, Hkv)
        return {
            "x": _w((lambda *s: torch.randn(*s, dtype=torch.bfloat16) * 0.8)(B, Sq, D)),
            "k_cache": _w((lambda *s: torch.randn(*s, dtype=torch.bfloat16) * 0.8)(B, Hkv, Sk, Dh)),
            "v_cache": _w((lambda *s: torch.randn(*s, dtype=torch.bfloat16) * 0.05)(B, Hkv, Sk, Dh)),
            "wq": _w((lambda *s: torch.randn(*s, dtype=torch.bfloat16) * 0.8)(D, Hq * Dh) * (D ** -0.5)),
            "wo": _w((lambda *s: torch.randn(*s, dtype=torch.bfloat16) * 0.05)(Hq * Dh, D) * ((Hq * Dh) ** -0.5)),
        }
    _A_in = _A_setup()

    def _B_setup():
        B, Sq, D = 16, 96, 448
        H, Sk, Dh = 16, 1024, 256
        return {
            "x": _w((lambda *s: torch.randn(*s, dtype=torch.bfloat16) * 0.8)(B, Sq, D)),
            "k_cache": _w((lambda *s: torch.randn(*s, dtype=torch.bfloat16) * 0.8)(B, H, Sk, Dh)),
            "v_cache": _w((lambda *s: torch.randn(*s, dtype=torch.bfloat16) * 0.05)(B, H, Sk, Dh)),
            "wq": _w((lambda *s: torch.randn(*s, dtype=torch.bfloat16) * 0.8)(D, H * Dh) * (D ** -0.5)),
            "wo": _w((lambda *s: torch.randn(*s, dtype=torch.bfloat16) * 0.05)(H * Dh, D) * ((H * Dh) ** -0.5)),
        }
    _B_in = _B_setup()

    return {
        "A_x": _A_in["x"],
        "A_k_cache": _A_in["k_cache"],
        "A_v_cache": _A_in["v_cache"],
        "A_wq": _A_in["wq"],
        "A_wo": _A_in["wo"],
        "B_x": _B_in["x"],
        "B_k_cache": _B_in["k_cache"],
        "B_v_cache": _B_in["v_cache"],
        "B_wq": _B_in["wq"],
        "B_wo": _B_in["wo"],
    }

def reference(A_x, A_k_cache, A_v_cache, A_wq, A_wo, B_x, B_k_cache, B_v_cache, B_wq, B_wo):
    def _A_ref(x, k_cache, v_cache, wq, wo):
        B, Sq, D = x.shape
        Hq, Dh = 16, 256
        Hkv = k_cache.shape[1]
        rep = Hq // Hkv
        q = (lambda x, *d: x.permute(*d))((x @ wq).reshape(B, Sq, Hq, Dh), 0, 2, 1, 3)
        k = (lambda x, n, axis: torch.repeat_interleave(x, n, dim=axis))(k_cache, rep, axis=1)
        v = (lambda x, n, axis: torch.repeat_interleave(x, n, dim=axis))(v_cache, rep, axis=1)
        scores = torch.einsum("bhqd,bhkd->bhqk", q, k) * (Dh ** -0.5)
        p = _softmax(scores, axis=-1)
        o = torch.einsum("bhqk,bhkd->bhqd", p, v)
        return (lambda x, *d: x.permute(*d))(o, 0, 2, 1, 3).reshape(B, Sq, Hq * Dh) @ wo

    def _B_ref(x, k_cache, v_cache, wq, wo):
        B, Sq, D = x.shape
        H, Dh = 16, 256
        q = (lambda x, *d: x.permute(*d))((x @ wq).reshape(B, Sq, H, Dh), 0, 2, 1, 3)
        scores = torch.einsum("bhqd,bhkd->bhqk", q, k_cache) * (Dh ** -0.5)
        p = _softmax(scores, axis=-1)
        o = torch.einsum("bhqk,bhkd->bhqd", p, v_cache)
        return (lambda x, *d: x.permute(*d))(o, 0, 2, 1, 3).reshape(B, Sq, H * Dh) @ wo

    a = _A_ref(A_x, A_k_cache, A_v_cache, A_wq, A_wo)
    b = _B_ref(B_x, B_k_cache, B_v_cache, B_wq, B_wo)
    return torch.concatenate([a, b], axis=-1)
```

```asm
; @launch grid=(256,1,1) block=(256,1,1) lds=163840
.amdgcn_target "amdgcn-amd-amdhsa--gfx950"
.text
.globl concat_heads__gqa_block_cached__mha_block_cached__near_ridge_kernel
.p2align 8
.type concat_heads__gqa_block_cached__mha_block_cached__near_ridge_kernel,@function
concat_heads__gqa_block_cached__mha_block_cached__near_ridge_kernel:
  s_cmp_ge_u32 s2, 256
  s_cbranch_scc1 L_end
  s_load_dwordx16 s[4:19], s[0:1], 0
  s_load_dwordx4 s[20:23], s[0:1], 64
  s_load_dwordx2 s[24:25], s[0:1], 96
  s_load_dwordx2 s[100:101], s[0:1], 88
  s_getpc_b64 s[28:29]
L_cw:
  s_lshr_b32 s30, s2, 3
  s_lshl_b32 s30, s30, 12
  v_lshl_add_u32 v2, v0, 4, s30
  v_min_u32 v2, L_codeend-L_cw, v2
  v_mov_b32 v3, s29
  v_add_co_u32 v2, vcc, s28, v2
  v_lshrrev_b32 v1, 6, v0
  v_and_b32 v106, 63, v0
  v_addc_co_u32 v3, vcc, 0, v3, vcc
  v_readfirstlane_b32 s52, v1
  global_load_dword v30, v[2:3], off nt
  v_lshrrev_b32 v107, 4, v106
  v_and_b32 v108, 15, v106
  s_and_b32 s26, s2, 7
  s_lshr_b32 s27, s2, 4
  s_bfe_u32 s3, s2, 0x10003
  s_lshr_b32 s53, s52, 1
  s_and_b32 s54, s52, 1
  s_lshl_b32 s55, s53, 16
  s_add_u32 s64, s27, s26
  s_mul_i32 s98, s64, 37
  s_lshr_b32 s98, s98, 8
  s_mul_i32 s98, s98, 7
  s_sub_u32 s98, s64, s98
  s_lshl_b32 s61, s98, 19
  s_cmp_eq_u32 s3, 0
  s_cbranch_scc1 L_flowA
L_flowB:
  s_mul_i32 s64, s52, 43008
  v_lshrrev_b32 v97, 3, v106
  v_mul_u32_u24 v97, 896, v97
  v_add_u32 v97, s64, v97
  v_and_b32 v0, 7, v106
  v_xor_b32 v0, v0, v107
  v_lshl_add_u32 v20, v0, 4, v97
  v_xor_b32 v0, 4, v0
  v_lshl_add_u32 v1, v0, 4, v97
  v_add_u32 v21, 6144, v1
  v_add_u32 v22, 12288, v20
  v_add_u32 v23, 21504, v1
  v_add_u32 v24, 27648, v20
  v_add_u32 v25, 33792, v1
  v_lshlrev_b32 v0, 1, v107
  v_xor_b32 v0, v0, v108
  v_lshlrev_b32 v97, 13, v107
  s_lshl_b32 s65, s52, 16
  v_add_u32 v97, s65, v97
  s_lshl_b32 s65, s54, 3
  v_xor_b32 v0, s65, v0
  v_lshl_add_u32 v88, v0, 4, v97
  v_add_u32 v89, 31744, v88
  s_lshl_b32 s64, s26, 1
  s_and_b32 s65, s27, 1
  s_add_u32 s64, s64, s65
  s_and_b32 s67, s27, 14
  s_mul_i32 s67, s67, 86016
  s_lshl_b32 s97, s52, 11
  s_lshl_b32 s65, s64, 9
  s_sub_u32 s60, 3670016, s65
  s_mul_i32 s77, s52, 6144
  s_lshl_b32 s78, s98, 7
  s_waitcnt lgkmcnt(0)
  s_add_u32 s36, s20, s65
  s_addc_u32 s37, s21, 0
  s_and_b32 s37, s37, 0xffff
  s_mov_b32 s38, s60
  s_mov_b32 s39, 0x20000
  s_add_u32 s44, s14, s67
  s_addc_u32 s45, s15, 0
  s_and_b32 s45, s45, 0xffff
  s_mov_b32 s46, 172032
  s_mov_b32 s47, 0x20000
  s_add_u32 m0, s97, 0
  s_nop 0
  buffer_load_dwordx4 v88, s[36:39], s61 offen offset:0 nt lds
  buffer_load_dwordx4 v89, s[36:39], s61 offen offset:1024 nt lds
  s_add_u32 s61, s61, 256
  s_add_u32 m0, s77, 65536
  s_nop 0
  buffer_load_dwordx4 v20, s[44:47], s78 offen offset:0  lds
  buffer_load_dwordx4 v21, s[44:47], s78 offen offset:1024  lds
  buffer_load_dwordx4 v22, s[44:47], s78 offen offset:2048  lds
  s_add_u32 m0, s77, 68608
  s_nop 0
  buffer_load_dwordx4 v23, s[44:47], s78 offen offset:0  lds
  buffer_load_dwordx4 v24, s[44:47], s78 offen offset:1024  lds
  buffer_load_dwordx4 v25, s[44:47], s78 offen offset:2048  lds
  s_add_u32 s78, s78, 128
  s_cmp_eq_u32 s78, 896
  s_cselect_b32 s78, 0, s78
  s_add_u32 m0, s97, 8192
  s_nop 0
  buffer_load_dwordx4 v88, s[36:39], s61 offen offset:0 nt lds
  buffer_load_dwordx4 v89, s[36:39], s61 offen offset:1024 nt lds
  s_add_u32 s61, s61, 261888
  s_cmp_eq_u32 s61, 3670016
  s_cselect_b32 s61, 0, s61
  v_lshrrev_b32 v109, 2, v108
  v_and_b32 v110, 3, v106
  v_lshl_add_u32 v97, v107, 3, v109
  v_lshlrev_b32 v97, 8, v97
  v_lshl_add_u32 v97, v110, 3, v97
  v_and_b32 v0, 1, v107
  v_lshl_add_u32 v0, v0, 2, v109
  v_xor_b32 v1, 0, v0
  v_lshl_add_u32 v80, v1, 5, v97
  v_xor_b32 v1, 1, v0
  v_lshl_add_u32 v81, v1, 5, v97
  v_xor_b32 v1, 2, v0
  v_lshl_add_u32 v82, v1, 5, v97
  v_xor_b32 v1, 3, v0
  v_lshl_add_u32 v83, v1, 5, v97
  v_xor_b32 v1, 4, v0
  v_lshl_add_u32 v84, v1, 5, v97
  v_xor_b32 v1, 5, v0
  v_lshl_add_u32 v85, v1, 5, v97
  v_xor_b32 v1, 6, v0
  v_lshl_add_u32 v86, v1, 5, v97
  v_xor_b32 v1, 7, v0
  v_lshl_add_u32 v87, v1, 5, v97
  s_mul_i32 s66, s52, 6144
  s_add_u32 s66, s66, 65536
  v_lshlrev_b32 v97, 7, v108
  v_add_u32 v97, s66, v97
  v_lshrrev_b32 v0, 1, v108
  v_xor_b32 v0, v0, v107
  v_lshl_add_u32 v92, v0, 4, v97
  v_xor_b32 v0, 4, v0
  v_lshl_add_u32 v93, v0, 4, v97
  s_add_u32 m0, s97, 16384
  s_nop 0
  buffer_load_dwordx4 v88, s[36:39], s61 offen offset:0 nt lds
  buffer_load_dwordx4 v89, s[36:39], s61 offen offset:1024 nt lds
  s_add_u32 s61, s61, 256
  s_add_u32 m0, s97, 24576
  s_nop 0
  buffer_load_dwordx4 v88, s[36:39], s61 offen offset:0 nt lds
  buffer_load_dwordx4 v89, s[36:39], s61 offen offset:1024 nt lds
  s_add_u32 s61, s61, 261888
  s_cmp_eq_u32 s61, 3670016
  s_cselect_b32 s61, 0, s61
  s_add_u32 m0, s97, 90112
  s_nop 0
  buffer_load_dwordx4 v88, s[36:39], s61 offen offset:0  lds
  buffer_load_dwordx4 v89, s[36:39], s61 offen offset:1024  lds
  s_add_u32 s61, s61, 256
  s_waitcnt vmcnt(8)
  s_barrier
  ds_read_b128 a[0:3], v92 offset:0
  ds_read_b128 a[4:7], v92 offset:2048
  ds_read_b128 a[8:11], v92 offset:4096
  ds_read_b64_tr_b16 a[96:97], v80 offset:0
  ds_read_b64_tr_b16 a[98:99], v80 offset:1024
  ds_read_b64_tr_b16 a[100:101], v81 offset:0
  ds_read_b64_tr_b16 a[102:103], v81 offset:1024
  ds_read_b64_tr_b16 a[104:105], v82 offset:0
  ds_read_b64_tr_b16 a[106:107], v82 offset:1024
  ds_read_b64_tr_b16 a[108:109], v83 offset:0
  ds_read_b64_tr_b16 a[110:111], v83 offset:1024
  ds_read_b64_tr_b16 a[112:113], v84 offset:0
  ds_read_b64_tr_b16 a[114:115], v84 offset:1024
  s_waitcnt lgkmcnt(10)
  s_waitcnt lgkmcnt(6)
  v_mfma_f32_16x16x32_bf16 v[112:115], a[96:99], a[0:3], 0
  ds_read_b64_tr_b16 a[116:117], v85 offset:0
  s_add_u32 m0, s97, 131072
  s_nop 0
  buffer_load_dwordx4 v88, s[36:39], s61 offen offset:0  lds
  v_mfma_f32_16x16x32_bf16 v[116:119], a[96:99], a[4:7], 0
  ds_read_b64_tr_b16 a[118:119], v85 offset:1024
  v_add_u32 v98, 90112, v80
  v_mfma_f32_16x16x32_bf16 v[120:123], a[96:99], a[8:11], 0
  v_add_u32 v99, 90112, v81
  v_add_u32 v100, 90112, v82
  v_mfma_f32_16x16x32_bf16 v[124:127], a[100:103], a[0:3], 0
  ds_read_b64_tr_b16 a[120:121], v86 offset:0
  v_add_u32 v101, 90112, v83
  v_mfma_f32_16x16x32_bf16 v[128:131], a[100:103], a[4:7], 0
  ds_read_b64_tr_b16 a[122:123], v86 offset:1024
  buffer_load_dwordx4 v89, s[36:39], s61 offen offset:1024  lds
  v_mfma_f32_16x16x32_bf16 v[132:135], a[100:103], a[8:11], 0
  s_add_u32 s61, s61, 261888
  s_waitcnt lgkmcnt(6)
  v_mfma_f32_16x16x32_bf16 v[136:139], a[104:107], a[0:3], 0
  ds_read_b64_tr_b16 a[124:125], v87 offset:0
  v_add_u32 v102, 90112, v84
  v_mfma_f32_16x16x32_bf16 v[140:143], a[104:107], a[4:7], 0
  ds_read_b64_tr_b16 a[126:127], v87 offset:1024
  v_add_u32 v103, 90112, v85
  v_mfma_f32_16x16x32_bf16 v[144:147], a[104:107], a[8:11], 0
  s_cmp_eq_u32 s61, 3670016
  s_cselect_b32 s61, 0, s61
  v_mfma_f32_16x16x32_bf16 v[148:151], a[108:111], a[0:3], 0
  s_add_u32 m0, s77, 139264
  s_nop 0
  buffer_load_dwordx4 v20, s[44:47], s78 offen offset:0  lds
  v_mfma_f32_16x16x32_bf16 v[152:155], a[108:111], a[4:7], 0
  v_add_u32 v104, 90112, v86
  v_add_u32 v105, 90112, v87
  v_mfma_f32_16x16x32_bf16 v[156:159], a[108:111], a[8:11], 0
  v_add_u32 v94, 73728, v92
  s_waitcnt lgkmcnt(4)
  v_mfma_f32_16x16x32_bf16 v[160:163], a[112:115], a[0:3], 0
  s_waitcnt vmcnt(9) lgkmcnt(0)
  s_barrier
  v_mfma_f32_16x16x32_bf16 v[164:167], a[112:115], a[4:7], 0
  ds_read_b64_tr_b16 a[96:97], v80 offset:8192
  buffer_load_dwordx4 v21, s[44:47], s78 offen offset:1024  lds
  v_mfma_f32_16x16x32_bf16 v[168:171], a[112:115], a[8:11], 0
  ds_read_b64_tr_b16 a[98:99], v80 offset:9216
  ds_read_b128 a[12:15], v93 offset:0
  v_mfma_f32_16x16x32_bf16 v[172:175], a[116:119], a[0:3], 0
  ds_read_b64_tr_b16 a[100:101], v81 offset:8192
  ds_read_b128 a[16:19], v93 offset:2048
  v_mfma_f32_16x16x32_bf16 v[176:179], a[116:119], a[4:7], 0
  ds_read_b64_tr_b16 a[102:103], v81 offset:9216
  ds_read_b128 a[20:23], v93 offset:4096
  v_mfma_f32_16x16x32_bf16 v[180:183], a[116:119], a[8:11], 0
  ds_read_b64_tr_b16 a[104:105], v82 offset:8192
  buffer_load_dwordx4 v22, s[44:47], s78 offen offset:2048  lds
  v_mfma_f32_16x16x32_bf16 v[184:187], a[120:123], a[0:3], 0
  ds_read_b64_tr_b16 a[106:107], v82 offset:9216
  v_add_u32 v95, 73728, v93
  v_mfma_f32_16x16x32_bf16 v[188:191], a[120:123], a[4:7], 0
  ds_read_b64_tr_b16 a[108:109], v83 offset:8192
  s_and_b32 s65, s27, 14
  v_mfma_f32_16x16x32_bf16 v[192:195], a[120:123], a[8:11], 0
  ds_read_b64_tr_b16 a[110:111], v83 offset:9216
  s_add_u32 s65, s65, s53
  v_mfma_f32_16x16x32_bf16 v[196:199], a[124:127], a[0:3], 0
  ds_read_b64_tr_b16 a[112:113], v84 offset:8192
  s_lshl_b32 s65, s65, 4
  v_mfma_f32_16x16x32_bf16 v[200:203], a[124:127], a[4:7], 0
  ds_read_b64_tr_b16 a[114:115], v84 offset:9216
  s_add_u32 s65, s65, s64
  v_mfma_f32_16x16x32_bf16 v[204:207], a[124:127], a[8:11], 0
  s_lshl_b32 s65, s65, 19
  s_waitcnt lgkmcnt(7)
  v_mfma_f32_16x16x32_bf16 v[208:211], a[96:99], a[0:3], 0
  ds_read_b64_tr_b16 a[116:117], v85 offset:8192
  s_add_u32 m0, s97, 0
  s_nop 0
  buffer_load_dwordx4 v88, s[36:39], s61 offen offset:0  lds
  v_mfma_f32_16x16x32_bf16 v[212:215], a[96:99], a[4:7], 0
  ds_read_b64_tr_b16 a[118:119], v85 offset:9216
  v_mfma_f32_16x16x32_bf16 v[216:219], a[96:99], a[8:11], 0
  s_add_u32 s28, s16, s65
  s_addc_u32 s29, s17, 0
  v_mfma_f32_16x16x32_bf16 v[220:223], a[100:103], a[0:3], 0
  ds_read_b64_tr_b16 a[120:121], v86 offset:8192
  s_and_b32 s29, s29, 0xffff
  v_mfma_f32_16x16x32_bf16 v[224:227], a[100:103], a[4:7], 0
  ds_read_b64_tr_b16 a[122:123], v86 offset:9216
  buffer_load_dwordx4 v89, s[36:39], s61 offen offset:1024  lds
  v_mfma_f32_16x16x32_bf16 v[228:231], a[100:103], a[8:11], 0
  s_add_u32 s61, s61, 256
  s_waitcnt lgkmcnt(6)
  v_mfma_f32_16x16x32_bf16 v[232:235], a[104:107], a[0:3], 0
  ds_read_b64_tr_b16 a[124:125], v87 offset:8192
  s_mov_b32 s30, 524288
  v_mfma_f32_16x16x32_bf16 v[236:239], a[104:107], a[4:7], 0
  ds_read_b64_tr_b16 a[126:127], v87 offset:9216
  s_mov_b32 s31, 0x20000
  v_mfma_f32_16x16x32_bf16 v[240:243], a[104:107], a[8:11], 0
  s_add_u32 m0, s77, 142336
  s_nop 0
  buffer_load_dwordx4 v23, s[44:47], s78 offen offset:0  lds
  v_mfma_f32_16x16x32_bf16 v[244:247], a[108:111], a[0:3], 0
  v_lshrrev_b32 v111, 5, v106
  v_and_b32 v96, 31, v106
  v_mfma_f32_16x16x32_bf16 v[248:251], a[108:111], a[4:7], 0
  s_lshl_b32 s66, s54, 13
  s_add_u32 s58, s55, s66
  v_mfma_f32_16x16x32_bf16 v[252:255], a[108:111], a[8:11], 0
  s_mov_b32 s67, s55
  s_waitcnt lgkmcnt(4)
  v_mfma_f32_16x16x32_bf16 v[32:35], a[112:115], a[0:3], 0
  s_waitcnt vmcnt(12) lgkmcnt(0)
  s_barrier
  v_mfma_f32_16x16x32_bf16 v[36:39], a[112:115], a[4:7], 0
  ds_read_b64_tr_b16 a[96:97], v80 offset:16384
  buffer_load_dwordx4 v24, s[44:47], s78 offen offset:1024  lds
  v_mfma_f32_16x16x32_bf16 v[40:43], a[112:115], a[8:11], 0
  ds_read_b64_tr_b16 a[98:99], v80 offset:17408
  v_lshlrev_b32 v97, 1, v111
  v_mfma_f32_16x16x32_bf16 v[44:47], a[116:119], a[0:3], 0
  ds_read_b64_tr_b16 a[100:101], v81 offset:16384
  v_xor_b32 v97, v97, v96
  v_mfma_f32_16x16x32_bf16 v[48:51], a[116:119], a[4:7], 0
  ds_read_b64_tr_b16 a[102:103], v81 offset:17408
  v_lshlrev_b32 v0, 9, v111
  v_mfma_f32_16x16x32_bf16 v[52:55], a[116:119], a[8:11], 0
  ds_read_b64_tr_b16 a[104:105], v82 offset:16384
  buffer_load_dwordx4 v25, s[44:47], s78 offen offset:2048  lds
  v_mfma_f32_16x16x32_bf16 v[56:59], a[120:123], a[0:3], 0
  ds_read_b64_tr_b16 a[106:107], v82 offset:17408
  s_add_u32 s78, s78, 128
  v_mfma_f32_16x16x32_bf16 v[60:63], a[120:123], a[4:7], 0
  ds_read_b64_tr_b16 a[108:109], v83 offset:16384
  v_add_u32 v0, s66, v0
  v_mfma_f32_16x16x32_bf16 v[64:67], a[120:123], a[8:11], 0
  ds_read_b64_tr_b16 a[110:111], v83 offset:17408
  v_xor_b32 v1, 0, v97
  v_mfma_f32_16x16x32_bf16 v[68:71], a[124:127], a[0:3], 0
  ds_read_b64_tr_b16 a[112:113], v84 offset:16384
  v_lshl_add_u32 v16, v1, 4, v0
  v_mfma_f32_16x16x32_bf16 v[72:75], a[124:127], a[4:7], 0
  ds_read_b64_tr_b16 a[114:115], v84 offset:17408
  v_xor_b32 v1, 4, v97
  v_mfma_f32_16x16x32_bf16 v[76:79], a[124:127], a[8:11], 0
  v_lshl_add_u32 v17, v1, 4, v0
  s_cmp_eq_u32 s78, 896
  s_cselect_b32 s78, 0, s78
  s_waitcnt lgkmcnt(6)
  v_mfma_f32_16x16x32_bf16 v[112:115], a[96:99], a[12:15], v[112:115]
  ds_read_b64_tr_b16 a[116:117], v85 offset:16384
  s_add_u32 m0, s97, 8192
  s_nop 0
  buffer_load_dwordx4 v88, s[36:39], s61 offen offset:0  lds
  v_mfma_f32_16x16x32_bf16 v[116:119], a[96:99], a[16:19], v[116:119]
  ds_read_b64_tr_b16 a[118:119], v85 offset:17408
  v_xor_b32 v1, 8, v97
  v_mfma_f32_16x16x32_bf16 v[120:123], a[96:99], a[20:23], v[120:123]
  v_lshl_add_u32 v18, v1, 4, v0
  v_xor_b32 v1, 12, v97
  v_mfma_f32_16x16x32_bf16 v[124:127], a[100:103], a[12:15], v[124:127]
  ds_read_b64_tr_b16 a[120:121], v86 offset:16384
  v_lshl_add_u32 v19, v1, 4, v0
  v_mfma_f32_16x16x32_bf16 v[128:131], a[100:103], a[16:19], v[128:131]
  ds_read_b64_tr_b16 a[122:123], v86 offset:17408
  buffer_load_dwordx4 v89, s[36:39], s61 offen offset:1024  lds
  v_mfma_f32_16x16x32_bf16 v[132:135], a[100:103], a[20:23], v[132:135]
  s_add_u32 s61, s61, 261888
  s_waitcnt lgkmcnt(6)
  v_mfma_f32_16x16x32_bf16 v[136:139], a[104:107], a[12:15], v[136:139]
  ds_read_b64_tr_b16 a[124:125], v87 offset:16384
  v_mfma_f32_16x16x32_bf16 v[140:143], a[104:107], a[16:19], v[140:143]
  ds_read_b64_tr_b16 a[126:127], v87 offset:17408
  v_mfma_f32_16x16x32_bf16 v[144:147], a[104:107], a[20:23], v[144:147]
  s_cmp_eq_u32 s61, 3670016
  s_cselect_b32 s61, 0, s61
  v_mfma_f32_16x16x32_bf16 v[148:151], a[108:111], a[12:15], v[148:151]
  s_add_u32 m0, s77, 65536
  s_nop 0
  buffer_load_dwordx4 v20, s[44:47], s78 offen offset:0  lds
  v_mfma_f32_16x16x32_bf16 v[152:155], a[108:111], a[16:19], v[152:155]
  s_add_u32 s32, s18, s65
  s_addc_u32 s33, s19, 0
  v_mfma_f32_16x16x32_bf16 v[156:159], a[108:111], a[20:23], v[156:159]
  s_and_b32 s33, s33, 0xffff
  s_waitcnt lgkmcnt(4)
  v_mfma_f32_16x16x32_bf16 v[160:163], a[112:115], a[12:15], v[160:163]
  s_waitcnt vmcnt(15) lgkmcnt(0)
  s_barrier
  v_mfma_f32_16x16x32_bf16 v[164:167], a[112:115], a[16:19], v[164:167]
  ds_read_b64_tr_b16 a[96:97], v80 offset:24576
  buffer_load_dwordx4 v21, s[44:47], s78 offen offset:1024  lds
  v_mfma_f32_16x16x32_bf16 v[168:171], a[112:115], a[20:23], v[168:171]
  ds_read_b64_tr_b16 a[98:99], v80 offset:25600
  s_mov_b32 s34, 524288
  v_mfma_f32_16x16x32_bf16 v[172:175], a[116:119], a[12:15], v[172:175]
  ds_read_b64_tr_b16 a[100:101], v81 offset:24576
  s_mov_b32 s35, 0x20000
  v_mfma_f32_16x16x32_bf16 v[176:179], a[116:119], a[16:19], v[176:179]
  ds_read_b64_tr_b16 a[102:103], v81 offset:25600
  v_and_b32 v97, 7, v108
  v_mfma_f32_16x16x32_bf16 v[180:183], a[116:119], a[20:23], v[180:183]
  ds_read_b64_tr_b16 a[104:105], v82 offset:24576
  buffer_load_dwordx4 v22, s[44:47], s78 offen offset:2048  lds
  v_mfma_f32_16x16x32_bf16 v[184:187], a[120:123], a[12:15], v[184:187]
  ds_read_b64_tr_b16 a[106:107], v82 offset:25600
  v_lshlrev_b32 v97, 1, v97
  v_mfma_f32_16x16x32_bf16 v[188:191], a[120:123], a[16:19], v[188:191]
  ds_read_b64_tr_b16 a[108:109], v83 offset:24576
  v_xor_b32 v97, v97, v107
  v_mfma_f32_16x16x32_bf16 v[192:195], a[120:123], a[20:23], v[192:195]
  ds_read_b64_tr_b16 a[110:111], v83 offset:25600
  v_lshlrev_b32 v0, 9, v108
  v_mfma_f32_16x16x32_bf16 v[196:199], a[124:127], a[12:15], v[196:199]
  ds_read_b64_tr_b16 a[112:113], v84 offset:24576
  v_add_u32 v0, s67, v0
  v_mfma_f32_16x16x32_bf16 v[200:203], a[124:127], a[16:19], v[200:203]
  ds_read_b64_tr_b16 a[114:115], v84 offset:25600
  v_xor_b32 v1, 0, v97
  v_mfma_f32_16x16x32_bf16 v[204:207], a[124:127], a[20:23], v[204:207]
  v_lshl_add_u32 v4, v1, 4, v0
  s_waitcnt lgkmcnt(6)
  v_mfma_f32_16x16x32_bf16 v[208:211], a[96:99], a[12:15], v[208:211]
  ds_read_b64_tr_b16 a[116:117], v85 offset:24576
  s_add_u32 m0, s97, 16384
  s_nop 0
  buffer_load_dwordx4 v88, s[36:39], s61 offen offset:0  lds
  v_mfma_f32_16x16x32_bf16 v[212:215], a[96:99], a[16:19], v[212:215]
  ds_read_b64_tr_b16 a[118:119], v85 offset:25600
  v_xor_b32 v1, 4, v97
  v_mfma_f32_16x16x32_bf16 v[216:219], a[96:99], a[20:23], v[216:219]
  v_lshl_add_u32 v5, v1, 4, v0
  v_xor_b32 v1, 8, v97
  v_mfma_f32_16x16x32_bf16 v[220:223], a[100:103], a[12:15], v[220:223]
  ds_read_b64_tr_b16 a[120:121], v86 offset:24576
  v_lshl_add_u32 v6, v1, 4, v0
  v_mfma_f32_16x16x32_bf16 v[224:227], a[100:103], a[16:19], v[224:227]
  ds_read_b64_tr_b16 a[122:123], v86 offset:25600
  buffer_load_dwordx4 v89, s[36:39], s61 offen offset:1024  lds
  v_mfma_f32_16x16x32_bf16 v[228:231], a[100:103], a[20:23], v[228:231]
  s_add_u32 s61, s61, 256
  s_waitcnt lgkmcnt(6)
  v_mfma_f32_16x16x32_bf16 v[232:235], a[104:107], a[12:15], v[232:235]
  ds_read_b64_tr_b16 a[124:125], v87 offset:24576
  v_xor_b32 v1, 12, v97
  v_mfma_f32_16x16x32_bf16 v[236:239], a[104:107], a[16:19], v[236:239]
  ds_read_b64_tr_b16 a[126:127], v87 offset:25600
  v_lshl_add_u32 v7, v1, 4, v0
  v_mfma_f32_16x16x32_bf16 v[240:243], a[104:107], a[20:23], v[240:243]
  s_add_u32 m0, s77, 68608
  s_nop 0
  buffer_load_dwordx4 v23, s[44:47], s78 offen offset:0  lds
  v_mfma_f32_16x16x32_bf16 v[244:247], a[108:111], a[12:15], v[244:247]
  v_lshl_add_u32 v97, v107, 2, v109
  v_lshlrev_b32 v0, 9, v97
  v_mfma_f32_16x16x32_bf16 v[248:251], a[108:111], a[16:19], v[248:251]
  v_lshl_add_u32 v0, v110, 3, v0
  v_add_u32 v0, s67, v0
  v_mfma_f32_16x16x32_bf16 v[252:255], a[108:111], a[20:23], v[252:255]
  v_and_b32 v97, 7, v97
  s_waitcnt lgkmcnt(4)
  v_mfma_f32_16x16x32_bf16 v[32:35], a[112:115], a[12:15], v[32:35]
  s_waitcnt vmcnt(8) lgkmcnt(0)
  s_barrier
  v_mfma_f32_16x16x32_bf16 v[36:39], a[112:115], a[16:19], v[36:39]
  ds_read_b64_tr_b16 a[96:97], v98 offset:0
  ds_read_b128 a[24:27], v94 offset:0
  v_mfma_f32_16x16x32_bf16 v[40:43], a[112:115], a[20:23], v[40:43]
  ds_read_b64_tr_b16 a[98:99], v98 offset:1024
  ds_read_b128 a[28:31], v94 offset:2048
  v_mfma_f32_16x16x32_bf16 v[44:47], a[116:119], a[12:15], v[44:47]
  ds_read_b64_tr_b16 a[100:101], v99 offset:0
  ds_read_b128 a[32:35], v94 offset:4096
  v_mfma_f32_16x16x32_bf16 v[48:51], a[116:119], a[16:19], v[48:51]
  ds_read_b64_tr_b16 a[102:103], v99 offset:1024
  buffer_load_dwordx4 v24, s[44:47], s78 offen offset:1024  lds
  v_mfma_f32_16x16x32_bf16 v[52:55], a[116:119], a[20:23], v[52:55]
  ds_read_b64_tr_b16 a[104:105], v100 offset:0
  v_xor_b32 v1, 0, v97
  v_mfma_f32_16x16x32_bf16 v[56:59], a[120:123], a[12:15], v[56:59]
  ds_read_b64_tr_b16 a[106:107], v100 offset:1024
  v_lshl_add_u32 v8, v1, 5, v0
  v_mfma_f32_16x16x32_bf16 v[60:63], a[120:123], a[16:19], v[60:63]
  ds_read_b64_tr_b16 a[108:109], v101 offset:0
  v_xor_b32 v1, 1, v97
  v_mfma_f32_16x16x32_bf16 v[64:67], a[120:123], a[20:23], v[64:67]
  ds_read_b64_tr_b16 a[110:111], v101 offset:1024
  buffer_load_dwordx4 v25, s[44:47], s78 offen offset:2048  lds
  v_mfma_f32_16x16x32_bf16 v[68:71], a[124:127], a[12:15], v[68:71]
  ds_read_b64_tr_b16 a[112:113], v102 offset:0
  s_add_u32 s78, s78, 128
  v_mfma_f32_16x16x32_bf16 v[72:75], a[124:127], a[16:19], v[72:75]
  ds_read_b64_tr_b16 a[114:115], v102 offset:1024
  v_lshl_add_u32 v9, v1, 5, v0
  v_mfma_f32_16x16x32_bf16 v[76:79], a[124:127], a[20:23], v[76:79]
  v_xor_b32 v1, 2, v97
  s_cmp_eq_u32 s78, 896
  s_cselect_b32 s78, 0, s78
  s_waitcnt lgkmcnt(7)
  s_waitcnt lgkmcnt(6)
  v_mfma_f32_16x16x32_bf16 v[112:115], a[96:99], a[24:27], v[112:115]
  ds_read_b64_tr_b16 a[116:117], v103 offset:0
  s_add_u32 m0, s97, 24576
  s_nop 0
  buffer_load_dwordx4 v88, s[36:39], s61 offen offset:0  lds
  v_mfma_f32_16x16x32_bf16 v[116:119], a[96:99], a[28:31], v[116:119]
  ds_read_b64_tr_b16 a[118:119], v103 offset:1024
  ds_read_b128 a[36:39], v95 offset:0
  v_mfma_f32_16x16x32_bf16 v[120:123], a[96:99], a[32:35], v[120:123]
  ds_read_b128 a[40:43], v95 offset:2048
  v_lshl_add_u32 v10, v1, 5, v0
  v_mfma_f32_16x16x32_bf16 v[124:127], a[100:103], a[24:27], v[124:127]
  ds_read_b64_tr_b16 a[120:121], v104 offset:0
  v_xor_b32 v1, 3, v97
  v_mfma_f32_16x16x32_bf16 v[128:131], a[100:103], a[28:31], v[128:131]
  ds_read_b64_tr_b16 a[122:123], v104 offset:1024
  buffer_load_dwordx4 v89, s[36:39], s61 offen offset:1024  lds
  v_mfma_f32_16x16x32_bf16 v[132:135], a[100:103], a[32:35], v[132:135]
  s_add_u32 s61, s61, 261888
  s_waitcnt lgkmcnt(8)
  v_mfma_f32_16x16x32_bf16 v[136:139], a[104:107], a[24:27], v[136:139]
  ds_read_b64_tr_b16 a[124:125], v105 offset:0
  ds_read_b128 a[44:47], v95 offset:4096
  v_mfma_f32_16x16x32_bf16 v[140:143], a[104:107], a[28:31], v[140:143]
  ds_read_b64_tr_b16 a[126:127], v105 offset:1024
  v_lshl_add_u32 v11, v1, 5, v0
  v_mfma_f32_16x16x32_bf16 v[144:147], a[104:107], a[32:35], v[144:147]
  s_cmp_eq_u32 s61, 3670016
  s_cselect_b32 s61, 0, s61
  v_mfma_f32_16x16x32_bf16 v[148:151], a[108:111], a[24:27], v[148:151]
  v_xor_b32 v1, 4, v97
  v_lshl_add_u32 v12, v1, 5, v0
  v_mfma_f32_16x16x32_bf16 v[152:155], a[108:111], a[28:31], v[152:155]
  v_xor_b32 v1, 5, v97
  v_lshl_add_u32 v13, v1, 5, v0
  v_mfma_f32_16x16x32_bf16 v[156:159], a[108:111], a[32:35], v[156:159]
  v_xor_b32 v1, 6, v97
  s_waitcnt lgkmcnt(7)
  v_mfma_f32_16x16x32_bf16 v[160:163], a[112:115], a[24:27], v[160:163]
  s_waitcnt lgkmcnt(0)
  s_barrier
  v_mfma_f32_16x16x32_bf16 v[164:167], a[112:115], a[28:31], v[164:167]
  ds_read_b64_tr_b16 a[96:97], v98 offset:40960
  v_lshl_add_u32 v14, v1, 5, v0
  v_mfma_f32_16x16x32_bf16 v[168:171], a[112:115], a[32:35], v[168:171]
  ds_read_b64_tr_b16 a[98:99], v98 offset:41984
  v_xor_b32 v1, 7, v97
  v_mfma_f32_16x16x32_bf16 v[172:175], a[116:119], a[24:27], v[172:175]
  ds_read_b64_tr_b16 a[100:101], v99 offset:40960
  v_lshl_add_u32 v15, v1, 5, v0
  v_mfma_f32_16x16x32_bf16 v[176:179], a[116:119], a[28:31], v[176:179]
  ds_read_b64_tr_b16 a[102:103], v99 offset:41984
  s_mul_i32 s65, s64, 229376
  v_mfma_f32_16x16x32_bf16 v[180:183], a[116:119], a[32:35], v[180:183]
  ds_read_b64_tr_b16 a[104:105], v100 offset:40960
  v_mfma_f32_16x16x32_bf16 v[184:187], a[120:123], a[24:27], v[184:187]
  ds_read_b64_tr_b16 a[106:107], v100 offset:41984
  v_mfma_f32_16x16x32_bf16 v[188:191], a[120:123], a[28:31], v[188:191]
  ds_read_b64_tr_b16 a[108:109], v101 offset:40960
  v_mfma_f32_16x16x32_bf16 v[192:195], a[120:123], a[32:35], v[192:195]
  ds_read_b64_tr_b16 a[110:111], v101 offset:41984
  v_mfma_f32_16x16x32_bf16 v[196:199], a[124:127], a[24:27], v[196:199]
  ds_read_b64_tr_b16 a[112:113], v102 offset:40960
  v_mfma_f32_16x16x32_bf16 v[200:203], a[124:127], a[28:31], v[200:203]
  ds_read_b64_tr_b16 a[114:115], v102 offset:41984
  v_mfma_f32_16x16x32_bf16 v[204:207], a[124:127], a[32:35], v[204:207]
  s_waitcnt lgkmcnt(6)
  v_mfma_f32_16x16x32_bf16 v[208:211], a[96:99], a[24:27], v[208:211]
  ds_read_b64_tr_b16 a[116:117], v103 offset:40960
  s_add_u32 m0, s97, 90112
  s_nop 0
  buffer_load_dwordx4 v88, s[36:39], s61 offen offset:0  lds
  v_mfma_f32_16x16x32_bf16 v[212:215], a[96:99], a[28:31], v[212:215]
  ds_read_b64_tr_b16 a[118:119], v103 offset:41984
  v_mfma_f32_16x16x32_bf16 v[216:219], a[96:99], a[32:35], v[216:219]
  s_add_u32 s40, s22, s65
  s_addc_u32 s41, s23, 0
  v_mfma_f32_16x16x32_bf16 v[220:223], a[100:103], a[24:27], v[220:223]
  ds_read_b64_tr_b16 a[120:121], v104 offset:40960
  s_and_b32 s41, s41, 0xffff
  v_mfma_f32_16x16x32_bf16 v[224:227], a[100:103], a[28:31], v[224:227]
  ds_read_b64_tr_b16 a[122:123], v104 offset:41984
  buffer_load_dwordx4 v89, s[36:39], s61 offen offset:1024  lds
  v_mfma_f32_16x16x32_bf16 v[228:231], a[100:103], a[32:35], v[228:231]
  s_add_u32 s61, s61, 256
  s_waitcnt lgkmcnt(6)
  v_mfma_f32_16x16x32_bf16 v[232:235], a[104:107], a[24:27], v[232:235]
  ds_read_b64_tr_b16 a[124:125], v105 offset:40960
  s_mov_b32 s42, 229376
  v_mfma_f32_16x16x32_bf16 v[236:239], a[104:107], a[28:31], v[236:239]
  ds_read_b64_tr_b16 a[126:127], v105 offset:41984
  s_mov_b32 s43, 0x20000
  v_mfma_f32_16x16x32_bf16 v[240:243], a[104:107], a[32:35], v[240:243]
  s_add_u32 m0, s77, 139264
  s_nop 0
  buffer_load_dwordx4 v20, s[44:47], s78 offen offset:0  lds
  v_mfma_f32_16x16x32_bf16 v[244:247], a[108:111], a[24:27], v[244:247]
  s_lshl_b32 s65, s27, 3
  s_add_u32 s65, s65, s26
  v_mfma_f32_16x16x32_bf16 v[248:251], a[108:111], a[28:31], v[248:251]
  s_lshl_b32 s65, s65, 2
  s_add_u32 s65, s65, s52
  v_mfma_f32_16x16x32_bf16 v[252:255], a[108:111], a[32:35], v[252:255]
  s_mul_i32 s65, s65, 43008
  s_waitcnt lgkmcnt(4)
  v_mfma_f32_16x16x32_bf16 v[32:35], a[112:115], a[24:27], v[32:35]
  s_waitcnt lgkmcnt(0)
  s_barrier
  v_mfma_f32_16x16x32_bf16 v[36:39], a[112:115], a[28:31], v[36:39]
  ds_read_b64_tr_b16 a[96:97], v80 offset:0
  buffer_load_dwordx4 v21, s[44:47], s78 offen offset:1024  lds
  v_mfma_f32_16x16x32_bf16 v[40:43], a[112:115], a[32:35], v[40:43]
  ds_read_b64_tr_b16 a[98:99], v80 offset:1024
  s_add_u32 s65, s65, 11010048
  v_mfma_f32_16x16x32_bf16 v[44:47], a[116:119], a[24:27], v[44:47]
  ds_read_b64_tr_b16 a[100:101], v81 offset:0
  v_mfma_f32_16x16x32_bf16 v[48:51], a[116:119], a[28:31], v[48:51]
  ds_read_b64_tr_b16 a[102:103], v81 offset:1024
  v_mfma_f32_16x16x32_bf16 v[52:55], a[116:119], a[32:35], v[52:55]
  ds_read_b64_tr_b16 a[104:105], v82 offset:0
  buffer_load_dwordx4 v22, s[44:47], s78 offen offset:2048  lds
  v_mfma_f32_16x16x32_bf16 v[56:59], a[120:123], a[24:27], v[56:59]
  ds_read_b64_tr_b16 a[106:107], v82 offset:1024
  v_mfma_f32_16x16x32_bf16 v[60:63], a[120:123], a[28:31], v[60:63]
  ds_read_b64_tr_b16 a[108:109], v83 offset:0
  v_mfma_f32_16x16x32_bf16 v[64:67], a[120:123], a[32:35], v[64:67]
  ds_read_b64_tr_b16 a[110:111], v83 offset:1024
  v_mfma_f32_16x16x32_bf16 v[68:71], a[124:127], a[24:27], v[68:71]
  ds_read_b64_tr_b16 a[112:113], v84 offset:0
  v_mfma_f32_16x16x32_bf16 v[72:75], a[124:127], a[28:31], v[72:75]
  ds_read_b64_tr_b16 a[114:115], v84 offset:1024
  v_mfma_f32_16x16x32_bf16 v[76:79], a[124:127], a[32:35], v[76:79]
  s_waitcnt lgkmcnt(6)
  v_mfma_f32_16x16x32_bf16 v[112:115], a[96:99], a[36:39], v[112:115]
  ds_read_b64_tr_b16 a[116:117], v85 offset:0
  s_add_u32 m0, s97, 131072
  s_nop 0
  buffer_load_dwordx4 v88, s[36:39], s61 offen offset:0  lds
  v_mfma_f32_16x16x32_bf16 v[116:119], a[96:99], a[40:43], v[116:119]
  ds_read_b64_tr_b16 a[118:119], v85 offset:1024
  v_mfma_f32_16x16x32_bf16 v[120:123], a[96:99], a[44:47], v[120:123]
  s_add_u32 s48, s24, s65
  s_addc_u32 s49, s25, 0
  v_mfma_f32_16x16x32_bf16 v[124:127], a[100:103], a[36:39], v[124:127]
  ds_read_b64_tr_b16 a[120:121], v86 offset:0
  s_and_b32 s49, s49, 0xffff
  v_mfma_f32_16x16x32_bf16 v[128:131], a[100:103], a[40:43], v[128:131]
  ds_read_b64_tr_b16 a[122:123], v86 offset:1024
  buffer_load_dwordx4 v89, s[36:39], s61 offen offset:1024  lds
  v_mfma_f32_16x16x32_bf16 v[132:135], a[100:103], a[44:47], v[132:135]
  s_add_u32 s61, s61, 261888
  s_waitcnt lgkmcnt(6)
  v_mfma_f32_16x16x32_bf16 v[136:139], a[104:107], a[36:39], v[136:139]
  ds_read_b64_tr_b16 a[124:125], v87 offset:0
  s_mov_b32 s50, 43008
  v_mfma_f32_16x16x32_bf16 v[140:143], a[104:107], a[40:43], v[140:143]
  ds_read_b64_tr_b16 a[126:127], v87 offset:1024
  s_mov_b32 s51, 0x20000
  v_mfma_f32_16x16x32_bf16 v[144:147], a[104:107], a[44:47], v[144:147]
  s_cmp_eq_u32 s61, 3670016
  s_cselect_b32 s61, 0, s61
  v_mfma_f32_16x16x32_bf16 v[148:151], a[108:111], a[36:39], v[148:151]
  s_add_u32 m0, s77, 142336
  s_nop 0
  buffer_load_dwordx4 v23, s[44:47], s78 offen offset:0  lds
  v_mfma_f32_16x16x32_bf16 v[152:155], a[108:111], a[40:43], v[152:155]
  s_add_u32 s20, s24, 33554432
  s_addc_u32 s21, s25, 0
  v_mfma_f32_16x16x32_bf16 v[156:159], a[108:111], a[44:47], v[156:159]
  v_mov_b32 v3, 0
  s_waitcnt lgkmcnt(4)
  v_mfma_f32_16x16x32_bf16 v[160:163], a[112:115], a[36:39], v[160:163]
  s_waitcnt vmcnt(18) lgkmcnt(0)
  s_barrier
  v_mfma_f32_16x16x32_bf16 v[164:167], a[112:115], a[40:43], v[164:167]
  ds_read_b64_tr_b16 a[96:97], v80 offset:8192
  buffer_load_dwordx4 v24, s[44:47], s78 offen offset:1024  lds
  v_mfma_f32_16x16x32_bf16 v[168:171], a[112:115], a[44:47], v[168:171]
  ds_read_b64_tr_b16 a[98:99], v80 offset:9216
  s_add_u32 s79, s2, 64
  v_mfma_f32_16x16x32_bf16 v[172:175], a[116:119], a[36:39], v[172:175]
  ds_read_b64_tr_b16 a[100:101], v81 offset:8192
  s_lshl_b32 s79, s79, 8
  v_mfma_f32_16x16x32_bf16 v[176:179], a[116:119], a[40:43], v[176:179]
  ds_read_b64_tr_b16 a[102:103], v81 offset:9216
  v_and_b32 v2, 31, v106
  v_mfma_f32_16x16x32_bf16 v[180:183], a[116:119], a[44:47], v[180:183]
  ds_read_b64_tr_b16 a[104:105], v82 offset:8192
  buffer_load_dwordx4 v25, s[44:47], s78 offen offset:2048  lds
  v_mfma_f32_16x16x32_bf16 v[184:187], a[120:123], a[36:39], v[184:187]
  ds_read_b64_tr_b16 a[106:107], v82 offset:9216
  s_add_u32 s78, s78, 128
  v_mfma_f32_16x16x32_bf16 v[188:191], a[120:123], a[40:43], v[188:191]
  ds_read_b64_tr_b16 a[108:109], v83 offset:8192
  v_lshl_add_u32 v2, v2, 2, s79
  v_mfma_f32_16x16x32_bf16 v[192:195], a[120:123], a[44:47], v[192:195]
  ds_read_b64_tr_b16 a[110:111], v83 offset:9216
  global_store_dword v2, v3, s[20:21] sc1
  v_mfma_f32_16x16x32_bf16 v[196:199], a[124:127], a[36:39], v[196:199]
  ds_read_b64_tr_b16 a[112:113], v84 offset:8192
  s_mov_b32 s63, 0x3db8aa3b
  v_mfma_f32_16x16x32_bf16 v[200:203], a[124:127], a[40:43], v[200:203]
  ds_read_b64_tr_b16 a[114:115], v84 offset:9216
  s_mov_b32 s56, 32768
  v_mfma_f32_16x16x32_bf16 v[204:207], a[124:127], a[44:47], v[204:207]
  s_mov_b32 s57, 0
  s_cmp_eq_u32 s78, 896
  s_cselect_b32 s78, 0, s78
  s_waitcnt lgkmcnt(6)
  v_mfma_f32_16x16x32_bf16 v[208:211], a[96:99], a[36:39], v[208:211]
  ds_read_b64_tr_b16 a[116:117], v85 offset:8192
  s_add_u32 m0, s97, 0
  s_nop 0
  buffer_load_dwordx4 v88, s[36:39], s61 offen offset:0  lds
  v_mfma_f32_16x16x32_bf16 v[212:215], a[96:99], a[40:43], v[212:215]
  ds_read_b64_tr_b16 a[118:119], v85 offset:9216
  s_lshl_b32 s66, s54, 13
  v_mfma_f32_16x16x32_bf16 v[216:219], a[96:99], a[44:47], v[216:219]
  s_add_u32 s59, s55, s66
  v_mfma_f32_16x16x32_bf16 v[220:223], a[100:103], a[36:39], v[220:223]
  ds_read_b64_tr_b16 a[120:121], v86 offset:8192
  v_mfma_f32_16x16x32_bf16 v[224:227], a[100:103], a[40:43], v[224:227]
  ds_read_b64_tr_b16 a[122:123], v86 offset:9216
  buffer_load_dwordx4 v89, s[36:39], s61 offen offset:1024  lds
  v_mfma_f32_16x16x32_bf16 v[228:231], a[100:103], a[44:47], v[228:231]
  s_add_u32 s61, s61, 256
  s_waitcnt lgkmcnt(6)
  v_mfma_f32_16x16x32_bf16 v[232:235], a[104:107], a[36:39], v[232:235]
  ds_read_b64_tr_b16 a[124:125], v87 offset:8192
  v_mfma_f32_16x16x32_bf16 v[236:239], a[104:107], a[40:43], v[236:239]
  ds_read_b64_tr_b16 a[126:127], v87 offset:9216
  v_mfma_f32_16x16x32_bf16 v[240:243], a[104:107], a[44:47], v[240:243]
  s_getpc_b64 s[72:73]
L_pcB0:
  s_add_u32 s72, s72, L_slow0-L_pcB0
  s_addc_u32 s73, s73, 0
  v_mfma_f32_16x16x32_bf16 v[244:247], a[108:111], a[36:39], v[244:247]
  s_getpc_b64 s[74:75]
L_pcB1:
  s_add_u32 s74, s74, L_slow1-L_pcB1
  s_addc_u32 s75, s75, 0
  v_mfma_f32_16x16x32_bf16 v[248:251], a[108:111], a[40:43], v[248:251]
  v_mfma_f32_16x16x32_bf16 v[252:255], a[108:111], a[44:47], v[252:255]
  s_waitcnt lgkmcnt(4)
  v_mfma_f32_16x16x32_bf16 v[32:35], a[112:115], a[36:39], v[32:35]
  s_waitcnt vmcnt(14) lgkmcnt(0)
  s_barrier
  v_mfma_f32_16x16x32_bf16 v[36:39], a[112:115], a[40:43], v[36:39]
  ds_read_b64_tr_b16 a[96:97], v80 offset:16384
  ds_read_b128 a[48:51], v92 offset:0
  v_mfma_f32_16x16x32_bf16 v[40:43], a[112:115], a[44:47], v[40:43]
  ds_read_b64_tr_b16 a[98:99], v80 offset:17408
  ds_read_b128 a[52:55], v92 offset:2048
  v_mfma_f32_16x16x32_bf16 v[44:47], a[116:119], a[36:39], v[44:47]
  ds_read_b64_tr_b16 a[100:101], v81 offset:16384
  ds_read_b128 a[56:59], v92 offset:4096
  v_mfma_f32_16x16x32_bf16 v[48:51], a[116:119], a[40:43], v[48:51]
  ds_read_b64_tr_b16 a[102:103], v81 offset:17408
  v_mfma_f32_16x16x32_bf16 v[52:55], a[116:119], a[44:47], v[52:55]
  ds_read_b64_tr_b16 a[104:105], v82 offset:16384
  v_mfma_f32_16x16x32_bf16 v[56:59], a[120:123], a[36:39], v[56:59]
  ds_read_b64_tr_b16 a[106:107], v82 offset:17408
  v_mfma_f32_16x16x32_bf16 v[60:63], a[120:123], a[40:43], v[60:63]
  ds_read_b64_tr_b16 a[108:109], v83 offset:16384
  v_mfma_f32_16x16x32_bf16 v[64:67], a[120:123], a[44:47], v[64:67]
  ds_read_b64_tr_b16 a[110:111], v83 offset:17408
  v_mfma_f32_16x16x32_bf16 v[68:71], a[124:127], a[36:39], v[68:71]
  ds_read_b64_tr_b16 a[112:113], v84 offset:16384
  v_mfma_f32_16x16x32_bf16 v[72:75], a[124:127], a[40:43], v[72:75]
  ds_read_b64_tr_b16 a[114:115], v84 offset:17408
  v_mfma_f32_16x16x32_bf16 v[76:79], a[124:127], a[44:47], v[76:79]
  s_waitcnt lgkmcnt(7)
L_h8B:
  s_waitcnt lgkmcnt(6)
  v_mfma_f32_16x16x32_bf16 v[112:115], a[96:99], a[48:51], v[112:115]
  ds_read_b64_tr_b16 a[116:117], v85 offset:16384
  s_add_u32 m0, s97, 8192
  s_nop 0
  buffer_load_dwordx4 v88, s[36:39], s61 offen offset:0  lds
  v_mfma_f32_16x16x32_bf16 v[116:119], a[96:99], a[52:55], v[116:119]
  ds_read_b64_tr_b16 a[118:119], v85 offset:17408
  ds_read_b128 a[60:63], v93 offset:0
  v_mfma_f32_16x16x32_bf16 v[120:123], a[96:99], a[56:59], v[120:123]
  ds_read_b128 a[64:67], v93 offset:2048
  v_mfma_f32_16x16x32_bf16 v[124:127], a[100:103], a[48:51], v[124:127]
  ds_read_b64_tr_b16 a[120:121], v86 offset:16384
  v_mfma_f32_16x16x32_bf16 v[128:131], a[100:103], a[52:55], v[128:131]
  ds_read_b64_tr_b16 a[122:123], v86 offset:17408
  buffer_load_dwordx4 v89, s[36:39], s61 offen offset:1024  lds
  v_mfma_f32_16x16x32_bf16 v[132:135], a[100:103], a[56:59], v[132:135]
  s_add_u32 s61, s61, 261888
  s_waitcnt lgkmcnt(8)
  v_mfma_f32_16x16x32_bf16 v[136:139], a[104:107], a[48:51], v[136:139]
  ds_read_b64_tr_b16 a[124:125], v87 offset:16384
  ds_read_b128 a[68:71], v93 offset:4096
  v_mfma_f32_16x16x32_bf16 v[140:143], a[104:107], a[52:55], v[140:143]
  ds_read_b64_tr_b16 a[126:127], v87 offset:17408
  v_mfma_f32_16x16x32_bf16 v[144:147], a[104:107], a[56:59], v[144:147]
  s_cmp_eq_u32 s61, 3670016
  s_cselect_b32 s61, 0, s61
  v_mfma_f32_16x16x32_bf16 v[148:151], a[108:111], a[48:51], v[148:151]
  v_mfma_f32_16x16x32_bf16 v[152:155], a[108:111], a[52:55], v[152:155]
  v_mfma_f32_16x16x32_bf16 v[156:159], a[108:111], a[56:59], v[156:159]
  s_waitcnt lgkmcnt(7)
  v_mfma_f32_16x16x32_bf16 v[160:163], a[112:115], a[48:51], v[160:163]
  s_waitcnt vmcnt(14) lgkmcnt(0)
  s_barrier
  v_mfma_f32_16x16x32_bf16 v[164:167], a[112:115], a[52:55], v[164:167]
  ds_read_b64_tr_b16 a[96:97], v80 offset:24576
  v_mfma_f32_16x16x32_bf16 v[168:171], a[112:115], a[56:59], v[168:171]
  ds_read_b64_tr_b16 a[98:99], v80 offset:25600
  v_mfma_f32_16x16x32_bf16 v[172:175], a[116:119], a[48:51], v[172:175]
  ds_read_b64_tr_b16 a[100:101], v81 offset:24576
  v_mfma_f32_16x16x32_bf16 v[176:179], a[116:119], a[52:55], v[176:179]
  ds_read_b64_tr_b16 a[102:103], v81 offset:25600
  v_mfma_f32_16x16x32_bf16 v[180:183], a[116:119], a[56:59], v[180:183]
  ds_read_b64_tr_b16 a[104:105], v82 offset:24576
  v_mfma_f32_16x16x32_bf16 v[184:187], a[120:123], a[48:51], v[184:187]
  ds_read_b64_tr_b16 a[106:107], v82 offset:25600
  v_mfma_f32_16x16x32_bf16 v[188:191], a[120:123], a[52:55], v[188:191]
  ds_read_b64_tr_b16 a[108:109], v83 offset:24576
  v_mfma_f32_16x16x32_bf16 v[192:195], a[120:123], a[56:59], v[192:195]
  ds_read_b64_tr_b16 a[110:111], v83 offset:25600
  v_mfma_f32_16x16x32_bf16 v[196:199], a[124:127], a[48:51], v[196:199]
  ds_read_b64_tr_b16 a[112:113], v84 offset:24576
  v_mfma_f32_16x16x32_bf16 v[200:203], a[124:127], a[52:55], v[200:203]
  ds_read_b64_tr_b16 a[114:115], v84 offset:25600
  v_mfma_f32_16x16x32_bf16 v[204:207], a[124:127], a[56:59], v[204:207]
  s_waitcnt lgkmcnt(6)
  v_mfma_f32_16x16x32_bf16 v[208:211], a[96:99], a[48:51], v[208:211]
  ds_read_b64_tr_b16 a[116:117], v85 offset:24576
  s_add_u32 m0, s97, 16384
  s_nop 0
  buffer_load_dwordx4 v88, s[36:39], s61 offen offset:0  lds
  v_mfma_f32_16x16x32_bf16 v[212:215], a[96:99], a[52:55], v[212:215]
  ds_read_b64_tr_b16 a[118:119], v85 offset:25600
  v_mfma_f32_16x16x32_bf16 v[216:219], a[96:99], a[56:59], v[216:219]
  v_mfma_f32_16x16x32_bf16 v[220:223], a[100:103], a[48:51], v[220:223]
  ds_read_b64_tr_b16 a[120:121], v86 offset:24576
  v_mfma_f32_16x16x32_bf16 v[224:227], a[100:103], a[52:55], v[224:227]
  ds_read_b64_tr_b16 a[122:123], v86 offset:25600
  buffer_load_dwordx4 v89, s[36:39], s61 offen offset:1024  lds
  v_mfma_f32_16x16x32_bf16 v[228:231], a[100:103], a[56:59], v[228:231]
  s_add_u32 s61, s61, 256
  s_waitcnt lgkmcnt(6)
  v_mfma_f32_16x16x32_bf16 v[232:235], a[104:107], a[48:51], v[232:235]
  ds_read_b64_tr_b16 a[124:125], v87 offset:24576
  v_mfma_f32_16x16x32_bf16 v[236:239], a[104:107], a[52:55], v[236:239]
  ds_read_b64_tr_b16 a[126:127], v87 offset:25600
  v_mfma_f32_16x16x32_bf16 v[240:243], a[104:107], a[56:59], v[240:243]
  s_add_u32 m0, s77, 65536
  s_nop 0
  buffer_load_dwordx4 v20, s[44:47], s78 offen offset:0  lds
  v_mfma_f32_16x16x32_bf16 v[244:247], a[108:111], a[48:51], v[244:247]
  v_mfma_f32_16x16x32_bf16 v[248:251], a[108:111], a[52:55], v[248:251]
  v_mfma_f32_16x16x32_bf16 v[252:255], a[108:111], a[56:59], v[252:255]
  s_waitcnt lgkmcnt(4)
  v_mfma_f32_16x16x32_bf16 v[32:35], a[112:115], a[48:51], v[32:35]
  s_waitcnt vmcnt(15) lgkmcnt(0)
  s_barrier
  v_mfma_f32_16x16x32_bf16 v[36:39], a[112:115], a[52:55], v[36:39]
  ds_read_b64_tr_b16 a[96:97], v98 offset:0
  buffer_load_dwordx4 v21, s[44:47], s78 offen offset:1024  lds
  v_mfma_f32_16x16x32_bf16 v[40:43], a[112:115], a[56:59], v[40:43]
  ds_read_b64_tr_b16 a[98:99], v98 offset:1024
  v_mfma_f32_16x16x32_bf16 v[44:47], a[116:119], a[48:51], v[44:47]
  ds_read_b64_tr_b16 a[100:101], v99 offset:0
  v_mfma_f32_16x16x32_bf16 v[48:51], a[116:119], a[52:55], v[48:51]
  ds_read_b64_tr_b16 a[102:103], v99 offset:1024
  v_mfma_f32_16x16x32_bf16 v[52:55], a[116:119], a[56:59], v[52:55]
  ds_read_b64_tr_b16 a[104:105], v100 offset:0
  buffer_load_dwordx4 v22, s[44:47], s78 offen offset:2048  lds
  v_mfma_f32_16x16x32_bf16 v[56:59], a[120:123], a[48:51], v[56:59]
  ds_read_b64_tr_b16 a[106:107], v100 offset:1024
  v_mfma_f32_16x16x32_bf16 v[60:63], a[120:123], a[52:55], v[60:63]
  ds_read_b64_tr_b16 a[108:109], v101 offset:0
  v_mfma_f32_16x16x32_bf16 v[64:67], a[120:123], a[56:59], v[64:67]
  ds_read_b64_tr_b16 a[110:111], v101 offset:1024
  v_mfma_f32_16x16x32_bf16 v[68:71], a[124:127], a[48:51], v[68:71]
  ds_read_b64_tr_b16 a[112:113], v102 offset:0
  v_mfma_f32_16x16x32_bf16 v[72:75], a[124:127], a[52:55], v[72:75]
  ds_read_b64_tr_b16 a[114:115], v102 offset:1024
  v_mfma_f32_16x16x32_bf16 v[76:79], a[124:127], a[56:59], v[76:79]
  s_waitcnt lgkmcnt(6)
  v_mfma_f32_16x16x32_bf16 v[112:115], a[96:99], a[60:63], v[112:115]
  ds_read_b64_tr_b16 a[116:117], v103 offset:0
  s_add_u32 m0, s97, 24576
  s_nop 0
  buffer_load_dwordx4 v88, s[36:39], s61 offen offset:0  lds
  v_mfma_f32_16x16x32_bf16 v[116:119], a[96:99], a[64:67], v[116:119]
  ds_read_b64_tr_b16 a[118:119], v103 offset:1024
  v_mfma_f32_16x16x32_bf16 v[120:123], a[96:99], a[68:71], v[120:123]
  v_mfma_f32_16x16x32_bf16 v[124:127], a[100:103], a[60:63], v[124:127]
  ds_read_b64_tr_b16 a[120:121], v104 offset:0
  v_mfma_f32_16x16x32_bf16 v[128:131], a[100:103], a[64:67], v[128:131]
  ds_read_b64_tr_b16 a[122:123], v104 offset:1024
  buffer_load_dwordx4 v89, s[36:39], s61 offen offset:1024  lds
  v_mfma_f32_16x16x32_bf16 v[132:135], a[100:103], a[68:71], v[132:135]
  s_add_u32 s61, s61, 261888
  s_waitcnt lgkmcnt(6)
  v_mfma_f32_16x16x32_bf16 v[136:139], a[104:107], a[60:63], v[136:139]
  ds_read_b64_tr_b16 a[124:125], v105 offset:0
  v_mfma_f32_16x16x32_bf16 v[140:143], a[104:107], a[64:67], v[140:143]
  ds_read_b64_tr_b16 a[126:127], v105 offset:1024
  v_mfma_f32_16x16x32_bf16 v[144:147], a[104:107], a[68:71], v[144:147]
  s_cmp_eq_u32 s61, 3670016
  s_cselect_b32 s61, 0, s61
  v_mfma_f32_16x16x32_bf16 v[148:151], a[108:111], a[60:63], v[148:151]
  s_add_u32 m0, s77, 68608
  s_nop 0
  buffer_load_dwordx4 v23, s[44:47], s78 offen offset:0  lds
  v_mfma_f32_16x16x32_bf16 v[152:155], a[108:111], a[64:67], v[152:155]
  v_mfma_f32_16x16x32_bf16 v[156:159], a[108:111], a[68:71], v[156:159]
  s_waitcnt lgkmcnt(4)
  v_mfma_f32_16x16x32_bf16 v[160:163], a[112:115], a[60:63], v[160:163]
  s_waitcnt vmcnt(15) lgkmcnt(0)
  s_barrier
  v_mfma_f32_16x16x32_bf16 v[164:167], a[112:115], a[64:67], v[164:167]
  ds_read_b64_tr_b16 a[96:97], v98 offset:40960
  buffer_load_dwordx4 v24, s[44:47], s78 offen offset:1024  lds
  v_mfma_f32_16x16x32_bf16 v[168:171], a[112:115], a[68:71], v[168:171]
  ds_read_b64_tr_b16 a[98:99], v98 offset:41984
  v_mfma_f32_16x16x32_bf16 v[172:175], a[116:119], a[60:63], v[172:175]
  ds_read_b64_tr_b16 a[100:101], v99 offset:40960
  v_mfma_f32_16x16x32_bf16 v[176:179], a[116:119], a[64:67], v[176:179]
  ds_read_b64_tr_b16 a[102:103], v99 offset:41984
  v_mfma_f32_16x16x32_bf16 v[180:183], a[116:119], a[68:71], v[180:183]
  ds_read_b64_tr_b16 a[104:105], v100 offset:40960
  buffer_load_dwordx4 v25, s[44:47], s78 offen offset:2048  lds
  v_mfma_f32_16x16x32_bf16 v[184:187], a[120:123], a[60:63], v[184:187]
  ds_read_b64_tr_b16 a[106:107], v100 offset:41984
  s_add_u32 s78, s78, 128
  v_mfma_f32_16x16x32_bf16 v[188:191], a[120:123], a[64:67], v[188:191]
  ds_read_b64_tr_b16 a[108:109], v101 offset:40960
  v_mfma_f32_16x16x32_bf16 v[192:195], a[120:123], a[68:71], v[192:195]
  ds_read_b64_tr_b16 a[110:111], v101 offset:41984
  v_mfma_f32_16x16x32_bf16 v[196:199], a[124:127], a[60:63], v[196:199]
  ds_read_b64_tr_b16 a[112:113], v102 offset:40960
  v_mfma_f32_16x16x32_bf16 v[200:203], a[124:127], a[64:67], v[200:203]
  ds_read_b64_tr_b16 a[114:115], v102 offset:41984
  v_mfma_f32_16x16x32_bf16 v[204:207], a[124:127], a[68:71], v[204:207]
  s_cmp_eq_u32 s78, 896
  s_cselect_b32 s78, 0, s78
  s_waitcnt lgkmcnt(6)
  v_mfma_f32_16x16x32_bf16 v[208:211], a[96:99], a[60:63], v[208:211]
  ds_read_b64_tr_b16 a[116:117], v103 offset:40960
  s_add_u32 m0, s97, 90112
  s_nop 0
  buffer_load_dwordx4 v88, s[36:39], s61 offen offset:0  lds
  v_mfma_f32_16x16x32_bf16 v[212:215], a[96:99], a[64:67], v[212:215]
  ds_read_b64_tr_b16 a[118:119], v103 offset:41984
  v_mfma_f32_16x16x32_bf16 v[216:219], a[96:99], a[68:71], v[216:219]
  v_mfma_f32_16x16x32_bf16 v[220:223], a[100:103], a[60:63], v[220:223]
  ds_read_b64_tr_b16 a[120:121], v104 offset:40960
  v_mfma_f32_16x16x32_bf16 v[224:227], a[100:103], a[64:67], v[224:227]
  ds_read_b64_tr_b16 a[122:123], v104 offset:41984
  buffer_load_dwordx4 v89, s[36:39], s61 offen offset:1024  lds
  v_mfma_f32_16x16x32_bf16 v[228:231], a[100:103], a[68:71], v[228:231]
  s_add_u32 s61, s61, 256
  s_waitcnt lgkmcnt(6)
  v_mfma_f32_16x16x32_bf16 v[232:235], a[104:107], a[60:63], v[232:235]
  ds_read_b64_tr_b16 a[124:125], v105 offset:40960
  v_mfma_f32_16x16x32_bf16 v[236:239], a[104:107], a[64:67], v[236:239]
  ds_read_b64_tr_b16 a[126:127], v105 offset:41984
  v_mfma_f32_16x16x32_bf16 v[240:243], a[104:107], a[68:71], v[240:243]
  s_add_u32 m0, s58, 32768
  s_mov_b32 s68, 0
  buffer_load_dwordx4 v16, s[28:31], s68 offen offset:0 nt lds
  v_mfma_f32_16x16x32_bf16 v[244:247], a[108:111], a[60:63], v[244:247]
  v_mfma_f32_16x16x32_bf16 v[248:251], a[108:111], a[64:67], v[248:251]
  v_mfma_f32_16x16x32_bf16 v[252:255], a[108:111], a[68:71], v[252:255]
  s_waitcnt lgkmcnt(4)
  v_mfma_f32_16x16x32_bf16 v[32:35], a[112:115], a[60:63], v[32:35]
  s_waitcnt vmcnt(15) lgkmcnt(0)
  s_barrier
  v_mfma_f32_16x16x32_bf16 v[36:39], a[112:115], a[64:67], v[36:39]
  ds_read_b64_tr_b16 a[96:97], v80 offset:0
  ds_read_b128 a[72:75], v94 offset:0
  v_mfma_f32_16x16x32_bf16 v[40:43], a[112:115], a[68:71], v[40:43]
  ds_read_b64_tr_b16 a[98:99], v80 offset:1024
  ds_read_b128 a[76:79], v94 offset:2048
  v_mfma_f32_16x16x32_bf16 v[44:47], a[116:119], a[60:63], v[44:47]
  ds_read_b64_tr_b16 a[100:101], v81 offset:0
  ds_read_b128 a[80:83], v94 offset:4096
  v_mfma_f32_16x16x32_bf16 v[48:51], a[116:119], a[64:67], v[48:51]
  ds_read_b64_tr_b16 a[102:103], v81 offset:1024
  buffer_load_dwordx4 v17, s[28:31], s68 offen offset:1024 nt lds
  v_mfma_f32_16x16x32_bf16 v[52:55], a[116:119], a[68:71], v[52:55]
  ds_read_b64_tr_b16 a[104:105], v82 offset:0
  v_mfma_f32_16x16x32_bf16 v[56:59], a[120:123], a[60:63], v[56:59]
  ds_read_b64_tr_b16 a[106:107], v82 offset:1024
  v_mfma_f32_16x16x32_bf16 v[60:63], a[120:123], a[64:67], v[60:63]
  ds_read_b64_tr_b16 a[108:109], v83 offset:0
  v_mfma_f32_16x16x32_bf16 v[64:67], a[120:123], a[68:71], v[64:67]
  ds_read_b64_tr_b16 a[110:111], v83 offset:1024
  v_mfma_f32_16x16x32_bf16 v[68:71], a[124:127], a[60:63], v[68:71]
  ds_read_b64_tr_b16 a[112:113], v84 offset:0
  v_mfma_f32_16x16x32_bf16 v[72:75], a[124:127], a[64:67], v[72:75]
  ds_read_b64_tr_b16 a[114:115], v84 offset:1024
  v_mfma_f32_16x16x32_bf16 v[76:79], a[124:127], a[68:71], v[76:79]
  s_waitcnt lgkmcnt(7)
  s_waitcnt lgkmcnt(6)
  v_mfma_f32_16x16x32_bf16 v[112:115], a[96:99], a[72:75], v[112:115]
  ds_read_b64_tr_b16 a[116:117], v85 offset:0
  s_add_u32 m0, s97, 131072
  s_nop 0
  buffer_load_dwordx4 v88, s[36:39], s61 offen offset:0  lds
  v_mfma_f32_16x16x32_bf16 v[116:119], a[96:99], a[76:79], v[116:119]
  ds_read_b64_tr_b16 a[118:119], v85 offset:1024
  ds_read_b128 a[84:87], v95 offset:0
  v_mfma_f32_16x16x32_bf16 v[120:123], a[96:99], a[80:83], v[120:123]
  ds_read_b128 a[88:91], v95 offset:2048
  v_mfma_f32_16x16x32_bf16 v[124:127], a[100:103], a[72:75], v[124:127]
  ds_read_b64_tr_b16 a[120:121], v86 offset:0
  v_mfma_f32_16x16x32_bf16 v[128:131], a[100:103], a[76:79], v[128:131]
  ds_read_b64_tr_b16 a[122:123], v86 offset:1024
  buffer_load_dwordx4 v89, s[36:39], s61 offen offset:1024  lds
  v_mfma_f32_16x16x32_bf16 v[132:135], a[100:103], a[80:83], v[132:135]
  s_add_u32 s61, s61, 261888
  s_waitcnt lgkmcnt(8)
  v_mfma_f32_16x16x32_bf16 v[136:139], a[104:107], a[72:75], v[136:139]
  ds_read_b64_tr_b16 a[124:125], v87 offset:0
  ds_read_b128 a[92:95], v95 offset:4096
  v_mfma_f32_16x16x32_bf16 v[140:143], a[104:107], a[76:79], v[140:143]
  ds_read_b64_tr_b16 a[126:127], v87 offset:1024
  v_mfma_f32_16x16x32_bf16 v[144:147], a[104:107], a[80:83], v[144:147]
  s_cmp_eq_u32 s61, 3670016
  s_cselect_b32 s61, 0, s61
  v_mfma_f32_16x16x32_bf16 v[148:151], a[108:111], a[72:75], v[148:151]
  v_mfma_f32_16x16x32_bf16 v[152:155], a[108:111], a[76:79], v[152:155]
  v_mfma_f32_16x16x32_bf16 v[156:159], a[108:111], a[80:83], v[156:159]
  s_waitcnt lgkmcnt(7)
  v_mfma_f32_16x16x32_bf16 v[160:163], a[112:115], a[72:75], v[160:163]
  s_waitcnt vmcnt(16) lgkmcnt(0)
  s_barrier
  v_mfma_f32_16x16x32_bf16 v[164:167], a[112:115], a[76:79], v[164:167]
  ds_read_b64_tr_b16 a[96:97], v80 offset:8192
  v_mfma_f32_16x16x32_bf16 v[168:171], a[112:115], a[80:83], v[168:171]
  ds_read_b64_tr_b16 a[98:99], v80 offset:9216
  v_mfma_f32_16x16x32_bf16 v[172:175], a[116:119], a[72:75], v[172:175]
  ds_read_b64_tr_b16 a[100:101], v81 offset:8192
  v_mfma_f32_16x16x32_bf16 v[176:179], a[116:119], a[76:79], v[176:179]
  ds_read_b64_tr_b16 a[102:103], v81 offset:9216
  v_mfma_f32_16x16x32_bf16 v[180:183], a[116:119], a[80:83], v[180:183]
  ds_read_b64_tr_b16 a[104:105], v82 offset:8192
  v_mfma_f32_16x16x32_bf16 v[184:187], a[120:123], a[72:75], v[184:187]
  ds_read_b64_tr_b16 a[106:107], v82 offset:9216
  v_mfma_f32_16x16x32_bf16 v[188:191], a[120:123], a[76:79], v[188:191]
  ds_read_b64_tr_b16 a[108:109], v83 offset:8192
  v_mfma_f32_16x16x32_bf16 v[192:195], a[120:123], a[80:83], v[192:195]
  ds_read_b64_tr_b16 a[110:111], v83 offset:9216
  v_mfma_f32_16x16x32_bf16 v[196:199], a[124:127], a[72:75], v[196:199]
  ds_read_b64_tr_b16 a[112:113], v84 offset:8192
  v_mfma_f32_16x16x32_bf16 v[200:203], a[124:127], a[76:79], v[200:203]
  ds_read_b64_tr_b16 a[114:115], v84 offset:9216
  v_mfma_f32_16x16x32_bf16 v[204:207], a[124:127], a[80:83], v[204:207]
  s_waitcnt lgkmcnt(6)
  v_mfma_f32_16x16x32_bf16 v[208:211], a[96:99], a[72:75], v[208:211]
  ds_read_b64_tr_b16 a[116:117], v85 offset:8192
  s_add_u32 m0, s97, 0
  s_nop 0
  buffer_load_dwordx4 v88, s[36:39], s61 offen offset:0  lds
  v_mfma_f32_16x16x32_bf16 v[212:215], a[96:99], a[76:79], v[212:215]
  ds_read_b64_tr_b16 a[118:119], v85 offset:9216
  v_mfma_f32_16x16x32_bf16 v[216:219], a[96:99], a[80:83], v[216:219]
  v_mfma_f32_16x16x32_bf16 v[220:223], a[100:103], a[72:75], v[220:223]
  ds_read_b64_tr_b16 a[120:121], v86 offset:8192
  v_mfma_f32_16x16x32_bf16 v[224:227], a[100:103], a[76:79], v[224:227]
  ds_read_b64_tr_b16 a[122:123], v86 offset:9216
  buffer_load_dwordx4 v89, s[36:39], s61 offen offset:1024  lds
  v_mfma_f32_16x16x32_bf16 v[228:231], a[100:103], a[80:83], v[228:231]
  s_add_u32 s61, s61, 256
  s_waitcnt lgkmcnt(6)
  v_mfma_f32_16x16x32_bf16 v[232:235], a[104:107], a[72:75], v[232:235]
  ds_read_b64_tr_b16 a[124:125], v87 offset:8192
  v_mfma_f32_16x16x32_bf16 v[236:239], a[104:107], a[76:79], v[236:239]
  ds_read_b64_tr_b16 a[126:127], v87 offset:9216
  v_mfma_f32_16x16x32_bf16 v[240:243], a[104:107], a[80:83], v[240:243]
  s_add_u32 m0, s77, 139264
  s_nop 0
  buffer_load_dwordx4 v20, s[44:47], s78 offen offset:0  lds
  v_mfma_f32_16x16x32_bf16 v[244:247], a[108:111], a[72:75], v[244:247]
  v_mfma_f32_16x16x32_bf16 v[248:251], a[108:111], a[76:79], v[248:251]
  v_mfma_f32_16x16x32_bf16 v[252:255], a[108:111], a[80:83], v[252:255]
  s_waitcnt lgkmcnt(4)
  v_mfma_f32_16x16x32_bf16 v[32:35], a[112:115], a[72:75], v[32:35]
  s_waitcnt vmcnt(17) lgkmcnt(0)
  s_barrier
  v_mfma_f32_16x16x32_bf16 v[36:39], a[112:115], a[76:79], v[36:39]
  ds_read_b64_tr_b16 a[96:97], v80 offset:16384
  buffer_load_dwordx4 v21, s[44:47], s78 offen offset:1024  lds
  v_mfma_f32_16x16x32_bf16 v[40:43], a[112:115], a[80:83], v[40:43]
  ds_read_b64_tr_b16 a[98:99], v80 offset:17408
  v_mfma_f32_16x16x32_bf16 v[44:47], a[116:119], a[72:75], v[44:47]
  ds_read_b64_tr_b16 a[100:101], v81 offset:16384
  v_mfma_f32_16x16x32_bf16 v[48:51], a[116:119], a[76:79], v[48:51]
  ds_read_b64_tr_b16 a[102:103], v81 offset:17408
  v_mfma_f32_16x16x32_bf16 v[52:55], a[116:119], a[80:83], v[52:55]
  ds_read_b64_tr_b16 a[104:105], v82 offset:16384
  buffer_load_dwordx4 v22, s[44:47], s78 offen offset:2048  lds
  v_mfma_f32_16x16x32_bf16 v[56:59], a[120:123], a[72:75], v[56:59]
  ds_read_b64_tr_b16 a[106:107], v82 offset:17408
  v_mfma_f32_16x16x32_bf16 v[60:63], a[120:123], a[76:79], v[60:63]
  ds_read_b64_tr_b16 a[108:109], v83 offset:16384
  v_mfma_f32_16x16x32_bf16 v[64:67], a[120:123], a[80:83], v[64:67]
  ds_read_b64_tr_b16 a[110:111], v83 offset:17408
  v_mfma_f32_16x16x32_bf16 v[68:71], a[124:127], a[72:75], v[68:71]
  ds_read_b64_tr_b16 a[112:113], v84 offset:16384
  s_add_u32 m0, s58, 32768
  s_mov_b32 s68, 0
  buffer_load_dwordx4 v18, s[28:31], s68 offen offset:2048 nt lds
  v_mfma_f32_16x16x32_bf16 v[72:75], a[124:127], a[76:79], v[72:75]
  ds_read_b64_tr_b16 a[114:115], v84 offset:17408
  v_mfma_f32_16x16x32_bf16 v[76:79], a[124:127], a[80:83], v[76:79]
  buffer_load_dwordx4 v19, s[28:31], s68 offen offset:3072 nt lds
  s_waitcnt lgkmcnt(6)
  v_mfma_f32_16x16x32_bf16 v[112:115], a[96:99], a[84:87], v[112:115]
  ds_read_b64_tr_b16 a[116:117], v85 offset:16384
  v_mfma_f32_16x16x32_bf16 v[116:119], a[96:99], a[88:91], v[116:119]
  ds_read_b64_tr_b16 a[118:119], v85 offset:17408
  s_add_u32 m0, s97, 8192
  s_nop 0
  buffer_load_dwordx4 v88, s[36:39], s61 offen offset:0  lds
  v_mfma_f32_16x16x32_bf16 v[120:123], a[96:99], a[92:95], v[120:123]
  v_mfma_f32_16x16x32_bf16 v[124:127], a[100:103], a[84:87], v[124:127]
  ds_read_b64_tr_b16 a[120:121], v86 offset:16384
  v_mfma_f32_16x16x32_bf16 v[128:131], a[100:103], a[88:91], v[128:131]
  ds_read_b64_tr_b16 a[122:123], v86 offset:17408
  v_mfma_f32_16x16x32_bf16 v[132:135], a[100:103], a[92:95], v[132:135]
  buffer_load_dwordx4 v89, s[36:39], s61 offen offset:1024  lds
  s_waitcnt lgkmcnt(6)
  v_mfma_f32_16x16x32_bf16 v[136:139], a[104:107], a[84:87], v[136:139]
  ds_read_b64_tr_b16 a[124:125], v87 offset:16384
  s_add_u32 s61, s61, 261888
  v_mfma_f32_16x16x32_bf16 v[140:143], a[104:107], a[88:91], v[140:143]
  ds_read_b64_tr_b16 a[126:127], v87 offset:17408
  v_mfma_f32_16x16x32_bf16 v[144:147], a[104:107], a[92:95], v[144:147]
  s_cmp_eq_u32 s61, 3670016
  s_cselect_b32 s61, 0, s61
  v_mfma_f32_16x16x32_bf16 v[148:151], a[108:111], a[84:87], v[148:151]
  s_add_u32 m0, s77, 142336
  s_nop 0
  buffer_load_dwordx4 v23, s[44:47], s78 offen offset:0  lds
  v_mfma_f32_16x16x32_bf16 v[152:155], a[108:111], a[88:91], v[152:155]
  v_mfma_f32_16x16x32_bf16 v[156:159], a[108:111], a[92:95], v[156:159]
  s_waitcnt lgkmcnt(4)
  v_mfma_f32_16x16x32_bf16 v[160:163], a[112:115], a[84:87], v[160:163]
  s_waitcnt vmcnt(19) lgkmcnt(0)
  s_barrier
  v_mfma_f32_16x16x32_bf16 v[164:167], a[112:115], a[88:91], v[164:167]
  ds_read_b64_tr_b16 a[96:97], v80 offset:24576
  buffer_load_dwordx4 v24, s[44:47], s78 offen offset:1024  lds
  v_mfma_f32_16x16x32_bf16 v[168:171], a[112:115], a[92:95], v[168:171]
  ds_read_b64_tr_b16 a[98:99], v80 offset:25600
  v_mfma_f32_16x16x32_bf16 v[172:175], a[116:119], a[84:87], v[172:175]
  ds_read_b64_tr_b16 a[100:101], v81 offset:24576
  v_mfma_f32_16x16x32_bf16 v[176:179], a[116:119], a[88:91], v[176:179]
  ds_read_b64_tr_b16 a[102:103], v81 offset:25600
  v_mfma_f32_16x16x32_bf16 v[180:183], a[116:119], a[92:95], v[180:183]
  ds_read_b64_tr_b16 a[104:105], v82 offset:24576
  buffer_load_dwordx4 v25, s[44:47], s78 offen offset:2048  lds
  v_mfma_f32_16x16x32_bf16 v[184:187], a[120:123], a[84:87], v[184:187]
  ds_read_b64_tr_b16 a[106:107], v82 offset:25600
  s_add_u32 s78, s78, 128
  v_mfma_f32_16x16x32_bf16 v[188:191], a[120:123], a[88:91], v[188:191]
  ds_read_b64_tr_b16 a[108:109], v83 offset:24576
  v_mfma_f32_16x16x32_bf16 v[192:195], a[120:123], a[92:95], v[192:195]
  ds_read_b64_tr_b16 a[110:111], v83 offset:25600
  v_mfma_f32_16x16x32_bf16 v[196:199], a[124:127], a[84:87], v[196:199]
  ds_read_b64_tr_b16 a[112:113], v84 offset:24576
  v_mfma_f32_16x16x32_bf16 v[200:203], a[124:127], a[88:91], v[200:203]
  ds_read_b64_tr_b16 a[114:115], v84 offset:25600
  v_mfma_f32_16x16x32_bf16 v[204:207], a[124:127], a[92:95], v[204:207]
  s_cmp_eq_u32 s78, 896
  s_cselect_b32 s78, 0, s78
  s_waitcnt lgkmcnt(6)
  v_mfma_f32_16x16x32_bf16 v[208:211], a[96:99], a[84:87], v[208:211]
  ds_read_b64_tr_b16 a[116:117], v85 offset:24576
  s_add_u32 m0, s97, 16384
  s_nop 0
  buffer_load_dwordx4 v88, s[36:39], s61 offen offset:0  lds
  v_mfma_f32_16x16x32_bf16 v[212:215], a[96:99], a[88:91], v[212:215]
  ds_read_b64_tr_b16 a[118:119], v85 offset:25600
  v_mfma_f32_16x16x32_bf16 v[216:219], a[96:99], a[92:95], v[216:219]
  v_mfma_f32_16x16x32_bf16 v[220:223], a[100:103], a[84:87], v[220:223]
  ds_read_b64_tr_b16 a[120:121], v86 offset:24576
  v_mfma_f32_16x16x32_bf16 v[224:227], a[100:103], a[88:91], v[224:227]
  ds_read_b64_tr_b16 a[122:123], v86 offset:25600
  buffer_load_dwordx4 v89, s[36:39], s61 offen offset:1024  lds
  v_mfma_f32_16x16x32_bf16 v[228:231], a[100:103], a[92:95], v[228:231]
  s_add_u32 s61, s61, 256
  s_waitcnt lgkmcnt(6)
  v_mfma_f32_16x16x32_bf16 v[232:235], a[104:107], a[84:87], v[232:235]
  ds_read_b64_tr_b16 a[124:125], v87 offset:24576
  v_mfma_f32_16x16x32_bf16 v[236:239], a[104:107], a[88:91], v[236:239]
  ds_read_b64_tr_b16 a[126:127], v87 offset:25600
  v_mfma_f32_16x16x32_bf16 v[240:243], a[104:107], a[92:95], v[240:243]
  s_add_u32 m0, s58, 36864
  s_mov_b32 s68, 4096
  buffer_load_dwordx4 v16, s[28:31], s68 offen offset:0 nt lds
  v_mfma_f32_16x16x32_bf16 v[244:247], a[108:111], a[84:87], v[244:247]
  v_mfma_f32_16x16x32_bf16 v[248:251], a[108:111], a[88:91], v[248:251]
  v_mfma_f32_16x16x32_bf16 v[252:255], a[108:111], a[92:95], v[252:255]
  s_waitcnt lgkmcnt(4)
  v_mfma_f32_16x16x32_bf16 v[32:35], a[112:115], a[84:87], v[32:35]
  s_waitcnt vmcnt(19) lgkmcnt(0)
  s_barrier
  v_mfma_f32_16x16x32_bf16 v[36:39], a[112:115], a[88:91], v[36:39]
  ds_read_b64_tr_b16 a[96:97], v98 offset:0
  ds_read_b128 a[128:131], v92 offset:0
  v_mfma_f32_16x16x32_bf16 v[40:43], a[112:115], a[92:95], v[40:43]
  ds_read_b64_tr_b16 a[98:99], v98 offset:1024
  ds_read_b128 a[132:135], v92 offset:2048
  v_mfma_f32_16x16x32_bf16 v[44:47], a[116:119], a[84:87], v[44:47]
  ds_read_b64_tr_b16 a[100:101], v99 offset:0
  ds_read_b128 a[136:139], v92 offset:4096
  v_mfma_f32_16x16x32_bf16 v[48:51], a[116:119], a[88:91], v[48:51]
  ds_read_b64_tr_b16 a[102:103], v99 offset:1024
  buffer_load_dwordx4 v17, s[28:31], s68 offen offset:1024 nt lds
  v_mfma_f32_16x16x32_bf16 v[52:55], a[116:119], a[92:95], v[52:55]
  ds_read_b64_tr_b16 a[104:105], v100 offset:0
  v_mfma_f32_16x16x32_bf16 v[56:59], a[120:123], a[84:87], v[56:59]
  ds_read_b64_tr_b16 a[106:107], v100 offset:1024
  v_mfma_f32_16x16x32_bf16 v[60:63], a[120:123], a[88:91], v[60:63]
  ds_read_b64_tr_b16 a[108:109], v101 offset:0
  v_mfma_f32_16x16x32_bf16 v[64:67], a[120:123], a[92:95], v[64:67]
  ds_read_b64_tr_b16 a[110:111], v101 offset:1024
  v_mfma_f32_16x16x32_bf16 v[68:71], a[124:127], a[84:87], v[68:71]
  ds_read_b64_tr_b16 a[112:113], v102 offset:0
  v_mfma_f32_16x16x32_bf16 v[72:75], a[124:127], a[88:91], v[72:75]
  ds_read_b64_tr_b16 a[114:115], v102 offset:1024
  v_mfma_f32_16x16x32_bf16 v[76:79], a[124:127], a[92:95], v[76:79]
  s_waitcnt lgkmcnt(7)
  s_getpc_b64 s[70:71]
L_cw3B:
  s_add_u32 s70, s70, L_postB-L_cw3B
  s_addc_u32 s71, s71, 0
  s_lshl_b32 s60, s27, 2
  s_add_u32 s60, s60, s52
  s_lshl_b32 s60, s60, 8
  v_lshl_add_u32 v28, v106, 7, s60
  v_mov_b32 v29, s71
  v_add_co_u32 v28, vcc, s70, v28
  s_nop 1
  v_addc_co_u32 v29, vcc, 0, v29, vcc
  s_mov_b64 exec, 3
  global_load_dword v31, v[28:29], off
  s_mov_b64 exec, -1
  s_waitcnt lgkmcnt(6)
  v_mfma_f32_16x16x32_bf16 v[112:115], a[96:99], a[128:131], v[112:115]
  ds_read_b64_tr_b16 a[116:117], v103 offset:0
  s_add_u32 m0, s97, 24576
  s_nop 0
  buffer_load_dwordx4 v88, s[36:39], s61 offen offset:0  lds
  v_mfma_f32_16x16x32_bf16 v[116:119], a[96:99], a[132:135], v[116:119]
  ds_read_b64_tr_b16 a[118:119], v103 offset:1024
  ds_read_b128 a[140:143], v93 offset:0
  v_mfma_f32_16x16x32_bf16 v[120:123], a[96:99], a[136:139], v[120:123]
  ds_read_b128 a[144:147], v93 offset:2048
  v_mfma_f32_16x16x32_bf16 v[124:127], a[100:103], a[128:131], v[124:127]
  ds_read_b64_tr_b16 a[120:121], v104 offset:0
  v_mfma_f32_16x16x32_bf16 v[128:131], a[100:103], a[132:135], v[128:131]
  ds_read_b64_tr_b16 a[122:123], v104 offset:1024
  buffer_load_dwordx4 v89, s[36:39], s61 offen offset:1024  lds
  v_mfma_f32_16x16x32_bf16 v[132:135], a[100:103], a[136:139], v[132:135]
  s_add_u32 s61, s61, 261888
  s_waitcnt lgkmcnt(8)
  v_mfma_f32_16x16x32_bf16 v[136:139], a[104:107], a[128:131], v[136:139]
  ds_read_b64_tr_b16 a[124:125], v105 offset:0
  ds_read_b128 a[148:151], v93 offset:4096
  v_mfma_f32_16x16x32_bf16 v[140:143], a[104:107], a[132:135], v[140:143]
  ds_read_b64_tr_b16 a[126:127], v105 offset:1024
  v_mfma_f32_16x16x32_bf16 v[144:147], a[104:107], a[136:139], v[144:147]
  s_cmp_eq_u32 s61, 3670016
  s_cselect_b32 s61, 0, s61
  v_mfma_f32_16x16x32_bf16 v[148:151], a[108:111], a[128:131], v[148:151]
  v_mfma_f32_16x16x32_bf16 v[152:155], a[108:111], a[132:135], v[152:155]
  v_mfma_f32_16x16x32_bf16 v[156:159], a[108:111], a[136:139], v[156:159]
  s_waitcnt lgkmcnt(7)
  v_mfma_f32_16x16x32_bf16 v[160:163], a[112:115], a[128:131], v[160:163]
  s_waitcnt vmcnt(19) lgkmcnt(0)
  s_barrier
  v_mfma_f32_16x16x32_bf16 v[164:167], a[112:115], a[132:135], v[164:167]
  ds_read_b64_tr_b16 a[96:97], v98 offset:40960
  v_mfma_f32_16x16x32_bf16 v[168:171], a[112:115], a[136:139], v[168:171]
  ds_read_b64_tr_b16 a[98:99], v98 offset:41984
  v_mfma_f32_16x16x32_bf16 v[172:175], a[116:119], a[128:131], v[172:175]
  ds_read_b64_tr_b16 a[100:101], v99 offset:40960
  v_mfma_f32_16x16x32_bf16 v[176:179], a[116:119], a[132:135], v[176:179]
  ds_read_b64_tr_b16 a[102:103], v99 offset:41984
  v_mfma_f32_16x16x32_bf16 v[180:183], a[116:119], a[136:139], v[180:183]
  ds_read_b64_tr_b16 a[104:105], v100 offset:40960
  v_mfma_f32_16x16x32_bf16 v[184:187], a[120:123], a[128:131], v[184:187]
  ds_read_b64_tr_b16 a[106:107], v100 offset:41984
  v_mfma_f32_16x16x32_bf16 v[188:191], a[120:123], a[132:135], v[188:191]
  ds_read_b64_tr_b16 a[108:109], v101 offset:40960
  v_mfma_f32_16x16x32_bf16 v[192:195], a[120:123], a[136:139], v[192:195]
  ds_read_b64_tr_b16 a[110:111], v101 offset:41984
  v_mfma_f32_16x16x32_bf16 v[196:199], a[124:127], a[128:131], v[196:199]
  ds_read_b64_tr_b16 a[112:113], v102 offset:40960
  v_mfma_f32_16x16x32_bf16 v[200:203], a[124:127], a[132:135], v[200:203]
  ds_read_b64_tr_b16 a[114:115], v102 offset:41984
  v_mfma_f32_16x16x32_bf16 v[204:207], a[124:127], a[136:139], v[204:207]
  s_waitcnt lgkmcnt(6)
  v_mfma_f32_16x16x32_bf16 v[208:211], a[96:99], a[128:131], v[208:211]
  ds_read_b64_tr_b16 a[116:117], v103 offset:40960
  s_add_u32 m0, s97, 90112
  s_nop 0
  buffer_load_dwordx4 v88, s[36:39], s61 offen offset:0  lds
  v_mfma_f32_16x16x32_bf16 v[212:215], a[96:99], a[132:135], v[212:215]
  ds_read_b64_tr_b16 a[118:119], v103 offset:41984
  v_mfma_f32_16x16x32_bf16 v[216:219], a[96:99], a[136:139], v[216:219]
  v_mfma_f32_16x16x32_bf16 v[220:223], a[100:103], a[128:131], v[220:223]
  ds_read_b64_tr_b16 a[120:121], v104 offset:40960
  v_mfma_f32_16x16x32_bf16 v[224:227], a[100:103], a[132:135], v[224:227]
  ds_read_b64_tr_b16 a[122:123], v104 offset:41984
  buffer_load_dwordx4 v89, s[36:39], s61 offen offset:1024  lds
  v_mfma_f32_16x16x32_bf16 v[228:231], a[100:103], a[136:139], v[228:231]
  s_add_u32 s61, s61, 256
  s_waitcnt lgkmcnt(6)
  v_mfma_f32_16x16x32_bf16 v[232:235], a[104:107], a[128:131], v[232:235]
  ds_read_b64_tr_b16 a[124:125], v105 offset:40960
  v_mfma_f32_16x16x32_bf16 v[236:239], a[104:107], a[132:135], v[236:239]
  ds_read_b64_tr_b16 a[126:127], v105 offset:41984
  v_mfma_f32_16x16x32_bf16 v[240:243], a[104:107], a[136:139], v[240:243]
  s_add_u32 m0, s77, 65536
  s_nop 0
  buffer_load_dwordx4 v20, s[44:47], s78 offen offset:0  lds
  v_mfma_f32_16x16x32_bf16 v[244:247], a[108:111], a[128:131], v[244:247]
  v_mfma_f32_16x16x32_bf16 v[248:251], a[108:111], a[132:135], v[248:251]
  v_mfma_f32_16x16x32_bf16 v[252:255], a[108:111], a[136:139], v[252:255]
  s_waitcnt lgkmcnt(4)
  v_mfma_f32_16x16x32_bf16 v[32:35], a[112:115], a[128:131], v[32:35]
  s_waitcnt vmcnt(20) lgkmcnt(0)
  s_barrier
  v_mfma_f32_16x16x32_bf16 v[36:39], a[112:115], a[132:135], v[36:39]
  ds_read_b64_tr_b16 a[96:97], v80 offset:0
  buffer_load_dwordx4 v21, s[44:47], s78 offen offset:1024  lds
  v_mfma_f32_16x16x32_bf16 v[40:43], a[112:115], a[136:139], v[40:43]
  ds_read_b64_tr_b16 a[98:99], v80 offset:1024
  v_mfma_f32_16x16x32_bf16 v[44:47], a[116:119], a[128:131], v[44:47]
  ds_read_b64_tr_b16 a[100:101], v81 offset:0
  v_mfma_f32_16x16x32_bf16 v[48:51], a[116:119], a[132:135], v[48:51]
  ds_read_b64_tr_b16 a[102:103], v81 offset:1024
  v_mfma_f32_16x16x32_bf16 v[52:55], a[116:119], a[136:139], v[52:55]
  ds_read_b64_tr_b16 a[104:105], v82 offset:0
  buffer_load_dwordx4 v22, s[44:47], s78 offen offset:2048  lds
  v_mfma_f32_16x16x32_bf16 v[56:59], a[120:123], a[128:131], v[56:59]
  ds_read_b64_tr_b16 a[106:107], v82 offset:1024
  v_mfma_f32_16x16x32_bf16 v[60:63], a[120:123], a[132:135], v[60:63]
  ds_read_b64_tr_b16 a[108:109], v83 offset:0
  v_mfma_f32_16x16x32_bf16 v[64:67], a[120:123], a[136:139], v[64:67]
  ds_read_b64_tr_b16 a[110:111], v83 offset:1024
  v_mfma_f32_16x16x32_bf16 v[68:71], a[124:127], a[128:131], v[68:71]
  ds_read_b64_tr_b16 a[112:113], v84 offset:0
  s_add_u32 m0, s58, 36864
  s_mov_b32 s68, 4096
  buffer_load_dwordx4 v18, s[28:31], s68 offen offset:2048 nt lds
  v_mfma_f32_16x16x32_bf16 v[72:75], a[124:127], a[132:135], v[72:75]
  ds_read_b64_tr_b16 a[114:115], v84 offset:1024
  v_mfma_f32_16x16x32_bf16 v[76:79], a[124:127], a[136:139], v[76:79]
  buffer_load_dwordx4 v19, s[28:31], s68 offen offset:3072 nt lds
  s_waitcnt lgkmcnt(6)
  v_mfma_f32_16x16x32_bf16 v[112:115], a[96:99], a[140:143], v[112:115]
  ds_read_b64_tr_b16 a[116:117], v85 offset:0
  v_mfma_f32_16x16x32_bf16 v[116:119], a[96:99], a[144:147], v[116:119]
  ds_read_b64_tr_b16 a[118:119], v85 offset:1024
  s_add_u32 m0, s97, 131072
  s_nop 0
  buffer_load_dwordx4 v88, s[36:39], s61 offen offset:0  lds
  v_mfma_f32_16x16x32_bf16 v[120:123], a[96:99], a[148:151], v[120:123]
  v_mfma_f32_16x16x32_bf16 v[124:127], a[100:103], a[140:143], v[124:127]
  ds_read_b64_tr_b16 a[120:121], v86 offset:0
  v_mfma_f32_16x16x32_bf16 v[128:131], a[100:103], a[144:147], v[128:131]
  ds_read_b64_tr_b16 a[122:123], v86 offset:1024
  v_mfma_f32_16x16x32_bf16 v[132:135], a[100:103], a[148:151], v[132:135]
  buffer_load_dwordx4 v89, s[36:39], s61 offen offset:1024  lds
  s_waitcnt lgkmcnt(6)
  v_mfma_f32_16x16x32_bf16 v[136:139], a[104:107], a[140:143], v[136:139]
  ds_read_b64_tr_b16 a[124:125], v87 offset:0
  s_add_u32 s61, s61, 261888
  v_mfma_f32_16x16x32_bf16 v[140:143], a[104:107], a[144:147], v[140:143]
  ds_read_b64_tr_b16 a[126:127], v87 offset:1024
  v_mfma_f32_16x16x32_bf16 v[144:147], a[104:107], a[148:151], v[144:147]
  s_cmp_eq_u32 s61, 3670016
  s_cselect_b32 s61, 0, s61
  v_mfma_f32_16x16x32_bf16 v[148:151], a[108:111], a[140:143], v[148:151]
  s_add_u32 m0, s77, 68608
  s_nop 0
  buffer_load_dwordx4 v23, s[44:47], s78 offen offset:0  lds
  v_mfma_f32_16x16x32_bf16 v[152:155], a[108:111], a[144:147], v[152:155]
  v_mfma_f32_16x16x32_bf16 v[156:159], a[108:111], a[148:151], v[156:159]
  s_waitcnt lgkmcnt(4)
  v_mfma_f32_16x16x32_bf16 v[160:163], a[112:115], a[140:143], v[160:163]
  s_waitcnt vmcnt(20) lgkmcnt(0)
  s_barrier
  v_mfma_f32_16x16x32_bf16 v[164:167], a[112:115], a[144:147], v[164:167]
  ds_read_b64_tr_b16 a[96:97], v80 offset:8192
  buffer_load_dwordx4 v24, s[44:47], s78 offen offset:1024  lds
  v_mfma_f32_16x16x32_bf16 v[168:171], a[112:115], a[148:151], v[168:171]
  ds_read_b64_tr_b16 a[98:99], v80 offset:9216
  v_mfma_f32_16x16x32_bf16 v[172:175], a[116:119], a[140:143], v[172:175]
  ds_read_b64_tr_b16 a[100:101], v81 offset:8192
  v_mfma_f32_16x16x32_bf16 v[176:179], a[116:119], a[144:147], v[176:179]
  ds_read_b64_tr_b16 a[102:103], v81 offset:9216
  v_mfma_f32_16x16x32_bf16 v[180:183], a[116:119], a[148:151], v[180:183]
  ds_read_b64_tr_b16 a[104:105], v82 offset:8192
  buffer_load_dwordx4 v25, s[44:47], s78 offen offset:2048  lds
  v_mfma_f32_16x16x32_bf16 v[184:187], a[120:123], a[140:143], v[184:187]
  ds_read_b64_tr_b16 a[106:107], v82 offset:9216
  s_add_u32 s78, s78, 128
  v_mfma_f32_16x16x32_bf16 v[188:191], a[120:123], a[144:147], v[188:191]
  ds_read_b64_tr_b16 a[108:109], v83 offset:8192
  v_mfma_f32_16x16x32_bf16 v[192:195], a[120:123], a[148:151], v[192:195]
  ds_read_b64_tr_b16 a[110:111], v83 offset:9216
  v_mfma_f32_16x16x32_bf16 v[196:199], a[124:127], a[140:143], v[196:199]
  ds_read_b64_tr_b16 a[112:113], v84 offset:8192
  v_mfma_f32_16x16x32_bf16 v[200:203], a[124:127], a[144:147], v[200:203]
  ds_read_b64_tr_b16 a[114:115], v84 offset:9216
  v_mfma_f32_16x16x32_bf16 v[204:207], a[124:127], a[148:151], v[204:207]
  s_cmp_eq_u32 s78, 896
  s_cselect_b32 s78, 0, s78
  s_waitcnt lgkmcnt(6)
  v_mfma_f32_16x16x32_bf16 v[208:211], a[96:99], a[140:143], v[208:211]
  ds_read_b64_tr_b16 a[116:117], v85 offset:8192
  s_add_u32 m0, s97, 0
  s_nop 0
  buffer_load_dwordx4 v88, s[36:39], s61 offen offset:0  lds
  v_mfma_f32_16x16x32_bf16 v[212:215], a[96:99], a[144:147], v[212:215]
  ds_read_b64_tr_b16 a[118:119], v85 offset:9216
  v_mfma_f32_16x16x32_bf16 v[216:219], a[96:99], a[148:151], v[216:219]
  v_mfma_f32_16x16x32_bf16 v[220:223], a[100:103], a[140:143], v[220:223]
  ds_read_b64_tr_b16 a[120:121], v86 offset:8192
  v_mfma_f32_16x16x32_bf16 v[224:227], a[100:103], a[144:147], v[224:227]
  ds_read_b64_tr_b16 a[122:123], v86 offset:9216
  buffer_load_dwordx4 v89, s[36:39], s61 offen offset:1024  lds
  v_mfma_f32_16x16x32_bf16 v[228:231], a[100:103], a[148:151], v[228:231]
  s_add_u32 s61, s61, 256
  s_waitcnt lgkmcnt(6)
  v_mfma_f32_16x16x32_bf16 v[232:235], a[104:107], a[140:143], v[232:235]
  ds_read_b64_tr_b16 a[124:125], v87 offset:8192
  v_mfma_f32_16x16x32_bf16 v[236:239], a[104:107], a[144:147], v[236:239]
  ds_read_b64_tr_b16 a[126:127], v87 offset:9216
  v_mfma_f32_16x16x32_bf16 v[240:243], a[104:107], a[148:151], v[240:243]
  s_add_u32 m0, s58, 49152
  s_mov_b32 s68, 16384
  buffer_load_dwordx4 v16, s[28:31], s68 offen offset:0 nt lds
  v_mfma_f32_16x16x32_bf16 v[244:247], a[108:111], a[140:143], v[244:247]
  v_mfma_f32_16x16x32_bf16 v[248:251], a[108:111], a[144:147], v[248:251]
  v_mfma_f32_16x16x32_bf16 v[252:255], a[108:111], a[148:151], v[252:255]
  s_waitcnt lgkmcnt(4)
  v_mfma_f32_16x16x32_bf16 v[32:35], a[112:115], a[140:143], v[32:35]
  s_waitcnt vmcnt(20) lgkmcnt(0)
  s_barrier
  v_mfma_f32_16x16x32_bf16 v[36:39], a[112:115], a[144:147], v[36:39]
  ds_read_b64_tr_b16 a[96:97], v80 offset:16384
  ds_read_b128 a[152:155], v94 offset:0
  v_mfma_f32_16x16x32_bf16 v[40:43], a[112:115], a[148:151], v[40:43]
  ds_read_b64_tr_b16 a[98:99], v80 offset:17408
  ds_read_b128 a[156:159], v94 offset:2048
  v_mfma_f32_16x16x32_bf16 v[44:47], a[116:119], a[140:143], v[44:47]
  ds_read_b64_tr_b16 a[100:101], v81 offset:16384
  ds_read_b128 a[160:163], v94 offset:4096
  v_mfma_f32_16x16x32_bf16 v[48:51], a[116:119], a[144:147], v[48:51]
  ds_read_b64_tr_b16 a[102:103], v81 offset:17408
  buffer_load_dwordx4 v17, s[28:31], s68 offen offset:1024 nt lds
  v_mfma_f32_16x16x32_bf16 v[52:55], a[116:119], a[148:151], v[52:55]
  ds_read_b64_tr_b16 a[104:105], v82 offset:16384
  v_mfma_f32_16x16x32_bf16 v[56:59], a[120:123], a[140:143], v[56:59]
  ds_read_b64_tr_b16 a[106:107], v82 offset:17408
  v_mfma_f32_16x16x32_bf16 v[60:63], a[120:123], a[144:147], v[60:63]
  ds_read_b64_tr_b16 a[108:109], v83 offset:16384
  v_mfma_f32_16x16x32_bf16 v[64:67], a[120:123], a[148:151], v[64:67]
  ds_read_b64_tr_b16 a[110:111], v83 offset:17408
  v_mfma_f32_16x16x32_bf16 v[68:71], a[124:127], a[140:143], v[68:71]
  ds_read_b64_tr_b16 a[112:113], v84 offset:16384
  v_mfma_f32_16x16x32_bf16 v[72:75], a[124:127], a[144:147], v[72:75]
  ds_read_b64_tr_b16 a[114:115], v84 offset:17408
  v_mfma_f32_16x16x32_bf16 v[76:79], a[124:127], a[148:151], v[76:79]
  s_waitcnt lgkmcnt(7)
  s_waitcnt lgkmcnt(6)
  v_mfma_f32_16x16x32_bf16 v[112:115], a[96:99], a[152:155], v[112:115]
  ds_read_b64_tr_b16 a[116:117], v85 offset:16384
  s_add_u32 m0, s97, 8192
  s_nop 0
  buffer_load_dwordx4 v88, s[36:39], s61 offen offset:0  lds
  v_mfma_f32_16x16x32_bf16 v[116:119], a[96:99], a[156:159], v[116:119]
  ds_read_b64_tr_b16 a[118:119], v85 offset:17408
  ds_read_b128 a[164:167], v95 offset:0
  v_mfma_f32_16x16x32_bf16 v[120:123], a[96:99], a[160:163], v[120:123]
  ds_read_b128 a[168:171], v95 offset:2048
  v_mfma_f32_16x16x32_bf16 v[124:127], a[100:103], a[152:155], v[124:127]
  ds_read_b64_tr_b16 a[120:121], v86 offset:16384
  v_mfma_f32_16x16x32_bf16 v[128:131], a[100:103], a[156:159], v[128:131]
  ds_read_b64_tr_b16 a[122:123], v86 offset:17408
  buffer_load_dwordx4 v89, s[36:39], s61 offen offset:1024  lds
  v_mfma_f32_16x16x32_bf16 v[132:135], a[100:103], a[160:163], v[132:135]
  s_add_u32 s61, s61, 261888
  s_waitcnt lgkmcnt(8)
  v_mfma_f32_16x16x32_bf16 v[136:139], a[104:107], a[152:155], v[136:139]
  ds_read_b64_tr_b16 a[124:125], v87 offset:16384
  ds_read_b128 a[172:175], v95 offset:4096
  v_mfma_f32_16x16x32_bf16 v[140:143], a[104:107], a[156:159], v[140:143]
  ds_read_b64_tr_b16 a[126:127], v87 offset:17408
  v_mfma_f32_16x16x32_bf16 v[144:147], a[104:107], a[160:163], v[144:147]
  s_cmp_eq_u32 s61, 3670016
  s_cselect_b32 s61, 0, s61
  v_mfma_f32_16x16x32_bf16 v[148:151], a[108:111], a[152:155], v[148:151]
  s_add_u32 m0, s58, 49152
  s_mov_b32 s68, 16384
  buffer_load_dwordx4 v18, s[28:31], s68 offen offset:2048 nt lds
  v_mfma_f32_16x16x32_bf16 v[152:155], a[108:111], a[156:159], v[152:155]
  v_mfma_f32_16x16x32_bf16 v[156:159], a[108:111], a[160:163], v[156:159]
  s_waitcnt lgkmcnt(7)
  v_mfma_f32_16x16x32_bf16 v[160:163], a[112:115], a[152:155], v[160:163]
  s_waitcnt vmcnt(19) lgkmcnt(0)
  s_barrier
  v_mfma_f32_16x16x32_bf16 v[164:167], a[112:115], a[156:159], v[164:167]
  ds_read_b64_tr_b16 a[96:97], v80 offset:24576
  buffer_load_dwordx4 v19, s[28:31], s68 offen offset:3072 nt lds
  v_mfma_f32_16x16x32_bf16 v[168:171], a[112:115], a[160:163], v[168:171]
  ds_read_b64_tr_b16 a[98:99], v80 offset:25600
  v_mfma_f32_16x16x32_bf16 v[172:175], a[116:119], a[152:155], v[172:175]
  ds_read_b64_tr_b16 a[100:101], v81 offset:24576
  v_mfma_f32_16x16x32_bf16 v[176:179], a[116:119], a[156:159], v[176:179]
  ds_read_b64_tr_b16 a[102:103], v81 offset:25600
  v_mfma_f32_16x16x32_bf16 v[180:183], a[116:119], a[160:163], v[180:183]
  ds_read_b64_tr_b16 a[104:105], v82 offset:24576
  v_mfma_f32_16x16x32_bf16 v[184:187], a[120:123], a[152:155], v[184:187]
  ds_read_b64_tr_b16 a[106:107], v82 offset:25600
  v_mfma_f32_16x16x32_bf16 v[188:191], a[120:123], a[156:159], v[188:191]
  ds_read_b64_tr_b16 a[108:109], v83 offset:24576
  v_mfma_f32_16x16x32_bf16 v[192:195], a[120:123], a[160:163], v[192:195]
  ds_read_b64_tr_b16 a[110:111], v83 offset:25600
  v_mfma_f32_16x16x32_bf16 v[196:199], a[124:127], a[152:155], v[196:199]
  ds_read_b64_tr_b16 a[112:113], v84 offset:24576
  v_mfma_f32_16x16x32_bf16 v[200:203], a[124:127], a[156:159], v[200:203]
  ds_read_b64_tr_b16 a[114:115], v84 offset:25600
  v_mfma_f32_16x16x32_bf16 v[204:207], a[124:127], a[160:163], v[204:207]
  s_waitcnt lgkmcnt(6)
  v_mfma_f32_16x16x32_bf16 v[208:211], a[96:99], a[152:155], v[208:211]
  ds_read_b64_tr_b16 a[116:117], v85 offset:24576
  s_add_u32 m0, s97, 16384
  s_nop 0
  buffer_load_dwordx4 v88, s[36:39], s61 offen offset:0  lds
  v_mfma_f32_16x16x32_bf16 v[212:215], a[96:99], a[156:159], v[212:215]
  ds_read_b64_tr_b16 a[118:119], v85 offset:25600
  v_mfma_f32_16x16x32_bf16 v[216:219], a[96:99], a[160:163], v[216:219]
  v_mfma_f32_16x16x32_bf16 v[220:223], a[100:103], a[152:155], v[220:223]
  ds_read_b64_tr_b16 a[120:121], v86 offset:24576
  v_mfma_f32_16x16x32_bf16 v[224:227], a[100:103], a[156:159], v[224:227]
  ds_read_b64_tr_b16 a[122:123], v86 offset:25600
  buffer_load_dwordx4 v89, s[36:39], s61 offen offset:1024  lds
  v_mfma_f32_16x16x32_bf16 v[228:231], a[100:103], a[160:163], v[228:231]
  s_add_u32 s61, s61, 256
  s_waitcnt lgkmcnt(6)
  v_mfma_f32_16x16x32_bf16 v[232:235], a[104:107], a[152:155], v[232:235]
  ds_read_b64_tr_b16 a[124:125], v87 offset:24576
  v_mfma_f32_16x16x32_bf16 v[236:239], a[104:107], a[156:159], v[236:239]
  ds_read_b64_tr_b16 a[126:127], v87 offset:25600
  v_mfma_f32_16x16x32_bf16 v[240:243], a[104:107], a[160:163], v[240:243]
  s_add_u32 m0, s58, 53248
  s_mov_b32 s68, 20480
  buffer_load_dwordx4 v16, s[28:31], s68 offen offset:0 nt lds
  v_mfma_f32_16x16x32_bf16 v[244:247], a[108:111], a[152:155], v[244:247]
  v_mfma_f32_16x16x32_bf16 v[248:251], a[108:111], a[156:159], v[248:251]
  v_mfma_f32_16x16x32_bf16 v[252:255], a[108:111], a[160:163], v[252:255]
  s_waitcnt lgkmcnt(4)
  v_mfma_f32_16x16x32_bf16 v[32:35], a[112:115], a[152:155], v[32:35]
  s_waitcnt vmcnt(21) lgkmcnt(0)
  s_barrier
  v_mfma_f32_16x16x32_bf16 v[36:39], a[112:115], a[156:159], v[36:39]
  ds_read_b64_tr_b16 a[96:97], v98 offset:0
  buffer_load_dwordx4 v17, s[28:31], s68 offen offset:1024 nt lds
  v_mfma_f32_16x16x32_bf16 v[40:43], a[112:115], a[160:163], v[40:43]
  ds_read_b64_tr_b16 a[98:99], v98 offset:1024
  v_mfma_f32_16x16x32_bf16 v[44:47], a[116:119], a[152:155], v[44:47]
  ds_read_b64_tr_b16 a[100:101], v99 offset:0
  v_mfma_f32_16x16x32_bf16 v[48:51], a[116:119], a[156:159], v[48:51]
  ds_read_b64_tr_b16 a[102:103], v99 offset:1024
  v_mfma_f32_16x16x32_bf16 v[52:55], a[116:119], a[160:163], v[52:55]
  ds_read_b64_tr_b16 a[104:105], v100 offset:0
  v_mfma_f32_16x16x32_bf16 v[56:59], a[120:123], a[152:155], v[56:59]
  ds_read_b64_tr_b16 a[106:107], v100 offset:1024
  v_mfma_f32_16x16x32_bf16 v[60:63], a[120:123], a[156:159], v[60:63]
  ds_read_b64_tr_b16 a[108:109], v101 offset:0
  v_mfma_f32_16x16x32_bf16 v[64:67], a[120:123], a[160:163], v[64:67]
  ds_read_b64_tr_b16 a[110:111], v101 offset:1024
  v_mfma_f32_16x16x32_bf16 v[68:71], a[124:127], a[152:155], v[68:71]
  ds_read_b64_tr_b16 a[112:113], v102 offset:0
  v_mfma_f32_16x16x32_bf16 v[72:75], a[124:127], a[156:159], v[72:75]
  ds_read_b64_tr_b16 a[114:115], v102 offset:1024
  v_mfma_f32_16x16x32_bf16 v[76:79], a[124:127], a[160:163], v[76:79]
  s_waitcnt lgkmcnt(6)
  v_mfma_f32_16x16x32_bf16 v[112:115], a[96:99], a[164:167], v[112:115]
  ds_read_b64_tr_b16 a[116:117], v103 offset:0
  s_add_u32 m0, s97, 24576
  s_nop 0
  buffer_load_dwordx4 v88, s[36:39], s61 offen offset:0  lds
  v_mfma_f32_16x16x32_bf16 v[116:119], a[96:99], a[168:171], v[116:119]
  ds_read_b64_tr_b16 a[118:119], v103 offset:1024
  v_mfma_f32_16x16x32_bf16 v[120:123], a[96:99], a[172:175], v[120:123]
  v_mfma_f32_16x16x32_bf16 v[124:127], a[100:103], a[164:167], v[124:127]
  ds_read_b64_tr_b16 a[120:121], v104 offset:0
  v_mfma_f32_16x16x32_bf16 v[128:131], a[100:103], a[168:171], v[128:131]
  ds_read_b64_tr_b16 a[122:123], v104 offset:1024
  buffer_load_dwordx4 v89, s[36:39], s61 offen offset:1024  lds
  v_mfma_f32_16x16x32_bf16 v[132:135], a[100:103], a[172:175], v[132:135]
  s_add_u32 s61, s61, 261888
  s_waitcnt lgkmcnt(6)
  v_mfma_f32_16x16x32_bf16 v[136:139], a[104:107], a[164:167], v[136:139]
  ds_read_b64_tr_b16 a[124:125], v105 offset:0
  v_mfma_f32_16x16x32_bf16 v[140:143], a[104:107], a[168:171], v[140:143]
  ds_read_b64_tr_b16 a[126:127], v105 offset:1024
  v_mfma_f32_16x16x32_bf16 v[144:147], a[104:107], a[172:175], v[144:147]
  s_cmp_eq_u32 s61, 3670016
  s_cselect_b32 s61, 0, s61
  v_mfma_f32_16x16x32_bf16 v[148:151], a[108:111], a[164:167], v[148:151]
  s_add_u32 m0, s58, 53248
  s_mov_b32 s68, 20480
  buffer_load_dwordx4 v18, s[28:31], s68 offen offset:2048 nt lds
  v_mfma_f32_16x16x32_bf16 v[152:155], a[108:111], a[168:171], v[152:155]
  v_mfma_f32_16x16x32_bf16 v[156:159], a[108:111], a[172:175], v[156:159]
  s_waitcnt lgkmcnt(4)
  v_mfma_f32_16x16x32_bf16 v[160:163], a[112:115], a[164:167], v[160:163]
  s_waitcnt vmcnt(18) lgkmcnt(0)
  s_barrier
  v_mfma_f32_16x16x32_bf16 v[164:167], a[112:115], a[168:171], v[164:167]
  ds_read_b64_tr_b16 a[96:97], v98 offset:40960
  buffer_load_dwordx4 v19, s[28:31], s68 offen offset:3072 nt lds
  v_mfma_f32_16x16x32_bf16 v[168:171], a[112:115], a[172:175], v[168:171]
  ds_read_b64_tr_b16 a[98:99], v98 offset:41984
  v_mfma_f32_16x16x32_bf16 v[172:175], a[116:119], a[164:167], v[172:175]
  ds_read_b64_tr_b16 a[100:101], v99 offset:40960
  v_mfma_f32_16x16x32_bf16 v[176:179], a[116:119], a[168:171], v[176:179]
  ds_read_b64_tr_b16 a[102:103], v99 offset:41984
  v_mfma_f32_16x16x32_bf16 v[180:183], a[116:119], a[172:175], v[180:183]
  ds_read_b64_tr_b16 a[104:105], v100 offset:40960
  v_mfma_f32_16x16x32_bf16 v[184:187], a[120:123], a[164:167], v[184:187]
  ds_read_b64_tr_b16 a[106:107], v100 offset:41984
  v_mfma_f32_16x16x32_bf16 v[188:191], a[120:123], a[168:171], v[188:191]
  ds_read_b64_tr_b16 a[108:109], v101 offset:40960
  v_mfma_f32_16x16x32_bf16 v[192:195], a[120:123], a[172:175], v[192:195]
  ds_read_b64_tr_b16 a[110:111], v101 offset:41984
  v_mfma_f32_16x16x32_bf16 v[196:199], a[124:127], a[164:167], v[196:199]
  ds_read_b64_tr_b16 a[112:113], v102 offset:40960
  v_mfma_f32_16x16x32_bf16 v[200:203], a[124:127], a[168:171], v[200:203]
  ds_read_b64_tr_b16 a[114:115], v102 offset:41984
  v_mfma_f32_16x16x32_bf16 v[204:207], a[124:127], a[172:175], v[204:207]
  s_waitcnt lgkmcnt(6)
  v_mfma_f32_16x16x32_bf16 v[208:211], a[96:99], a[164:167], v[208:211]
  ds_read_b64_tr_b16 a[116:117], v103 offset:40960
  v_mfma_f32_16x16x32_bf16 v[212:215], a[96:99], a[168:171], v[212:215]
  ds_read_b64_tr_b16 a[118:119], v103 offset:41984
  v_mfma_f32_16x16x32_bf16 v[216:219], a[96:99], a[172:175], v[216:219]
  v_mfma_f32_16x16x32_bf16 v[220:223], a[100:103], a[164:167], v[220:223]
  ds_read_b64_tr_b16 a[120:121], v104 offset:40960
  v_mfma_f32_16x16x32_bf16 v[224:227], a[100:103], a[168:171], v[224:227]
  ds_read_b64_tr_b16 a[122:123], v104 offset:41984
  v_mfma_f32_16x16x32_bf16 v[228:231], a[100:103], a[172:175], v[228:231]
  s_waitcnt lgkmcnt(6)
  v_mfma_f32_16x16x32_bf16 v[232:235], a[104:107], a[164:167], v[232:235]
  ds_read_b64_tr_b16 a[124:125], v105 offset:40960
  v_mfma_f32_16x16x32_bf16 v[236:239], a[104:107], a[168:171], v[236:239]
  ds_read_b64_tr_b16 a[126:127], v105 offset:41984
  v_mfma_f32_16x16x32_bf16 v[240:243], a[104:107], a[172:175], v[240:243]
  v_mfma_f32_16x16x32_bf16 v[244:247], a[108:111], a[164:167], v[244:247]
  v_mfma_f32_16x16x32_bf16 v[248:251], a[108:111], a[168:171], v[248:251]
  v_mfma_f32_16x16x32_bf16 v[252:255], a[108:111], a[172:175], v[252:255]
  s_waitcnt lgkmcnt(4)
  v_mfma_f32_16x16x32_bf16 v[32:35], a[112:115], a[164:167], v[32:35]
  s_waitcnt vmcnt(14) lgkmcnt(0)
  s_barrier
  v_mfma_f32_16x16x32_bf16 v[36:39], a[112:115], a[168:171], v[36:39]
  ds_read_b64_tr_b16 a[96:97], v80 offset:0
  ds_read_b128 a[176:179], v92 offset:0
  v_mfma_f32_16x16x32_bf16 v[40:43], a[112:115], a[172:175], v[40:43]
  ds_read_b64_tr_b16 a[98:99], v80 offset:1024
  ds_read_b128 a[180:183], v92 offset:2048
  v_mfma_f32_16x16x32_bf16 v[44:47], a[116:119], a[164:167], v[44:47]
  ds_read_b64_tr_b16 a[100:101], v81 offset:0
  ds_read_b128 a[184:187], v92 offset:4096
  v_mfma_f32_16x16x32_bf16 v[48:51], a[116:119], a[168:171], v[48:51]
  ds_read_b64_tr_b16 a[102:103], v81 offset:1024
  v_mfma_f32_16x16x32_bf16 v[52:55], a[116:119], a[172:175], v[52:55]
  ds_read_b64_tr_b16 a[104:105], v82 offset:0
  v_mfma_f32_16x16x32_bf16 v[56:59], a[120:123], a[164:167], v[56:59]
  ds_read_b64_tr_b16 a[106:107], v82 offset:1024
  v_mfma_f32_16x16x32_bf16 v[60:63], a[120:123], a[168:171], v[60:63]
  ds_read_b64_tr_b16 a[108:109], v83 offset:0
  v_mfma_f32_16x16x32_bf16 v[64:67], a[120:123], a[172:175], v[64:67]
  ds_read_b64_tr_b16 a[110:111], v83 offset:1024
  v_mfma_f32_16x16x32_bf16 v[68:71], a[124:127], a[164:167], v[68:71]
  ds_read_b64_tr_b16 a[112:113], v84 offset:0
  v_mfma_f32_16x16x32_bf16 v[72:75], a[124:127], a[168:171], v[72:75]
  ds_read_b64_tr_b16 a[114:115], v84 offset:1024
  v_mfma_f32_16x16x32_bf16 v[76:79], a[124:127], a[172:175], v[76:79]
  s_waitcnt lgkmcnt(7)
  s_waitcnt lgkmcnt(6)
  v_mfma_f32_16x16x32_bf16 v[112:115], a[96:99], a[176:179], v[112:115]
  ds_read_b64_tr_b16 a[116:117], v85 offset:0
  ds_read_b128 a[188:191], v93 offset:0
  v_mfma_f32_16x16x32_bf16 v[116:119], a[96:99], a[180:183], v[116:119]
  ds_read_b64_tr_b16 a[118:119], v85 offset:1024
  ds_read_b128 a[192:195], v93 offset:2048
  v_mfma_f32_16x16x32_bf16 v[120:123], a[96:99], a[184:187], v[120:123]
  v_mfma_f32_16x16x32_bf16 v[124:127], a[100:103], a[176:179], v[124:127]
  ds_read_b64_tr_b16 a[120:121], v86 offset:0
  v_mfma_f32_16x16x32_bf16 v[128:131], a[100:103], a[180:183], v[128:131]
  ds_read_b64_tr_b16 a[122:123], v86 offset:1024
  v_mfma_f32_16x16x32_bf16 v[132:135], a[100:103], a[184:187], v[132:135]
  s_waitcnt lgkmcnt(8)
  v_mfma_f32_16x16x32_bf16 v[136:139], a[104:107], a[176:179], v[136:139]
  ds_read_b64_tr_b16 a[124:125], v87 offset:0
  ds_read_b128 a[196:199], v93 offset:4096
  v_mfma_f32_16x16x32_bf16 v[140:143], a[104:107], a[180:183], v[140:143]
  ds_read_b64_tr_b16 a[126:127], v87 offset:1024
  v_mfma_f32_16x16x32_bf16 v[144:147], a[104:107], a[184:187], v[144:147]
  v_mfma_f32_16x16x32_bf16 v[148:151], a[108:111], a[176:179], v[148:151]
  v_mfma_f32_16x16x32_bf16 v[152:155], a[108:111], a[180:183], v[152:155]
  v_mfma_f32_16x16x32_bf16 v[156:159], a[108:111], a[184:187], v[156:159]
  s_waitcnt lgkmcnt(6)
  v_mfma_f32_16x16x32_bf16 v[160:163], a[112:115], a[176:179], v[160:163]
  s_waitcnt vmcnt(10) lgkmcnt(0)
  s_barrier
  v_mfma_f32_16x16x32_bf16 v[164:167], a[112:115], a[180:183], v[164:167]
  ds_read_b64_tr_b16 a[96:97], v80 offset:8192
  v_mfma_f32_16x16x32_bf16 v[168:171], a[112:115], a[184:187], v[168:171]
  ds_read_b64_tr_b16 a[98:99], v80 offset:9216
  v_mfma_f32_16x16x32_bf16 v[172:175], a[116:119], a[176:179], v[172:175]
  ds_read_b64_tr_b16 a[100:101], v81 offset:8192
  v_mfma_f32_16x16x32_bf16 v[176:179], a[116:119], a[180:183], v[176:179]
  ds_read_b64_tr_b16 a[102:103], v81 offset:9216
  v_mfma_f32_16x16x32_bf16 v[180:183], a[116:119], a[184:187], v[180:183]
  ds_read_b64_tr_b16 a[104:105], v82 offset:8192
  v_mfma_f32_16x16x32_bf16 v[184:187], a[120:123], a[176:179], v[184:187]
  ds_read_b64_tr_b16 a[106:107], v82 offset:9216
  v_mfma_f32_16x16x32_bf16 v[188:191], a[120:123], a[180:183], v[188:191]
  ds_read_b64_tr_b16 a[108:109], v83 offset:8192
  v_mfma_f32_16x16x32_bf16 v[192:195], a[120:123], a[184:187], v[192:195]
  ds_read_b64_tr_b16 a[110:111], v83 offset:9216
  v_mfma_f32_16x16x32_bf16 v[196:199], a[124:127], a[176:179], v[196:199]
  ds_read_b64_tr_b16 a[112:113], v84 offset:8192
  v_mfma_f32_16x16x32_bf16 v[200:203], a[124:127], a[180:183], v[200:203]
  ds_read_b64_tr_b16 a[114:115], v84 offset:9216
  v_mfma_f32_16x16x32_bf16 v[204:207], a[124:127], a[184:187], v[204:207]
  s_waitcnt lgkmcnt(6)
  v_mfma_f32_16x16x32_bf16 v[208:211], a[96:99], a[176:179], v[208:211]
  ds_read_b64_tr_b16 a[116:117], v85 offset:8192
  v_mfma_f32_16x16x32_bf16 v[212:215], a[96:99], a[180:183], v[212:215]
  ds_read_b64_tr_b16 a[118:119], v85 offset:9216
  v_mfma_f32_16x16x32_bf16 v[216:219], a[96:99], a[184:187], v[216:219]
  v_mfma_f32_16x16x32_bf16 v[220:223], a[100:103], a[176:179], v[220:223]
  ds_read_b64_tr_b16 a[120:121], v86 offset:8192
  v_mfma_f32_16x16x32_bf16 v[224:227], a[100:103], a[180:183], v[224:227]
  ds_read_b64_tr_b16 a[122:123], v86 offset:9216
  v_mfma_f32_16x16x32_bf16 v[228:231], a[100:103], a[184:187], v[228:231]
  s_waitcnt lgkmcnt(6)
  v_mfma_f32_16x16x32_bf16 v[232:235], a[104:107], a[176:179], v[232:235]
  ds_read_b64_tr_b16 a[124:125], v87 offset:8192
  v_mfma_f32_16x16x32_bf16 v[236:239], a[104:107], a[180:183], v[236:239]
  ds_read_b64_tr_b16 a[126:127], v87 offset:9216
  v_mfma_f32_16x16x32_bf16 v[240:243], a[104:107], a[184:187], v[240:243]
  v_mfma_f32_16x16x32_bf16 v[244:247], a[108:111], a[176:179], v[244:247]
  v_mfma_f32_16x16x32_bf16 v[248:251], a[108:111], a[180:183], v[248:251]
  v_mfma_f32_16x16x32_bf16 v[252:255], a[108:111], a[184:187], v[252:255]
  s_waitcnt lgkmcnt(4)
  v_mfma_f32_16x16x32_bf16 v[32:35], a[112:115], a[176:179], v[32:35]
  s_waitcnt vmcnt(6) lgkmcnt(0)
  s_barrier
  v_mfma_f32_16x16x32_bf16 v[36:39], a[112:115], a[180:183], v[36:39]
  ds_read_b64_tr_b16 a[96:97], v80 offset:16384
  v_mfma_f32_16x16x32_bf16 v[40:43], a[112:115], a[184:187], v[40:43]
  ds_read_b64_tr_b16 a[98:99], v80 offset:17408
  v_mfma_f32_16x16x32_bf16 v[44:47], a[116:119], a[176:179], v[44:47]
  ds_read_b64_tr_b16 a[100:101], v81 offset:16384
  v_mfma_f32_16x16x32_bf16 v[48:51], a[116:119], a[180:183], v[48:51]
  ds_read_b64_tr_b16 a[102:103], v81 offset:17408
  v_mfma_f32_16x16x32_bf16 v[52:55], a[116:119], a[184:187], v[52:55]
  ds_read_b64_tr_b16 a[104:105], v82 offset:16384
  v_mfma_f32_16x16x32_bf16 v[56:59], a[120:123], a[176:179], v[56:59]
  ds_read_b64_tr_b16 a[106:107], v82 offset:17408
  v_mfma_f32_16x16x32_bf16 v[60:63], a[120:123], a[180:183], v[60:63]
  ds_read_b64_tr_b16 a[108:109], v83 offset:16384
  v_mfma_f32_16x16x32_bf16 v[64:67], a[120:123], a[184:187], v[64:67]
  ds_read_b64_tr_b16 a[110:111], v83 offset:17408
  v_mfma_f32_16x16x32_bf16 v[68:71], a[124:127], a[176:179], v[68:71]
  ds_read_b64_tr_b16 a[112:113], v84 offset:16384
  v_mfma_f32_16x16x32_bf16 v[72:75], a[124:127], a[180:183], v[72:75]
  ds_read_b64_tr_b16 a[114:115], v84 offset:17408
  v_mfma_f32_16x16x32_bf16 v[76:79], a[124:127], a[184:187], v[76:79]
  s_waitcnt lgkmcnt(6)
  v_mfma_f32_16x16x32_bf16 v[112:115], a[96:99], a[188:191], v[112:115]
  ds_read_b64_tr_b16 a[116:117], v85 offset:16384
  s_add_u32 m0, s58, 0
  v_mfma_f32_16x16x32_bf16 v[116:119], a[96:99], a[192:195], v[116:119]
  ds_read_b64_tr_b16 a[118:119], v85 offset:17408
  s_add_u32 s69, s57, 4096
  v_mfma_f32_16x16x32_bf16 v[120:123], a[96:99], a[196:199], v[120:123]
  buffer_load_dwordx4 v16, s[32:35], s57 offen offset:0 nt lds
  v_mfma_f32_16x16x32_bf16 v[124:127], a[100:103], a[188:191], v[124:127]
  ds_read_b64_tr_b16 a[120:121], v86 offset:16384
  v_mfma_f32_16x16x32_bf16 v[128:131], a[100:103], a[192:195], v[128:131]
  ds_read_b64_tr_b16 a[122:123], v86 offset:17408
  v_mfma_f32_16x16x32_bf16 v[132:135], a[100:103], a[196:199], v[132:135]
  s_waitcnt lgkmcnt(6)
  v_mfma_f32_16x16x32_bf16 v[136:139], a[104:107], a[188:191], v[136:139]
  ds_read_b64_tr_b16 a[124:125], v87 offset:16384
  buffer_load_dwordx4 v17, s[32:35], s57 offen offset:1024 nt lds
  v_mfma_f32_16x16x32_bf16 v[140:143], a[104:107], a[192:195], v[140:143]
  ds_read_b64_tr_b16 a[126:127], v87 offset:17408
  v_mfma_f32_16x16x32_bf16 v[144:147], a[104:107], a[196:199], v[144:147]
  v_mfma_f32_16x16x32_bf16 v[148:151], a[108:111], a[188:191], v[148:151]
  v_mfma_f32_16x16x32_bf16 v[152:155], a[108:111], a[192:195], v[152:155]
  buffer_load_dwordx4 v18, s[32:35], s57 offen offset:2048 nt lds
  v_mfma_f32_16x16x32_bf16 v[156:159], a[108:111], a[196:199], v[156:159]
  s_waitcnt lgkmcnt(4)
  v_mfma_f32_16x16x32_bf16 v[160:163], a[112:115], a[188:191], v[160:163]
  s_waitcnt vmcnt(5) lgkmcnt(0)
  s_barrier
  v_mfma_f32_16x16x32_bf16 v[164:167], a[112:115], a[192:195], v[164:167]
  ds_read_b64_tr_b16 a[96:97], v80 offset:24576
  v_mfma_f32_16x16x32_bf16 v[168:171], a[112:115], a[196:199], v[168:171]
  ds_read_b64_tr_b16 a[98:99], v80 offset:25600
  buffer_load_dwordx4 v19, s[32:35], s57 offen offset:3072 nt lds
  v_mfma_f32_16x16x32_bf16 v[172:175], a[116:119], a[188:191], v[172:175]
  ds_read_b64_tr_b16 a[100:101], v81 offset:24576
  s_add_u32 m0, s58, 4096
  v_mfma_f32_16x16x32_bf16 v[176:179], a[116:119], a[192:195], v[176:179]
  ds_read_b64_tr_b16 a[102:103], v81 offset:25600
  s_add_u32 s57, s57, 16384
  v_mfma_f32_16x16x32_bf16 v[180:183], a[116:119], a[196:199], v[180:183]
  ds_read_b64_tr_b16 a[104:105], v82 offset:24576
  v_mfma_f32_16x16x32_bf16 v[184:187], a[120:123], a[188:191], v[184:187]
  ds_read_b64_tr_b16 a[106:107], v82 offset:25600
  buffer_load_dwordx4 v16, s[32:35], s69 offen offset:0 nt lds
  v_mfma_f32_16x16x32_bf16 v[188:191], a[120:123], a[192:195], v[188:191]
  ds_read_b64_tr_b16 a[108:109], v83 offset:24576
  v_mfma_f32_16x16x32_bf16 v[192:195], a[120:123], a[196:199], v[192:195]
  ds_read_b64_tr_b16 a[110:111], v83 offset:25600
  v_mfma_f32_16x16x32_bf16 v[196:199], a[124:127], a[188:191], v[196:199]
  ds_read_b64_tr_b16 a[112:113], v84 offset:24576
  v_mfma_f32_16x16x32_bf16 v[200:203], a[124:127], a[192:195], v[200:203]
  ds_read_b64_tr_b16 a[114:115], v84 offset:25600
  buffer_load_dwordx4 v17, s[32:35], s69 offen offset:1024 nt lds
  v_mfma_f32_16x16x32_bf16 v[204:207], a[124:127], a[196:199], v[204:207]
  buffer_load_dwordx4 v18, s[32:35], s69 offen offset:2048 nt lds
  buffer_load_dwordx4 v19, s[32:35], s69 offen offset:3072 nt lds
  s_waitcnt lgkmcnt(6)
  v_mfma_f32_16x16x32_bf16 v[208:211], a[96:99], a[188:191], v[208:211]
  ds_read_b64_tr_b16 a[116:117], v85 offset:24576
  v_mfma_f32_16x16x32_bf16 v[212:215], a[96:99], a[192:195], v[212:215]
  ds_read_b64_tr_b16 a[118:119], v85 offset:25600
  v_mfma_f32_16x16x32_bf16 v[216:219], a[96:99], a[196:199], v[216:219]
  v_mfma_f32_16x16x32_bf16 v[220:223], a[100:103], a[188:191], v[220:223]
  ds_read_b64_tr_b16 a[120:121], v86 offset:24576
  v_cvt_pk_bf16_f32 v0, v112, v113
  v_mfma_f32_16x16x32_bf16 v[224:227], a[100:103], a[192:195], v[224:227]
  ds_read_b64_tr_b16 a[122:123], v86 offset:25600
  v_cvt_pk_bf16_f32 v1, v114, v115
  v_mfma_f32_16x16x32_bf16 v[228:231], a[100:103], a[196:199], v[228:231]
  v_cvt_pk_bf16_f32 v2, v124, v125
  s_waitcnt lgkmcnt(6)
  v_mfma_f32_16x16x32_bf16 v[232:235], a[104:107], a[188:191], v[232:235]
  ds_read_b64_tr_b16 a[124:125], v87 offset:24576
  v_cvt_pk_bf16_f32 v3, v126, v127
  v_mfma_f32_16x16x32_bf16 v[236:239], a[104:107], a[192:195], v[236:239]
  ds_read_b64_tr_b16 a[126:127], v87 offset:25600
  v_cvt_pk_bf16_f32 v108, v116, v117
  v_mfma_f32_16x16x32_bf16 v[240:243], a[104:107], a[196:199], v[240:243]
  v_cvt_pk_bf16_f32 v109, v118, v119
  v_cvt_pk_bf16_f32 v110, v128, v129
  v_mfma_f32_16x16x32_bf16 v[244:247], a[108:111], a[188:191], v[244:247]
  v_cvt_pk_bf16_f32 v111, v130, v131
  v_cvt_pk_bf16_f32 v24, v120, v121
  v_mfma_f32_16x16x32_bf16 v[248:251], a[108:111], a[192:195], v[248:251]
  v_cvt_pk_bf16_f32 v25, v122, v123
  v_cvt_pk_bf16_f32 v26, v132, v133
  v_mfma_f32_16x16x32_bf16 v[252:255], a[108:111], a[196:199], v[252:255]
  v_cvt_pk_bf16_f32 v27, v134, v135
  s_waitcnt lgkmcnt(4)
  v_mfma_f32_16x16x32_bf16 v[32:35], a[112:115], a[188:191], v[32:35]
  s_waitcnt lgkmcnt(0)
  s_barrier
  v_mfma_f32_16x16x32_bf16 v[36:39], a[112:115], a[192:195], v[36:39]
  ds_read_b128 a[96:99], v4 offset:32768
  v_permlane32_swap_b32 v0, v2
  v_mfma_f32_16x16x32_bf16 v[40:43], a[112:115], a[196:199], v[40:43]
  ds_read_b128 a[100:103], v4 offset:40960
  v_permlane32_swap_b32 v1, v3
  v_mfma_f32_16x16x32_bf16 v[44:47], a[116:119], a[188:191], v[44:47]
  ds_read_b128 a[104:107], v5 offset:32768
  v_permlane32_swap_b32 v108, v110
  v_mfma_f32_16x16x32_bf16 v[48:51], a[116:119], a[192:195], v[48:51]
  ds_read_b128 a[108:111], v5 offset:40960
  v_permlane32_swap_b32 v109, v111
  v_mfma_f32_16x16x32_bf16 v[52:55], a[116:119], a[196:199], v[52:55]
  ds_read_b128 a[112:115], v6 offset:32768
  v_permlane32_swap_b32 v24, v26
  v_mfma_f32_16x16x32_bf16 v[56:59], a[120:123], a[188:191], v[56:59]
  v_permlane32_swap_b32 v25, v27
  v_permlane16_swap_b32 v0, v2
  v_mfma_f32_16x16x32_bf16 v[60:63], a[120:123], a[192:195], v[60:63]
  v_permlane16_swap_b32 v1, v3
  v_permlane16_swap_b32 v108, v110
  v_mfma_f32_16x16x32_bf16 v[64:67], a[120:123], a[196:199], v[64:67]
  v_permlane16_swap_b32 v109, v111
  v_permlane16_swap_b32 v24, v26
  v_mfma_f32_16x16x32_bf16 v[68:71], a[124:127], a[188:191], v[68:71]
  v_permlane16_swap_b32 v25, v27
  v_mfma_f32_16x16x32_bf16 v[72:75], a[124:127], a[192:195], v[72:75]
  v_mfma_f32_16x16x32_bf16 v[76:79], a[124:127], a[196:199], v[76:79]
L_postB:
  v_accvgpr_write_b32 a0, v0
  v_accvgpr_write_b32 a1, v1
  v_accvgpr_write_b32 a2, v2
  v_accvgpr_write_b32 a3, v3
  v_accvgpr_write_b32 a4, v108
  v_accvgpr_write_b32 a5, v109
  v_accvgpr_write_b32 a6, v110
  v_accvgpr_write_b32 a7, v111
  v_accvgpr_write_b32 a8, v24
  v_accvgpr_write_b32 a9, v25
  v_accvgpr_write_b32 a10, v26
  v_accvgpr_write_b32 a11, v27
  v_cvt_pk_bf16_f32 v0, v136, v137
  v_cvt_pk_bf16_f32 v1, v138, v139
  v_cvt_pk_bf16_f32 v2, v148, v149
  v_cvt_pk_bf16_f32 v3, v150, v151
  v_cvt_pk_bf16_f32 v108, v140, v141
  v_cvt_pk_bf16_f32 v109, v142, v143
  v_cvt_pk_bf16_f32 v110, v152, v153
  v_cvt_pk_bf16_f32 v111, v154, v155
  v_cvt_pk_bf16_f32 v24, v144, v145
  v_cvt_pk_bf16_f32 v25, v146, v147
  v_cvt_pk_bf16_f32 v26, v156, v157
  v_cvt_pk_bf16_f32 v27, v158, v159
  v_permlane32_swap_b32 v0, v2
  v_permlane32_swap_b32 v1, v3
  v_permlane32_swap_b32 v108, v110
  v_permlane32_swap_b32 v109, v111
  v_permlane32_swap_b32 v24, v26
  v_permlane32_swap_b32 v25, v27
  v_permlane16_swap_b32 v0, v2
  v_permlane16_swap_b32 v1, v3
  v_permlane16_swap_b32 v108, v110
  v_permlane16_swap_b32 v109, v111
  v_permlane16_swap_b32 v24, v26
  v_permlane16_swap_b32 v25, v27
  v_accvgpr_write_b32 a12, v0
  v_accvgpr_write_b32 a13, v1
  v_accvgpr_write_b32 a14, v2
  v_accvgpr_write_b32 a15, v3
  v_accvgpr_write_b32 a16, v108
  v_accvgpr_write_b32 a17, v109
  v_accvgpr_write_b32 a18, v110
  v_accvgpr_write_b32 a19, v111
  v_accvgpr_write_b32 a20, v24
  v_accvgpr_write_b32 a21, v25
  v_accvgpr_write_b32 a22, v26
  v_accvgpr_write_b32 a23, v27
  s_nop 1
  s_mov_b32 s76, 0
  s_waitcnt lgkmcnt(3)
  v_mfma_f32_16x16x32_bf16 v[112:115], a[96:99], a[0:3], 0
  ds_read_b128 a[116:119], v6 offset:40960
  s_add_u32 m0, s58, 16384
  v_mfma_f32_16x16x32_bf16 v[116:119], a[96:99], a[4:7], 0
  ds_read_b128 a[120:123], v7 offset:32768
  s_add_u32 s68, s56, 4096
  v_mfma_f32_16x16x32_bf16 v[120:123], a[96:99], a[8:11], 0
  ds_read_b128 a[124:127], v7 offset:40960
  buffer_load_dwordx4 v16, s[28:31], s56 offen offset:0 nt lds
  v_mfma_f32_16x16x32_bf16 v[124:127], a[100:103], a[0:3], 0
  ds_read_b128 a[128:131], v4 offset:33024
  v_cvt_pk_bf16_f32 v0, v160, v161
  v_mfma_f32_16x16x32_bf16 v[128:131], a[100:103], a[4:7], 0
  ds_read_b128 a[132:135], v4 offset:41216
  buffer_load_dwordx4 v17, s[28:31], s56 offen offset:1024 nt lds
  v_mfma_f32_16x16x32_bf16 v[132:135], a[100:103], a[8:11], 0
  ds_read_b128 a[136:139], v5 offset:33024
  v_cvt_pk_bf16_f32 v1, v162, v163
  s_waitcnt lgkmcnt(7)
  v_mfma_f32_16x16x32_bf16 v[112:115], a[104:107], a[12:15], v[112:115]
  ds_read_b128 a[140:143], v5 offset:41216
  buffer_load_dwordx4 v18, s[28:31], s56 offen offset:2048 nt lds
  v_mfma_f32_16x16x32_bf16 v[116:119], a[104:107], a[16:19], v[116:119]
  ds_read_b128 a[144:147], v6 offset:33024
  v_cvt_pk_bf16_f32 v2, v172, v173
  v_mfma_f32_16x16x32_bf16 v[120:123], a[104:107], a[20:23], v[120:123]
  ds_read_b128 a[148:151], v6 offset:41216
  buffer_load_dwordx4 v19, s[28:31], s56 offen offset:3072 nt lds
  v_mfma_f32_16x16x32_bf16 v[124:127], a[108:111], a[12:15], v[124:127]
  ds_read_b128 a[152:155], v7 offset:33024
  s_add_u32 m0, s58, 20480
  v_mfma_f32_16x16x32_bf16 v[128:131], a[108:111], a[16:19], v[128:131]
  ds_read_b128 a[156:159], v7 offset:41216
  v_cvt_pk_bf16_f32 v3, v174, v175
  v_cvt_pk_bf16_f32 v108, v164, v165
  v_cvt_pk_bf16_f32 v109, v166, v167
  v_cvt_pk_bf16_f32 v110, v176, v177
  v_cvt_pk_bf16_f32 v111, v178, v179
  v_cvt_pk_bf16_f32 v24, v168, v169
  v_cvt_pk_bf16_f32 v25, v170, v171
  v_cvt_pk_bf16_f32 v26, v180, v181
  v_cvt_pk_bf16_f32 v27, v182, v183
  v_permlane32_swap_b32 v0, v2
  v_permlane32_swap_b32 v1, v3
  v_permlane32_swap_b32 v108, v110
  v_permlane32_swap_b32 v109, v111
  v_permlane32_swap_b32 v24, v26
  v_permlane32_swap_b32 v25, v27
  v_permlane16_swap_b32 v0, v2
  v_permlane16_swap_b32 v1, v3
  v_permlane16_swap_b32 v108, v110
  v_permlane16_swap_b32 v109, v111
  v_permlane16_swap_b32 v24, v26
  v_permlane16_swap_b32 v25, v27
  v_accvgpr_write_b32 a24, v0
  v_accvgpr_write_b32 a25, v1
  v_accvgpr_write_b32 a26, v2
  v_accvgpr_write_b32 a27, v3
  v_accvgpr_write_b32 a28, v108
  v_accvgpr_write_b32 a29, v109
  v_accvgpr_write_b32 a30, v110
  v_accvgpr_write_b32 a31, v111
  v_accvgpr_write_b32 a32, v24
  v_accvgpr_write_b32 a33, v25
  v_accvgpr_write_b32 a34, v26
  v_accvgpr_write_b32 a35, v27
  v_mfma_f32_16x16x32_bf16 v[132:135], a[108:111], a[20:23], v[132:135]
  s_add_u32 s56, s56, 16384
  buffer_load_dwordx4 v16, s[28:31], s68 offen offset:0 nt lds
  s_waitcnt lgkmcnt(10)
  v_mfma_f32_16x16x32_bf16 v[112:115], a[112:115], a[24:27], v[112:115]
  v_cvt_pk_bf16_f32 v0, v184, v185
  v_cvt_pk_bf16_f32 v1, v186, v187
  v_mfma_f32_16x16x32_bf16 v[116:119], a[112:115], a[28:31], v[116:119]
  buffer_load_dwordx4 v17, s[28:31], s68 offen offset:1024 nt lds
  v_mfma_f32_16x16x32_bf16 v[120:123], a[112:115], a[32:35], v[120:123]
  v_cvt_pk_bf16_f32 v2, v196, v197
  v_cvt_pk_bf16_f32 v3, v198, v199
  v_mfma_f32_16x16x32_bf16 v[124:127], a[116:119], a[24:27], v[124:127]
  s_waitcnt lgkmcnt(0)
  s_barrier
  v_mfma_f32_16x16x32_bf16 v[128:131], a[116:119], a[28:31], v[128:131]
  v_cvt_pk_bf16_f32 v108, v188, v189
  v_cvt_pk_bf16_f32 v109, v190, v191
  v_cvt_pk_bf16_f32 v110, v200, v201
  v_cvt_pk_bf16_f32 v111, v202, v203
  v_cvt_pk_bf16_f32 v24, v192, v193
  v_cvt_pk_bf16_f32 v25, v194, v195
  v_cvt_pk_bf16_f32 v26, v204, v205
  v_cvt_pk_bf16_f32 v27, v206, v207
  v_permlane32_swap_b32 v0, v2
  v_permlane32_swap_b32 v1, v3
  v_permlane32_swap_b32 v108, v110
  v_permlane32_swap_b32 v109, v111
  v_permlane32_swap_b32 v24, v26
  v_permlane32_swap_b32 v25, v27
  v_permlane16_swap_b32 v0, v2
  v_permlane16_swap_b32 v1, v3
  v_permlane16_swap_b32 v108, v110
  v_permlane16_swap_b32 v109, v111
  v_permlane16_swap_b32 v24, v26
  v_permlane16_swap_b32 v25, v27
  v_accvgpr_write_b32 a36, v0
  v_accvgpr_write_b32 a37, v1
  v_accvgpr_write_b32 a38, v2
  v_accvgpr_write_b32 a39, v3
  v_accvgpr_write_b32 a40, v108
  v_accvgpr_write_b32 a41, v109
  v_accvgpr_write_b32 a42, v110
  v_accvgpr_write_b32 a43, v111
  v_accvgpr_write_b32 a44, v24
  v_accvgpr_write_b32 a45, v25
  v_accvgpr_write_b32 a46, v26
  v_accvgpr_write_b32 a47, v27
  v_mfma_f32_16x16x32_bf16 v[132:135], a[116:119], a[32:35], v[132:135]
  buffer_load_dwordx4 v18, s[28:31], s68 offen offset:2048 nt lds
  v_mfma_f32_16x16x32_bf16 v[112:115], a[120:123], a[36:39], v[112:115]
  v_cvt_pk_bf16_f32 v0, v208, v209
  v_cvt_pk_bf16_f32 v1, v210, v211
  v_mfma_f32_16x16x32_bf16 v[116:119], a[120:123], a[40:43], v[116:119]
  buffer_load_dwordx4 v19, s[28:31], s68 offen offset:3072 nt lds
  v_mfma_f32_16x16x32_bf16 v[120:123], a[120:123], a[44:47], v[120:123]
  s_add_u32 m0, s58, 32768
  s_add_u32 s69, s57, 4096
  v_mfma_f32_16x16x32_bf16 v[124:127], a[124:127], a[36:39], v[124:127]
  buffer_load_dwordx4 v16, s[32:35], s57 offen offset:0 nt lds
  v_mfma_f32_16x16x32_bf16 v[128:131], a[124:127], a[40:43], v[128:131]
  v_cvt_pk_bf16_f32 v2, v220, v221
  v_cvt_pk_bf16_f32 v3, v222, v223
  v_cvt_pk_bf16_f32 v108, v212, v213
  v_cvt_pk_bf16_f32 v109, v214, v215
  v_cvt_pk_bf16_f32 v110, v224, v225
  v_cvt_pk_bf16_f32 v111, v226, v227
  v_cvt_pk_bf16_f32 v24, v216, v217
  v_cvt_pk_bf16_f32 v25, v218, v219
  v_cvt_pk_bf16_f32 v26, v228, v229
  v_cvt_pk_bf16_f32 v27, v230, v231
  v_permlane32_swap_b32 v0, v2
  v_permlane32_swap_b32 v1, v3
  v_permlane32_swap_b32 v108, v110
  v_permlane32_swap_b32 v109, v111
  v_permlane32_swap_b32 v24, v26
  v_permlane32_swap_b32 v25, v27
  v_permlane16_swap_b32 v0, v2
  v_permlane16_swap_b32 v1, v3
  v_permlane16_swap_b32 v108, v110
  v_permlane16_swap_b32 v109, v111
  v_permlane16_swap_b32 v24, v26
  v_permlane16_swap_b32 v25, v27
  v_accvgpr_write_b32 a48, v0
  v_accvgpr_write_b32 a49, v1
  v_accvgpr_write_b32 a50, v2
  v_accvgpr_write_b32 a51, v3
  v_accvgpr_write_b32 a52, v108
  v_accvgpr_write_b32 a53, v109
  v_accvgpr_write_b32 a54, v110
  v_accvgpr_write_b32 a55, v111
  v_accvgpr_write_b32 a56, v24
  v_accvgpr_write_b32 a57, v25
  v_accvgpr_write_b32 a58, v26
  v_accvgpr_write_b32 a59, v27
  v_mfma_f32_16x16x32_bf16 v[132:135], a[124:127], a[44:47], v[132:135]
  buffer_load_dwordx4 v17, s[32:35], s57 offen offset:1024 nt lds
  v_mfma_f32_16x16x32_bf16 v[112:115], a[128:131], a[48:51], v[112:115]
  v_cvt_pk_bf16_f32 v0, v232, v233
  v_cvt_pk_bf16_f32 v1, v234, v235
  v_mfma_f32_16x16x32_bf16 v[116:119], a[128:131], a[52:55], v[116:119]
  buffer_load_dwordx4 v18, s[32:35], s57 offen offset:2048 nt lds
  v_mfma_f32_16x16x32_bf16 v[120:123], a[128:131], a[56:59], v[120:123]
  v_cvt_pk_bf16_f32 v2, v244, v245
  v_cvt_pk_bf16_f32 v3, v246, v247
  v_mfma_f32_16x16x32_bf16 v[124:127], a[132:135], a[48:51], v[124:127]
  buffer_load_dwordx4 v19, s[32:35], s57 offen offset:3072 nt lds
  v_mfma_f32_16x16x32_bf16 v[128:131], a[132:135], a[52:55], v[128:131]
  v_cvt_pk_bf16_f32 v108, v236, v237
  v_cvt_pk_bf16_f32 v109, v238, v239
  v_cvt_pk_bf16_f32 v110, v248, v249
  v_cvt_pk_bf16_f32 v111, v250, v251
  v_cvt_pk_bf16_f32 v24, v240, v241
  v_cvt_pk_bf16_f32 v25, v242, v243
  v_cvt_pk_bf16_f32 v26, v252, v253
  v_cvt_pk_bf16_f32 v27, v254, v255
  v_permlane32_swap_b32 v0, v2
  v_permlane32_swap_b32 v1, v3
  v_permlane32_swap_b32 v108, v110
  v_permlane32_swap_b32 v109, v111
  v_permlane32_swap_b32 v24, v26
  v_permlane32_swap_b32 v25, v27
  v_permlane16_swap_b32 v0, v2
  v_permlane16_swap_b32 v1, v3
  v_permlane16_swap_b32 v108, v110
  v_permlane16_swap_b32 v109, v111
  v_permlane16_swap_b32 v24, v26
  v_permlane16_swap_b32 v25, v27
  v_accvgpr_write_b32 a60, v0
  v_accvgpr_write_b32 a61, v1
  v_accvgpr_write_b32 a62, v2
  v_accvgpr_write_b32 a63, v3
  v_accvgpr_write_b32 a64, v108
  v_accvgpr_write_b32 a65, v109
  v_accvgpr_write_b32 a66, v110
  v_accvgpr_write_b32 a67, v111
  v_accvgpr_write_b32 a68, v24
  v_accvgpr_write_b32 a69, v25
  v_accvgpr_write_b32 a70, v26
  v_accvgpr_write_b32 a71, v27
  v_mfma_f32_16x16x32_bf16 v[132:135], a[132:135], a[56:59], v[132:135]
  s_add_u32 m0, s58, 36864
  s_add_u32 s57, s57, 16384
  v_mfma_f32_16x16x32_bf16 v[112:115], a[136:139], a[60:63], v[112:115]
  buffer_load_dwordx4 v16, s[32:35], s69 offen offset:0 nt lds
  v_mfma_f32_16x16x32_bf16 v[116:119], a[136:139], a[64:67], v[116:119]
  v_cvt_pk_bf16_f32 v0, v32, v33
  v_cvt_pk_bf16_f32 v1, v34, v35
  v_mfma_f32_16x16x32_bf16 v[120:123], a[136:139], a[68:71], v[120:123]
  buffer_load_dwordx4 v17, s[32:35], s69 offen offset:1024 nt lds
  v_mfma_f32_16x16x32_bf16 v[124:127], a[140:143], a[60:63], v[124:127]
  v_cvt_pk_bf16_f32 v2, v44, v45
  v_cvt_pk_bf16_f32 v3, v46, v47
  v_mfma_f32_16x16x32_bf16 v[128:131], a[140:143], a[64:67], v[128:131]
  v_cvt_pk_bf16_f32 v108, v36, v37
  v_cvt_pk_bf16_f32 v109, v38, v39
  v_cvt_pk_bf16_f32 v110, v48, v49
  v_cvt_pk_bf16_f32 v111, v50, v51
  v_cvt_pk_bf16_f32 v24, v40, v41
  v_cvt_pk_bf16_f32 v25, v42, v43
  v_cvt_pk_bf16_f32 v26, v52, v53
  v_cvt_pk_bf16_f32 v27, v54, v55
  v_permlane32_swap_b32 v0, v2
  v_permlane32_swap_b32 v1, v3
  v_permlane32_swap_b32 v108, v110
  v_permlane32_swap_b32 v109, v111
  v_permlane32_swap_b32 v24, v26
  v_permlane32_swap_b32 v25, v27
  v_permlane16_swap_b32 v0, v2
  v_permlane16_swap_b32 v1, v3
  v_permlane16_swap_b32 v108, v110
  v_permlane16_swap_b32 v109, v111
  v_permlane16_swap_b32 v24, v26
  v_permlane16_swap_b32 v25, v27
  v_accvgpr_write_b32 a72, v0
  v_accvgpr_write_b32 a73, v1
  v_accvgpr_write_b32 a74, v2
  v_accvgpr_write_b32 a75, v3
  v_accvgpr_write_b32 a76, v108
  v_accvgpr_write_b32 a77, v109
  v_accvgpr_write_b32 a78, v110
  v_accvgpr_write_b32 a79, v111
  v_accvgpr_write_b32 a80, v24
  v_accvgpr_write_b32 a81, v25
  v_accvgpr_write_b32 a82, v26
  v_accvgpr_write_b32 a83, v27
  v_mfma_f32_16x16x32_bf16 v[132:135], a[140:143], a[68:71], v[132:135]
  buffer_load_dwordx4 v18, s[32:35], s69 offen offset:2048 nt lds
  v_mfma_f32_16x16x32_bf16 v[112:115], a[144:147], a[72:75], v[112:115]
  buffer_load_dwordx4 v19, s[32:35], s69 offen offset:3072 nt lds
  s_waitcnt vmcnt(24)
  s_barrier
  v_mfma_f32_16x16x32_bf16 v[116:119], a[144:147], a[76:79], v[116:119]
  ds_read_b128 a[96:99], v4 offset:49152
  v_cvt_pk_bf16_f32 v0, v56, v57
  v_mfma_f32_16x16x32_bf16 v[120:123], a[144:147], a[80:83], v[120:123]
  ds_read_b128 a[100:103], v5 offset:49152
  v_cvt_pk_bf16_f32 v1, v58, v59
  v_mfma_f32_16x16x32_bf16 v[124:127], a[148:151], a[72:75], v[124:127]
  ds_read_b128 a[104:107], v6 offset:49152
  v_cvt_pk_bf16_f32 v2, v68, v69
  v_mfma_f32_16x16x32_bf16 v[128:131], a[148:151], a[76:79], v[128:131]
  ds_read_b128 a[108:111], v7 offset:49152
  v_cvt_pk_bf16_f32 v3, v70, v71
  v_cvt_pk_bf16_f32 v108, v60, v61
  v_cvt_pk_bf16_f32 v109, v62, v63
  v_cvt_pk_bf16_f32 v110, v72, v73
  v_cvt_pk_bf16_f32 v111, v74, v75
  v_cvt_pk_bf16_f32 v24, v64, v65
  v_cvt_pk_bf16_f32 v25, v66, v67
  v_cvt_pk_bf16_f32 v26, v76, v77
  v_cvt_pk_bf16_f32 v27, v78, v79
  v_permlane32_swap_b32 v0, v2
  v_permlane32_swap_b32 v1, v3
  v_permlane32_swap_b32 v108, v110
  v_permlane32_swap_b32 v109, v111
  v_permlane32_swap_b32 v24, v26
  v_permlane32_swap_b32 v25, v27
  v_permlane16_swap_b32 v0, v2
  v_permlane16_swap_b32 v1, v3
  v_permlane16_swap_b32 v108, v110
  v_permlane16_swap_b32 v109, v111
  v_permlane16_swap_b32 v24, v26
  v_permlane16_swap_b32 v25, v27
  v_accvgpr_write_b32 a84, v0
  v_accvgpr_write_b32 a85, v1
  v_accvgpr_write_b32 a86, v2
  v_accvgpr_write_b32 a87, v3
  v_accvgpr_write_b32 a88, v108
  v_accvgpr_write_b32 a89, v109
  v_accvgpr_write_b32 a90, v110
  v_accvgpr_write_b32 a91, v111
  v_accvgpr_write_b32 a92, v24
  v_accvgpr_write_b32 a93, v25
  v_accvgpr_write_b32 a94, v26
  v_accvgpr_write_b32 a95, v27
  v_mfma_f32_16x16x32_bf16 v[132:135], a[148:151], a[80:83], v[132:135]
  ds_read_b128 a[112:115], v4 offset:49408
  v_mfma_f32_16x16x32_bf16 v[112:115], a[152:155], a[84:87], v[112:115]
  ds_read_b128 a[116:119], v5 offset:49408
  v_mfma_f32_16x16x32_bf16 v[116:119], a[152:155], a[88:91], v[116:119]
  ds_read_b128 a[120:123], v6 offset:49408
  v_mfma_f32_16x16x32_bf16 v[120:123], a[152:155], a[92:95], v[120:123]
  ds_read_b128 a[124:127], v7 offset:49408
  v_mfma_f32_16x16x32_bf16 v[124:127], a[156:159], a[84:87], v[124:127]
  ds_read_b128 a[128:131], v4 offset:57344
  v_mfma_f32_16x16x32_bf16 v[128:131], a[156:159], a[88:91], v[128:131]
  ds_read_b128 a[132:135], v5 offset:57344
  v_mfma_f32_16x16x32_bf16 v[132:135], a[156:159], a[92:95], v[132:135]
  ds_read_b128 a[136:139], v6 offset:57344
  s_waitcnt lgkmcnt(9)
  v_mfma_f32_16x16x32_bf16 v[32:35], a[96:99], a[0:3], 0
  ds_read_b128 a[140:143], v7 offset:57344
  v_mfma_f32_16x16x32_bf16 v[36:39], a[96:99], a[4:7], 0
  ds_read_b128 a[144:147], v4 offset:57600
  v_mfma_f32_16x16x32_bf16 v[40:43], a[96:99], a[8:11], 0
  ds_read_b128 a[148:151], v5 offset:57600
  v_mfma_f32_16x16x32_bf16 v[32:35], a[100:103], a[12:15], v[32:35]
  ds_read_b128 a[152:155], v6 offset:57600
  v_mfma_f32_16x16x32_bf16 v[36:39], a[100:103], a[16:19], v[36:39]
  ds_read_b128 a[156:159], v7 offset:57600
  v_mfma_f32_16x16x32_bf16 v[40:43], a[100:103], a[20:23], v[40:43]
  s_waitcnt lgkmcnt(12)
  v_mfma_f32_16x16x32_bf16 v[32:35], a[104:107], a[24:27], v[32:35]
  v_max3_f32 v136, v112, v113, v114
  v_max3_f32 v136, v136, v115, v124
  v_mfma_f32_16x16x32_bf16 v[36:39], a[104:107], a[28:31], v[36:39]
  v_max3_f32 v136, v136, v125, v126
  v_max_f32 v136, v136, v127
  v_mfma_f32_16x16x32_bf16 v[40:43], a[104:107], a[32:35], v[40:43]
  v_mov_b32 v137, v136
  s_nop 1
  v_permlane32_swap_b32 v136, v137
  v_mfma_f32_16x16x32_bf16 v[32:35], a[108:111], a[36:39], v[32:35]
  s_waitcnt lgkmcnt(0)
  s_barrier
  v_mfma_f32_16x16x32_bf16 v[36:39], a[108:111], a[40:43], v[36:39]
  s_add_u32 m0, s58, 49152
  s_add_u32 s68, s56, 4096
  v_mfma_f32_16x16x32_bf16 v[40:43], a[108:111], a[44:47], v[40:43]
  buffer_load_dwordx4 v16, s[28:31], s56 offen offset:0 nt lds
  v_mfma_f32_16x16x32_bf16 v[32:35], a[112:115], a[48:51], v[32:35]
  v_max_f32 v136, v136, v137
  v_max3_f32 v138, v116, v117, v118
  v_mfma_f32_16x16x32_bf16 v[36:39], a[112:115], a[52:55], v[36:39]
  buffer_load_dwordx4 v17, s[28:31], s56 offen offset:1024 nt lds
  v_mfma_f32_16x16x32_bf16 v[40:43], a[112:115], a[56:59], v[40:43]
  v_mov_b32 v137, v136
  s_nop 1
  v_permlane16_swap_b32 v136, v137
  v_mfma_f32_16x16x32_bf16 v[32:35], a[116:119], a[60:63], v[32:35]
  buffer_load_dwordx4 v18, s[28:31], s56 offen offset:2048 nt lds
  v_mfma_f32_16x16x32_bf16 v[36:39], a[116:119], a[64:67], v[36:39]
  v_max_f32 v136, v136, v137
  v_mul_f32 v23, s63, v136
  v_mfma_f32_16x16x32_bf16 v[40:43], a[116:119], a[68:71], v[40:43]
  buffer_load_dwordx4 v19, s[28:31], s56 offen offset:3072 nt lds
  v_mfma_f32_16x16x32_bf16 v[32:35], a[120:123], a[72:75], v[32:35]
  s_add_u32 m0, s58, 53248
  s_add_u32 s56, s56, 16384
  v_mfma_f32_16x16x32_bf16 v[36:39], a[120:123], a[76:79], v[36:39]
  buffer_load_dwordx4 v16, s[28:31], s68 offen offset:0 nt lds
  v_mfma_f32_16x16x32_bf16 v[40:43], a[120:123], a[80:83], v[40:43]
  v_fma_f32 v144, v112, s63, -v23
  v_fma_f32 v145, v113, s63, -v23
  v_mfma_f32_16x16x32_bf16 v[32:35], a[124:127], a[84:87], v[32:35]
  buffer_load_dwordx4 v17, s[28:31], s68 offen offset:1024 nt lds
  v_mfma_f32_16x16x32_bf16 v[36:39], a[124:127], a[88:91], v[36:39]
  v_fma_f32 v146, v114, s63, -v23
  v_fma_f32 v147, v115, s63, -v23
  v_mfma_f32_16x16x32_bf16 v[40:43], a[124:127], a[92:95], v[40:43]
  buffer_load_dwordx4 v18, s[28:31], s68 offen offset:2048 nt lds
  v_mfma_f32_16x16x32_bf16 v[44:47], a[128:131], a[0:3], 0
  v_exp_f32 v144, v144
  v_mfma_f32_16x16x32_bf16 v[48:51], a[128:131], a[4:7], 0
  buffer_load_dwordx4 v19, s[28:31], s68 offen offset:3072 nt lds
  v_mfma_f32_16x16x32_bf16 v[52:55], a[128:131], a[8:11], 0
  v_exp_f32 v145, v145
  v_mfma_f32_16x16x32_bf16 v[44:47], a[132:135], a[12:15], v[44:47]
  v_exp_f32 v146, v146
  v_exp_f32 v147, v147
  v_add_f32 v20, v144, v145
  v_cvt_pk_bf16_f32 v56, v144, v145
  v_add_f32 v20, v20, v146
  v_cvt_pk_bf16_f32 v57, v146, v147
  v_add_f32 v20, v20, v147
  v_fma_f32 v144, v124, s63, -v23
  v_fma_f32 v145, v125, s63, -v23
  v_fma_f32 v146, v126, s63, -v23
  v_fma_f32 v147, v127, s63, -v23
  v_exp_f32 v144, v144
  v_exp_f32 v145, v145
  v_exp_f32 v146, v146
  v_exp_f32 v147, v147
  v_add_f32 v20, v20, v144
  v_cvt_pk_bf16_f32 v58, v144, v145
  v_add_f32 v20, v20, v145
  v_add_f32 v20, v20, v146
  v_cvt_pk_bf16_f32 v59, v146, v147
  v_add_f32 v20, v20, v147
  v_max3_f32 v138, v138, v119, v128
  v_max3_f32 v138, v138, v129, v130
  v_max_f32 v138, v138, v131
  v_mov_b32 v139, v138
  s_nop 1
  v_permlane32_swap_b32 v138, v139
  v_max_f32 v138, v138, v139
  v_mov_b32 v139, v138
  s_nop 1
  v_permlane16_swap_b32 v138, v139
  v_max_f32 v138, v138, v139
  v_mul_f32 v24, s63, v138
  v_fma_f32 v148, v116, s63, -v24
  v_fma_f32 v149, v117, s63, -v24
  v_fma_f32 v150, v118, s63, -v24
  v_fma_f32 v151, v119, s63, -v24
  v_exp_f32 v148, v148
  v_exp_f32 v149, v149
  v_exp_f32 v150, v150
  v_exp_f32 v151, v151
  v_add_f32 v21, v148, v149
  v_cvt_pk_bf16_f32 v60, v148, v149
  v_add_f32 v21, v21, v150
  v_cvt_pk_bf16_f32 v61, v150, v151
  v_add_f32 v21, v21, v151
  v_fma_f32 v148, v128, s63, -v24
  v_fma_f32 v149, v129, s63, -v24
  v_fma_f32 v150, v130, s63, -v24
  v_fma_f32 v151, v131, s63, -v24
  v_exp_f32 v148, v148
  v_exp_f32 v149, v149
  v_exp_f32 v150, v150
  v_exp_f32 v151, v151
  v_add_f32 v21, v21, v148
  v_cvt_pk_bf16_f32 v62, v148, v149
  v_add_f32 v21, v21, v149
  v_add_f32 v21, v21, v150
  v_cvt_pk_bf16_f32 v63, v150, v151
  v_add_f32 v21, v21, v151
  v_max3_f32 v140, v120, v121, v122
  v_max3_f32 v140, v140, v123, v132
  v_max3_f32 v140, v140, v133, v134
  v_max_f32 v140, v140, v135
  v_mov_b32 v141, v140
  s_nop 1
  v_permlane32_swap_b32 v140, v141
  v_max_f32 v140, v140, v141
  v_mov_b32 v141, v140
  s_nop 1
  v_permlane16_swap_b32 v140, v141
  v_max_f32 v140, v140, v141
  v_mul_f32 v25, s63, v140
  v_fma_f32 v152, v120, s63, -v25
  v_fma_f32 v153, v121, s63, -v25
  v_fma_f32 v154, v122, s63, -v25
  v_fma_f32 v155, v123, s63, -v25
  v_exp_f32 v152, v152
  v_exp_f32 v153, v153
  v_exp_f32 v154, v154
  v_exp_f32 v155, v155
  v_add_f32 v22, v152, v153
  v_cvt_pk_bf16_f32 v64, v152, v153
  v_add_f32 v22, v22, v154
  v_cvt_pk_bf16_f32 v65, v154, v155
  v_add_f32 v22, v22, v155
  v_fma_f32 v152, v132, s63, -v25
  v_fma_f32 v153, v133, s63, -v25
  v_fma_f32 v154, v134, s63, -v25
  v_fma_f32 v155, v135, s63, -v25
  v_exp_f32 v152, v152
  v_exp_f32 v153, v153
  v_exp_f32 v154, v154
  v_exp_f32 v155, v155
  v_add_f32 v22, v22, v152
  v_cvt_pk_bf16_f32 v66, v152, v153
  v_add_f32 v22, v22, v153
  v_add_f32 v22, v22, v154
  v_cvt_pk_bf16_f32 v67, v154, v155
  v_add_f32 v22, v22, v155
  v_mfma_f32_16x16x32_bf16 v[48:51], a[132:135], a[16:19], v[48:51]
  v_mfma_f32_16x16x32_bf16 v[52:55], a[132:135], a[20:23], v[52:55]
  v_fma_f32 v0, v32, s63, -v23
  v_fma_f32 v1, v33, s63, -v23
  v_mfma_f32_16x16x32_bf16 v[44:47], a[136:139], a[24:27], v[44:47]
  v_fma_f32 v2, v34, s63, -v23
  v_fma_f32 v3, v35, s63, -v23
  v_mfma_f32_16x16x32_bf16 v[48:51], a[136:139], a[28:31], v[48:51]
  v_exp_f32 v0, v0
  v_mfma_f32_16x16x32_bf16 v[52:55], a[136:139], a[32:35], v[52:55]
  v_exp_f32 v1, v1
  v_mfma_f32_16x16x32_bf16 v[44:47], a[140:143], a[36:39], v[44:47]
  v_exp_f32 v2, v2
  v_mfma_f32_16x16x32_bf16 v[48:51], a[140:143], a[40:43], v[48:51]
  v_exp_f32 v3, v3
  v_mfma_f32_16x16x32_bf16 v[52:55], a[140:143], a[44:47], v[52:55]
  v_add_f32 v26, v0, v1
  v_cvt_pk_bf16_f32 v68, v0, v1
  v_mfma_f32_16x16x32_bf16 v[44:47], a[144:147], a[48:51], v[44:47]
  s_waitcnt vmcnt(24)
  s_barrier
  v_mfma_f32_16x16x32_bf16 v[48:51], a[144:147], a[52:55], v[48:51]
  ds_read_b64_tr_b16 a[96:97], v8 offset:0
  ds_read_b64_tr_b16 a[98:99], v8 offset:8192
  v_mfma_f32_16x16x32_bf16 v[52:55], a[144:147], a[56:59], v[52:55]
  ds_read_b64_tr_b16 a[100:101], v9 offset:0
  ds_read_b64_tr_b16 a[102:103], v9 offset:8192
  v_mfma_f32_16x16x32_bf16 v[44:47], a[148:151], a[60:63], v[44:47]
  ds_read_b64_tr_b16 a[104:105], v10 offset:0
  ds_read_b64_tr_b16 a[106:107], v10 offset:8192
  v_mfma_f32_16x16x32_bf16 v[48:51], a[148:151], a[64:67], v[48:51]
  ds_read_b64_tr_b16 a[108:109], v11 offset:0
  ds_read_b64_tr_b16 a[110:111], v11 offset:8192
  v_mfma_f32_16x16x32_bf16 v[52:55], a[148:151], a[68:71], v[52:55]
  ds_read_b64_tr_b16 a[112:113], v12 offset:0
  ds_read_b64_tr_b16 a[114:115], v12 offset:8192
  v_mfma_f32_16x16x32_bf16 v[44:47], a[152:155], a[72:75], v[44:47]
  ds_read_b64_tr_b16 a[116:117], v13 offset:0
  ds_read_b64_tr_b16 a[118:119], v13 offset:8192
  v_mfma_f32_16x16x32_bf16 v[48:51], a[152:155], a[76:79], v[48:51]
  s_waitcnt lgkmcnt(8)
  ds_read_b64_tr_b16 a[120:121], v14 offset:0
  ds_read_b64_tr_b16 a[122:123], v14 offset:8192
  v_mfma_f32_16x16x32_bf16 v[52:55], a[152:155], a[80:83], v[52:55]
  ds_read_b64_tr_b16 a[124:125], v15 offset:0
  ds_read_b64_tr_b16 a[126:127], v15 offset:8192
  v_mfma_f32_16x16x32_bf16 v[44:47], a[156:159], a[84:87], v[44:47]
  s_waitcnt lgkmcnt(8)
  ds_read_b64_tr_b16 a[128:129], v8 offset:256
  ds_read_b64_tr_b16 a[130:131], v8 offset:8448
  v_mfma_f32_16x16x32_bf16 v[48:51], a[156:159], a[88:91], v[48:51]
  ds_read_b64_tr_b16 a[132:133], v9 offset:256
  ds_read_b64_tr_b16 a[134:135], v9 offset:8448
  v_mfma_f32_16x16x32_bf16 v[52:55], a[156:159], a[92:95], v[52:55]
  s_waitcnt lgkmcnt(8)
  ds_read_b64_tr_b16 a[136:137], v10 offset:256
  ds_read_b64_tr_b16 a[138:139], v10 offset:8448
  v_add_f32 v26, v26, v2
  v_cvt_pk_bf16_f32 v69, v2, v3
  v_add_f32 v26, v26, v3
  v_fma_f32 v96, v36, s63, -v24
  v_fma_f32 v97, v37, s63, -v24
  v_fma_f32 v98, v38, s63, -v24
  v_fma_f32 v99, v39, s63, -v24
  v_exp_f32 v96, v96
  v_exp_f32 v97, v97
  v_exp_f32 v98, v98
  v_exp_f32 v99, v99
  v_add_f32 v27, v96, v97
  v_cvt_pk_bf16_f32 v72, v96, v97
  v_add_f32 v27, v27, v98
  v_cvt_pk_bf16_f32 v73, v98, v99
  v_add_f32 v27, v27, v99
  v_fma_f32 v108, v40, s63, -v25
  v_fma_f32 v109, v41, s63, -v25
  v_fma_f32 v110, v42, s63, -v25
  v_fma_f32 v111, v43, s63, -v25
  v_exp_f32 v108, v108
  v_exp_f32 v109, v109
  v_exp_f32 v110, v110
  v_exp_f32 v111, v111
  v_add_f32 v28, v108, v109
  v_cvt_pk_bf16_f32 v76, v108, v109
  v_add_f32 v28, v28, v110
  v_cvt_pk_bf16_f32 v77, v110, v111
  v_add_f32 v28, v28, v111
  v_mfma_f32_16x16x32_bf16 v[112:115], a[96:99], v[56:59], 0
  ds_read_b64_tr_b16 a[140:141], v11 offset:256
  ds_read_b64_tr_b16 a[142:143], v11 offset:8448
  v_mfma_f32_16x16x32_bf16 v[116:119], a[96:99], v[60:63], 0
  s_waitcnt lgkmcnt(8)
  ds_read_b64_tr_b16 a[144:145], v12 offset:256
  ds_read_b64_tr_b16 a[146:147], v12 offset:8448
  v_mfma_f32_16x16x32_bf16 v[120:123], a[96:99], v[64:67], 0
  ds_read_b64_tr_b16 a[148:149], v13 offset:256
  ds_read_b64_tr_b16 a[150:151], v13 offset:8448
  v_mfma_f32_16x16x32_bf16 v[124:127], a[100:103], v[56:59], 0
  s_waitcnt lgkmcnt(8)
  ds_read_b64_tr_b16 a[152:153], v14 offset:256
  ds_read_b64_tr_b16 a[154:155], v14 offset:8448
  v_mfma_f32_16x16x32_bf16 v[128:131], a[100:103], v[60:63], 0
  ds_read_b64_tr_b16 a[156:157], v15 offset:256
  ds_read_b64_tr_b16 a[158:159], v15 offset:8448
  v_mfma_f32_16x16x32_bf16 v[132:135], a[100:103], v[64:67], 0
  v_fma_f32 v0, v44, s63, -v23
  v_fma_f32 v1, v45, s63, -v23
  v_mfma_f32_16x16x32_bf16 v[136:139], a[104:107], v[56:59], 0
  v_fma_f32 v2, v46, s63, -v23
  v_fma_f32 v3, v47, s63, -v23
  v_mfma_f32_16x16x32_bf16 v[140:143], a[104:107], v[60:63], 0
  v_exp_f32 v0, v0
  v_mfma_f32_16x16x32_bf16 v[144:147], a[104:107], v[64:67], 0
  v_exp_f32 v1, v1
  v_mfma_f32_16x16x32_bf16 v[148:151], a[108:111], v[56:59], 0
  s_waitcnt lgkmcnt(0)
  s_barrier
  v_mfma_f32_16x16x32_bf16 v[152:155], a[108:111], v[60:63], 0
  s_add_u32 m0, s58, 0
  s_add_u32 s69, s57, 4096
  v_mfma_f32_16x16x32_bf16 v[156:159], a[108:111], v[64:67], 0
  buffer_load_dwordx4 v16, s[32:35], s57 offen offset:0 nt lds
  v_mfma_f32_16x16x32_bf16 v[160:163], a[112:115], v[56:59], 0
  v_exp_f32 v2, v2
  v_mfma_f32_16x16x32_bf16 v[164:167], a[112:115], v[60:63], 0
  buffer_load_dwordx4 v17, s[32:35], s57 offen offset:1024 nt lds
  v_mfma_f32_16x16x32_bf16 v[168:171], a[112:115], v[64:67], 0
  v_exp_f32 v3, v3
  v_mfma_f32_16x16x32_bf16 v[172:175], a[116:119], v[56:59], 0
  buffer_load_dwordx4 v18, s[32:35], s57 offen offset:2048 nt lds
  v_mfma_f32_16x16x32_bf16 v[176:179], a[116:119], v[60:63], 0
  v_add_f32 v26, v26, v0
  v_cvt_pk_bf16_f32 v70, v0, v1
  v_mfma_f32_16x16x32_bf16 v[180:183], a[116:119], v[64:67], 0
  buffer_load_dwordx4 v19, s[32:35], s57 offen offset:3072 nt lds
  v_mfma_f32_16x16x32_bf16 v[184:187], a[120:123], v[56:59], 0
  s_add_u32 m0, s58, 4096
  s_add_u32 s57, s57, 16384
  v_mfma_f32_16x16x32_bf16 v[188:191], a[120:123], v[60:63], 0
  buffer_load_dwordx4 v16, s[32:35], s69 offen offset:0 nt lds
  v_mfma_f32_16x16x32_bf16 v[192:195], a[120:123], v[64:67], 0
  v_add_f32 v26, v26, v1
  v_add_f32 v26, v26, v2
  v_mfma_f32_16x16x32_bf16 v[196:199], a[124:127], v[56:59], 0
  buffer_load_dwordx4 v17, s[32:35], s69 offen offset:1024 nt lds
  v_mfma_f32_16x16x32_bf16 v[200:203], a[124:127], v[60:63], 0
  v_cvt_pk_bf16_f32 v71, v2, v3
  v_add_f32 v26, v26, v3
  v_mfma_f32_16x16x32_bf16 v[204:207], a[124:127], v[64:67], 0
  buffer_load_dwordx4 v18, s[32:35], s69 offen offset:2048 nt lds
  v_mfma_f32_16x16x32_bf16 v[208:211], a[128:131], v[56:59], 0
  v_fma_f32 v96, v48, s63, -v24
  v_fma_f32 v97, v49, s63, -v24
  v_mfma_f32_16x16x32_bf16 v[212:215], a[128:131], v[60:63], 0
  buffer_load_dwordx4 v19, s[32:35], s69 offen offset:3072 nt lds
  v_mfma_f32_16x16x32_bf16 v[216:219], a[128:131], v[64:67], 0
  v_fma_f32 v98, v50, s63, -v24
  v_fma_f32 v99, v51, s63, -v24
  v_mfma_f32_16x16x32_bf16 v[220:223], a[132:135], v[56:59], 0
  v_exp_f32 v96, v96
  v_mfma_f32_16x16x32_bf16 v[224:227], a[132:135], v[60:63], 0
  v_exp_f32 v97, v97
  v_mfma_f32_16x16x32_bf16 v[228:231], a[132:135], v[64:67], 0
  v_exp_f32 v98, v98
  v_mfma_f32_16x16x32_bf16 v[232:235], a[136:139], v[56:59], 0
  v_exp_f32 v99, v99
  v_mfma_f32_16x16x32_bf16 v[236:239], a[136:139], v[60:63], 0
  v_add_f32 v27, v27, v96
  v_cvt_pk_bf16_f32 v74, v96, v97
  v_mfma_f32_16x16x32_bf16 v[240:243], a[136:139], v[64:67], 0
  v_add_f32 v27, v27, v97
  v_add_f32 v27, v27, v98
  v_mfma_f32_16x16x32_bf16 v[244:247], a[140:143], v[56:59], 0
  v_cvt_pk_bf16_f32 v75, v98, v99
  v_add_f32 v27, v27, v99
  v_mfma_f32_16x16x32_bf16 v[248:251], a[140:143], v[60:63], 0
  v_fma_f32 v108, v52, s63, -v25
  v_fma_f32 v109, v53, s63, -v25
  v_mfma_f32_16x16x32_bf16 v[252:255], a[140:143], v[64:67], 0
  v_fma_f32 v110, v54, s63, -v25
  v_fma_f32 v111, v55, s63, -v25
  v_mfma_f32_16x16x32_bf16 a[160:163], a[144:147], v[56:59], 0
  s_waitcnt vmcnt(24)
  s_barrier
  v_mfma_f32_16x16x32_bf16 a[164:167], a[144:147], v[60:63], 0
  ds_read_b128 a[96:99], v4 offset:16384
  v_mfma_f32_16x16x32_bf16 a[168:171], a[144:147], v[64:67], 0
  ds_read_b128 a[100:103], v5 offset:16384
  v_mfma_f32_16x16x32_bf16 a[172:175], a[148:151], v[56:59], 0
  ds_read_b128 a[104:107], v6 offset:16384
  v_mfma_f32_16x16x32_bf16 a[176:179], a[148:151], v[60:63], 0
  ds_read_b128 a[108:111], v7 offset:16384
  v_mfma_f32_16x16x32_bf16 a[180:183], a[148:151], v[64:67], 0
  ds_read_b128 a[112:115], v4 offset:16640
  v_mfma_f32_16x16x32_bf16 a[184:187], a[152:155], v[56:59], 0
  ds_read_b128 a[116:119], v5 offset:16640
  v_mfma_f32_16x16x32_bf16 a[188:191], a[152:155], v[60:63], 0
  ds_read_b128 a[120:123], v6 offset:16640
  v_mfma_f32_16x16x32_bf16 a[192:195], a[152:155], v[64:67], 0
  ds_read_b128 a[124:127], v7 offset:16640
  v_mfma_f32_16x16x32_bf16 a[196:199], a[156:159], v[56:59], 0
  ds_read_b128 a[128:131], v4 offset:24576
  v_mfma_f32_16x16x32_bf16 a[200:203], a[156:159], v[60:63], 0
  ds_read_b128 a[132:135], v5 offset:24576
  v_mfma_f32_16x16x32_bf16 a[204:207], a[156:159], v[64:67], 0
  ds_read_b128 a[136:139], v6 offset:24576
  v_exp_f32 v108, v108
  v_exp_f32 v109, v109
  v_exp_f32 v110, v110
  v_exp_f32 v111, v111
  v_add_f32 v28, v28, v108
  v_cvt_pk_bf16_f32 v78, v108, v109
  v_add_f32 v28, v28, v109
  v_add_f32 v28, v28, v110
  v_cvt_pk_bf16_f32 v79, v110, v111
  v_add_f32 v28, v28, v111
  v_max3_f32 v29, v26, v27, v28
  v_cmp_lt_f32 vcc, 0x44800000, v29
  s_nop 0
  s_cbranch_vccz L_ok1
  s_swappc_b64 s[70:71], s[74:75]
L_ok1:
  v_add_f32 v20, v20, v26
  v_add_f32 v21, v21, v27
  v_add_f32 v22, v22, v28
  s_waitcnt lgkmcnt(9)
  v_mfma_f32_16x16x32_bf16 v[32:35], a[96:99], a[0:3], 0
  ds_read_b128 a[140:143], v7 offset:24576
  v_mfma_f32_16x16x32_bf16 v[36:39], a[96:99], a[4:7], 0
  ds_read_b128 a[144:147], v4 offset:24832
  v_mfma_f32_16x16x32_bf16 v[40:43], a[96:99], a[8:11], 0
  ds_read_b128 a[148:151], v5 offset:24832
  v_mfma_f32_16x16x32_bf16 v[32:35], a[100:103], a[12:15], v[32:35]
  ds_read_b128 a[152:155], v6 offset:24832
  v_mfma_f32_16x16x32_bf16 v[36:39], a[100:103], a[16:19], v[36:39]
  ds_read_b128 a[156:159], v7 offset:24832
  v_mfma_f32_16x16x32_bf16 v[40:43], a[100:103], a[20:23], v[40:43]
  s_waitcnt lgkmcnt(12)
  v_mfma_f32_16x16x32_bf16 v[32:35], a[104:107], a[24:27], v[32:35]
  v_mfma_f32_16x16x32_bf16 v[36:39], a[104:107], a[28:31], v[36:39]
  v_mfma_f32_16x16x32_bf16 v[40:43], a[104:107], a[32:35], v[40:43]
  v_mfma_f32_16x16x32_bf16 v[32:35], a[108:111], a[36:39], v[32:35]
  s_waitcnt lgkmcnt(0)
  s_barrier
  v_mfma_f32_16x16x32_bf16 v[36:39], a[108:111], a[40:43], v[36:39]
  s_add_u32 m0, s58, 16384
  s_add_u32 s68, s56, 4096
  v_mfma_f32_16x16x32_bf16 v[40:43], a[108:111], a[44:47], v[40:43]
  buffer_load_dwordx4 v16, s[28:31], s56 offen offset:0 nt lds
  v_mfma_f32_16x16x32_bf16 v[32:35], a[112:115], a[48:51], v[32:35]
  v_mfma_f32_16x16x32_bf16 v[36:39], a[112:115], a[52:55], v[36:39]
  buffer_load_dwordx4 v17, s[28:31], s56 offen offset:1024 nt lds
  v_mfma_f32_16x16x32_bf16 v[40:43], a[112:115], a[56:59], v[40:43]
  v_mfma_f32_16x16x32_bf16 v[32:35], a[116:119], a[60:63], v[32:35]
  buffer_load_dwordx4 v18, s[28:31], s56 offen offset:2048 nt lds
  v_mfma_f32_16x16x32_bf16 v[36:39], a[116:119], a[64:67], v[36:39]
  v_mfma_f32_16x16x32_bf16 v[40:43], a[116:119], a[68:71], v[40:43]
  buffer_load_dwordx4 v19, s[28:31], s56 offen offset:3072 nt lds
  v_mfma_f32_16x16x32_bf16 v[32:35], a[120:123], a[72:75], v[32:35]
  s_add_u32 m0, s58, 20480
  s_add_u32 s56, s56, 16384
  v_mfma_f32_16x16x32_bf16 v[36:39], a[120:123], a[76:79], v[36:39]
  buffer_load_dwordx4 v16, s[28:31], s68 offen offset:0 nt lds
  v_mfma_f32_16x16x32_bf16 v[40:43], a[120:123], a[80:83], v[40:43]
  v_mfma_f32_16x16x32_bf16 v[32:35], a[124:127], a[84:87], v[32:35]
  buffer_load_dwordx4 v17, s[28:31], s68 offen offset:1024 nt lds
  v_mfma_f32_16x16x32_bf16 v[36:39], a[124:127], a[88:91], v[36:39]
  v_mfma_f32_16x16x32_bf16 v[40:43], a[124:127], a[92:95], v[40:43]
  buffer_load_dwordx4 v18, s[28:31], s68 offen offset:2048 nt lds
  v_mfma_f32_16x16x32_bf16 v[44:47], a[128:131], a[0:3], 0
  v_mfma_f32_16x16x32_bf16 v[48:51], a[128:131], a[4:7], 0
  buffer_load_dwordx4 v19, s[28:31], s68 offen offset:3072 nt lds
  v_mfma_f32_16x16x32_bf16 v[52:55], a[128:131], a[8:11], 0
  v_mfma_f32_16x16x32_bf16 v[44:47], a[132:135], a[12:15], v[44:47]
  v_mfma_f32_16x16x32_bf16 v[48:51], a[132:135], a[16:19], v[48:51]
  v_mfma_f32_16x16x32_bf16 v[52:55], a[132:135], a[20:23], v[52:55]
  v_fma_f32 v0, v32, s63, -v23
  v_fma_f32 v1, v33, s63, -v23
  v_mfma_f32_16x16x32_bf16 v[44:47], a[136:139], a[24:27], v[44:47]
  v_fma_f32 v2, v34, s63, -v23
  v_fma_f32 v3, v35, s63, -v23
  v_mfma_f32_16x16x32_bf16 v[48:51], a[136:139], a[28:31], v[48:51]
  v_exp_f32 v0, v0
  v_mfma_f32_16x16x32_bf16 v[52:55], a[136:139], a[32:35], v[52:55]
  v_exp_f32 v1, v1
  v_mfma_f32_16x16x32_bf16 v[44:47], a[140:143], a[36:39], v[44:47]
  v_exp_f32 v2, v2
  v_mfma_f32_16x16x32_bf16 v[48:51], a[140:143], a[40:43], v[48:51]
  v_exp_f32 v3, v3
  v_mfma_f32_16x16x32_bf16 v[52:55], a[140:143], a[44:47], v[52:55]
  v_add_f32 v26, v0, v1
  v_cvt_pk_bf16_f32 v56, v0, v1
  v_mfma_f32_16x16x32_bf16 v[44:47], a[144:147], a[48:51], v[44:47]
  s_waitcnt vmcnt(24)
  s_barrier
  v_mfma_f32_16x16x32_bf16 v[48:51], a[144:147], a[52:55], v[48:51]
  ds_read_b64_tr_b16 a[96:97], v8 offset:32768
  ds_read_b64_tr_b16 a[98:99], v8 offset:40960
  v_mfma_f32_16x16x32_bf16 v[52:55], a[144:147], a[56:59], v[52:55]
  ds_read_b64_tr_b16 a[100:101], v9 offset:32768
  ds_read_b64_tr_b16 a[102:103], v9 offset:40960
  v_mfma_f32_16x16x32_bf16 v[44:47], a[148:151], a[60:63], v[44:47]
  ds_read_b64_tr_b16 a[104:105], v10 offset:32768
  ds_read_b64_tr_b16 a[106:107], v10 offset:40960
  v_mfma_f32_16x16x32_bf16 v[48:51], a[148:151], a[64:67], v[48:51]
  ds_read_b64_tr_b16 a[108:109], v11 offset:32768
  ds_read_b64_tr_b16 a[110:111], v11 offset:40960
  v_mfma_f32_16x16x32_bf16 v[52:55], a[148:151], a[68:71], v[52:55]
  ds_read_b64_tr_b16 a[112:113], v12 offset:32768
  ds_read_b64_tr_b16 a[114:115], v12 offset:40960
  v_mfma_f32_16x16x32_bf16 v[44:47], a[152:155], a[72:75], v[44:47]
  ds_read_b64_tr_b16 a[116:117], v13 offset:32768
  ds_read_b64_tr_b16 a[118:119], v13 offset:40960
  v_mfma_f32_16x16x32_bf16 v[48:51], a[152:155], a[76:79], v[48:51]
  s_waitcnt lgkmcnt(8)
  ds_read_b64_tr_b16 a[120:121], v14 offset:32768
  ds_read_b64_tr_b16 a[122:123], v14 offset:40960
  v_mfma_f32_16x16x32_bf16 v[52:55], a[152:155], a[80:83], v[52:55]
  ds_read_b64_tr_b16 a[124:125], v15 offset:32768
  ds_read_b64_tr_b16 a[126:127], v15 offset:40960
  v_mfma_f32_16x16x32_bf16 v[44:47], a[156:159], a[84:87], v[44:47]
  s_waitcnt lgkmcnt(8)
  ds_read_b64_tr_b16 a[128:129], v8 offset:33024
  ds_read_b64_tr_b16 a[130:131], v8 offset:41216
  v_mfma_f32_16x16x32_bf16 v[48:51], a[156:159], a[88:91], v[48:51]
  ds_read_b64_tr_b16 a[132:133], v9 offset:33024
  ds_read_b64_tr_b16 a[134:135], v9 offset:41216
  v_mfma_f32_16x16x32_bf16 v[52:55], a[156:159], a[92:95], v[52:55]
  s_waitcnt lgkmcnt(8)
  ds_read_b64_tr_b16 a[136:137], v10 offset:33024
  ds_read_b64_tr_b16 a[138:139], v10 offset:41216
  v_add_f32 v26, v26, v2
  v_cvt_pk_bf16_f32 v57, v2, v3
  v_add_f32 v26, v26, v3
  v_fma_f32 v96, v36, s63, -v24
  v_fma_f32 v97, v37, s63, -v24
  v_fma_f32 v98, v38, s63, -v24
  v_fma_f32 v99, v39, s63, -v24
  v_exp_f32 v96, v96
  v_exp_f32 v97, v97
  v_exp_f32 v98, v98
  v_exp_f32 v99, v99
  v_add_f32 v27, v96, v97
  v_cvt_pk_bf16_f32 v60, v96, v97
  v_add_f32 v27, v27, v98
  v_cvt_pk_bf16_f32 v61, v98, v99
  v_add_f32 v27, v27, v99
  v_fma_f32 v108, v40, s63, -v25
  v_fma_f32 v109, v41, s63, -v25
  v_fma_f32 v110, v42, s63, -v25
  v_fma_f32 v111, v43, s63, -v25
  v_exp_f32 v108, v108
  v_exp_f32 v109, v109
  v_exp_f32 v110, v110
  v_exp_f32 v111, v111
  v_add_f32 v28, v108, v109
  v_cvt_pk_bf16_f32 v64, v108, v109
  v_add_f32 v28, v28, v110
  v_cvt_pk_bf16_f32 v65, v110, v111
  v_add_f32 v28, v28, v111
  v_mfma_f32_16x16x32_bf16 v[112:115], a[96:99], v[68:71], v[112:115]
  ds_read_b64_tr_b16 a[140:141], v11 offset:33024
  ds_read_b64_tr_b16 a[142:143], v11 offset:41216
  v_mfma_f32_16x16x32_bf16 v[116:119], a[96:99], v[72:75], v[116:119]
  s_waitcnt lgkmcnt(8)
  ds_read_b64_tr_b16 a[144:145], v12 offset:33024
  ds_read_b64_tr_b16 a[146:147], v12 offset:41216
  v_mfma_f32_16x16x32_bf16 v[120:123], a[96:99], v[76:79], v[120:123]
  ds_read_b64_tr_b16 a[148:149], v13 offset:33024
  ds_read_b64_tr_b16 a[150:151], v13 offset:41216
  v_mfma_f32_16x16x32_bf16 v[124:127], a[100:103], v[68:71], v[124:127]
  s_waitcnt lgkmcnt(8)
  ds_read_b64_tr_b16 a[152:153], v14 offset:33024
  ds_read_b64_tr_b16 a[154:155], v14 offset:41216
  v_mfma_f32_16x16x32_bf16 v[128:131], a[100:103], v[72:75], v[128:131]
  ds_read_b64_tr_b16 a[156:157], v15 offset:33024
  ds_read_b64_tr_b16 a[158:159], v15 offset:41216
  v_mfma_f32_16x16x32_bf16 v[132:135], a[100:103], v[76:79], v[132:135]
  v_fma_f32 v0, v44, s63, -v23
  v_fma_f32 v1, v45, s63, -v23
  v_mfma_f32_16x16x32_bf16 v[136:139], a[104:107], v[68:71], v[136:139]
  v_fma_f32 v2, v46, s63, -v23
  v_fma_f32 v3, v47, s63, -v23
  v_mfma_f32_16x16x32_bf16 v[140:143], a[104:107], v[72:75], v[140:143]
  v_exp_f32 v0, v0
  v_mfma_f32_16x16x32_bf16 v[144:147], a[104:107], v[76:79], v[144:147]
  v_exp_f32 v1, v1
  v_mfma_f32_16x16x32_bf16 v[148:151], a[108:111], v[68:71], v[148:151]
  s_waitcnt lgkmcnt(0)
  s_barrier
  v_mfma_f32_16x16x32_bf16 v[152:155], a[108:111], v[72:75], v[152:155]
  s_add_u32 m0, s58, 32768
  s_add_u32 s69, s57, 4096
  v_mfma_f32_16x16x32_bf16 v[156:159], a[108:111], v[76:79], v[156:159]
  buffer_load_dwordx4 v16, s[32:35], s57 offen offset:0 nt lds
  v_mfma_f32_16x16x32_bf16 v[160:163], a[112:115], v[68:71], v[160:163]
  v_exp_f32 v2, v2
  v_mfma_f32_16x16x32_bf16 v[164:167], a[112:115], v[72:75], v[164:167]
  buffer_load_dwordx4 v17, s[32:35], s57 offen offset:1024 nt lds
  v_mfma_f32_16x16x32_bf16 v[168:171], a[112:115], v[76:79], v[168:171]
  v_exp_f32 v3, v3
  v_mfma_f32_16x16x32_bf16 v[172:175], a[116:119], v[68:71], v[172:175]
  buffer_load_dwordx4 v18, s[32:35], s57 offen offset:2048 nt lds
  v_mfma_f32_16x16x32_bf16 v[176:179], a[116:119], v[72:75], v[176:179]
  v_add_f32 v26, v26, v0
  v_cvt_pk_bf16_f32 v58, v0, v1
  v_mfma_f32_16x16x32_bf16 v[180:183], a[116:119], v[76:79], v[180:183]
  buffer_load_dwordx4 v19, s[32:35], s57 offen offset:3072 nt lds
  v_mfma_f32_16x16x32_bf16 v[184:187], a[120:123], v[68:71], v[184:187]
  s_add_u32 m0, s58, 36864
  s_add_u32 s57, s57, 16384
  v_mfma_f32_16x16x32_bf16 v[188:191], a[120:123], v[72:75], v[188:191]
  buffer_load_dwordx4 v16, s[32:35], s69 offen offset:0 nt lds
  v_mfma_f32_16x16x32_bf16 v[192:195], a[120:123], v[76:79], v[192:195]
  v_add_f32 v26, v26, v1
  v_add_f32 v26, v26, v2
  v_mfma_f32_16x16x32_bf16 v[196:199], a[124:127], v[68:71], v[196:199]
  buffer_load_dwordx4 v17, s[32:35], s69 offen offset:1024 nt lds
  v_mfma_f32_16x16x32_bf16 v[200:203], a[124:127], v[72:75], v[200:203]
  v_cvt_pk_bf16_f32 v59, v2, v3
  v_add_f32 v26, v26, v3
  v_mfma_f32_16x16x32_bf16 v[204:207], a[124:127], v[76:79], v[204:207]
  buffer_load_dwordx4 v18, s[32:35], s69 offen offset:2048 nt lds
  v_mfma_f32_16x16x32_bf16 v[208:211], a[128:131], v[68:71], v[208:211]
  v_fma_f32 v96, v48, s63, -v24
  v_fma_f32 v97, v49, s63, -v24
  v_mfma_f32_16x16x32_bf16 v[212:215], a[128:131], v[72:75], v[212:215]
  buffer_load_dwordx4 v19, s[32:35], s69 offen offset:3072 nt lds
  v_mfma_f32_16x16x32_bf16 v[216:219], a[128:131], v[76:79], v[216:219]
  v_fma_f32 v98, v50, s63, -v24
  v_fma_f32 v99, v51, s63, -v24
  v_mfma_f32_16x16x32_bf16 v[220:223], a[132:135], v[68:71], v[220:223]
  v_exp_f32 v96, v96
  v_mfma_f32_16x16x32_bf16 v[224:227], a[132:135], v[72:75], v[224:227]
  v_exp_f32 v97, v97
  v_mfma_f32_16x16x32_bf16 v[228:231], a[132:135], v[76:79], v[228:231]
  v_exp_f32 v98, v98
  v_mfma_f32_16x16x32_bf16 v[232:235], a[136:139], v[68:71], v[232:235]
  v_exp_f32 v99, v99
  v_mfma_f32_16x16x32_bf16 v[236:239], a[136:139], v[72:75], v[236:239]
  v_add_f32 v27, v27, v96
  v_cvt_pk_bf16_f32 v62, v96, v97
  v_mfma_f32_16x16x32_bf16 v[240:243], a[136:139], v[76:79], v[240:243]
  v_add_f32 v27, v27, v97
  v_add_f32 v27, v27, v98
  v_mfma_f32_16x16x32_bf16 v[244:247], a[140:143], v[68:71], v[244:247]
  v_cvt_pk_bf16_f32 v63, v98, v99
  v_add_f32 v27, v27, v99
  v_mfma_f32_16x16x32_bf16 v[248:251], a[140:143], v[72:75], v[248:251]
  v_fma_f32 v108, v52, s63, -v25
  v_fma_f32 v109, v53, s63, -v25
  v_mfma_f32_16x16x32_bf16 v[252:255], a[140:143], v[76:79], v[252:255]
  v_fma_f32 v110, v54, s63, -v25
  v_fma_f32 v111, v55, s63, -v25
  v_mfma_f32_16x16x32_bf16 a[160:163], a[144:147], v[68:71], a[160:163]
  s_waitcnt vmcnt(24)
  s_barrier
  v_mfma_f32_16x16x32_bf16 a[164:167], a[144:147], v[72:75], a[164:167]
  ds_read_b128 a[96:99], v4 offset:49152
  v_mfma_f32_16x16x32_bf16 a[168:171], a[144:147], v[76:79], a[168:171]
  ds_read_b128 a[100:103], v5 offset:49152
  v_mfma_f32_16x16x32_bf16 a[172:175], a[148:151], v[68:71], a[172:175]
  ds_read_b128 a[104:107], v6 offset:49152
  v_mfma_f32_16x16x32_bf16 a[176:179], a[148:151], v[72:75], a[176:179]
  ds_read_b128 a[108:111], v7 offset:49152
  v_mfma_f32_16x16x32_bf16 a[180:183], a[148:151], v[76:79], a[180:183]
  ds_read_b128 a[112:115], v4 offset:49408
  v_mfma_f32_16x16x32_bf16 a[184:187], a[152:155], v[68:71], a[184:187]
  ds_read_b128 a[116:119], v5 offset:49408
  v_mfma_f32_16x16x32_bf16 a[188:191], a[152:155], v[72:75], a[188:191]
  ds_read_b128 a[120:123], v6 offset:49408
  v_mfma_f32_16x16x32_bf16 a[192:195], a[152:155], v[76:79], a[192:195]
  ds_read_b128 a[124:127], v7 offset:49408
  v_mfma_f32_16x16x32_bf16 a[196:199], a[156:159], v[68:71], a[196:199]
  ds_read_b128 a[128:131], v4 offset:57344
  v_mfma_f32_16x16x32_bf16 a[200:203], a[156:159], v[72:75], a[200:203]
  ds_read_b128 a[132:135], v5 offset:57344
  v_mfma_f32_16x16x32_bf16 a[204:207], a[156:159], v[76:79], a[204:207]
  ds_read_b128 a[136:139], v6 offset:57344
  v_exp_f32 v108, v108
  v_exp_f32 v109, v109
  v_exp_f32 v110, v110
  v_exp_f32 v111, v111
  v_add_f32 v28, v28, v108
  v_cvt_pk_bf16_f32 v66, v108, v109
  v_add_f32 v28, v28, v109
  v_add_f32 v28, v28, v110
  v_cvt_pk_bf16_f32 v67, v110, v111
  v_add_f32 v28, v28, v111
  v_max3_f32 v29, v26, v27, v28
  v_cmp_lt_f32 vcc, 0x44800000, v29
  s_nop 0
  s_cbranch_vccz L_ok2
  s_swappc_b64 s[70:71], s[72:73]
L_ok2:
  v_add_f32 v20, v20, v26
  v_add_f32 v21, v21, v27
  v_add_f32 v22, v22, v28
  v_mbcnt_lo_u32_b32 v107, -1, 0
  v_mbcnt_hi_u32_b32 v107, -1, v107
  v_lshrrev_b32 v100, 4, v107
  v_and_b32 v95, 15, v107
  v_lshrrev_b32 v101, 2, v95
  v_and_b32 v102, 3, v107
  v_lshrrev_b32 v103, 5, v107
  v_and_b32 v104, 31, v107
  v_lshl_add_u32 v105, v100, 2, v101
  v_bfe_u32 v106, v105, 1, 2
  v_lshlrev_b32 v105, 7, v105
  v_lshl_add_u32 v105, v102, 3, v105
  v_xor_b32 v80, 0, v106
  v_lshl_add_u32 v80, v80, 5, v105
  v_add_u32 v84, 0x10000, v80
  v_xor_b32 v81, 1, v106
  v_lshl_add_u32 v81, v81, 5, v105
  v_add_u32 v85, 0x10000, v81
  v_xor_b32 v82, 2, v106
  v_lshl_add_u32 v82, v82, 5, v105
  v_add_u32 v86, 0x10000, v82
  v_xor_b32 v83, 3, v106
  v_lshl_add_u32 v83, v83, 5, v105
  v_add_u32 v87, 0x10000, v83
  v_lshrrev_b32 v105, 3, v107
  v_mul_u32_u24 v105, 896, v105
  v_lshlrev_b32 v106, 1, v100
  v_and_b32 v102, 7, v107
  v_xor_b32 v106, v106, v102
  v_lshl_add_u32 v105, v106, 4, v105
  s_mul_i32 s64, s52, 28672
  v_add_u32 v105, s64, v105
  v_add_u32 v88, 0, v105
  v_add_u32 v89, 6144, v105
  v_add_u32 v90, 12288, v105
  v_add_u32 v91, 18432, v105
  v_lshlrev_b32 v92, 4, v107
  s_lshl_b32 s97, s52, 12
  s_mov_b32 s60, 14
.p2align 3
L_attB:
  s_cmp_eq_u32 s60, 3
  s_cbranch_scc1 L_warmB
L_warmretB:
  s_cmp_eq_u32 s60, 10
  s_cbranch_scc1 L_iniB
L_iniretB:
  s_waitcnt lgkmcnt(9)
  v_mfma_f32_16x16x32_bf16 v[32:35], a[96:99], a[0:3], 0
  ds_read_b128 a[140:143], v7 offset:57344
  v_mfma_f32_16x16x32_bf16 v[36:39], a[96:99], a[4:7], 0
  ds_read_b128 a[144:147], v4 offset:57600
  v_mfma_f32_16x16x32_bf16 v[40:43], a[96:99], a[8:11], 0
  ds_read_b128 a[148:151], v5 offset:57600
  v_mfma_f32_16x16x32_bf16 v[32:35], a[100:103], a[12:15], v[32:35]
  ds_read_b128 a[152:155], v6 offset:57600
  v_mfma_f32_16x16x32_bf16 v[36:39], a[100:103], a[16:19], v[36:39]
  ds_read_b128 a[156:159], v7 offset:57600
  v_mfma_f32_16x16x32_bf16 v[40:43], a[100:103], a[20:23], v[40:43]
  s_waitcnt lgkmcnt(12)
  v_mfma_f32_16x16x32_bf16 v[32:35], a[104:107], a[24:27], v[32:35]
  v_mfma_f32_16x16x32_bf16 v[36:39], a[104:107], a[28:31], v[36:39]
  v_mfma_f32_16x16x32_bf16 v[40:43], a[104:107], a[32:35], v[40:43]
  v_mfma_f32_16x16x32_bf16 v[32:35], a[108:111], a[36:39], v[32:35]
  s_waitcnt lgkmcnt(0)
  s_barrier
  v_mfma_f32_16x16x32_bf16 v[36:39], a[108:111], a[40:43], v[36:39]
  s_add_u32 m0, s58, 49152
  s_add_u32 s68, s56, 4096
  v_mfma_f32_16x16x32_bf16 v[40:43], a[108:111], a[44:47], v[40:43]
  buffer_load_dwordx4 v16, s[28:31], s56 offen offset:0 nt lds
  v_mfma_f32_16x16x32_bf16 v[32:35], a[112:115], a[48:51], v[32:35]
  v_mfma_f32_16x16x32_bf16 v[36:39], a[112:115], a[52:55], v[36:39]
  buffer_load_dwordx4 v17, s[28:31], s56 offen offset:1024 nt lds
  v_mfma_f32_16x16x32_bf16 v[40:43], a[112:115], a[56:59], v[40:43]
  v_mfma_f32_16x16x32_bf16 v[32:35], a[116:119], a[60:63], v[32:35]
  buffer_load_dwordx4 v18, s[28:31], s56 offen offset:2048 nt lds
  v_mfma_f32_16x16x32_bf16 v[36:39], a[116:119], a[64:67], v[36:39]
  v_mfma_f32_16x16x32_bf16 v[40:43], a[116:119], a[68:71], v[40:43]
  buffer_load_dwordx4 v19, s[28:31], s56 offen offset:3072 nt lds
  v_mfma_f32_16x16x32_bf16 v[32:35], a[120:123], a[72:75], v[32:35]
  s_add_u32 m0, s58, 53248
  s_add_u32 s56, s56, 16384
  v_mfma_f32_16x16x32_bf16 v[36:39], a[120:123], a[76:79], v[36:39]
  buffer_load_dwordx4 v16, s[28:31], s68 offen offset:0 nt lds
  v_mfma_f32_16x16x32_bf16 v[40:43], a[120:123], a[80:83], v[40:43]
  v_mfma_f32_16x16x32_bf16 v[32:35], a[124:127], a[84:87], v[32:35]
  buffer_load_dwordx4 v17, s[28:31], s68 offen offset:1024 nt lds
  v_mfma_f32_16x16x32_bf16 v[36:39], a[124:127], a[88:91], v[36:39]
  v_mfma_f32_16x16x32_bf16 v[40:43], a[124:127], a[92:95], v[40:43]
  buffer_load_dwordx4 v18, s[28:31], s68 offen offset:2048 nt lds
  v_mfma_f32_16x16x32_bf16 v[44:47], a[128:131], a[0:3], 0
  v_mfma_f32_16x16x32_bf16 v[48:51], a[128:131], a[4:7], 0
  buffer_load_dwordx4 v19, s[28:31], s68 offen offset:3072 nt lds
  v_mfma_f32_16x16x32_bf16 v[52:55], a[128:131], a[8:11], 0
  v_mfma_f32_16x16x32_bf16 v[44:47], a[132:135], a[12:15], v[44:47]
  v_mfma_f32_16x16x32_bf16 v[48:51], a[132:135], a[16:19], v[48:51]
  v_mfma_f32_16x16x32_bf16 v[52:55], a[132:135], a[20:23], v[52:55]
  v_fma_f32 v0, v32, s63, -v23
  v_fma_f32 v1, v33, s63, -v23
  v_mfma_f32_16x16x32_bf16 v[44:47], a[136:139], a[24:27], v[44:47]
  v_fma_f32 v2, v34, s63, -v23
  v_fma_f32 v3, v35, s63, -v23
  v_mfma_f32_16x16x32_bf16 v[48:51], a[136:139], a[28:31], v[48:51]
  v_exp_f32 v0, v0
  v_mfma_f32_16x16x32_bf16 v[52:55], a[136:139], a[32:35], v[52:55]
  v_exp_f32 v1, v1
  v_mfma_f32_16x16x32_bf16 v[44:47], a[140:143], a[36:39], v[44:47]
  v_exp_f32 v2, v2
  v_mfma_f32_16x16x32_bf16 v[48:51], a[140:143], a[40:43], v[48:51]
  v_exp_f32 v3, v3
  v_mfma_f32_16x16x32_bf16 v[52:55], a[140:143], a[44:47], v[52:55]
  v_add_f32 v26, v0, v1
  v_cvt_pk_bf16_f32 v68, v0, v1
  v_mfma_f32_16x16x32_bf16 v[44:47], a[144:147], a[48:51], v[44:47]
  s_waitcnt vmcnt(24)
  s_barrier
  v_mfma_f32_16x16x32_bf16 v[48:51], a[144:147], a[52:55], v[48:51]
  ds_read_b64_tr_b16 a[96:97], v8 offset:0
  ds_read_b64_tr_b16 a[98:99], v8 offset:8192
  v_mfma_f32_16x16x32_bf16 v[52:55], a[144:147], a[56:59], v[52:55]
  ds_read_b64_tr_b16 a[100:101], v9 offset:0
  ds_read_b64_tr_b16 a[102:103], v9 offset:8192
  v_mfma_f32_16x16x32_bf16 v[44:47], a[148:151], a[60:63], v[44:47]
  ds_read_b64_tr_b16 a[104:105], v10 offset:0
  ds_read_b64_tr_b16 a[106:107], v10 offset:8192
  v_mfma_f32_16x16x32_bf16 v[48:51], a[148:151], a[64:67], v[48:51]
  ds_read_b64_tr_b16 a[108:109], v11 offset:0
  ds_read_b64_tr_b16 a[110:111], v11 offset:8192
  v_mfma_f32_16x16x32_bf16 v[52:55], a[148:151], a[68:71], v[52:55]
  ds_read_b64_tr_b16 a[112:113], v12 offset:0
  ds_read_b64_tr_b16 a[114:115], v12 offset:8192
  v_mfma_f32_16x16x32_bf16 v[44:47], a[152:155], a[72:75], v[44:47]
  ds_read_b64_tr_b16 a[116:117], v13 offset:0
  ds_read_b64_tr_b16 a[118:119], v13 offset:8192
  v_mfma_f32_16x16x32_bf16 v[48:51], a[152:155], a[76:79], v[48:51]
  s_waitcnt lgkmcnt(8)
  ds_read_b64_tr_b16 a[120:121], v14 offset:0
  ds_read_b64_tr_b16 a[122:123], v14 offset:8192
  v_mfma_f32_16x16x32_bf16 v[52:55], a[152:155], a[80:83], v[52:55]
  ds_read_b64_tr_b16 a[124:125], v15 offset:0
  ds_read_b64_tr_b16 a[126:127], v15 offset:8192
  v_mfma_f32_16x16x32_bf16 v[44:47], a[156:159], a[84:87], v[44:47]
  s_waitcnt lgkmcnt(8)
  ds_read_b64_tr_b16 a[128:129], v8 offset:256
  ds_read_b64_tr_b16 a[130:131], v8 offset:8448
  v_mfma_f32_16x16x32_bf16 v[48:51], a[156:159], a[88:91], v[48:51]
  ds_read_b64_tr_b16 a[132:133], v9 offset:256
  ds_read_b64_tr_b16 a[134:135], v9 offset:8448
  v_mfma_f32_16x16x32_bf16 v[52:55], a[156:159], a[92:95], v[52:55]
  s_waitcnt lgkmcnt(8)
  ds_read_b64_tr_b16 a[136:137], v10 offset:256
  ds_read_b64_tr_b16 a[138:139], v10 offset:8448
  v_add_f32 v26, v26, v2
  v_cvt_pk_bf16_f32 v69, v2, v3
  v_add_f32 v26, v26, v3
  v_fma_f32 v96, v36, s63, -v24
  v_fma_f32 v97, v37, s63, -v24
  v_fma_f32 v98, v38, s63, -v24
  v_fma_f32 v99, v39, s63, -v24
  v_exp_f32 v96, v96
  v_exp_f32 v97, v97
  v_exp_f32 v98, v98
  v_exp_f32 v99, v99
  v_add_f32 v27, v96, v97
  v_cvt_pk_bf16_f32 v72, v96, v97
  v_add_f32 v27, v27, v98
  v_cvt_pk_bf16_f32 v73, v98, v99
  v_add_f32 v27, v27, v99
  v_fma_f32 v108, v40, s63, -v25
  v_fma_f32 v109, v41, s63, -v25
  v_fma_f32 v110, v42, s63, -v25
  v_fma_f32 v111, v43, s63, -v25
  v_exp_f32 v108, v108
  v_exp_f32 v109, v109
  v_exp_f32 v110, v110
  v_exp_f32 v111, v111
  v_add_f32 v28, v108, v109
  v_cvt_pk_bf16_f32 v76, v108, v109
  v_add_f32 v28, v28, v110
  v_cvt_pk_bf16_f32 v77, v110, v111
  v_add_f32 v28, v28, v111
  v_mfma_f32_16x16x32_bf16 v[112:115], a[96:99], v[56:59], v[112:115]
  ds_read_b64_tr_b16 a[140:141], v11 offset:256
  ds_read_b64_tr_b16 a[142:143], v11 offset:8448
  v_mfma_f32_16x16x32_bf16 v[116:119], a[96:99], v[60:63], v[116:119]
  s_waitcnt lgkmcnt(8)
  ds_read_b64_tr_b16 a[144:145], v12 offset:256
  ds_read_b64_tr_b16 a[146:147], v12 offset:8448
  v_mfma_f32_16x16x32_bf16 v[120:123], a[96:99], v[64:67], v[120:123]
  ds_read_b64_tr_b16 a[148:149], v13 offset:256
  ds_read_b64_tr_b16 a[150:151], v13 offset:8448
  v_mfma_f32_16x16x32_bf16 v[124:127], a[100:103], v[56:59], v[124:127]
  s_waitcnt lgkmcnt(8)
  ds_read_b64_tr_b16 a[152:153], v14 offset:256
  ds_read_b64_tr_b16 a[154:155], v14 offset:8448
  v_mfma_f32_16x16x32_bf16 v[128:131], a[100:103], v[60:63], v[128:131]
  ds_read_b64_tr_b16 a[156:157], v15 offset:256
  ds_read_b64_tr_b16 a[158:159], v15 offset:8448
  v_mfma_f32_16x16x32_bf16 v[132:135], a[100:103], v[64:67], v[132:135]
  v_fma_f32 v0, v44, s63, -v23
  v_fma_f32 v1, v45, s63, -v23
  v_mfma_f32_16x16x32_bf16 v[136:139], a[104:107], v[56:59], v[136:139]
  v_fma_f32 v2, v46, s63, -v23
  v_fma_f32 v3, v47, s63, -v23
  v_mfma_f32_16x16x32_bf16 v[140:143], a[104:107], v[60:63], v[140:143]
  v_exp_f32 v0, v0
  v_mfma_f32_16x16x32_bf16 v[144:147], a[104:107], v[64:67], v[144:147]
  v_exp_f32 v1, v1
  v_mfma_f32_16x16x32_bf16 v[148:151], a[108:111], v[56:59], v[148:151]
  s_waitcnt lgkmcnt(0)
  s_barrier
  v_mfma_f32_16x16x32_bf16 v[152:155], a[108:111], v[60:63], v[152:155]
  s_add_u32 m0, s58, 0
  s_add_u32 s69, s57, 4096
  v_mfma_f32_16x16x32_bf16 v[156:159], a[108:111], v[64:67], v[156:159]
  buffer_load_dwordx4 v16, s[32:35], s57 offen offset:0 nt lds
  v_mfma_f32_16x16x32_bf16 v[160:163], a[112:115], v[56:59], v[160:163]
  v_exp_f32 v2, v2
  v_mfma_f32_16x16x32_bf16 v[164:167], a[112:115], v[60:63], v[164:167]
  buffer_load_dwordx4 v17, s[32:35], s57 offen offset:1024 nt lds
  v_mfma_f32_16x16x32_bf16 v[168:171], a[112:115], v[64:67], v[168:171]
  v_exp_f32 v3, v3
  v_mfma_f32_16x16x32_bf16 v[172:175], a[116:119], v[56:59], v[172:175]
  buffer_load_dwordx4 v18, s[32:35], s57 offen offset:2048 nt lds
  v_mfma_f32_16x16x32_bf16 v[176:179], a[116:119], v[60:63], v[176:179]
  v_add_f32 v26, v26, v0
  v_cvt_pk_bf16_f32 v70, v0, v1
  v_mfma_f32_16x16x32_bf16 v[180:183], a[116:119], v[64:67], v[180:183]
  buffer_load_dwordx4 v19, s[32:35], s57 offen offset:3072 nt lds
  v_mfma_f32_16x16x32_bf16 v[184:187], a[120:123], v[56:59], v[184:187]
  s_add_u32 m0, s58, 4096
  s_add_u32 s57, s57, 16384
  v_mfma_f32_16x16x32_bf16 v[188:191], a[120:123], v[60:63], v[188:191]
  buffer_load_dwordx4 v16, s[32:35], s69 offen offset:0 nt lds
  v_mfma_f32_16x16x32_bf16 v[192:195], a[120:123], v[64:67], v[192:195]
  v_add_f32 v26, v26, v1
  v_add_f32 v26, v26, v2
  v_mfma_f32_16x16x32_bf16 v[196:199], a[124:127], v[56:59], v[196:199]
  buffer_load_dwordx4 v17, s[32:35], s69 offen offset:1024 nt lds
  v_mfma_f32_16x16x32_bf16 v[200:203], a[124:127], v[60:63], v[200:203]
  v_cvt_pk_bf16_f32 v71, v2, v3
  v_add_f32 v26, v26, v3
  v_mfma_f32_16x16x32_bf16 v[204:207], a[124:127], v[64:67], v[204:207]
  buffer_load_dwordx4 v18, s[32:35], s69 offen offset:2048 nt lds
  v_mfma_f32_16x16x32_bf16 v[208:211], a[128:131], v[56:59], v[208:211]
  v_fma_f32 v96, v48, s63, -v24
  v_fma_f32 v97, v49, s63, -v24
  v_mfma_f32_16x16x32_bf16 v[212:215], a[128:131], v[60:63], v[212:215]
  buffer_load_dwordx4 v19, s[32:35], s69 offen offset:3072 nt lds
  v_mfma_f32_16x16x32_bf16 v[216:219], a[128:131], v[64:67], v[216:219]
  v_fma_f32 v98, v50, s63, -v24
  v_fma_f32 v99, v51, s63, -v24
  v_mfma_f32_16x16x32_bf16 v[220:223], a[132:135], v[56:59], v[220:223]
  v_exp_f32 v96, v96
  v_mfma_f32_16x16x32_bf16 v[224:227], a[132:135], v[60:63], v[224:227]
  v_exp_f32 v97, v97
  v_mfma_f32_16x16x32_bf16 v[228:231], a[132:135], v[64:67], v[228:231]
  v_exp_f32 v98, v98
  v_mfma_f32_16x16x32_bf16 v[232:235], a[136:139], v[56:59], v[232:235]
  v_exp_f32 v99, v99
  v_mfma_f32_16x16x32_bf16 v[236:239], a[136:139], v[60:63], v[236:239]
  v_add_f32 v27, v27, v96
  v_cvt_pk_bf16_f32 v74, v96, v97
  v_mfma_f32_16x16x32_bf16 v[240:243], a[136:139], v[64:67], v[240:243]
  v_add_f32 v27, v27, v97
  v_add_f32 v27, v27, v98
  v_mfma_f32_16x16x32_bf16 v[244:247], a[140:143], v[56:59], v[244:247]
  v_cvt_pk_bf16_f32 v75, v98, v99
  v_add_f32 v27, v27, v99
  v_mfma_f32_16x16x32_bf16 v[248:251], a[140:143], v[60:63], v[248:251]
  v_fma_f32 v108, v52, s63, -v25
  v_fma_f32 v109, v53, s63, -v25
  v_mfma_f32_16x16x32_bf16 v[252:255], a[140:143], v[64:67], v[252:255]
  v_fma_f32 v110, v54, s63, -v25
  v_fma_f32 v111, v55, s63, -v25
  v_mfma_f32_16x16x32_bf16 a[160:163], a[144:147], v[56:59], a[160:163]
  s_waitcnt vmcnt(24)
  s_barrier
  v_mfma_f32_16x16x32_bf16 a[164:167], a[144:147], v[60:63], a[164:167]
  ds_read_b128 a[96:99], v4 offset:16384
  v_mfma_f32_16x16x32_bf16 a[168:171], a[144:147], v[64:67], a[168:171]
  ds_read_b128 a[100:103], v5 offset:16384
  v_mfma_f32_16x16x32_bf16 a[172:175], a[148:151], v[56:59], a[172:175]
  ds_read_b128 a[104:107], v6 offset:16384
  v_mfma_f32_16x16x32_bf16 a[176:179], a[148:151], v[60:63], a[176:179]
  ds_read_b128 a[108:111], v7 offset:16384
  v_mfma_f32_16x16x32_bf16 a[180:183], a[148:151], v[64:67], a[180:183]
  ds_read_b128 a[112:115], v4 offset:16640
  v_mfma_f32_16x16x32_bf16 a[184:187], a[152:155], v[56:59], a[184:187]
  ds_read_b128 a[116:119], v5 offset:16640
  v_mfma_f32_16x16x32_bf16 a[188:191], a[152:155], v[60:63], a[188:191]
  ds_read_b128 a[120:123], v6 offset:16640
  v_mfma_f32_16x16x32_bf16 a[192:195], a[152:155], v[64:67], a[192:195]
  ds_read_b128 a[124:127], v7 offset:16640
  v_mfma_f32_16x16x32_bf16 a[196:199], a[156:159], v[56:59], a[196:199]
  ds_read_b128 a[128:131], v4 offset:24576
  v_mfma_f32_16x16x32_bf16 a[200:203], a[156:159], v[60:63], a[200:203]
  ds_read_b128 a[132:135], v5 offset:24576
  v_mfma_f32_16x16x32_bf16 a[204:207], a[156:159], v[64:67], a[204:207]
  ds_read_b128 a[136:139], v6 offset:24576
  v_exp_f32 v108, v108
  v_exp_f32 v109, v109
  v_exp_f32 v110, v110
  v_exp_f32 v111, v111
  v_add_f32 v28, v28, v108
  v_cvt_pk_bf16_f32 v78, v108, v109
  v_add_f32 v28, v28, v109
  v_add_f32 v28, v28, v110
  v_cvt_pk_bf16_f32 v79, v110, v111
  v_add_f32 v28, v28, v111
  v_max3_f32 v29, v26, v27, v28
  v_cmp_lt_f32 vcc, 0x44800000, v29
  s_nop 0
  s_cbranch_vccz L_ok11
  s_swappc_b64 s[70:71], s[74:75]
L_ok11:
  v_add_f32 v20, v20, v26
  v_add_f32 v21, v21, v27
  v_add_f32 v22, v22, v28
  s_waitcnt lgkmcnt(9)
  v_mfma_f32_16x16x32_bf16 v[32:35], a[96:99], a[0:3], 0
  ds_read_b128 a[140:143], v7 offset:24576
  v_mfma_f32_16x16x32_bf16 v[36:39], a[96:99], a[4:7], 0
  ds_read_b128 a[144:147], v4 offset:24832
  v_mfma_f32_16x16x32_bf16 v[40:43], a[96:99], a[8:11], 0
  ds_read_b128 a[148:151], v5 offset:24832
  v_mfma_f32_16x16x32_bf16 v[32:35], a[100:103], a[12:15], v[32:35]
  ds_read_b128 a[152:155], v6 offset:24832
  v_mfma_f32_16x16x32_bf16 v[36:39], a[100:103], a[16:19], v[36:39]
  ds_read_b128 a[156:159], v7 offset:24832
  v_mfma_f32_16x16x32_bf16 v[40:43], a[100:103], a[20:23], v[40:43]
  s_waitcnt lgkmcnt(12)
  v_mfma_f32_16x16x32_bf16 v[32:35], a[104:107], a[24:27], v[32:35]
  v_mfma_f32_16x16x32_bf16 v[36:39], a[104:107], a[28:31], v[36:39]
  v_mfma_f32_16x16x32_bf16 v[40:43], a[104:107], a[32:35], v[40:43]
  v_mfma_f32_16x16x32_bf16 v[32:35], a[108:111], a[36:39], v[32:35]
  s_waitcnt lgkmcnt(0)
  s_barrier
  v_mfma_f32_16x16x32_bf16 v[36:39], a[108:111], a[40:43], v[36:39]
  s_add_u32 m0, s58, 16384
  s_add_u32 s68, s56, 4096
  v_mfma_f32_16x16x32_bf16 v[40:43], a[108:111], a[44:47], v[40:43]
  buffer_load_dwordx4 v16, s[28:31], s56 offen offset:0 nt lds
  v_mfma_f32_16x16x32_bf16 v[32:35], a[112:115], a[48:51], v[32:35]
  v_mfma_f32_16x16x32_bf16 v[36:39], a[112:115], a[52:55], v[36:39]
  buffer_load_dwordx4 v17, s[28:31], s56 offen offset:1024 nt lds
  v_mfma_f32_16x16x32_bf16 v[40:43], a[112:115], a[56:59], v[40:43]
  v_mfma_f32_16x16x32_bf16 v[32:35], a[116:119], a[60:63], v[32:35]
  buffer_load_dwordx4 v18, s[28:31], s56 offen offset:2048 nt lds
  v_mfma_f32_16x16x32_bf16 v[36:39], a[116:119], a[64:67], v[36:39]
  v_mfma_f32_16x16x32_bf16 v[40:43], a[116:119], a[68:71], v[40:43]
  buffer_load_dwordx4 v19, s[28:31], s56 offen offset:3072 nt lds
  v_mfma_f32_16x16x32_bf16 v[32:35], a[120:123], a[72:75], v[32:35]
  s_add_u32 m0, s58, 20480
  s_add_u32 s56, s56, 16384
  v_mfma_f32_16x16x32_bf16 v[36:39], a[120:123], a[76:79], v[36:39]
  buffer_load_dwordx4 v16, s[28:31], s68 offen offset:0 nt lds
  v_mfma_f32_16x16x32_bf16 v[40:43], a[120:123], a[80:83], v[40:43]
  v_mfma_f32_16x16x32_bf16 v[32:35], a[124:127], a[84:87], v[32:35]
  buffer_load_dwordx4 v17, s[28:31], s68 offen offset:1024 nt lds
  v_mfma_f32_16x16x32_bf16 v[36:39], a[124:127], a[88:91], v[36:39]
  v_mfma_f32_16x16x32_bf16 v[40:43], a[124:127], a[92:95], v[40:43]
  buffer_load_dwordx4 v18, s[28:31], s68 offen offset:2048 nt lds
  v_mfma_f32_16x16x32_bf16 v[44:47], a[128:131], a[0:3], 0
  v_mfma_f32_16x16x32_bf16 v[48:51], a[128:131], a[4:7], 0
  buffer_load_dwordx4 v19, s[28:31], s68 offen offset:3072 nt lds
  v_mfma_f32_16x16x32_bf16 v[52:55], a[128:131], a[8:11], 0
  v_mfma_f32_16x16x32_bf16 v[44:47], a[132:135], a[12:15], v[44:47]
  v_mfma_f32_16x16x32_bf16 v[48:51], a[132:135], a[16:19], v[48:51]
  v_mfma_f32_16x16x32_bf16 v[52:55], a[132:135], a[20:23], v[52:55]
  v_fma_f32 v0, v32, s63, -v23
  v_fma_f32 v1, v33, s63, -v23
  v_mfma_f32_16x16x32_bf16 v[44:47], a[136:139], a[24:27], v[44:47]
  v_fma_f32 v2, v34, s63, -v23
  v_fma_f32 v3, v35, s63, -v23
  v_mfma_f32_16x16x32_bf16 v[48:51], a[136:139], a[28:31], v[48:51]
  v_exp_f32 v0, v0
  v_mfma_f32_16x16x32_bf16 v[52:55], a[136:139], a[32:35], v[52:55]
  v_exp_f32 v1, v1
  v_mfma_f32_16x16x32_bf16 v[44:47], a[140:143], a[36:39], v[44:47]
  v_exp_f32 v2, v2
  v_mfma_f32_16x16x32_bf16 v[48:51], a[140:143], a[40:43], v[48:51]
  v_exp_f32 v3, v3
  v_mfma_f32_16x16x32_bf16 v[52:55], a[140:143], a[44:47], v[52:55]
  v_add_f32 v26, v0, v1
  v_cvt_pk_bf16_f32 v56, v0, v1
  v_mfma_f32_16x16x32_bf16 v[44:47], a[144:147], a[48:51], v[44:47]
  s_waitcnt vmcnt(24)
  s_barrier
  v_mfma_f32_16x16x32_bf16 v[48:51], a[144:147], a[52:55], v[48:51]
  ds_read_b64_tr_b16 a[96:97], v8 offset:32768
  ds_read_b64_tr_b16 a[98:99], v8 offset:40960
  v_mfma_f32_16x16x32_bf16 v[52:55], a[144:147], a[56:59], v[52:55]
  ds_read_b64_tr_b16 a[100:101], v9 offset:32768
  ds_read_b64_tr_b16 a[102:103], v9 offset:40960
  v_mfma_f32_16x16x32_bf16 v[44:47], a[148:151], a[60:63], v[44:47]
  ds_read_b64_tr_b16 a[104:105], v10 offset:32768
  ds_read_b64_tr_b16 a[106:107], v10 offset:40960
  v_mfma_f32_16x16x32_bf16 v[48:51], a[148:151], a[64:67], v[48:51]
  ds_read_b64_tr_b16 a[108:109], v11 offset:32768
  ds_read_b64_tr_b16 a[110:111], v11 offset:40960
  v_mfma_f32_16x16x32_bf16 v[52:55], a[148:151], a[68:71], v[52:55]
  ds_read_b64_tr_b16 a[112:113], v12 offset:32768
  ds_read_b64_tr_b16 a[114:115], v12 offset:40960
  v_mfma_f32_16x16x32_bf16 v[44:47], a[152:155], a[72:75], v[44:47]
  ds_read_b64_tr_b16 a[116:117], v13 offset:32768
  ds_read_b64_tr_b16 a[118:119], v13 offset:40960
  v_mfma_f32_16x16x32_bf16 v[48:51], a[152:155], a[76:79], v[48:51]
  s_waitcnt lgkmcnt(8)
  ds_read_b64_tr_b16 a[120:121], v14 offset:32768
  ds_read_b64_tr_b16 a[122:123], v14 offset:40960
  v_mfma_f32_16x16x32_bf16 v[52:55], a[152:155], a[80:83], v[52:55]
  ds_read_b64_tr_b16 a[124:125], v15 offset:32768
  ds_read_b64_tr_b16 a[126:127], v15 offset:40960
  v_mfma_f32_16x16x32_bf16 v[44:47], a[156:159], a[84:87], v[44:47]
  s_waitcnt lgkmcnt(8)
  ds_read_b64_tr_b16 a[128:129], v8 offset:33024
  ds_read_b64_tr_b16 a[130:131], v8 offset:41216
  v_mfma_f32_16x16x32_bf16 v[48:51], a[156:159], a[88:91], v[48:51]
  ds_read_b64_tr_b16 a[132:133], v9 offset:33024
  ds_read_b64_tr_b16 a[134:135], v9 offset:41216
  v_mfma_f32_16x16x32_bf16 v[52:55], a[156:159], a[92:95], v[52:55]
  s_waitcnt lgkmcnt(8)
  ds_read_b64_tr_b16 a[136:137], v10 offset:33024
  ds_read_b64_tr_b16 a[138:139], v10 offset:41216
  v_add_f32 v26, v26, v2
  v_cvt_pk_bf16_f32 v57, v2, v3
  v_add_f32 v26, v26, v3
  v_fma_f32 v96, v36, s63, -v24
  v_fma_f32 v97, v37, s63, -v24
  v_fma_f32 v98, v38, s63, -v24
  v_fma_f32 v99, v39, s63, -v24
  v_exp_f32 v96, v96
  v_exp_f32 v97, v97
  v_exp_f32 v98, v98
  v_exp_f32 v99, v99
  v_add_f32 v27, v96, v97
  v_cvt_pk_bf16_f32 v60, v96, v97
  v_add_f32 v27, v27, v98
  v_cvt_pk_bf16_f32 v61, v98, v99
  v_add_f32 v27, v27, v99
  v_fma_f32 v108, v40, s63, -v25
  v_fma_f32 v109, v41, s63, -v25
  v_fma_f32 v110, v42, s63, -v25
  v_fma_f32 v111, v43, s63, -v25
  v_exp_f32 v108, v108
  v_exp_f32 v109, v109
  v_exp_f32 v110, v110
  v_exp_f32 v111, v111
  v_add_f32 v28, v108, v109
  v_cvt_pk_bf16_f32 v64, v108, v109
  v_add_f32 v28, v28, v110
  v_cvt_pk_bf16_f32 v65, v110, v111
  v_add_f32 v28, v28, v111
  v_mfma_f32_16x16x32_bf16 v[112:115], a[96:99], v[68:71], v[112:115]
  ds_read_b64_tr_b16 a[140:141], v11 offset:33024
  ds_read_b64_tr_b16 a[142:143], v11 offset:41216
  v_mfma_f32_16x16x32_bf16 v[116:119], a[96:99], v[72:75], v[116:119]
  s_waitcnt lgkmcnt(8)
  ds_read_b64_tr_b16 a[144:145], v12 offset:33024
  ds_read_b64_tr_b16 a[146:147], v12 offset:41216
  v_mfma_f32_16x16x32_bf16 v[120:123], a[96:99], v[76:79], v[120:123]
  ds_read_b64_tr_b16 a[148:149], v13 offset:33024
  ds_read_b64_tr_b16 a[150:151], v13 offset:41216
  v_mfma_f32_16x16x32_bf16 v[124:127], a[100:103], v[68:71], v[124:127]
  s_waitcnt lgkmcnt(8)
  ds_read_b64_tr_b16 a[152:153], v14 offset:33024
  ds_read_b64_tr_b16 a[154:155], v14 offset:41216
  v_mfma_f32_16x16x32_bf16 v[128:131], a[100:103], v[72:75], v[128:131]
  ds_read_b64_tr_b16 a[156:157], v15 offset:33024
  ds_read_b64_tr_b16 a[158:159], v15 offset:41216
  v_mfma_f32_16x16x32_bf16 v[132:135], a[100:103], v[76:79], v[132:135]
  v_fma_f32 v0, v44, s63, -v23
  v_fma_f32 v1, v45, s63, -v23
  v_mfma_f32_16x16x32_bf16 v[136:139], a[104:107], v[68:71], v[136:139]
  v_fma_f32 v2, v46, s63, -v23
  v_fma_f32 v3, v47, s63, -v23
  v_mfma_f32_16x16x32_bf16 v[140:143], a[104:107], v[72:75], v[140:143]
  v_exp_f32 v0, v0
  v_mfma_f32_16x16x32_bf16 v[144:147], a[104:107], v[76:79], v[144:147]
  v_exp_f32 v1, v1
  v_mfma_f32_16x16x32_bf16 v[148:151], a[108:111], v[68:71], v[148:151]
  s_waitcnt lgkmcnt(0)
  s_barrier
  v_mfma_f32_16x16x32_bf16 v[152:155], a[108:111], v[72:75], v[152:155]
  s_add_u32 m0, s58, 32768
  s_add_u32 s69, s57, 4096
  v_mfma_f32_16x16x32_bf16 v[156:159], a[108:111], v[76:79], v[156:159]
  buffer_load_dwordx4 v16, s[32:35], s57 offen offset:0 nt lds
  v_mfma_f32_16x16x32_bf16 v[160:163], a[112:115], v[68:71], v[160:163]
  v_exp_f32 v2, v2
  v_mfma_f32_16x16x32_bf16 v[164:167], a[112:115], v[72:75], v[164:167]
  buffer_load_dwordx4 v17, s[32:35], s57 offen offset:1024 nt lds
  v_mfma_f32_16x16x32_bf16 v[168:171], a[112:115], v[76:79], v[168:171]
  v_exp_f32 v3, v3
  v_mfma_f32_16x16x32_bf16 v[172:175], a[116:119], v[68:71], v[172:175]
  buffer_load_dwordx4 v18, s[32:35], s57 offen offset:2048 nt lds
  v_mfma_f32_16x16x32_bf16 v[176:179], a[116:119], v[72:75], v[176:179]
  v_add_f32 v26, v26, v0
  v_cvt_pk_bf16_f32 v58, v0, v1
  v_mfma_f32_16x16x32_bf16 v[180:183], a[116:119], v[76:79], v[180:183]
  buffer_load_dwordx4 v19, s[32:35], s57 offen offset:3072 nt lds
  v_mfma_f32_16x16x32_bf16 v[184:187], a[120:123], v[68:71], v[184:187]
  s_add_u32 m0, s58, 36864
  s_add_u32 s57, s57, 16384
  v_mfma_f32_16x16x32_bf16 v[188:191], a[120:123], v[72:75], v[188:191]
  buffer_load_dwordx4 v16, s[32:35], s69 offen offset:0 nt lds
  v_mfma_f32_16x16x32_bf16 v[192:195], a[120:123], v[76:79], v[192:195]
  v_add_f32 v26, v26, v1
  v_add_f32 v26, v26, v2
  v_mfma_f32_16x16x32_bf16 v[196:199], a[124:127], v[68:71], v[196:199]
  buffer_load_dwordx4 v17, s[32:35], s69 offen offset:1024 nt lds
  v_mfma_f32_16x16x32_bf16 v[200:203], a[124:127], v[72:75], v[200:203]
  v_cvt_pk_bf16_f32 v59, v2, v3
  v_add_f32 v26, v26, v3
  v_mfma_f32_16x16x32_bf16 v[204:207], a[124:127], v[76:79], v[204:207]
  buffer_load_dwordx4 v18, s[32:35], s69 offen offset:2048 nt lds
  v_mfma_f32_16x16x32_bf16 v[208:211], a[128:131], v[68:71], v[208:211]
  v_fma_f32 v96, v48, s63, -v24
  v_fma_f32 v97, v49, s63, -v24
  v_mfma_f32_16x16x32_bf16 v[212:215], a[128:131], v[72:75], v[212:215]
  buffer_load_dwordx4 v19, s[32:35], s69 offen offset:3072 nt lds
  v_mfma_f32_16x16x32_bf16 v[216:219], a[128:131], v[76:79], v[216:219]
  v_fma_f32 v98, v50, s63, -v24
  v_fma_f32 v99, v51, s63, -v24
  v_mfma_f32_16x16x32_bf16 v[220:223], a[132:135], v[68:71], v[220:223]
  v_exp_f32 v96, v96
  v_mfma_f32_16x16x32_bf16 v[224:227], a[132:135], v[72:75], v[224:227]
  v_exp_f32 v97, v97
  v_mfma_f32_16x16x32_bf16 v[228:231], a[132:135], v[76:79], v[228:231]
  v_exp_f32 v98, v98
  v_mfma_f32_16x16x32_bf16 v[232:235], a[136:139], v[68:71], v[232:235]
  v_exp_f32 v99, v99
  v_mfma_f32_16x16x32_bf16 v[236:239], a[136:139], v[72:75], v[236:239]
  v_add_f32 v27, v27, v96
  v_cvt_pk_bf16_f32 v62, v96, v97
  v_mfma_f32_16x16x32_bf16 v[240:243], a[136:139], v[76:79], v[240:243]
  v_add_f32 v27, v27, v97
  v_add_f32 v27, v27, v98
  v_mfma_f32_16x16x32_bf16 v[244:247], a[140:143], v[68:71], v[244:247]
  v_cvt_pk_bf16_f32 v63, v98, v99
  v_add_f32 v27, v27, v99
  v_mfma_f32_16x16x32_bf16 v[248:251], a[140:143], v[72:75], v[248:251]
  v_fma_f32 v108, v52, s63, -v25
  v_fma_f32 v109, v53, s63, -v25
  v_mfma_f32_16x16x32_bf16 v[252:255], a[140:143], v[76:79], v[252:255]
  v_fma_f32 v110, v54, s63, -v25
  v_fma_f32 v111, v55, s63, -v25
  v_mfma_f32_16x16x32_bf16 a[160:163], a[144:147], v[68:71], a[160:163]
  s_waitcnt vmcnt(24)
  s_barrier
  v_mfma_f32_16x16x32_bf16 a[164:167], a[144:147], v[72:75], a[164:167]
  ds_read_b128 a[96:99], v4 offset:49152
  v_mfma_f32_16x16x32_bf16 a[168:171], a[144:147], v[76:79], a[168:171]
  ds_read_b128 a[100:103], v5 offset:49152
  v_mfma_f32_16x16x32_bf16 a[172:175], a[148:151], v[68:71], a[172:175]
  ds_read_b128 a[104:107], v6 offset:49152
  v_mfma_f32_16x16x32_bf16 a[176:179], a[148:151], v[72:75], a[176:179]
  ds_read_b128 a[108:111], v7 offset:49152
  v_mfma_f32_16x16x32_bf16 a[180:183], a[148:151], v[76:79], a[180:183]
  ds_read_b128 a[112:115], v4 offset:49408
  v_mfma_f32_16x16x32_bf16 a[184:187], a[152:155], v[68:71], a[184:187]
  ds_read_b128 a[116:119], v5 offset:49408
  v_mfma_f32_16x16x32_bf16 a[188:191], a[152:155], v[72:75], a[188:191]
  ds_read_b128 a[120:123], v6 offset:49408
  v_mfma_f32_16x16x32_bf16 a[192:195], a[152:155], v[76:79], a[192:195]
  ds_read_b128 a[124:127], v7 offset:49408
  v_mfma_f32_16x16x32_bf16 a[196:199], a[156:159], v[68:71], a[196:199]
  ds_read_b128 a[128:131], v4 offset:57344
  v_mfma_f32_16x16x32_bf16 a[200:203], a[156:159], v[72:75], a[200:203]
  ds_read_b128 a[132:135], v5 offset:57344
  v_mfma_f32_16x16x32_bf16 a[204:207], a[156:159], v[76:79], a[204:207]
  ds_read_b128 a[136:139], v6 offset:57344
  v_exp_f32 v108, v108
  v_exp_f32 v109, v109
  v_exp_f32 v110, v110
  v_exp_f32 v111, v111
  v_add_f32 v28, v28, v108
  v_cvt_pk_bf16_f32 v66, v108, v109
  v_add_f32 v28, v28, v109
  v_add_f32 v28, v28, v110
  v_cvt_pk_bf16_f32 v67, v110, v111
  v_add_f32 v28, v28, v111
  v_max3_f32 v29, v26, v27, v28
  v_cmp_lt_f32 vcc, 0x44800000, v29
  s_nop 0
  s_cbranch_vccz L_ok12
  s_swappc_b64 s[70:71], s[72:73]
L_ok12:
  v_add_f32 v20, v20, v26
  v_add_f32 v21, v21, v27
  v_add_f32 v22, v22, v28
  s_sub_u32 s60, s60, 1
  s_cmp_lg_u32 s60, 0
  s_cbranch_scc1 L_attB
L_tailB:
  s_cmp_lg_u32 s52, 0
  s_cbranch_scc1 L_chkB
  s_lshr_b32 s64, s27, 1
  s_lshl_b32 s64, s64, 2
  v_mov_b32 v30, s64
  global_load_dword v95, v30, s[100:101] sc1
L_chkB:
  s_mov_b32 s77, 0
  s_lshl_b32 s61, s98, 7
  s_mov_b32 s62, s61
  s_mov_b32 s79, s98
  s_waitcnt lgkmcnt(9)
  v_mfma_f32_16x16x32_bf16 v[32:35], a[96:99], a[0:3], 0
  ds_read_b128 a[140:143], v7 offset:57344
  v_mfma_f32_16x16x32_bf16 v[36:39], a[96:99], a[4:7], 0
  ds_read_b128 a[144:147], v4 offset:57600
  v_mfma_f32_16x16x32_bf16 v[40:43], a[96:99], a[8:11], 0
  ds_read_b128 a[148:151], v5 offset:57600
  v_mfma_f32_16x16x32_bf16 v[32:35], a[100:103], a[12:15], v[32:35]
  ds_read_b128 a[152:155], v6 offset:57600
  v_mfma_f32_16x16x32_bf16 v[36:39], a[100:103], a[16:19], v[36:39]
  ds_read_b128 a[156:159], v7 offset:57600
  v_mfma_f32_16x16x32_bf16 v[40:43], a[100:103], a[20:23], v[40:43]
  s_waitcnt lgkmcnt(12)
  v_mfma_f32_16x16x32_bf16 v[32:35], a[104:107], a[24:27], v[32:35]
  v_mfma_f32_16x16x32_bf16 v[36:39], a[104:107], a[28:31], v[36:39]
  v_mfma_f32_16x16x32_bf16 v[40:43], a[104:107], a[32:35], v[40:43]
  v_mfma_f32_16x16x32_bf16 v[32:35], a[108:111], a[36:39], v[32:35]
  s_waitcnt lgkmcnt(0)
  s_barrier
  v_mfma_f32_16x16x32_bf16 v[36:39], a[108:111], a[40:43], v[36:39]
  v_mfma_f32_16x16x32_bf16 v[40:43], a[108:111], a[44:47], v[40:43]
  v_mfma_f32_16x16x32_bf16 v[32:35], a[112:115], a[48:51], v[32:35]
  v_mfma_f32_16x16x32_bf16 v[36:39], a[112:115], a[52:55], v[36:39]
  v_mfma_f32_16x16x32_bf16 v[40:43], a[112:115], a[56:59], v[40:43]
  v_mfma_f32_16x16x32_bf16 v[32:35], a[116:119], a[60:63], v[32:35]
  v_mfma_f32_16x16x32_bf16 v[36:39], a[116:119], a[64:67], v[36:39]
  v_mfma_f32_16x16x32_bf16 v[40:43], a[116:119], a[68:71], v[40:43]
  v_mfma_f32_16x16x32_bf16 v[32:35], a[120:123], a[72:75], v[32:35]
  v_mfma_f32_16x16x32_bf16 v[36:39], a[120:123], a[76:79], v[36:39]
  v_mfma_f32_16x16x32_bf16 v[40:43], a[120:123], a[80:83], v[40:43]
  v_mfma_f32_16x16x32_bf16 v[32:35], a[124:127], a[84:87], v[32:35]
  v_mfma_f32_16x16x32_bf16 v[36:39], a[124:127], a[88:91], v[36:39]
  v_mfma_f32_16x16x32_bf16 v[40:43], a[124:127], a[92:95], v[40:43]
  v_mfma_f32_16x16x32_bf16 v[44:47], a[128:131], a[0:3], 0
  v_mfma_f32_16x16x32_bf16 v[48:51], a[128:131], a[4:7], 0
  v_mfma_f32_16x16x32_bf16 v[52:55], a[128:131], a[8:11], 0
  v_mfma_f32_16x16x32_bf16 v[44:47], a[132:135], a[12:15], v[44:47]
  v_mfma_f32_16x16x32_bf16 v[48:51], a[132:135], a[16:19], v[48:51]
  v_mfma_f32_16x16x32_bf16 v[52:55], a[132:135], a[20:23], v[52:55]
  v_fma_f32 v0, v32, s63, -v23
  v_fma_f32 v1, v33, s63, -v23
  v_mfma_f32_16x16x32_bf16 v[44:47], a[136:139], a[24:27], v[44:47]
  v_fma_f32 v2, v34, s63, -v23
  v_fma_f32 v3, v35, s63, -v23
  v_mfma_f32_16x16x32_bf16 v[48:51], a[136:139], a[28:31], v[48:51]
  v_exp_f32 v0, v0
  v_mfma_f32_16x16x32_bf16 v[52:55], a[136:139], a[32:35], v[52:55]
  v_exp_f32 v1, v1
  v_mfma_f32_16x16x32_bf16 v[44:47], a[140:143], a[36:39], v[44:47]
  v_exp_f32 v2, v2
  v_mfma_f32_16x16x32_bf16 v[48:51], a[140:143], a[40:43], v[48:51]
  v_exp_f32 v3, v3
  v_mfma_f32_16x16x32_bf16 v[52:55], a[140:143], a[44:47], v[52:55]
  v_add_f32 v26, v0, v1
  v_cvt_pk_bf16_f32 v68, v0, v1
  v_mfma_f32_16x16x32_bf16 v[44:47], a[144:147], a[48:51], v[44:47]
  s_waitcnt vmcnt(8)
  s_barrier
  v_mfma_f32_16x16x32_bf16 v[48:51], a[144:147], a[52:55], v[48:51]
  ds_read_b64_tr_b16 a[96:97], v8 offset:0
  ds_read_b64_tr_b16 a[98:99], v8 offset:8192
  v_mfma_f32_16x16x32_bf16 v[52:55], a[144:147], a[56:59], v[52:55]
  ds_read_b64_tr_b16 a[100:101], v9 offset:0
  ds_read_b64_tr_b16 a[102:103], v9 offset:8192
  v_mfma_f32_16x16x32_bf16 v[44:47], a[148:151], a[60:63], v[44:47]
  ds_read_b64_tr_b16 a[104:105], v10 offset:0
  ds_read_b64_tr_b16 a[106:107], v10 offset:8192
  v_mfma_f32_16x16x32_bf16 v[48:51], a[148:151], a[64:67], v[48:51]
  ds_read_b64_tr_b16 a[108:109], v11 offset:0
  ds_read_b64_tr_b16 a[110:111], v11 offset:8192
  v_mfma_f32_16x16x32_bf16 v[52:55], a[148:151], a[68:71], v[52:55]
  ds_read_b64_tr_b16 a[112:113], v12 offset:0
  ds_read_b64_tr_b16 a[114:115], v12 offset:8192
  v_mfma_f32_16x16x32_bf16 v[44:47], a[152:155], a[72:75], v[44:47]
  ds_read_b64_tr_b16 a[116:117], v13 offset:0
  ds_read_b64_tr_b16 a[118:119], v13 offset:8192
  v_mfma_f32_16x16x32_bf16 v[48:51], a[152:155], a[76:79], v[48:51]
  s_waitcnt lgkmcnt(8)
  ds_read_b64_tr_b16 a[120:121], v14 offset:0
  ds_read_b64_tr_b16 a[122:123], v14 offset:8192
  v_mfma_f32_16x16x32_bf16 v[52:55], a[152:155], a[80:83], v[52:55]
  ds_read_b64_tr_b16 a[124:125], v15 offset:0
  ds_read_b64_tr_b16 a[126:127], v15 offset:8192
  v_mfma_f32_16x16x32_bf16 v[44:47], a[156:159], a[84:87], v[44:47]
  s_waitcnt lgkmcnt(8)
  ds_read_b64_tr_b16 a[128:129], v8 offset:256
  ds_read_b64_tr_b16 a[130:131], v8 offset:8448
  v_mfma_f32_16x16x32_bf16 v[48:51], a[156:159], a[88:91], v[48:51]
  ds_read_b64_tr_b16 a[132:133], v9 offset:256
  ds_read_b64_tr_b16 a[134:135], v9 offset:8448
  v_mfma_f32_16x16x32_bf16 v[52:55], a[156:159], a[92:95], v[52:55]
  s_waitcnt lgkmcnt(8)
  ds_read_b64_tr_b16 a[136:137], v10 offset:256
  ds_read_b64_tr_b16 a[138:139], v10 offset:8448
  v_add_f32 v26, v26, v2
  v_cvt_pk_bf16_f32 v69, v2, v3
  v_add_f32 v26, v26, v3
  v_fma_f32 v96, v36, s63, -v24
  v_fma_f32 v97, v37, s63, -v24
  v_fma_f32 v98, v38, s63, -v24
  v_fma_f32 v99, v39, s63, -v24
  v_exp_f32 v96, v96
  v_exp_f32 v97, v97
  v_exp_f32 v98, v98
  v_exp_f32 v99, v99
  v_add_f32 v27, v96, v97
  v_cvt_pk_bf16_f32 v72, v96, v97
  v_add_f32 v27, v27, v98
  v_cvt_pk_bf16_f32 v73, v98, v99
  v_add_f32 v27, v27, v99
  v_fma_f32 v108, v40, s63, -v25
  v_fma_f32 v109, v41, s63, -v25
  v_fma_f32 v110, v42, s63, -v25
  v_fma_f32 v111, v43, s63, -v25
  v_exp_f32 v108, v108
  v_exp_f32 v109, v109
  v_exp_f32 v110, v110
  v_exp_f32 v111, v111
  v_add_f32 v28, v108, v109
  v_cvt_pk_bf16_f32 v76, v108, v109
  v_add_f32 v28, v28, v110
  v_cvt_pk_bf16_f32 v77, v110, v111
  v_add_f32 v28, v28, v111
  v_mfma_f32_16x16x32_bf16 v[112:115], a[96:99], v[56:59], v[112:115]
  ds_read_b64_tr_b16 a[140:141], v11 offset:256
  ds_read_b64_tr_b16 a[142:143], v11 offset:8448
  v_mfma_f32_16x16x32_bf16 v[116:119], a[96:99], v[60:63], v[116:119]
  s_waitcnt lgkmcnt(8)
  ds_read_b64_tr_b16 a[144:145], v12 offset:256
  ds_read_b64_tr_b16 a[146:147], v12 offset:8448
  v_mfma_f32_16x16x32_bf16 v[120:123], a[96:99], v[64:67], v[120:123]
  ds_read_b64_tr_b16 a[148:149], v13 offset:256
  ds_read_b64_tr_b16 a[150:151], v13 offset:8448
  v_mfma_f32_16x16x32_bf16 v[124:127], a[100:103], v[56:59], v[124:127]
  s_waitcnt lgkmcnt(8)
  ds_read_b64_tr_b16 a[152:153], v14 offset:256
  ds_read_b64_tr_b16 a[154:155], v14 offset:8448
  v_mfma_f32_16x16x32_bf16 v[128:131], a[100:103], v[60:63], v[128:131]
  ds_read_b64_tr_b16 a[156:157], v15 offset:256
  ds_read_b64_tr_b16 a[158:159], v15 offset:8448
  v_mfma_f32_16x16x32_bf16 v[132:135], a[100:103], v[64:67], v[132:135]
  s_add_u32 m0, s97, 16384
  s_add_u32 s62, s61, 114688
  buffer_load_dwordx4 v88, s[40:43], s61 offen offset:0  lds
  v_mfma_f32_16x16x32_bf16 v[136:139], a[104:107], v[56:59], v[136:139]
  v_fma_f32 v0, v44, s63, -v23
  v_fma_f32 v1, v45, s63, -v23
  v_mfma_f32_16x16x32_bf16 v[140:143], a[104:107], v[60:63], v[140:143]
  v_fma_f32 v2, v46, s63, -v23
  v_fma_f32 v3, v47, s63, -v23
  v_mfma_f32_16x16x32_bf16 v[144:147], a[104:107], v[64:67], v[144:147]
  v_exp_f32 v0, v0
  v_mfma_f32_16x16x32_bf16 v[148:151], a[108:111], v[56:59], v[148:151]
  s_waitcnt lgkmcnt(0)
  s_barrier
  v_mfma_f32_16x16x32_bf16 v[152:155], a[108:111], v[60:63], v[152:155]
  buffer_load_dwordx4 v89, s[40:43], s61 offen offset:1024  lds
  v_mfma_f32_16x16x32_bf16 v[156:159], a[108:111], v[64:67], v[156:159]
  v_exp_f32 v1, v1
  v_mfma_f32_16x16x32_bf16 v[160:163], a[112:115], v[56:59], v[160:163]
  v_exp_f32 v2, v2
  v_mfma_f32_16x16x32_bf16 v[164:167], a[112:115], v[60:63], v[164:167]
  v_exp_f32 v3, v3
  v_mfma_f32_16x16x32_bf16 v[168:171], a[112:115], v[64:67], v[168:171]
  buffer_load_dwordx4 v90, s[40:43], s61 offen offset:2048  lds
  v_mfma_f32_16x16x32_bf16 v[172:175], a[116:119], v[56:59], v[172:175]
  v_add_f32 v26, v26, v0
  v_cvt_pk_bf16_f32 v70, v0, v1
  v_mfma_f32_16x16x32_bf16 v[176:179], a[116:119], v[60:63], v[176:179]
  v_add_f32 v26, v26, v1
  v_add_f32 v26, v26, v2
  v_mfma_f32_16x16x32_bf16 v[180:183], a[116:119], v[64:67], v[180:183]
  v_cvt_pk_bf16_f32 v71, v2, v3
  v_add_f32 v26, v26, v3
  v_mfma_f32_16x16x32_bf16 v[184:187], a[120:123], v[56:59], v[184:187]
  buffer_load_dwordx4 v91, s[40:43], s61 offen offset:3072  lds
  v_mfma_f32_16x16x32_bf16 v[188:191], a[120:123], v[60:63], v[188:191]
  v_fma_f32 v96, v48, s63, -v24
  v_fma_f32 v97, v49, s63, -v24
  v_mfma_f32_16x16x32_bf16 v[192:195], a[120:123], v[64:67], v[192:195]
  v_fma_f32 v98, v50, s63, -v24
  v_fma_f32 v99, v51, s63, -v24
  v_mfma_f32_16x16x32_bf16 v[196:199], a[124:127], v[56:59], v[196:199]
  v_exp_f32 v96, v96
  v_mfma_f32_16x16x32_bf16 v[200:203], a[124:127], v[60:63], v[200:203]
  s_add_u32 m0, s97, 81920
  s_add_u32 s61, s61, 128
  buffer_load_dwordx4 v88, s[40:43], s62 offen offset:0  lds
  v_mfma_f32_16x16x32_bf16 v[204:207], a[124:127], v[64:67], v[204:207]
  v_exp_f32 v97, v97
  v_mfma_f32_16x16x32_bf16 v[208:211], a[128:131], v[56:59], v[208:211]
  v_exp_f32 v98, v98
  v_mfma_f32_16x16x32_bf16 v[212:215], a[128:131], v[60:63], v[212:215]
  v_exp_f32 v99, v99
  v_mfma_f32_16x16x32_bf16 v[216:219], a[128:131], v[64:67], v[216:219]
  buffer_load_dwordx4 v89, s[40:43], s62 offen offset:1024  lds
  v_mfma_f32_16x16x32_bf16 v[220:223], a[132:135], v[56:59], v[220:223]
  v_add_f32 v27, v27, v96
  v_cvt_pk_bf16_f32 v74, v96, v97
  v_mfma_f32_16x16x32_bf16 v[224:227], a[132:135], v[60:63], v[224:227]
  v_add_f32 v27, v27, v97
  v_add_f32 v27, v27, v98
  v_mfma_f32_16x16x32_bf16 v[228:231], a[132:135], v[64:67], v[228:231]
  v_cvt_pk_bf16_f32 v75, v98, v99
  v_add_f32 v27, v27, v99
  v_mfma_f32_16x16x32_bf16 v[232:235], a[136:139], v[56:59], v[232:235]
  buffer_load_dwordx4 v90, s[40:43], s62 offen offset:2048  lds
  v_mfma_f32_16x16x32_bf16 v[236:239], a[136:139], v[60:63], v[236:239]
  v_fma_f32 v108, v52, s63, -v25
  v_fma_f32 v109, v53, s63, -v25
  v_mfma_f32_16x16x32_bf16 v[240:243], a[136:139], v[64:67], v[240:243]
  v_fma_f32 v110, v54, s63, -v25
  v_fma_f32 v111, v55, s63, -v25
  v_mfma_f32_16x16x32_bf16 v[244:247], a[140:143], v[56:59], v[244:247]
  v_exp_f32 v108, v108
  v_mfma_f32_16x16x32_bf16 v[248:251], a[140:143], v[60:63], v[248:251]
  buffer_load_dwordx4 v91, s[40:43], s62 offen offset:3072  lds
  v_mfma_f32_16x16x32_bf16 v[252:255], a[140:143], v[64:67], v[252:255]
  s_cmp_eq_u32 s61, 896
  s_cselect_b32 s61, 0, s61
  v_mfma_f32_16x16x32_bf16 a[160:163], a[144:147], v[56:59], a[160:163]
  s_add_u32 m0, s97, 49152
  s_add_u32 s62, s61, 114688
  buffer_load_dwordx4 v88, s[40:43], s61 offen offset:0  lds
  s_waitcnt vmcnt(9)
  s_barrier
  v_mfma_f32_16x16x32_bf16 a[164:167], a[144:147], v[60:63], a[164:167]
  ds_read_b64_tr_b16 a[96:97], v8 offset:32768
  ds_read_b64_tr_b16 a[98:99], v8 offset:40960
  v_mfma_f32_16x16x32_bf16 a[168:171], a[144:147], v[64:67], a[168:171]
  ds_read_b64_tr_b16 a[100:101], v9 offset:32768
  ds_read_b64_tr_b16 a[102:103], v9 offset:40960
  v_mfma_f32_16x16x32_bf16 a[172:175], a[148:151], v[56:59], a[172:175]
  ds_read_b64_tr_b16 a[104:105], v10 offset:32768
  ds_read_b64_tr_b16 a[106:107], v10 offset:40960
  v_mfma_f32_16x16x32_bf16 a[176:179], a[148:151], v[60:63], a[176:179]
  ds_read_b64_tr_b16 a[108:109], v11 offset:32768
  ds_read_b64_tr_b16 a[110:111], v11 offset:40960
  v_mfma_f32_16x16x32_bf16 a[180:183], a[148:151], v[64:67], a[180:183]
  ds_read_b64_tr_b16 a[112:113], v12 offset:32768
  ds_read_b64_tr_b16 a[114:115], v12 offset:40960
  v_mfma_f32_16x16x32_bf16 a[184:187], a[152:155], v[56:59], a[184:187]
  ds_read_b64_tr_b16 a[116:117], v13 offset:32768
  ds_read_b64_tr_b16 a[118:119], v13 offset:40960
  v_mfma_f32_16x16x32_bf16 a[188:191], a[152:155], v[60:63], a[188:191]
  s_waitcnt lgkmcnt(8)
  ds_read_b64_tr_b16 a[120:121], v14 offset:32768
  ds_read_b64_tr_b16 a[122:123], v14 offset:40960
  v_mfma_f32_16x16x32_bf16 a[192:195], a[152:155], v[64:67], a[192:195]
  ds_read_b64_tr_b16 a[124:125], v15 offset:32768
  ds_read_b64_tr_b16 a[126:127], v15 offset:40960
  v_mfma_f32_16x16x32_bf16 a[196:199], a[156:159], v[56:59], a[196:199]
  s_waitcnt lgkmcnt(8)
  ds_read_b64_tr_b16 a[128:129], v8 offset:33024
  ds_read_b64_tr_b16 a[130:131], v8 offset:41216
  v_mfma_f32_16x16x32_bf16 a[200:203], a[156:159], v[60:63], a[200:203]
  ds_read_b64_tr_b16 a[132:133], v9 offset:33024
  ds_read_b64_tr_b16 a[134:135], v9 offset:41216
  v_mfma_f32_16x16x32_bf16 a[204:207], a[156:159], v[64:67], a[204:207]
  s_waitcnt lgkmcnt(8)
  ds_read_b64_tr_b16 a[136:137], v10 offset:33024
  ds_read_b64_tr_b16 a[138:139], v10 offset:41216
  buffer_load_dwordx4 v89, s[40:43], s61 offen offset:1024  lds
  buffer_load_dwordx4 v90, s[40:43], s61 offen offset:2048  lds
  buffer_load_dwordx4 v91, s[40:43], s61 offen offset:3072  lds
  v_exp_f32 v109, v109
  v_exp_f32 v110, v110
  v_exp_f32 v111, v111
  v_add_f32 v28, v28, v108
  v_cvt_pk_bf16_f32 v78, v108, v109
  v_add_f32 v28, v28, v109
  v_add_f32 v28, v28, v110
  v_cvt_pk_bf16_f32 v79, v110, v111
  v_add_f32 v28, v28, v111
  v_max3_f32 v29, v26, v27, v28
  v_cmp_lt_f32 vcc, 0x44800000, v29
  s_nop 0
  s_cbranch_vccz L_ok13
  s_swappc_b64 s[70:71], s[74:75]
L_ok13:
  v_add_f32 v20, v20, v26
  v_add_f32 v21, v21, v27
  v_add_f32 v22, v22, v28
  v_mfma_f32_16x16x32_bf16 v[112:115], a[96:99], v[68:71], v[112:115]
  ds_read_b64_tr_b16 a[140:141], v11 offset:33024
  ds_read_b64_tr_b16 a[142:143], v11 offset:41216
  v_mfma_f32_16x16x32_bf16 v[116:119], a[96:99], v[72:75], v[116:119]
  s_waitcnt lgkmcnt(8)
  ds_read_b64_tr_b16 a[144:145], v12 offset:33024
  ds_read_b64_tr_b16 a[146:147], v12 offset:41216
  v_mfma_f32_16x16x32_bf16 v[120:123], a[96:99], v[76:79], v[120:123]
  ds_read_b64_tr_b16 a[148:149], v13 offset:33024
  ds_read_b64_tr_b16 a[150:151], v13 offset:41216
  v_mfma_f32_16x16x32_bf16 v[124:127], a[100:103], v[68:71], v[124:127]
  s_waitcnt lgkmcnt(8)
  ds_read_b64_tr_b16 a[152:153], v14 offset:33024
  ds_read_b64_tr_b16 a[154:155], v14 offset:41216
  v_mfma_f32_16x16x32_bf16 v[128:131], a[100:103], v[72:75], v[128:131]
  ds_read_b64_tr_b16 a[156:157], v15 offset:33024
  ds_read_b64_tr_b16 a[158:159], v15 offset:41216
  v_mfma_f32_16x16x32_bf16 v[132:135], a[100:103], v[76:79], v[132:135]
  s_add_u32 m0, s97, 114688
  s_add_u32 s61, s61, 128
  buffer_load_dwordx4 v88, s[40:43], s62 offen offset:0  lds
  v_mfma_f32_16x16x32_bf16 v[136:139], a[104:107], v[68:71], v[136:139]
  v_cvt_pk_bf16_f32 v112, v112, v113
  v_cvt_pk_bf16_f32 v113, v114, v115
  v_mfma_f32_16x16x32_bf16 v[140:143], a[104:107], v[72:75], v[140:143]
  v_mfma_f32_16x16x32_bf16 v[144:147], a[104:107], v[76:79], v[144:147]
  v_mfma_f32_16x16x32_bf16 v[148:151], a[108:111], v[68:71], v[148:151]
  s_waitcnt lgkmcnt(0)
  s_barrier
  v_mfma_f32_16x16x32_bf16 v[152:155], a[108:111], v[72:75], v[152:155]
  buffer_load_dwordx4 v89, s[40:43], s62 offen offset:1024  lds
  v_mfma_f32_16x16x32_bf16 v[156:159], a[108:111], v[76:79], v[156:159]
  v_cvt_pk_bf16_f32 v114, v124, v125
  v_cvt_pk_bf16_f32 v115, v126, v127
  v_mfma_f32_16x16x32_bf16 v[160:163], a[112:115], v[68:71], v[160:163]
  v_cvt_pk_bf16_f32 v116, v116, v117
  v_cvt_pk_bf16_f32 v117, v118, v119
  v_mfma_f32_16x16x32_bf16 v[164:167], a[112:115], v[72:75], v[164:167]
  v_cvt_pk_bf16_f32 v118, v128, v129
  v_cvt_pk_bf16_f32 v119, v130, v131
  v_mfma_f32_16x16x32_bf16 v[168:171], a[112:115], v[76:79], v[168:171]
  buffer_load_dwordx4 v90, s[40:43], s62 offen offset:2048  lds
  v_mfma_f32_16x16x32_bf16 v[172:175], a[116:119], v[68:71], v[172:175]
  v_cvt_pk_bf16_f32 v120, v120, v121
  v_cvt_pk_bf16_f32 v121, v122, v123
  v_mfma_f32_16x16x32_bf16 v[176:179], a[116:119], v[72:75], v[176:179]
  v_cvt_pk_bf16_f32 v122, v132, v133
  v_cvt_pk_bf16_f32 v123, v134, v135
  v_mfma_f32_16x16x32_bf16 v[180:183], a[116:119], v[76:79], v[180:183]
  v_cvt_pk_bf16_f32 v124, v136, v137
  v_cvt_pk_bf16_f32 v125, v138, v139
  v_mfma_f32_16x16x32_bf16 v[184:187], a[120:123], v[68:71], v[184:187]
  buffer_load_dwordx4 v91, s[40:43], s62 offen offset:3072  lds
  v_mfma_f32_16x16x32_bf16 v[188:191], a[120:123], v[72:75], v[188:191]
  s_cmp_eq_u32 s61, 896
  s_cselect_b32 s61, 0, s61
  v_mfma_f32_16x16x32_bf16 v[192:195], a[120:123], v[76:79], v[192:195]
  v_cvt_pk_bf16_f32 v126, v148, v149
  v_cvt_pk_bf16_f32 v127, v150, v151
  v_mfma_f32_16x16x32_bf16 v[196:199], a[124:127], v[68:71], v[196:199]
  v_cvt_pk_bf16_f32 v128, v140, v141
  v_cvt_pk_bf16_f32 v129, v142, v143
  v_mfma_f32_16x16x32_bf16 v[200:203], a[124:127], v[72:75], v[200:203]
  s_add_u32 m0, s97, 0
  s_add_u32 s62, s61, 114688
  buffer_load_dwordx4 v88, s[40:43], s61 offen offset:0  lds
  v_mfma_f32_16x16x32_bf16 v[204:207], a[124:127], v[76:79], v[204:207]
  v_cvt_pk_bf16_f32 v130, v152, v153
  v_cvt_pk_bf16_f32 v131, v154, v155
  v_mfma_f32_16x16x32_bf16 v[208:211], a[128:131], v[68:71], v[208:211]
  v_cvt_pk_bf16_f32 v132, v144, v145
  v_cvt_pk_bf16_f32 v133, v146, v147
  v_mfma_f32_16x16x32_bf16 v[212:215], a[128:131], v[72:75], v[212:215]
  v_cvt_pk_bf16_f32 v134, v156, v157
  v_cvt_pk_bf16_f32 v135, v158, v159
  v_mfma_f32_16x16x32_bf16 v[216:219], a[128:131], v[76:79], v[216:219]
  buffer_load_dwordx4 v89, s[40:43], s61 offen offset:1024  lds
  v_mfma_f32_16x16x32_bf16 v[220:223], a[132:135], v[68:71], v[220:223]
  v_cvt_pk_bf16_f32 v136, v160, v161
  v_cvt_pk_bf16_f32 v137, v162, v163
  v_mfma_f32_16x16x32_bf16 v[224:227], a[132:135], v[72:75], v[224:227]
  v_cvt_pk_bf16_f32 v138, v172, v173
  v_cvt_pk_bf16_f32 v139, v174, v175
  v_mfma_f32_16x16x32_bf16 v[228:231], a[132:135], v[76:79], v[228:231]
  v_cvt_pk_bf16_f32 v140, v164, v165
  v_cvt_pk_bf16_f32 v141, v166, v167
  v_mfma_f32_16x16x32_bf16 v[232:235], a[136:139], v[68:71], v[232:235]
  buffer_load_dwordx4 v90, s[40:43], s61 offen offset:2048  lds
  v_mfma_f32_16x16x32_bf16 v[236:239], a[136:139], v[72:75], v[236:239]
  v_cvt_pk_bf16_f32 v142, v176, v177
  v_cvt_pk_bf16_f32 v143, v178, v179
  v_mfma_f32_16x16x32_bf16 v[240:243], a[136:139], v[76:79], v[240:243]
  v_cvt_pk_bf16_f32 v144, v168, v169
  v_cvt_pk_bf16_f32 v145, v170, v171
  v_mfma_f32_16x16x32_bf16 v[244:247], a[140:143], v[68:71], v[244:247]
  v_cvt_pk_bf16_f32 v146, v180, v181
  v_cvt_pk_bf16_f32 v147, v182, v183
  v_mfma_f32_16x16x32_bf16 v[248:251], a[140:143], v[72:75], v[248:251]
  buffer_load_dwordx4 v91, s[40:43], s61 offen offset:3072  lds
  v_mfma_f32_16x16x32_bf16 v[252:255], a[140:143], v[76:79], v[252:255]
  v_cvt_pk_bf16_f32 v148, v184, v185
  v_cvt_pk_bf16_f32 v149, v186, v187
  v_mfma_f32_16x16x32_bf16 a[160:163], a[144:147], v[68:71], a[160:163]
  s_add_u32 m0, s97, 65536
  s_add_u32 s61, s61, 128
  buffer_load_dwordx4 v88, s[40:43], s62 offen offset:0  lds
  s_waitcnt vmcnt(13)
  s_barrier
  v_mfma_f32_16x16x32_bf16 a[164:167], a[144:147], v[72:75], a[164:167]
  ds_read_b64_tr_b16 a[96:97], v80 offset:16384
  v_cvt_pk_bf16_f32 v150, v196, v197
  v_mfma_f32_16x16x32_bf16 a[168:171], a[144:147], v[76:79], a[168:171]
  ds_read_b64_tr_b16 a[98:99], v80 offset:18432
  buffer_load_dwordx4 v89, s[40:43], s62 offen offset:1024  lds
  v_mfma_f32_16x16x32_bf16 a[172:175], a[148:151], v[68:71], a[172:175]
  ds_read_b64_tr_b16 a[100:101], v81 offset:16384
  v_cvt_pk_bf16_f32 v151, v198, v199
  v_mfma_f32_16x16x32_bf16 a[176:179], a[148:151], v[72:75], a[176:179]
  ds_read_b64_tr_b16 a[102:103], v81 offset:18432
  v_cvt_pk_bf16_f32 v152, v188, v189
  v_mfma_f32_16x16x32_bf16 a[180:183], a[148:151], v[76:79], a[180:183]
  ds_read_b64_tr_b16 a[104:105], v82 offset:16384
  v_cvt_pk_bf16_f32 v153, v190, v191
  v_mfma_f32_16x16x32_bf16 a[184:187], a[152:155], v[68:71], a[184:187]
  ds_read_b64_tr_b16 a[106:107], v82 offset:18432
  buffer_load_dwordx4 v90, s[40:43], s62 offen offset:2048  lds
  v_mfma_f32_16x16x32_bf16 a[188:191], a[152:155], v[72:75], a[188:191]
  ds_read_b64_tr_b16 a[108:109], v83 offset:16384
  v_cvt_pk_bf16_f32 v154, v200, v201
  v_mfma_f32_16x16x32_bf16 a[192:195], a[152:155], v[76:79], a[192:195]
  ds_read_b64_tr_b16 a[110:111], v83 offset:18432
  v_cvt_pk_bf16_f32 v155, v202, v203
  v_mfma_f32_16x16x32_bf16 a[196:199], a[156:159], v[68:71], a[196:199]
  ds_read_b64_tr_b16 a[112:113], v80 offset:20480
  v_cvt_pk_bf16_f32 v156, v192, v193
  v_mfma_f32_16x16x32_bf16 a[200:203], a[156:159], v[72:75], a[200:203]
  ds_read_b64_tr_b16 a[114:115], v80 offset:22528
  buffer_load_dwordx4 v91, s[40:43], s62 offen offset:3072  lds
  v_mfma_f32_16x16x32_bf16 a[204:207], a[156:159], v[76:79], a[204:207]
  s_cmp_eq_u32 s61, 896
  s_cselect_b32 s61, 0, s61
  s_nop 1
  s_waitcnt lgkmcnt(6)
  v_mfma_f32_16x16x32_bf16 v[32:35], a[96:99], v[112:115], 0
  ds_read_b64_tr_b16 a[116:117], v81 offset:20480
  v_cvt_pk_bf16_f32 v157, v194, v195
  v_mfma_f32_16x16x32_bf16 v[36:39], a[96:99], v[116:119], 0
  ds_read_b64_tr_b16 a[118:119], v81 offset:22528
  v_cvt_pk_bf16_f32 v158, v204, v205
  v_mfma_f32_16x16x32_bf16 v[40:43], a[96:99], v[120:123], 0
  v_cvt_pk_bf16_f32 v159, v206, v207
  v_cvt_pk_bf16_f32 v160, v208, v209
  v_mfma_f32_16x16x32_bf16 v[44:47], a[100:103], v[112:115], 0
  ds_read_b64_tr_b16 a[120:121], v82 offset:20480
  v_cvt_pk_bf16_f32 v161, v210, v211
  v_mfma_f32_16x16x32_bf16 v[48:51], a[100:103], v[116:119], 0
  ds_read_b64_tr_b16 a[122:123], v82 offset:22528
  v_cvt_pk_bf16_f32 v162, v220, v221
  v_mfma_f32_16x16x32_bf16 v[52:55], a[100:103], v[120:123], 0
  v_cvt_pk_bf16_f32 v163, v222, v223
  s_waitcnt lgkmcnt(6)
  v_mfma_f32_16x16x32_bf16 v[56:59], a[104:107], v[112:115], 0
  ds_read_b64_tr_b16 a[124:125], v83 offset:20480
  v_cvt_pk_bf16_f32 v164, v212, v213
  v_mfma_f32_16x16x32_bf16 v[60:63], a[104:107], v[116:119], 0
  ds_read_b64_tr_b16 a[126:127], v83 offset:22528
  v_cvt_pk_bf16_f32 v165, v214, v215
  v_mfma_f32_16x16x32_bf16 v[64:67], a[104:107], v[120:123], 0
  v_cvt_pk_bf16_f32 v166, v224, v225
  v_cvt_pk_bf16_f32 v167, v226, v227
  v_mfma_f32_16x16x32_bf16 v[68:71], a[108:111], v[112:115], 0
  ds_read_b64_tr_b16 a[96:97], v80 offset:24576
  v_cvt_pk_bf16_f32 v168, v216, v217
  v_mfma_f32_16x16x32_bf16 v[72:75], a[108:111], v[116:119], 0
  ds_read_b64_tr_b16 a[98:99], v80 offset:26624
  v_cvt_pk_bf16_f32 v169, v218, v219
  v_mfma_f32_16x16x32_bf16 v[76:79], a[108:111], v[120:123], 0
  v_cvt_pk_bf16_f32 v170, v228, v229
  s_waitcnt lgkmcnt(6)
  v_mfma_f32_16x16x32_bf16 v[32:35], a[112:115], v[124:127], v[32:35]
  ds_read_b64_tr_b16 a[100:101], v81 offset:24576
  v_cvt_pk_bf16_f32 v171, v230, v231
  v_mfma_f32_16x16x32_bf16 v[36:39], a[112:115], v[128:131], v[36:39]
  ds_read_b64_tr_b16 a[102:103], v81 offset:26624
  v_cvt_pk_bf16_f32 v172, v232, v233
  v_mfma_f32_16x16x32_bf16 v[40:43], a[112:115], v[132:135], v[40:43]
  v_cvt_pk_bf16_f32 v173, v234, v235
  v_cvt_pk_bf16_f32 v174, v244, v245
  v_mfma_f32_16x16x32_bf16 v[44:47], a[116:119], v[124:127], v[44:47]
  ds_read_b64_tr_b16 a[104:105], v82 offset:24576
  v_cvt_pk_bf16_f32 v175, v246, v247
  v_mfma_f32_16x16x32_bf16 v[48:51], a[116:119], v[128:131], v[48:51]
  ds_read_b64_tr_b16 a[106:107], v82 offset:26624
  v_cvt_pk_bf16_f32 v176, v236, v237
  v_mfma_f32_16x16x32_bf16 v[52:55], a[116:119], v[132:135], v[52:55]
  v_cvt_pk_bf16_f32 v177, v238, v239
  s_waitcnt lgkmcnt(6)
  v_mfma_f32_16x16x32_bf16 v[56:59], a[120:123], v[124:127], v[56:59]
  ds_read_b64_tr_b16 a[108:109], v83 offset:24576
  v_cvt_pk_bf16_f32 v178, v248, v249
  v_mfma_f32_16x16x32_bf16 v[60:63], a[120:123], v[128:131], v[60:63]
  ds_read_b64_tr_b16 a[110:111], v83 offset:26624
  v_cvt_pk_bf16_f32 v179, v250, v251
  v_mfma_f32_16x16x32_bf16 v[64:67], a[120:123], v[132:135], v[64:67]
  v_cvt_pk_bf16_f32 v180, v240, v241
  v_cvt_pk_bf16_f32 v181, v242, v243
  v_mfma_f32_16x16x32_bf16 v[68:71], a[124:127], v[124:127], v[68:71]
  ds_read_b64_tr_b16 a[112:113], v80 offset:28672
  v_cvt_pk_bf16_f32 v182, v252, v253
  v_mfma_f32_16x16x32_bf16 v[72:75], a[124:127], v[128:131], v[72:75]
  ds_read_b64_tr_b16 a[114:115], v80 offset:30720
  v_cvt_pk_bf16_f32 v183, v254, v255
  v_mfma_f32_16x16x32_bf16 v[76:79], a[124:127], v[132:135], v[76:79]
  v_accvgpr_read_b32 v0, a160
  s_waitcnt lgkmcnt(6)
  v_mfma_f32_16x16x32_bf16 v[32:35], a[96:99], v[136:139], v[32:35]
  ds_read_b64_tr_b16 a[116:117], v81 offset:28672
  v_accvgpr_read_b32 v1, a161
  v_mfma_f32_16x16x32_bf16 v[36:39], a[96:99], v[140:143], v[36:39]
  ds_read_b64_tr_b16 a[118:119], v81 offset:30720
  v_accvgpr_read_b32 v2, a162
  v_mfma_f32_16x16x32_bf16 v[40:43], a[96:99], v[144:147], v[40:43]
  v_accvgpr_read_b32 v3, a163
  v_cvt_pk_bf16_f32 v184, v0, v1
  v_mfma_f32_16x16x32_bf16 v[44:47], a[100:103], v[136:139], v[44:47]
  ds_read_b64_tr_b16 a[120:121], v82 offset:28672
  v_cvt_pk_bf16_f32 v185, v2, v3
  v_mfma_f32_16x16x32_bf16 v[48:51], a[100:103], v[140:143], v[48:51]
  ds_read_b64_tr_b16 a[122:123], v82 offset:30720
  v_accvgpr_read_b32 v96, a172
  v_mfma_f32_16x16x32_bf16 v[52:55], a[100:103], v[144:147], v[52:55]
  v_accvgpr_read_b32 v97, a173
  s_waitcnt lgkmcnt(6)
  v_mfma_f32_16x16x32_bf16 v[56:59], a[104:107], v[136:139], v[56:59]
  ds_read_b64_tr_b16 a[124:125], v83 offset:28672
  v_accvgpr_read_b32 v98, a174
  v_mfma_f32_16x16x32_bf16 v[60:63], a[104:107], v[140:143], v[60:63]
  ds_read_b64_tr_b16 a[126:127], v83 offset:30720
  v_accvgpr_read_b32 v99, a175
  v_mfma_f32_16x16x32_bf16 v[64:67], a[104:107], v[144:147], v[64:67]
  v_cvt_pk_bf16_f32 v186, v96, v97
  v_cvt_pk_bf16_f32 v187, v98, v99
  v_mfma_f32_16x16x32_bf16 v[68:71], a[108:111], v[136:139], v[68:71]
  ds_read_b64_tr_b16 a[96:97], v84 offset:16384
  v_accvgpr_read_b32 v0, a164
  v_mfma_f32_16x16x32_bf16 v[72:75], a[108:111], v[140:143], v[72:75]
  ds_read_b64_tr_b16 a[98:99], v84 offset:18432
  v_accvgpr_read_b32 v1, a165
  v_mfma_f32_16x16x32_bf16 v[76:79], a[108:111], v[144:147], v[76:79]
  v_accvgpr_read_b32 v2, a166
  s_waitcnt lgkmcnt(6)
  v_mfma_f32_16x16x32_bf16 v[32:35], a[112:115], v[148:151], v[32:35]
  ds_read_b64_tr_b16 a[100:101], v84 offset:20480
  v_accvgpr_read_b32 v3, a167
  v_mfma_f32_16x16x32_bf16 v[36:39], a[112:115], v[152:155], v[36:39]
  ds_read_b64_tr_b16 a[102:103], v84 offset:22528
  v_cvt_pk_bf16_f32 v188, v0, v1
  v_mfma_f32_16x16x32_bf16 v[40:43], a[112:115], v[156:159], v[40:43]
  v_cvt_pk_bf16_f32 v189, v2, v3
  v_accvgpr_read_b32 v96, a176
  v_mfma_f32_16x16x32_bf16 v[44:47], a[116:119], v[148:151], v[44:47]
  ds_read_b64_tr_b16 a[104:105], v84 offset:24576
  v_accvgpr_read_b32 v97, a177
  v_mfma_f32_16x16x32_bf16 v[48:51], a[116:119], v[152:155], v[48:51]
  ds_read_b64_tr_b16 a[106:107], v84 offset:26624
  v_accvgpr_read_b32 v98, a178
  v_mfma_f32_16x16x32_bf16 v[52:55], a[116:119], v[156:159], v[52:55]
  v_accvgpr_read_b32 v99, a179
  s_waitcnt lgkmcnt(6)
  v_mfma_f32_16x16x32_bf16 v[56:59], a[120:123], v[148:151], v[56:59]
  ds_read_b64_tr_b16 a[108:109], v84 offset:28672
  v_cvt_pk_bf16_f32 v190, v96, v97
  v_mfma_f32_16x16x32_bf16 v[60:63], a[120:123], v[152:155], v[60:63]
  ds_read_b64_tr_b16 a[110:111], v84 offset:30720
  v_cvt_pk_bf16_f32 v191, v98, v99
  v_mfma_f32_16x16x32_bf16 v[64:67], a[120:123], v[156:159], v[64:67]
  v_accvgpr_read_b32 v0, a168
  v_accvgpr_read_b32 v1, a169
  v_mfma_f32_16x16x32_bf16 v[68:71], a[124:127], v[148:151], v[68:71]
  ds_read_b64_tr_b16 a[112:113], v85 offset:16384
  v_accvgpr_read_b32 v2, a170
  v_mfma_f32_16x16x32_bf16 v[72:75], a[124:127], v[152:155], v[72:75]
  ds_read_b64_tr_b16 a[114:115], v85 offset:18432
  v_accvgpr_read_b32 v3, a171
  v_mfma_f32_16x16x32_bf16 v[76:79], a[124:127], v[156:159], v[76:79]
  v_cvt_pk_bf16_f32 v192, v0, v1
  v_cvt_pk_bf16_f32 v193, v2, v3
  v_accvgpr_read_b32 v96, a180
  v_accvgpr_read_b32 v97, a181
  v_accvgpr_read_b32 v98, a182
  v_accvgpr_read_b32 v99, a183
  v_cvt_pk_bf16_f32 v194, v96, v97
  v_cvt_pk_bf16_f32 v195, v98, v99
  v_accvgpr_read_b32 v0, a184
  v_accvgpr_read_b32 v1, a185
  v_accvgpr_read_b32 v2, a186
  v_accvgpr_read_b32 v3, a187
  v_cvt_pk_bf16_f32 v196, v0, v1
  v_cvt_pk_bf16_f32 v197, v2, v3
  v_accvgpr_read_b32 v96, a196
  v_accvgpr_read_b32 v97, a197
  v_accvgpr_read_b32 v98, a198
  v_accvgpr_read_b32 v99, a199
  v_cvt_pk_bf16_f32 v198, v96, v97
  v_cvt_pk_bf16_f32 v199, v98, v99
  v_accvgpr_read_b32 v0, a188
  v_accvgpr_read_b32 v1, a189
  v_accvgpr_read_b32 v2, a190
  v_accvgpr_read_b32 v3, a191
  v_cvt_pk_bf16_f32 v200, v0, v1
  v_cvt_pk_bf16_f32 v201, v2, v3
  v_accvgpr_read_b32 v96, a200
  v_accvgpr_read_b32 v97, a201
  v_accvgpr_read_b32 v98, a202
  v_accvgpr_read_b32 v99, a203
  v_cvt_pk_bf16_f32 v202, v96, v97
  v_cvt_pk_bf16_f32 v203, v98, v99
  v_accvgpr_read_b32 v0, a192
  v_accvgpr_read_b32 v1, a193
  v_accvgpr_read_b32 v2, a194
  v_accvgpr_read_b32 v3, a195
  v_cvt_pk_bf16_f32 v204, v0, v1
  v_cvt_pk_bf16_f32 v205, v2, v3
  v_accvgpr_read_b32 v96, a204
  v_accvgpr_read_b32 v97, a205
  v_accvgpr_read_b32 v98, a206
  v_accvgpr_read_b32 v99, a207
  v_cvt_pk_bf16_f32 v206, v96, v97
  v_cvt_pk_bf16_f32 v207, v98, v99
  s_nop 1
  s_waitcnt lgkmcnt(6)
  v_mfma_f32_16x16x32_bf16 v[32:35], a[96:99], v[160:163], v[32:35]
  ds_read_b64_tr_b16 a[116:117], v85 offset:20480
  s_add_u32 m0, s97, 32768
  s_add_u32 s62, s61, 114688
  buffer_load_dwordx4 v88, s[40:43], s61 offen offset:0  lds
  v_mfma_f32_16x16x32_bf16 v[36:39], a[96:99], v[164:167], v[36:39]
  ds_read_b64_tr_b16 a[118:119], v85 offset:22528
  v_mov_b32 v108, v20
  v_mfma_f32_16x16x32_bf16 v[40:43], a[96:99], v[168:171], v[40:43]
  v_mov_b32 v109, v21
  v_mov_b32 v110, v22
  v_mfma_f32_16x16x32_bf16 v[32:35], a[100:103], v[172:175], v[32:35]
  ds_read_b64_tr_b16 a[120:121], v85 offset:24576
  v_permlane32_swap_b32 v20, v108
  v_mfma_f32_16x16x32_bf16 v[36:39], a[100:103], v[176:179], v[36:39]
  ds_read_b64_tr_b16 a[122:123], v85 offset:26624
  buffer_load_dwordx4 v89, s[40:43], s61 offen offset:1024  lds
  v_mfma_f32_16x16x32_bf16 v[40:43], a[100:103], v[180:183], v[40:43]
  v_permlane32_swap_b32 v21, v109
  s_waitcnt lgkmcnt(6)
  v_mfma_f32_16x16x32_bf16 v[32:35], a[104:107], v[184:187], v[32:35]
  ds_read_b64_tr_b16 a[124:125], v85 offset:28672
  v_permlane32_swap_b32 v22, v110
  v_mfma_f32_16x16x32_bf16 v[36:39], a[104:107], v[188:191], v[36:39]
  ds_read_b64_tr_b16 a[126:127], v85 offset:30720
  v_add_f32 v20, v20, v108
  v_mfma_f32_16x16x32_bf16 v[40:43], a[104:107], v[192:195], v[40:43]
  buffer_load_dwordx4 v90, s[40:43], s61 offen offset:2048  lds
  v_mfma_f32_16x16x32_bf16 v[32:35], a[108:111], v[196:199], v[32:35]
  ds_read_b64_tr_b16 a[96:97], v86 offset:16384
  v_add_f32 v21, v21, v109
  v_mfma_f32_16x16x32_bf16 v[36:39], a[108:111], v[200:203], v[36:39]
  ds_read_b64_tr_b16 a[98:99], v86 offset:18432
  v_add_f32 v22, v22, v110
  v_mfma_f32_16x16x32_bf16 v[40:43], a[108:111], v[204:207], v[40:43]
  v_mov_b32 v108, v20
  s_waitcnt lgkmcnt(6)
  v_mfma_f32_16x16x32_bf16 v[44:47], a[112:115], v[160:163], v[44:47]
  ds_read_b64_tr_b16 a[100:101], v86 offset:20480
  v_mov_b32 v109, v21
  v_mov_b32 v110, v22
  v_permlane16_swap_b32 v20, v108
  v_permlane16_swap_b32 v21, v109
  v_permlane16_swap_b32 v22, v110
  v_add_f32 v20, v20, v108
  v_add_f32 v21, v21, v109
  v_add_f32 v22, v22, v110
  v_rcp_f32 v26, v20
  v_rcp_f32 v28, v21
  v_rcp_f32 v30, v22
  v_mfma_f32_16x16x32_bf16 v[48:51], a[112:115], v[164:167], v[48:51]
  ds_read_b64_tr_b16 a[102:103], v86 offset:22528
  buffer_load_dwordx4 v91, s[40:43], s61 offen offset:3072  lds
  v_mfma_f32_16x16x32_bf16 v[52:55], a[112:115], v[168:171], v[52:55]
  v_mfma_f32_16x16x32_bf16 v[44:47], a[116:119], v[172:175], v[44:47]
  ds_read_b64_tr_b16 a[104:105], v86 offset:24576
  v_mul_f32 v32, v32, v26
  v_mfma_f32_16x16x32_bf16 v[48:51], a[116:119], v[176:179], v[48:51]
  ds_read_b64_tr_b16 a[106:107], v86 offset:26624
  v_mul_f32 v33, v33, v26
  v_mfma_f32_16x16x32_bf16 v[52:55], a[116:119], v[180:183], v[52:55]
  s_add_u32 m0, s97, 98304
  s_add_u32 s61, s61, 128
  buffer_load_dwordx4 v88, s[40:43], s62 offen offset:0  lds
  s_waitcnt lgkmcnt(6)
  v_mfma_f32_16x16x32_bf16 v[44:47], a[120:123], v[184:187], v[44:47]
  ds_read_b64_tr_b16 a[108:109], v86 offset:28672
  v_mul_f32 v34, v34, v26
  v_mfma_f32_16x16x32_bf16 v[48:51], a[120:123], v[188:191], v[48:51]
  ds_read_b64_tr_b16 a[110:111], v86 offset:30720
  v_mul_f32 v35, v35, v26
  v_mfma_f32_16x16x32_bf16 v[52:55], a[120:123], v[192:195], v[52:55]
  v_cvt_pk_bf16_f32 v208, v32, v33
  v_cvt_pk_bf16_f32 v209, v34, v35
  v_mfma_f32_16x16x32_bf16 v[44:47], a[124:127], v[196:199], v[44:47]
  ds_read_b64_tr_b16 a[112:113], v87 offset:16384
  buffer_load_dwordx4 v89, s[40:43], s62 offen offset:1024  lds
  v_mfma_f32_16x16x32_bf16 v[48:51], a[124:127], v[200:203], v[48:51]
  ds_read_b64_tr_b16 a[114:115], v87 offset:18432
  v_mul_f32 v36, v36, v28
  v_mfma_f32_16x16x32_bf16 v[52:55], a[124:127], v[204:207], v[52:55]
  v_mul_f32 v37, v37, v28
  s_waitcnt lgkmcnt(6)
  v_mfma_f32_16x16x32_bf16 v[56:59], a[96:99], v[160:163], v[56:59]
  ds_read_b64_tr_b16 a[116:117], v87 offset:20480
  v_mul_f32 v38, v38, v28
  v_mfma_f32_16x16x32_bf16 v[60:63], a[96:99], v[164:167], v[60:63]
  ds_read_b64_tr_b16 a[118:119], v87 offset:22528
  buffer_load_dwordx4 v90, s[40:43], s62 offen offset:2048  lds
  v_mfma_f32_16x16x32_bf16 v[64:67], a[96:99], v[168:171], v[64:67]
  v_mul_f32 v39, v39, v28
  v_cvt_pk_bf16_f32 v212, v36, v37
  v_mfma_f32_16x16x32_bf16 v[56:59], a[100:103], v[172:175], v[56:59]
  ds_read_b64_tr_b16 a[120:121], v87 offset:24576
  v_cvt_pk_bf16_f32 v213, v38, v39
  v_mfma_f32_16x16x32_bf16 v[60:63], a[100:103], v[176:179], v[60:63]
  ds_read_b64_tr_b16 a[122:123], v87 offset:26624
  v_mul_f32 v40, v40, v30
  v_mfma_f32_16x16x32_bf16 v[64:67], a[100:103], v[180:183], v[64:67]
  buffer_load_dwordx4 v91, s[40:43], s62 offen offset:3072  lds
  s_waitcnt lgkmcnt(6)
  v_mfma_f32_16x16x32_bf16 v[56:59], a[104:107], v[184:187], v[56:59]
  ds_read_b64_tr_b16 a[124:125], v87 offset:28672
  v_mul_f32 v41, v41, v30
  v_mfma_f32_16x16x32_bf16 v[60:63], a[104:107], v[188:191], v[60:63]
  ds_read_b64_tr_b16 a[126:127], v87 offset:30720
  v_mul_f32 v42, v42, v30
  v_mfma_f32_16x16x32_bf16 v[64:67], a[104:107], v[192:195], v[64:67]
  s_cmp_eq_u32 s61, 896
  s_cselect_b32 s61, 0, s61
  v_mfma_f32_16x16x32_bf16 v[56:59], a[108:111], v[196:199], v[56:59]
  v_mul_f32 v43, v43, v30
  v_cvt_pk_bf16_f32 v216, v40, v41
  v_mfma_f32_16x16x32_bf16 v[60:63], a[108:111], v[200:203], v[60:63]
  v_cvt_pk_bf16_f32 v217, v42, v43
  v_mul_f32 v44, v44, v26
  v_mfma_f32_16x16x32_bf16 v[64:67], a[108:111], v[204:207], v[64:67]
  v_mul_f32 v45, v45, v26
  s_waitcnt lgkmcnt(4)
  v_mfma_f32_16x16x32_bf16 v[68:71], a[112:115], v[160:163], v[68:71]
  s_waitcnt vmcnt(16) lgkmcnt(0)
  s_barrier
  v_mfma_f32_16x16x32_bf16 v[72:75], a[112:115], v[164:167], v[72:75]
  ds_read_b64_tr_b16 a[96:97], v80 offset:49152
  v_mul_f32 v46, v46, v26
  v_mfma_f32_16x16x32_bf16 v[76:79], a[112:115], v[168:171], v[76:79]
  ds_read_b64_tr_b16 a[98:99], v80 offset:51200
  v_mul_f32 v47, v47, v26
  v_mfma_f32_16x16x32_bf16 v[68:71], a[116:119], v[172:175], v[68:71]
  ds_read_b64_tr_b16 a[100:101], v80 offset:53248
  v_cvt_pk_bf16_f32 v210, v44, v45
  v_mfma_f32_16x16x32_bf16 v[72:75], a[116:119], v[176:179], v[72:75]
  ds_read_b64_tr_b16 a[102:103], v80 offset:55296
  v_cvt_pk_bf16_f32 v211, v46, v47
  v_mfma_f32_16x16x32_bf16 v[76:79], a[116:119], v[180:183], v[76:79]
  ds_read_b64_tr_b16 a[104:105], v80 offset:57344
  v_mul_f32 v48, v48, v28
  v_mfma_f32_16x16x32_bf16 v[68:71], a[120:123], v[184:187], v[68:71]
  ds_read_b64_tr_b16 a[106:107], v80 offset:59392
  v_mul_f32 v49, v49, v28
  v_mfma_f32_16x16x32_bf16 v[72:75], a[120:123], v[188:191], v[72:75]
  ds_read_b64_tr_b16 a[108:109], v80 offset:61440
  v_mul_f32 v50, v50, v28
  v_mfma_f32_16x16x32_bf16 v[76:79], a[120:123], v[192:195], v[76:79]
  ds_read_b64_tr_b16 a[110:111], v80 offset:63488
  v_mul_f32 v51, v51, v28
  v_mfma_f32_16x16x32_bf16 v[68:71], a[124:127], v[196:199], v[68:71]
  ds_read_b64_tr_b16 a[112:113], v81 offset:49152
  v_cvt_pk_bf16_f32 v214, v48, v49
  v_mfma_f32_16x16x32_bf16 v[72:75], a[124:127], v[200:203], v[72:75]
  ds_read_b64_tr_b16 a[114:115], v81 offset:51200
  v_cvt_pk_bf16_f32 v215, v50, v51
  v_mfma_f32_16x16x32_bf16 v[76:79], a[124:127], v[204:207], v[76:79]
  v_mul_f32 v52, v52, v30
  v_mul_f32 v53, v53, v30
  v_mul_f32 v54, v54, v30
  v_mul_f32 v55, v55, v30
  v_cvt_pk_bf16_f32 v218, v52, v53
  v_cvt_pk_bf16_f32 v219, v54, v55
  s_mul_i32 s78, s79, 6144
  s_add_u32 s79, s79, 1
  s_cmp_eq_u32 s79, 7
  s_cselect_b32 s79, 0, s79
  s_add_u32 s99, s78, 3072
  buffer_store_dwordx4 v[208:211], v92, s[48:51], s78 offen offset:0 sc1
  v_mul_f32 v56, v56, v26
  v_mul_f32 v57, v57, v26
  v_mul_f32 v58, v58, v26
  v_mul_f32 v59, v59, v26
  v_cvt_pk_bf16_f32 v220, v56, v57
  v_cvt_pk_bf16_f32 v221, v58, v59
  v_mul_f32 v60, v60, v28
  v_mul_f32 v61, v61, v28
  v_mul_f32 v62, v62, v28
  v_mul_f32 v63, v63, v28
  v_cvt_pk_bf16_f32 v224, v60, v61
  v_cvt_pk_bf16_f32 v225, v62, v63
  v_mul_f32 v64, v64, v30
  v_mul_f32 v65, v65, v30
  v_mul_f32 v66, v66, v30
  v_mul_f32 v67, v67, v30
  v_cvt_pk_bf16_f32 v228, v64, v65
  v_cvt_pk_bf16_f32 v229, v66, v67
  s_waitcnt lgkmcnt(6)
  v_mfma_f32_16x16x32_bf16 v[32:35], a[96:99], v[112:115], 0
  ds_read_b64_tr_b16 a[116:117], v81 offset:53248
  s_add_u32 m0, s97, 16384
  s_add_u32 s62, s61, 114688
  buffer_load_dwordx4 v88, s[40:43], s61 offen offset:0  lds
  v_mfma_f32_16x16x32_bf16 v[36:39], a[96:99], v[116:119], 0
  ds_read_b64_tr_b16 a[118:119], v81 offset:55296
  v_mfma_f32_16x16x32_bf16 v[40:43], a[96:99], v[120:123], 0
  v_mfma_f32_16x16x32_bf16 v[32:35], a[100:103], v[124:127], v[32:35]
  ds_read_b64_tr_b16 a[120:121], v81 offset:57344
  v_mul_f32 v68, v68, v26
  v_mfma_f32_16x16x32_bf16 v[36:39], a[100:103], v[128:131], v[36:39]
  ds_read_b64_tr_b16 a[122:123], v81 offset:59392
  buffer_load_dwordx4 v89, s[40:43], s61 offen offset:1024  lds
  v_mfma_f32_16x16x32_bf16 v[40:43], a[100:103], v[132:135], v[40:43]
  v_mul_f32 v69, v69, v26
  s_waitcnt lgkmcnt(6)
  v_mfma_f32_16x16x32_bf16 v[32:35], a[104:107], v[136:139], v[32:35]
  ds_read_b64_tr_b16 a[124:125], v81 offset:61440
  v_mul_f32 v70, v70, v26
  v_mfma_f32_16x16x32_bf16 v[36:39], a[104:107], v[140:143], v[36:39]
  ds_read_b64_tr_b16 a[126:127], v81 offset:63488
  v_mul_f32 v71, v71, v26
  v_mfma_f32_16x16x32_bf16 v[40:43], a[104:107], v[144:147], v[40:43]
  buffer_load_dwordx4 v90, s[40:43], s61 offen offset:2048  lds
  v_mfma_f32_16x16x32_bf16 v[32:35], a[108:111], v[148:151], v[32:35]
  ds_read_b64_tr_b16 a[96:97], v82 offset:49152
  v_cvt_pk_bf16_f32 v222, v68, v69
  v_mfma_f32_16x16x32_bf16 v[36:39], a[108:111], v[152:155], v[36:39]
  ds_read_b64_tr_b16 a[98:99], v82 offset:51200
  v_cvt_pk_bf16_f32 v223, v70, v71
  v_mfma_f32_16x16x32_bf16 v[40:43], a[108:111], v[156:159], v[40:43]
  v_mul_f32 v72, v72, v28
  s_waitcnt lgkmcnt(6)
  v_mfma_f32_16x16x32_bf16 v[44:47], a[112:115], v[112:115], 0
  ds_read_b64_tr_b16 a[100:101], v82 offset:53248
  buffer_load_dwordx4 v91, s[40:43], s61 offen offset:3072  lds
  v_mfma_f32_16x16x32_bf16 v[48:51], a[112:115], v[116:119], 0
  ds_read_b64_tr_b16 a[102:103], v82 offset:55296
  v_mul_f32 v73, v73, v28
  v_mfma_f32_16x16x32_bf16 v[52:55], a[112:115], v[120:123], 0
  v_mul_f32 v74, v74, v28
  v_mul_f32 v75, v75, v28
  v_mfma_f32_16x16x32_bf16 v[44:47], a[116:119], v[124:127], v[44:47]
  ds_read_b64_tr_b16 a[104:105], v82 offset:57344
  v_cvt_pk_bf16_f32 v226, v72, v73
  v_mfma_f32_16x16x32_bf16 v[48:51], a[116:119], v[128:131], v[48:51]
  ds_read_b64_tr_b16 a[106:107], v82 offset:59392
  s_add_u32 m0, s97, 81920
  s_add_u32 s61, s61, 128
  buffer_load_dwordx4 v88, s[40:43], s62 offen offset:0  lds
  v_mfma_f32_16x16x32_bf16 v[52:55], a[116:119], v[132:135], v[52:55]
  v_cvt_pk_bf16_f32 v227, v74, v75
  s_waitcnt lgkmcnt(6)
  v_mfma_f32_16x16x32_bf16 v[44:47], a[120:123], v[136:139], v[44:47]
  ds_read_b64_tr_b16 a[108:109], v82 offset:61440
  v_mul_f32 v76, v76, v30
  v_mfma_f32_16x16x32_bf16 v[48:51], a[120:123], v[140:143], v[48:51]
  ds_read_b64_tr_b16 a[110:111], v82 offset:63488
  v_mul_f32 v77, v77, v30
  v_mfma_f32_16x16x32_bf16 v[52:55], a[120:123], v[144:147], v[52:55]
  buffer_load_dwordx4 v89, s[40:43], s62 offen offset:1024  lds
  v_mfma_f32_16x16x32_bf16 v[44:47], a[124:127], v[148:151], v[44:47]
  ds_read_b64_tr_b16 a[112:113], v83 offset:49152
  v_mul_f32 v78, v78, v30
  v_mfma_f32_16x16x32_bf16 v[48:51], a[124:127], v[152:155], v[48:51]
  ds_read_b64_tr_b16 a[114:115], v83 offset:51200
  v_mul_f32 v79, v79, v30
  v_mfma_f32_16x16x32_bf16 v[52:55], a[124:127], v[156:159], v[52:55]
  v_cvt_pk_bf16_f32 v230, v76, v77
  s_waitcnt lgkmcnt(6)
  v_mfma_f32_16x16x32_bf16 v[56:59], a[96:99], v[112:115], 0
  ds_read_b64_tr_b16 a[116:117], v83 offset:53248
  buffer_load_dwordx4 v90, s[40:43], s62 offen offset:2048  lds
  v_mfma_f32_16x16x32_bf16 v[60:63], a[96:99], v[116:119], 0
  ds_read_b64_tr_b16 a[118:119], v83 offset:55296
  v_cvt_pk_bf16_f32 v231, v78, v79
  v_mfma_f32_16x16x32_bf16 v[64:67], a[96:99], v[120:123], 0
  v_mfma_f32_16x16x32_bf16 v[56:59], a[100:103], v[124:127], v[56:59]
  ds_read_b64_tr_b16 a[120:121], v83 offset:57344
  v_mfma_f32_16x16x32_bf16 v[60:63], a[100:103], v[128:131], v[60:63]
  ds_read_b64_tr_b16 a[122:123], v83 offset:59392
  buffer_load_dwordx4 v91, s[40:43], s62 offen offset:3072  lds
  v_mfma_f32_16x16x32_bf16 v[64:67], a[100:103], v[132:135], v[64:67]
  s_waitcnt lgkmcnt(6)
  v_mfma_f32_16x16x32_bf16 v[56:59], a[104:107], v[136:139], v[56:59]
  ds_read_b64_tr_b16 a[124:125], v83 offset:61440
  v_mfma_f32_16x16x32_bf16 v[60:63], a[104:107], v[140:143], v[60:63]
  ds_read_b64_tr_b16 a[126:127], v83 offset:63488
  v_mfma_f32_16x16x32_bf16 v[64:67], a[104:107], v[144:147], v[64:67]
  s_cmp_eq_u32 s61, 896
  s_cselect_b32 s61, 0, s61
  v_mfma_f32_16x16x32_bf16 v[56:59], a[108:111], v[148:151], v[56:59]
  ds_read_b64_tr_b16 a[96:97], v84 offset:49152
  v_mfma_f32_16x16x32_bf16 v[60:63], a[108:111], v[152:155], v[60:63]
  ds_read_b64_tr_b16 a[98:99], v84 offset:51200
  v_mfma_f32_16x16x32_bf16 v[64:67], a[108:111], v[156:159], v[64:67]
  buffer_store_dwordx4 v[212:215], v92, s[48:51], s78 offen offset:1024 sc1
  s_waitcnt lgkmcnt(6)
  v_mfma_f32_16x16x32_bf16 v[68:71], a[112:115], v[112:115], 0
  ds_read_b64_tr_b16 a[100:101], v84 offset:53248
  v_mfma_f32_16x16x32_bf16 v[72:75], a[112:115], v[116:119], 0
  ds_read_b64_tr_b16 a[102:103], v84 offset:55296
  v_mfma_f32_16x16x32_bf16 v[76:79], a[112:115], v[120:123], 0
  v_mfma_f32_16x16x32_bf16 v[68:71], a[116:119], v[124:127], v[68:71]
  ds_read_b64_tr_b16 a[104:105], v84 offset:57344
  v_mfma_f32_16x16x32_bf16 v[72:75], a[116:119], v[128:131], v[72:75]
  ds_read_b64_tr_b16 a[106:107], v84 offset:59392
  v_mfma_f32_16x16x32_bf16 v[76:79], a[116:119], v[132:135], v[76:79]
  s_waitcnt lgkmcnt(6)
  v_mfma_f32_16x16x32_bf16 v[68:71], a[120:123], v[136:139], v[68:71]
  ds_read_b64_tr_b16 a[108:109], v84 offset:61440
  buffer_store_dwordx4 v[216:219], v92, s[48:51], s78 offen offset:2048 sc1
  v_mfma_f32_16x16x32_bf16 v[72:75], a[120:123], v[140:143], v[72:75]
  ds_read_b64_tr_b16 a[110:111], v84 offset:63488
  v_mfma_f32_16x16x32_bf16 v[76:79], a[120:123], v[144:147], v[76:79]
  v_mfma_f32_16x16x32_bf16 v[68:71], a[124:127], v[148:151], v[68:71]
  ds_read_b64_tr_b16 a[112:113], v85 offset:49152
  v_mfma_f32_16x16x32_bf16 v[72:75], a[124:127], v[152:155], v[72:75]
  ds_read_b64_tr_b16 a[114:115], v85 offset:51200
  v_mfma_f32_16x16x32_bf16 v[76:79], a[124:127], v[156:159], v[76:79]
  buffer_store_dwordx4 v[220:223], v92, s[48:51], s99 offen offset:0 sc1
  s_waitcnt lgkmcnt(6)
  v_mfma_f32_16x16x32_bf16 v[32:35], a[96:99], v[160:163], v[32:35]
  ds_read_b64_tr_b16 a[116:117], v85 offset:53248
  v_mfma_f32_16x16x32_bf16 v[36:39], a[96:99], v[164:167], v[36:39]
  ds_read_b64_tr_b16 a[118:119], v85 offset:55296
  buffer_store_dwordx4 v[224:227], v92, s[48:51], s99 offen offset:1024 sc1
  v_mfma_f32_16x16x32_bf16 v[40:43], a[96:99], v[168:171], v[40:43]
  v_mfma_f32_16x16x32_bf16 v[32:35], a[100:103], v[172:175], v[32:35]
  ds_read_b64_tr_b16 a[120:121], v85 offset:57344
  v_mfma_f32_16x16x32_bf16 v[36:39], a[100:103], v[176:179], v[36:39]
  ds_read_b64_tr_b16 a[122:123], v85 offset:59392
  v_mfma_f32_16x16x32_bf16 v[40:43], a[100:103], v[180:183], v[40:43]
  s_waitcnt lgkmcnt(6)
  v_mfma_f32_16x16x32_bf16 v[32:35], a[104:107], v[184:187], v[32:35]
  ds_read_b64_tr_b16 a[124:125], v85 offset:61440
  v_mfma_f32_16x16x32_bf16 v[36:39], a[104:107], v[188:191], v[36:39]
  ds_read_b64_tr_b16 a[126:127], v85 offset:63488
  v_mfma_f32_16x16x32_bf16 v[40:43], a[104:107], v[192:195], v[40:43]
  v_mfma_f32_16x16x32_bf16 v[32:35], a[108:111], v[196:199], v[32:35]
  ds_read_b64_tr_b16 a[96:97], v86 offset:49152
  v_mfma_f32_16x16x32_bf16 v[36:39], a[108:111], v[200:203], v[36:39]
  ds_read_b64_tr_b16 a[98:99], v86 offset:51200
  v_mfma_f32_16x16x32_bf16 v[40:43], a[108:111], v[204:207], v[40:43]
  s_waitcnt lgkmcnt(6)
  v_mfma_f32_16x16x32_bf16 v[44:47], a[112:115], v[160:163], v[44:47]
  ds_read_b64_tr_b16 a[100:101], v86 offset:53248
  v_mfma_f32_16x16x32_bf16 v[48:51], a[112:115], v[164:167], v[48:51]
  ds_read_b64_tr_b16 a[102:103], v86 offset:55296
  v_mfma_f32_16x16x32_bf16 v[52:55], a[112:115], v[168:171], v[52:55]
  buffer_store_dwordx4 v[228:231], v92, s[48:51], s99 offen offset:2048 sc1
  v_mfma_f32_16x16x32_bf16 v[44:47], a[116:119], v[172:175], v[44:47]
  ds_read_b64_tr_b16 a[104:105], v86 offset:57344
  v_mul_f32 v32, v32, v26
  v_mfma_f32_16x16x32_bf16 v[48:51], a[116:119], v[176:179], v[48:51]
  ds_read_b64_tr_b16 a[106:107], v86 offset:59392
  v_mul_f32 v33, v33, v26
  v_mfma_f32_16x16x32_bf16 v[52:55], a[116:119], v[180:183], v[52:55]
  v_mul_f32 v34, v34, v26
  s_waitcnt lgkmcnt(6)
  v_mfma_f32_16x16x32_bf16 v[44:47], a[120:123], v[184:187], v[44:47]
  ds_read_b64_tr_b16 a[108:109], v86 offset:61440
  v_mul_f32 v35, v35, v26
  v_mfma_f32_16x16x32_bf16 v[48:51], a[120:123], v[188:191], v[48:51]
  ds_read_b64_tr_b16 a[110:111], v86 offset:63488
  v_cvt_pk_bf16_f32 v208, v32, v33
  v_mfma_f32_16x16x32_bf16 v[52:55], a[120:123], v[192:195], v[52:55]
  v_cvt_pk_bf16_f32 v209, v34, v35
  v_mul_f32 v36, v36, v28
  v_mfma_f32_16x16x32_bf16 v[44:47], a[124:127], v[196:199], v[44:47]
  ds_read_b64_tr_b16 a[112:113], v87 offset:49152
  v_mul_f32 v37, v37, v28
  v_mfma_f32_16x16x32_bf16 v[48:51], a[124:127], v[200:203], v[48:51]
  ds_read_b64_tr_b16 a[114:115], v87 offset:51200
  v_mul_f32 v38, v38, v28
  v_mfma_f32_16x16x32_bf16 v[52:55], a[124:127], v[204:207], v[52:55]
  v_mul_f32 v39, v39, v28
  s_waitcnt lgkmcnt(6)
  v_mfma_f32_16x16x32_bf16 v[56:59], a[96:99], v[160:163], v[56:59]
  ds_read_b64_tr_b16 a[116:117], v87 offset:53248
  v_cvt_pk_bf16_f32 v212, v36, v37
  v_mfma_f32_16x16x32_bf16 v[60:63], a[96:99], v[164:167], v[60:63]
  ds_read_b64_tr_b16 a[118:119], v87 offset:55296
  v_cvt_pk_bf16_f32 v213, v38, v39
  v_mfma_f32_16x16x32_bf16 v[64:67], a[96:99], v[168:171], v[64:67]
  v_mul_f32 v40, v40, v30
  v_mul_f32 v41, v41, v30
  v_mfma_f32_16x16x32_bf16 v[56:59], a[100:103], v[172:175], v[56:59]
  ds_read_b64_tr_b16 a[120:121], v87 offset:57344
  v_mul_f32 v42, v42, v30
  v_mfma_f32_16x16x32_bf16 v[60:63], a[100:103], v[176:179], v[60:63]
  ds_read_b64_tr_b16 a[122:123], v87 offset:59392
  v_mul_f32 v43, v43, v30
  v_mfma_f32_16x16x32_bf16 v[64:67], a[100:103], v[180:183], v[64:67]
  v_cvt_pk_bf16_f32 v216, v40, v41
  s_waitcnt lgkmcnt(6)
  v_mfma_f32_16x16x32_bf16 v[56:59], a[104:107], v[184:187], v[56:59]
  ds_read_b64_tr_b16 a[124:125], v87 offset:61440
  v_cvt_pk_bf16_f32 v217, v42, v43
  v_mfma_f32_16x16x32_bf16 v[60:63], a[104:107], v[188:191], v[60:63]
  ds_read_b64_tr_b16 a[126:127], v87 offset:63488
  v_mul_f32 v44, v44, v26
  v_mfma_f32_16x16x32_bf16 v[64:67], a[104:107], v[192:195], v[64:67]
  v_mul_f32 v45, v45, v26
  v_mul_f32 v46, v46, v26
  v_mfma_f32_16x16x32_bf16 v[56:59], a[108:111], v[196:199], v[56:59]
  v_mul_f32 v47, v47, v26
  v_cvt_pk_bf16_f32 v210, v44, v45
  v_mfma_f32_16x16x32_bf16 v[60:63], a[108:111], v[200:203], v[60:63]
  v_cvt_pk_bf16_f32 v211, v46, v47
  v_mul_f32 v48, v48, v28
  v_mfma_f32_16x16x32_bf16 v[64:67], a[108:111], v[204:207], v[64:67]
  v_mul_f32 v49, v49, v28
  s_waitcnt lgkmcnt(4)
  v_mfma_f32_16x16x32_bf16 v[68:71], a[112:115], v[160:163], v[68:71]
  s_waitcnt vmcnt(22) lgkmcnt(0)
  s_barrier
  v_mfma_f32_16x16x32_bf16 v[72:75], a[112:115], v[164:167], v[72:75]
  ds_read_b64_tr_b16 a[96:97], v80 offset:0
  v_mul_f32 v50, v50, v28
  v_mfma_f32_16x16x32_bf16 v[76:79], a[112:115], v[168:171], v[76:79]
  ds_read_b64_tr_b16 a[98:99], v80 offset:2048
  v_mul_f32 v51, v51, v28
  v_mfma_f32_16x16x32_bf16 v[68:71], a[116:119], v[172:175], v[68:71]
  ds_read_b64_tr_b16 a[100:101], v80 offset:4096
  v_cvt_pk_bf16_f32 v214, v48, v49
  v_mfma_f32_16x16x32_bf16 v[72:75], a[116:119], v[176:179], v[72:75]
  ds_read_b64_tr_b16 a[102:103], v80 offset:6144
  v_cvt_pk_bf16_f32 v215, v50, v51
  v_mfma_f32_16x16x32_bf16 v[76:79], a[116:119], v[180:183], v[76:79]
  ds_read_b64_tr_b16 a[104:105], v80 offset:8192
  v_mul_f32 v52, v52, v30
  v_mfma_f32_16x16x32_bf16 v[68:71], a[120:123], v[184:187], v[68:71]
  ds_read_b64_tr_b16 a[106:107], v80 offset:10240
  v_mul_f32 v53, v53, v30
  v_mfma_f32_16x16x32_bf16 v[72:75], a[120:123], v[188:191], v[72:75]
  ds_read_b64_tr_b16 a[108:109], v80 offset:12288
  v_mul_f32 v54, v54, v30
  v_mfma_f32_16x16x32_bf16 v[76:79], a[120:123], v[192:195], v[76:79]
  ds_read_b64_tr_b16 a[110:111], v80 offset:14336
  v_mul_f32 v55, v55, v30
  v_mfma_f32_16x16x32_bf16 v[68:71], a[124:127], v[196:199], v[68:71]
  ds_read_b64_tr_b16 a[112:113], v81 offset:0
  v_cvt_pk_bf16_f32 v218, v52, v53
  v_mfma_f32_16x16x32_bf16 v[72:75], a[124:127], v[200:203], v[72:75]
  ds_read_b64_tr_b16 a[114:115], v81 offset:2048
  v_cvt_pk_bf16_f32 v219, v54, v55
  v_mfma_f32_16x16x32_bf16 v[76:79], a[124:127], v[204:207], v[76:79]
  s_mul_i32 s78, s79, 6144
  s_add_u32 s79, s79, 1
  s_cmp_eq_u32 s79, 7
  s_cselect_b32 s79, 0, s79
  s_add_u32 s99, s78, 3072
  buffer_store_dwordx4 v[208:211], v92, s[48:51], s78 offen offset:0 sc1
  v_mul_f32 v56, v56, v26
  v_mul_f32 v57, v57, v26
  v_mul_f32 v58, v58, v26
  v_mul_f32 v59, v59, v26
  v_cvt_pk_bf16_f32 v220, v56, v57
  v_cvt_pk_bf16_f32 v221, v58, v59
  v_mul_f32 v60, v60, v28
  v_mul_f32 v61, v61, v28
  v_mul_f32 v62, v62, v28
  v_mul_f32 v63, v63, v28
  v_cvt_pk_bf16_f32 v224, v60, v61
  v_cvt_pk_bf16_f32 v225, v62, v63
  v_mul_f32 v64, v64, v30
  v_mul_f32 v65, v65, v30
  v_mul_f32 v66, v66, v30
  v_mul_f32 v67, v67, v30
  v_cvt_pk_bf16_f32 v228, v64, v65
  v_cvt_pk_bf16_f32 v229, v66, v67
  s_waitcnt lgkmcnt(6)
  v_mfma_f32_16x16x32_bf16 v[32:35], a[96:99], v[112:115], 0
  ds_read_b64_tr_b16 a[116:117], v81 offset:4096
  s_add_u32 m0, s97, 49152
  s_add_u32 s62, s61, 114688
  buffer_load_dwordx4 v88, s[40:43], s61 offen offset:0  lds
  v_mfma_f32_16x16x32_bf16 v[36:39], a[96:99], v[116:119], 0
  ds_read_b64_tr_b16 a[118:119], v81 offset:6144
  v_mfma_f32_16x16x32_bf16 v[40:43], a[96:99], v[120:123], 0
  v_mfma_f32_16x16x32_bf16 v[32:35], a[100:103], v[124:127], v[32:35]
  ds_read_b64_tr_b16 a[120:121], v81 offset:8192
  v_mul_f32 v68, v68, v26
  v_mfma_f32_16x16x32_bf16 v[36:39], a[100:103], v[128:131], v[36:39]
  ds_read_b64_tr_b16 a[122:123], v81 offset:10240
  buffer_load_dwordx4 v89, s[40:43], s61 offen offset:1024  lds
  v_mfma_f32_16x16x32_bf16 v[40:43], a[100:103], v[132:135], v[40:43]
  v_mul_f32 v69, v69, v26
  s_waitcnt lgkmcnt(6)
  v_mfma_f32_16x16x32_bf16 v[32:35], a[104:107], v[136:139], v[32:35]
  ds_read_b64_tr_b16 a[124:125], v81 offset:12288
  v_mul_f32 v70, v70, v26
  v_mfma_f32_16x16x32_bf16 v[36:39], a[104:107], v[140:143], v[36:39]
  ds_read_b64_tr_b16 a[126:127], v81 offset:14336
  v_mul_f32 v71, v71, v26
  v_mfma_f32_16x16x32_bf16 v[40:43], a[104:107], v[144:147], v[40:43]
  buffer_load_dwordx4 v90, s[40:43], s61 offen offset:2048  lds
  v_mfma_f32_16x16x32_bf16 v[32:35], a[108:111], v[148:151], v[32:35]
  ds_read_b64_tr_b16 a[96:97], v82 offset:0
  v_cvt_pk_bf16_f32 v222, v68, v69
  v_mfma_f32_16x16x32_bf16 v[36:39], a[108:111], v[152:155], v[36:39]
  ds_read_b64_tr_b16 a[98:99], v82 offset:2048
  v_cvt_pk_bf16_f32 v223, v70, v71
  v_mfma_f32_16x16x32_bf16 v[40:43], a[108:111], v[156:159], v[40:43]
  v_mul_f32 v72, v72, v28
  s_waitcnt lgkmcnt(6)
  v_mfma_f32_16x16x32_bf16 v[44:47], a[112:115], v[112:115], 0
  ds_read_b64_tr_b16 a[100:101], v82 offset:4096
  buffer_load_dwordx4 v91, s[40:43], s61 offen offset:3072  lds
  v_mfma_f32_16x16x32_bf16 v[48:51], a[112:115], v[116:119], 0
  ds_read_b64_tr_b16 a[102:103], v82 offset:6144
  v_mul_f32 v73, v73, v28
  v_mfma_f32_16x16x32_bf16 v[52:55], a[112:115], v[120:123], 0
  v_mul_f32 v74, v74, v28
  v_mul_f32 v75, v75, v28
  v_mfma_f32_16x16x32_bf16 v[44:47], a[116:119], v[124:127], v[44:47]
  ds_read_b64_tr_b16 a[104:105], v82 offset:8192
  v_cvt_pk_bf16_f32 v226, v72, v73
  v_mfma_f32_16x16x32_bf16 v[48:51], a[116:119], v[128:131], v[48:51]
  ds_read_b64_tr_b16 a[106:107], v82 offset:10240
  s_add_u32 m0, s97, 114688
  s_add_u32 s61, s61, 128
  buffer_load_dwordx4 v88, s[40:43], s62 offen offset:0  lds
  v_mfma_f32_16x16x32_bf16 v[52:55], a[116:119], v[132:135], v[52:55]
  v_cvt_pk_bf16_f32 v227, v74, v75
  s_waitcnt lgkmcnt(6)
  v_mfma_f32_16x16x32_bf16 v[44:47], a[120:123], v[136:139], v[44:47]
  ds_read_b64_tr_b16 a[108:109], v82 offset:12288
  v_mul_f32 v76, v76, v30
  v_mfma_f32_16x16x32_bf16 v[48:51], a[120:123], v[140:143], v[48:51]
  ds_read_b64_tr_b16 a[110:111], v82 offset:14336
  v_mul_f32 v77, v77, v30
  v_mfma_f32_16x16x32_bf16 v[52:55], a[120:123], v[144:147], v[52:55]
  buffer_load_dwordx4 v89, s[40:43], s62 offen offset:1024  lds
  v_mfma_f32_16x16x32_bf16 v[44:47], a[124:127], v[148:151], v[44:47]
  ds_read_b64_tr_b16 a[112:113], v83 offset:0
  v_mul_f32 v78, v78, v30
  v_mfma_f32_16x16x32_bf16 v[48:51], a[124:127], v[152:155], v[48:51]
  ds_read_b64_tr_b16 a[114:115], v83 offset:2048
  v_mul_f32 v79, v79, v30
  v_mfma_f32_16x16x32_bf16 v[52:55], a[124:127], v[156:159], v[52:55]
  v_cvt_pk_bf16_f32 v230, v76, v77
  s_waitcnt lgkmcnt(6)
  v_mfma_f32_16x16x32_bf16 v[56:59], a[96:99], v[112:115], 0
  ds_read_b64_tr_b16 a[116:117], v83 offset:4096
  buffer_load_dwordx4 v90, s[40:43], s62 offen offset:2048  lds
  v_mfma_f32_16x16x32_bf16 v[60:63], a[96:99], v[116:119], 0
  ds_read_b64_tr_b16 a[118:119], v83 offset:6144
  v_cvt_pk_bf16_f32 v231, v78, v79
  v_mfma_f32_16x16x32_bf16 v[64:67], a[96:99], v[120:123], 0
  v_mfma_f32_16x16x32_bf16 v[56:59], a[100:103], v[124:127], v[56:59]
  ds_read_b64_tr_b16 a[120:121], v83 offset:8192
  v_mfma_f32_16x16x32_bf16 v[60:63], a[100:103], v[128:131], v[60:63]
  ds_read_b64_tr_b16 a[122:123], v83 offset:10240
  buffer_load_dwordx4 v91, s[40:43], s62 offen offset:3072  lds
  v_mfma_f32_16x16x32_bf16 v[64:67], a[100:103], v[132:135], v[64:67]
  s_waitcnt lgkmcnt(6)
  v_mfma_f32_16x16x32_bf16 v[56:59], a[104:107], v[136:139], v[56:59]
  ds_read_b64_tr_b16 a[124:125], v83 offset:12288
  v_mfma_f32_16x16x32_bf16 v[60:63], a[104:107], v[140:143], v[60:63]
  ds_read_b64_tr_b16 a[126:127], v83 offset:14336
  v_mfma_f32_16x16x32_bf16 v[64:67], a[104:107], v[144:147], v[64:67]
  s_cmp_eq_u32 s61, 896
  s_cselect_b32 s61, 0, s61
  v_mfma_f32_16x16x32_bf16 v[56:59], a[108:111], v[148:151], v[56:59]
  ds_read_b64_tr_b16 a[96:97], v84 offset:0
  v_mfma_f32_16x16x32_bf16 v[60:63], a[108:111], v[152:155], v[60:63]
  ds_read_b64_tr_b16 a[98:99], v84 offset:2048
  v_mfma_f32_16x16x32_bf16 v[64:67], a[108:111], v[156:159], v[64:67]
  buffer_store_dwordx4 v[212:215], v92, s[48:51], s78 offen offset:1024 sc1
  s_waitcnt lgkmcnt(6)
  v_mfma_f32_16x16x32_bf16 v[68:71], a[112:115], v[112:115], 0
  ds_read_b64_tr_b16 a[100:101], v84 offset:4096
  v_mfma_f32_16x16x32_bf16 v[72:75], a[112:115], v[116:119], 0
  ds_read_b64_tr_b16 a[102:103], v84 offset:6144
  v_mfma_f32_16x16x32_bf16 v[76:79], a[112:115], v[120:123], 0
  v_mfma_f32_16x16x32_bf16 v[68:71], a[116:119], v[124:127], v[68:71]
  ds_read_b64_tr_b16 a[104:105], v84 offset:8192
  v_mfma_f32_16x16x32_bf16 v[72:75], a[116:119], v[128:131], v[72:75]
  ds_read_b64_tr_b16 a[106:107], v84 offset:10240
  v_mfma_f32_16x16x32_bf16 v[76:79], a[116:119], v[132:135], v[76:79]
  s_waitcnt lgkmcnt(6)
  v_mfma_f32_16x16x32_bf16 v[68:71], a[120:123], v[136:139], v[68:71]
  ds_read_b64_tr_b16 a[108:109], v84 offset:12288
  buffer_store_dwordx4 v[216:219], v92, s[48:51], s78 offen offset:2048 sc1
  v_mfma_f32_16x16x32_bf16 v[72:75], a[120:123], v[140:143], v[72:75]
  ds_read_b64_tr_b16 a[110:111], v84 offset:14336
  v_mfma_f32_16x16x32_bf16 v[76:79], a[120:123], v[144:147], v[76:79]
  v_mfma_f32_16x16x32_bf16 v[68:71], a[124:127], v[148:151], v[68:71]
  ds_read_b64_tr_b16 a[112:113], v85 offset:0
  v_mfma_f32_16x16x32_bf16 v[72:75], a[124:127], v[152:155], v[72:75]
  ds_read_b64_tr_b16 a[114:115], v85 offset:2048
  v_mfma_f32_16x16x32_bf16 v[76:79], a[124:127], v[156:159], v[76:79]
  buffer_store_dwordx4 v[220:223], v92, s[48:51], s99 offen offset:0 sc1
  s_waitcnt lgkmcnt(6)
  v_mfma_f32_16x16x32_bf16 v[32:35], a[96:99], v[160:163], v[32:35]
  ds_read_b64_tr_b16 a[116:117], v85 offset:4096
  v_mfma_f32_16x16x32_bf16 v[36:39], a[96:99], v[164:167], v[36:39]
  ds_read_b64_tr_b16 a[118:119], v85 offset:6144
  buffer_store_dwordx4 v[224:227], v92, s[48:51], s99 offen offset:1024 sc1
  v_mfma_f32_16x16x32_bf16 v[40:43], a[96:99], v[168:171], v[40:43]
  v_mfma_f32_16x16x32_bf16 v[32:35], a[100:103], v[172:175], v[32:35]
  ds_read_b64_tr_b16 a[120:121], v85 offset:8192
  v_mfma_f32_16x16x32_bf16 v[36:39], a[100:103], v[176:179], v[36:39]
  ds_read_b64_tr_b16 a[122:123], v85 offset:10240
  v_mfma_f32_16x16x32_bf16 v[40:43], a[100:103], v[180:183], v[40:43]
  s_waitcnt lgkmcnt(6)
  v_mfma_f32_16x16x32_bf16 v[32:35], a[104:107], v[184:187], v[32:35]
  ds_read_b64_tr_b16 a[124:125], v85 offset:12288
  v_mfma_f32_16x16x32_bf16 v[36:39], a[104:107], v[188:191], v[36:39]
  ds_read_b64_tr_b16 a[126:127], v85 offset:14336
  v_mfma_f32_16x16x32_bf16 v[40:43], a[104:107], v[192:195], v[40:43]
  v_mfma_f32_16x16x32_bf16 v[32:35], a[108:111], v[196:199], v[32:35]
  ds_read_b64_tr_b16 a[96:97], v86 offset:0
  v_mfma_f32_16x16x32_bf16 v[36:39], a[108:111], v[200:203], v[36:39]
  ds_read_b64_tr_b16 a[98:99], v86 offset:2048
  v_mfma_f32_16x16x32_bf16 v[40:43], a[108:111], v[204:207], v[40:43]
  s_waitcnt lgkmcnt(6)
  v_mfma_f32_16x16x32_bf16 v[44:47], a[112:115], v[160:163], v[44:47]
  ds_read_b64_tr_b16 a[100:101], v86 offset:4096
  v_mfma_f32_16x16x32_bf16 v[48:51], a[112:115], v[164:167], v[48:51]
  ds_read_b64_tr_b16 a[102:103], v86 offset:6144
  v_mfma_f32_16x16x32_bf16 v[52:55], a[112:115], v[168:171], v[52:55]
  buffer_store_dwordx4 v[228:231], v92, s[48:51], s99 offen offset:2048 sc1
  v_mfma_f32_16x16x32_bf16 v[44:47], a[116:119], v[172:175], v[44:47]
  ds_read_b64_tr_b16 a[104:105], v86 offset:8192
  v_mul_f32 v32, v32, v26
  v_mfma_f32_16x16x32_bf16 v[48:51], a[116:119], v[176:179], v[48:51]
  ds_read_b64_tr_b16 a[106:107], v86 offset:10240
  v_mul_f32 v33, v33, v26
  v_mfma_f32_16x16x32_bf16 v[52:55], a[116:119], v[180:183], v[52:55]
  v_mul_f32 v34, v34, v26
  s_waitcnt lgkmcnt(6)
  v_mfma_f32_16x16x32_bf16 v[44:47], a[120:123], v[184:187], v[44:47]
  ds_read_b64_tr_b16 a[108:109], v86 offset:12288
  v_mul_f32 v35, v35, v26
  v_mfma_f32_16x16x32_bf16 v[48:51], a[120:123], v[188:191], v[48:51]
  ds_read_b64_tr_b16 a[110:111], v86 offset:14336
  v_cvt_pk_bf16_f32 v208, v32, v33
  v_mfma_f32_16x16x32_bf16 v[52:55], a[120:123], v[192:195], v[52:55]
  v_cvt_pk_bf16_f32 v209, v34, v35
  v_mul_f32 v36, v36, v28
  v_mfma_f32_16x16x32_bf16 v[44:47], a[124:127], v[196:199], v[44:47]
  ds_read_b64_tr_b16 a[112:113], v87 offset:0
  v_mul_f32 v37, v37, v28
  v_mfma_f32_16x16x32_bf16 v[48:51], a[124:127], v[200:203], v[48:51]
  ds_read_b64_tr_b16 a[114:115], v87 offset:2048
  v_mul_f32 v38, v38, v28
  v_mfma_f32_16x16x32_bf16 v[52:55], a[124:127], v[204:207], v[52:55]
  v_mul_f32 v39, v39, v28
  s_waitcnt lgkmcnt(6)
  v_mfma_f32_16x16x32_bf16 v[56:59], a[96:99], v[160:163], v[56:59]
  ds_read_b64_tr_b16 a[116:117], v87 offset:4096
  v_cvt_pk_bf16_f32 v212, v36, v37
  v_mfma_f32_16x16x32_bf16 v[60:63], a[96:99], v[164:167], v[60:63]
  ds_read_b64_tr_b16 a[118:119], v87 offset:6144
  v_cvt_pk_bf16_f32 v213, v38, v39
  v_mfma_f32_16x16x32_bf16 v[64:67], a[96:99], v[168:171], v[64:67]
  v_mul_f32 v40, v40, v30
  v_mul_f32 v41, v41, v30
  v_mfma_f32_16x16x32_bf16 v[56:59], a[100:103], v[172:175], v[56:59]
  ds_read_b64_tr_b16 a[120:121], v87 offset:8192
  v_mul_f32 v42, v42, v30
  v_mfma_f32_16x16x32_bf16 v[60:63], a[100:103], v[176:179], v[60:63]
  ds_read_b64_tr_b16 a[122:123], v87 offset:10240
  v_mul_f32 v43, v43, v30
  v_mfma_f32_16x16x32_bf16 v[64:67], a[100:103], v[180:183], v[64:67]
  v_cvt_pk_bf16_f32 v216, v40, v41
  s_waitcnt lgkmcnt(6)
  v_mfma_f32_16x16x32_bf16 v[56:59], a[104:107], v[184:187], v[56:59]
  ds_read_b64_tr_b16 a[124:125], v87 offset:12288
  v_cvt_pk_bf16_f32 v217, v42, v43
  v_mfma_f32_16x16x32_bf16 v[60:63], a[104:107], v[188:191], v[60:63]
  ds_read_b64_tr_b16 a[126:127], v87 offset:14336
  v_mul_f32 v44, v44, v26
  v_mfma_f32_16x16x32_bf16 v[64:67], a[104:107], v[192:195], v[64:67]
  v_mul_f32 v45, v45, v26
  v_mul_f32 v46, v46, v26
  v_mfma_f32_16x16x32_bf16 v[56:59], a[108:111], v[196:199], v[56:59]
  v_mul_f32 v47, v47, v26
  v_cvt_pk_bf16_f32 v210, v44, v45
  v_mfma_f32_16x16x32_bf16 v[60:63], a[108:111], v[200:203], v[60:63]
  v_cvt_pk_bf16_f32 v211, v46, v47
  v_mul_f32 v48, v48, v28
  v_mfma_f32_16x16x32_bf16 v[64:67], a[108:111], v[204:207], v[64:67]
  v_mul_f32 v49, v49, v28
  s_waitcnt lgkmcnt(4)
  v_mfma_f32_16x16x32_bf16 v[68:71], a[112:115], v[160:163], v[68:71]
  s_waitcnt vmcnt(28) lgkmcnt(0)
  s_barrier
  v_mfma_f32_16x16x32_bf16 v[72:75], a[112:115], v[164:167], v[72:75]
  ds_read_b64_tr_b16 a[96:97], v80 offset:32768
  v_mul_f32 v50, v50, v28
  v_mfma_f32_16x16x32_bf16 v[76:79], a[112:115], v[168:171], v[76:79]
  ds_read_b64_tr_b16 a[98:99], v80 offset:34816
  v_mul_f32 v51, v51, v28
  v_mfma_f32_16x16x32_bf16 v[68:71], a[116:119], v[172:175], v[68:71]
  ds_read_b64_tr_b16 a[100:101], v80 offset:36864
  v_cvt_pk_bf16_f32 v214, v48, v49
  v_mfma_f32_16x16x32_bf16 v[72:75], a[116:119], v[176:179], v[72:75]
  ds_read_b64_tr_b16 a[102:103], v80 offset:38912
  v_cvt_pk_bf16_f32 v215, v50, v51
  v_mfma_f32_16x16x32_bf16 v[76:79], a[116:119], v[180:183], v[76:79]
  ds_read_b64_tr_b16 a[104:105], v80 offset:40960
  v_mul_f32 v52, v52, v30
  v_mfma_f32_16x16x32_bf16 v[68:71], a[120:123], v[184:187], v[68:71]
  ds_read_b64_tr_b16 a[106:107], v80 offset:43008
  v_mul_f32 v53, v53, v30
  v_mfma_f32_16x16x32_bf16 v[72:75], a[120:123], v[188:191], v[72:75]
  ds_read_b64_tr_b16 a[108:109], v80 offset:45056
  v_mul_f32 v54, v54, v30
  v_mfma_f32_16x16x32_bf16 v[76:79], a[120:123], v[192:195], v[76:79]
  ds_read_b64_tr_b16 a[110:111], v80 offset:47104
  v_mul_f32 v55, v55, v30
  v_mfma_f32_16x16x32_bf16 v[68:71], a[124:127], v[196:199], v[68:71]
  ds_read_b64_tr_b16 a[112:113], v81 offset:32768
  v_cvt_pk_bf16_f32 v218, v52, v53
  v_mfma_f32_16x16x32_bf16 v[72:75], a[124:127], v[200:203], v[72:75]
  ds_read_b64_tr_b16 a[114:115], v81 offset:34816
  v_cvt_pk_bf16_f32 v219, v54, v55
  v_mfma_f32_16x16x32_bf16 v[76:79], a[124:127], v[204:207], v[76:79]
  s_mul_i32 s78, s79, 6144
  s_add_u32 s79, s79, 1
  s_cmp_eq_u32 s79, 7
  s_cselect_b32 s79, 0, s79
  s_add_u32 s99, s78, 3072
  buffer_store_dwordx4 v[208:211], v92, s[48:51], s78 offen offset:0 sc1
  v_mul_f32 v56, v56, v26
  v_mul_f32 v57, v57, v26
  v_mul_f32 v58, v58, v26
  v_mul_f32 v59, v59, v26
  v_cvt_pk_bf16_f32 v220, v56, v57
  v_cvt_pk_bf16_f32 v221, v58, v59
  v_mul_f32 v60, v60, v28
  v_mul_f32 v61, v61, v28
  v_mul_f32 v62, v62, v28
  v_mul_f32 v63, v63, v28
  v_cvt_pk_bf16_f32 v224, v60, v61
  v_cvt_pk_bf16_f32 v225, v62, v63
  v_mul_f32 v64, v64, v30
  v_mul_f32 v65, v65, v30
  v_mul_f32 v66, v66, v30
  v_mul_f32 v67, v67, v30
  v_cvt_pk_bf16_f32 v228, v64, v65
  v_cvt_pk_bf16_f32 v229, v66, v67
  s_waitcnt lgkmcnt(6)
  v_mfma_f32_16x16x32_bf16 v[32:35], a[96:99], v[112:115], 0
  ds_read_b64_tr_b16 a[116:117], v81 offset:36864
  s_add_u32 m0, s97, 0
  s_add_u32 s62, s61, 114688
  buffer_load_dwordx4 v88, s[40:43], s61 offen offset:0  lds
  v_mfma_f32_16x16x32_bf16 v[36:39], a[96:99], v[116:119], 0
  ds_read_b64_tr_b16 a[118:119], v81 offset:38912
  v_mfma_f32_16x16x32_bf16 v[40:43], a[96:99], v[120:123], 0
  v_mfma_f32_16x16x32_bf16 v[32:35], a[100:103], v[124:127], v[32:35]
  ds_read_b64_tr_b16 a[120:121], v81 offset:40960
  v_mul_f32 v68, v68, v26
  v_mfma_f32_16x16x32_bf16 v[36:39], a[100:103], v[128:131], v[36:39]
  ds_read_b64_tr_b16 a[122:123], v81 offset:43008
  buffer_load_dwordx4 v89, s[40:43], s61 offen offset:1024  lds
  v_mfma_f32_16x16x32_bf16 v[40:43], a[100:103], v[132:135], v[40:43]
  v_mul_f32 v69, v69, v26
  s_waitcnt lgkmcnt(6)
  v_mfma_f32_16x16x32_bf16 v[32:35], a[104:107], v[136:139], v[32:35]
  ds_read_b64_tr_b16 a[124:125], v81 offset:45056
  v_mul_f32 v70, v70, v26
  v_mfma_f32_16x16x32_bf16 v[36:39], a[104:107], v[140:143], v[36:39]
  ds_read_b64_tr_b16 a[126:127], v81 offset:47104
  v_mul_f32 v71, v71, v26
  v_mfma_f32_16x16x32_bf16 v[40:43], a[104:107], v[144:147], v[40:43]
  buffer_load_dwordx4 v90, s[40:43], s61 offen offset:2048  lds
  v_mfma_f32_16x16x32_bf16 v[32:35], a[108:111], v[148:151], v[32:35]
  ds_read_b64_tr_b16 a[96:97], v82 offset:32768
  v_cvt_pk_bf16_f32 v222, v68, v69
  v_mfma_f32_16x16x32_bf16 v[36:39], a[108:111], v[152:155], v[36:39]
  ds_read_b64_tr_b16 a[98:99], v82 offset:34816
  v_cvt_pk_bf16_f32 v223, v70, v71
  v_mfma_f32_16x16x32_bf16 v[40:43], a[108:111], v[156:159], v[40:43]
  v_mul_f32 v72, v72, v28
  s_waitcnt lgkmcnt(6)
  v_mfma_f32_16x16x32_bf16 v[44:47], a[112:115], v[112:115], 0
  ds_read_b64_tr_b16 a[100:101], v82 offset:36864
  buffer_load_dwordx4 v91, s[40:43], s61 offen offset:3072  lds
  v_mfma_f32_16x16x32_bf16 v[48:51], a[112:115], v[116:119], 0
  ds_read_b64_tr_b16 a[102:103], v82 offset:38912
  v_mul_f32 v73, v73, v28
  v_mfma_f32_16x16x32_bf16 v[52:55], a[112:115], v[120:123], 0
  v_mul_f32 v74, v74, v28
  v_mul_f32 v75, v75, v28
  v_mfma_f32_16x16x32_bf16 v[44:47], a[116:119], v[124:127], v[44:47]
  ds_read_b64_tr_b16 a[104:105], v82 offset:40960
  v_cvt_pk_bf16_f32 v226, v72, v73
  v_mfma_f32_16x16x32_bf16 v[48:51], a[116:119], v[128:131], v[48:51]
  ds_read_b64_tr_b16 a[106:107], v82 offset:43008
  s_add_u32 m0, s97, 65536
  s_add_u32 s61, s61, 128
  buffer_load_dwordx4 v88, s[40:43], s62 offen offset:0  lds
  v_mfma_f32_16x16x32_bf16 v[52:55], a[116:119], v[132:135], v[52:55]
  v_cvt_pk_bf16_f32 v227, v74, v75
  s_waitcnt lgkmcnt(6)
  v_mfma_f32_16x16x32_bf16 v[44:47], a[120:123], v[136:139], v[44:47]
  ds_read_b64_tr_b16 a[108:109], v82 offset:45056
  v_mul_f32 v76, v76, v30
  v_mfma_f32_16x16x32_bf16 v[48:51], a[120:123], v[140:143], v[48:51]
  ds_read_b64_tr_b16 a[110:111], v82 offset:47104
  v_mul_f32 v77, v77, v30
  v_mfma_f32_16x16x32_bf16 v[52:55], a[120:123], v[144:147], v[52:55]
  buffer_load_dwordx4 v89, s[40:43], s62 offen offset:1024  lds
  v_mfma_f32_16x16x32_bf16 v[44:47], a[124:127], v[148:151], v[44:47]
  ds_read_b64_tr_b16 a[112:113], v83 offset:32768
  v_mul_f32 v78, v78, v30
  v_mfma_f32_16x16x32_bf16 v[48:51], a[124:127], v[152:155], v[48:51]
  ds_read_b64_tr_b16 a[114:115], v83 offset:34816
  v_mul_f32 v79, v79, v30
  v_mfma_f32_16x16x32_bf16 v[52:55], a[124:127], v[156:159], v[52:55]
  v_cvt_pk_bf16_f32 v230, v76, v77
  s_waitcnt lgkmcnt(6)
  v_mfma_f32_16x16x32_bf16 v[56:59], a[96:99], v[112:115], 0
  ds_read_b64_tr_b16 a[116:117], v83 offset:36864
  buffer_load_dwordx4 v90, s[40:43], s62 offen offset:2048  lds
  v_mfma_f32_16x16x32_bf16 v[60:63], a[96:99], v[116:119], 0
  ds_read_b64_tr_b16 a[118:119], v83 offset:38912
  v_cvt_pk_bf16_f32 v231, v78, v79
  v_mfma_f32_16x16x32_bf16 v[64:67], a[96:99], v[120:123], 0
  v_mfma_f32_16x16x32_bf16 v[56:59], a[100:103], v[124:127], v[56:59]
  ds_read_b64_tr_b16 a[120:121], v83 offset:40960
  v_mfma_f32_16x16x32_bf16 v[60:63], a[100:103], v[128:131], v[60:63]
  ds_read_b64_tr_b16 a[122:123], v83 offset:43008
  buffer_load_dwordx4 v91, s[40:43], s62 offen offset:3072  lds
  v_mfma_f32_16x16x32_bf16 v[64:67], a[100:103], v[132:135], v[64:67]
  s_waitcnt lgkmcnt(6)
  v_mfma_f32_16x16x32_bf16 v[56:59], a[104:107], v[136:139], v[56:59]
  ds_read_b64_tr_b16 a[124:125], v83 offset:45056
  v_mfma_f32_16x16x32_bf16 v[60:63], a[104:107], v[140:143], v[60:63]
  ds_read_b64_tr_b16 a[126:127], v83 offset:47104
  v_mfma_f32_16x16x32_bf16 v[64:67], a[104:107], v[144:147], v[64:67]
  s_cmp_eq_u32 s61, 896
  s_cselect_b32 s61, 0, s61
  v_mfma_f32_16x16x32_bf16 v[56:59], a[108:111], v[148:151], v[56:59]
  ds_read_b64_tr_b16 a[96:97], v84 offset:32768
  v_mfma_f32_16x16x32_bf16 v[60:63], a[108:111], v[152:155], v[60:63]
  ds_read_b64_tr_b16 a[98:99], v84 offset:34816
  v_mfma_f32_16x16x32_bf16 v[64:67], a[108:111], v[156:159], v[64:67]
  buffer_store_dwordx4 v[212:215], v92, s[48:51], s78 offen offset:1024 sc1
  s_waitcnt lgkmcnt(6)
  v_mfma_f32_16x16x32_bf16 v[68:71], a[112:115], v[112:115], 0
  ds_read_b64_tr_b16 a[100:101], v84 offset:36864
  v_mfma_f32_16x16x32_bf16 v[72:75], a[112:115], v[116:119], 0
  ds_read_b64_tr_b16 a[102:103], v84 offset:38912
  v_mfma_f32_16x16x32_bf16 v[76:79], a[112:115], v[120:123], 0
  v_mfma_f32_16x16x32_bf16 v[68:71], a[116:119], v[124:127], v[68:71]
  ds_read_b64_tr_b16 a[104:105], v84 offset:40960
  v_mfma_f32_16x16x32_bf16 v[72:75], a[116:119], v[128:131], v[72:75]
  ds_read_b64_tr_b16 a[106:107], v84 offset:43008
  v_mfma_f32_16x16x32_bf16 v[76:79], a[116:119], v[132:135], v[76:79]
  s_waitcnt lgkmcnt(6)
  v_mfma_f32_16x16x32_bf16 v[68:71], a[120:123], v[136:139], v[68:71]
  ds_read_b64_tr_b16 a[108:109], v84 offset:45056
  buffer_store_dwordx4 v[216:219], v92, s[48:51], s78 offen offset:2048 sc1
  v_mfma_f32_16x16x32_bf16 v[72:75], a[120:123], v[140:143], v[72:75]
  ds_read_b64_tr_b16 a[110:111], v84 offset:47104
  v_mfma_f32_16x16x32_bf16 v[76:79], a[120:123], v[144:147], v[76:79]
  v_mfma_f32_16x16x32_bf16 v[68:71], a[124:127], v[148:151], v[68:71]
  ds_read_b64_tr_b16 a[112:113], v85 offset:32768
  v_mfma_f32_16x16x32_bf16 v[72:75], a[124:127], v[152:155], v[72:75]
  ds_read_b64_tr_b16 a[114:115], v85 offset:34816
  v_mfma_f32_16x16x32_bf16 v[76:79], a[124:127], v[156:159], v[76:79]
  buffer_store_dwordx4 v[220:223], v92, s[48:51], s99 offen offset:0 sc1
  s_waitcnt lgkmcnt(6)
  v_mfma_f32_16x16x32_bf16 v[32:35], a[96:99], v[160:163], v[32:35]
  ds_read_b64_tr_b16 a[116:117], v85 offset:36864
  v_mfma_f32_16x16x32_bf16 v[36:39], a[96:99], v[164:167], v[36:39]
  ds_read_b64_tr_b16 a[118:119], v85 offset:38912
  buffer_store_dwordx4 v[224:227], v92, s[48:51], s99 offen offset:1024 sc1
  v_mfma_f32_16x16x32_bf16 v[40:43], a[96:99], v[168:171], v[40:43]
  v_mfma_f32_16x16x32_bf16 v[32:35], a[100:103], v[172:175], v[32:35]
  ds_read_b64_tr_b16 a[120:121], v85 offset:40960
  v_mfma_f32_16x16x32_bf16 v[36:39], a[100:103], v[176:179], v[36:39]
  ds_read_b64_tr_b16 a[122:123], v85 offset:43008
  v_mfma_f32_16x16x32_bf16 v[40:43], a[100:103], v[180:183], v[40:43]
  s_waitcnt lgkmcnt(6)
  v_mfma_f32_16x16x32_bf16 v[32:35], a[104:107], v[184:187], v[32:35]
  ds_read_b64_tr_b16 a[124:125], v85 offset:45056
  v_mfma_f32_16x16x32_bf16 v[36:39], a[104:107], v[188:191], v[36:39]
  ds_read_b64_tr_b16 a[126:127], v85 offset:47104
  v_mfma_f32_16x16x32_bf16 v[40:43], a[104:107], v[192:195], v[40:43]
  v_mfma_f32_16x16x32_bf16 v[32:35], a[108:111], v[196:199], v[32:35]
  ds_read_b64_tr_b16 a[96:97], v86 offset:32768
  v_mfma_f32_16x16x32_bf16 v[36:39], a[108:111], v[200:203], v[36:39]
  ds_read_b64_tr_b16 a[98:99], v86 offset:34816
  v_mfma_f32_16x16x32_bf16 v[40:43], a[108:111], v[204:207], v[40:43]
  s_waitcnt lgkmcnt(6)
  v_mfma_f32_16x16x32_bf16 v[44:47], a[112:115], v[160:163], v[44:47]
  ds_read_b64_tr_b16 a[100:101], v86 offset:36864
  v_mfma_f32_16x16x32_bf16 v[48:51], a[112:115], v[164:167], v[48:51]
  ds_read_b64_tr_b16 a[102:103], v86 offset:38912
  v_mfma_f32_16x16x32_bf16 v[52:55], a[112:115], v[168:171], v[52:55]
  buffer_store_dwordx4 v[228:231], v92, s[48:51], s99 offen offset:2048 sc1
  v_mfma_f32_16x16x32_bf16 v[44:47], a[116:119], v[172:175], v[44:47]
  ds_read_b64_tr_b16 a[104:105], v86 offset:40960
  v_mul_f32 v32, v32, v26
  v_mfma_f32_16x16x32_bf16 v[48:51], a[116:119], v[176:179], v[48:51]
  ds_read_b64_tr_b16 a[106:107], v86 offset:43008
  v_mul_f32 v33, v33, v26
  v_mfma_f32_16x16x32_bf16 v[52:55], a[116:119], v[180:183], v[52:55]
  v_mul_f32 v34, v34, v26
  s_waitcnt lgkmcnt(6)
  v_mfma_f32_16x16x32_bf16 v[44:47], a[120:123], v[184:187], v[44:47]
  ds_read_b64_tr_b16 a[108:109], v86 offset:45056
  v_mul_f32 v35, v35, v26
  v_mfma_f32_16x16x32_bf16 v[48:51], a[120:123], v[188:191], v[48:51]
  ds_read_b64_tr_b16 a[110:111], v86 offset:47104
  v_cvt_pk_bf16_f32 v208, v32, v33
  v_mfma_f32_16x16x32_bf16 v[52:55], a[120:123], v[192:195], v[52:55]
  v_cvt_pk_bf16_f32 v209, v34, v35
  v_mul_f32 v36, v36, v28
  v_mfma_f32_16x16x32_bf16 v[44:47], a[124:127], v[196:199], v[44:47]
  ds_read_b64_tr_b16 a[112:113], v87 offset:32768
  v_mul_f32 v37, v37, v28
  v_mfma_f32_16x16x32_bf16 v[48:51], a[124:127], v[200:203], v[48:51]
  ds_read_b64_tr_b16 a[114:115], v87 offset:34816
  v_mul_f32 v38, v38, v28
  v_mfma_f32_16x16x32_bf16 v[52:55], a[124:127], v[204:207], v[52:55]
  v_mul_f32 v39, v39, v28
  s_waitcnt lgkmcnt(6)
  v_mfma_f32_16x16x32_bf16 v[56:59], a[96:99], v[160:163], v[56:59]
  ds_read_b64_tr_b16 a[116:117], v87 offset:36864
  v_cvt_pk_bf16_f32 v212, v36, v37
  v_mfma_f32_16x16x32_bf16 v[60:63], a[96:99], v[164:167], v[60:63]
  ds_read_b64_tr_b16 a[118:119], v87 offset:38912
  v_cvt_pk_bf16_f32 v213, v38, v39
  v_mfma_f32_16x16x32_bf16 v[64:67], a[96:99], v[168:171], v[64:67]
  v_mul_f32 v40, v40, v30
  v_mul_f32 v41, v41, v30
  v_mfma_f32_16x16x32_bf16 v[56:59], a[100:103], v[172:175], v[56:59]
  ds_read_b64_tr_b16 a[120:121], v87 offset:40960
  v_mul_f32 v42, v42, v30
  v_mfma_f32_16x16x32_bf16 v[60:63], a[100:103], v[176:179], v[60:63]
  ds_read_b64_tr_b16 a[122:123], v87 offset:43008
  v_mul_f32 v43, v43, v30
  v_mfma_f32_16x16x32_bf16 v[64:67], a[100:103], v[180:183], v[64:67]
  v_cvt_pk_bf16_f32 v216, v40, v41
  s_waitcnt lgkmcnt(6)
  v_mfma_f32_16x16x32_bf16 v[56:59], a[104:107], v[184:187], v[56:59]
  ds_read_b64_tr_b16 a[124:125], v87 offset:45056
  v_cvt_pk_bf16_f32 v217, v42, v43
  v_mfma_f32_16x16x32_bf16 v[60:63], a[104:107], v[188:191], v[60:63]
  ds_read_b64_tr_b16 a[126:127], v87 offset:47104
  v_mul_f32 v44, v44, v26
  v_mfma_f32_16x16x32_bf16 v[64:67], a[104:107], v[192:195], v[64:67]
  v_mul_f32 v45, v45, v26
  v_mul_f32 v46, v46, v26
  v_mfma_f32_16x16x32_bf16 v[56:59], a[108:111], v[196:199], v[56:59]
  v_mul_f32 v47, v47, v26
  v_cvt_pk_bf16_f32 v210, v44, v45
  v_mfma_f32_16x16x32_bf16 v[60:63], a[108:111], v[200:203], v[60:63]
  v_cvt_pk_bf16_f32 v211, v46, v47
  v_mul_f32 v48, v48, v28
  v_mfma_f32_16x16x32_bf16 v[64:67], a[108:111], v[204:207], v[64:67]
  v_mul_f32 v49, v49, v28
  s_waitcnt lgkmcnt(4)
  v_mfma_f32_16x16x32_bf16 v[68:71], a[112:115], v[160:163], v[68:71]
  s_waitcnt vmcnt(5) lgkmcnt(0)
  s_barrier
  v_mfma_f32_16x16x32_bf16 v[72:75], a[112:115], v[164:167], v[72:75]
  ds_read_b64_tr_b16 a[96:97], v80 offset:16384
  v_mul_f32 v50, v50, v28
  v_mfma_f32_16x16x32_bf16 v[76:79], a[112:115], v[168:171], v[76:79]
  ds_read_b64_tr_b16 a[98:99], v80 offset:18432
  v_mul_f32 v51, v51, v28
  v_mfma_f32_16x16x32_bf16 v[68:71], a[116:119], v[172:175], v[68:71]
  ds_read_b64_tr_b16 a[100:101], v80 offset:20480
  v_cvt_pk_bf16_f32 v214, v48, v49
  v_mfma_f32_16x16x32_bf16 v[72:75], a[116:119], v[176:179], v[72:75]
  ds_read_b64_tr_b16 a[102:103], v80 offset:22528
  v_cvt_pk_bf16_f32 v215, v50, v51
  v_mfma_f32_16x16x32_bf16 v[76:79], a[116:119], v[180:183], v[76:79]
  ds_read_b64_tr_b16 a[104:105], v80 offset:24576
  v_mul_f32 v52, v52, v30
  v_mfma_f32_16x16x32_bf16 v[68:71], a[120:123], v[184:187], v[68:71]
  ds_read_b64_tr_b16 a[106:107], v80 offset:26624
  v_mul_f32 v53, v53, v30
  v_mfma_f32_16x16x32_bf16 v[72:75], a[120:123], v[188:191], v[72:75]
  ds_read_b64_tr_b16 a[108:109], v80 offset:28672
  v_mul_f32 v54, v54, v30
  v_mfma_f32_16x16x32_bf16 v[76:79], a[120:123], v[192:195], v[76:79]
  ds_read_b64_tr_b16 a[110:111], v80 offset:30720
  v_mul_f32 v55, v55, v30
  v_mfma_f32_16x16x32_bf16 v[68:71], a[124:127], v[196:199], v[68:71]
  ds_read_b64_tr_b16 a[112:113], v81 offset:16384
  v_cvt_pk_bf16_f32 v218, v52, v53
  v_mfma_f32_16x16x32_bf16 v[72:75], a[124:127], v[200:203], v[72:75]
  ds_read_b64_tr_b16 a[114:115], v81 offset:18432
  v_cvt_pk_bf16_f32 v219, v54, v55
  v_mfma_f32_16x16x32_bf16 v[76:79], a[124:127], v[204:207], v[76:79]
  s_mul_i32 s78, s79, 6144
  s_add_u32 s79, s79, 1
  s_cmp_eq_u32 s79, 7
  s_cselect_b32 s79, 0, s79
  s_add_u32 s99, s78, 3072
  buffer_store_dwordx4 v[208:211], v92, s[48:51], s78 offen offset:0 sc1
  v_mul_f32 v56, v56, v26
  v_mul_f32 v57, v57, v26
  v_mul_f32 v58, v58, v26
  v_mul_f32 v59, v59, v26
  v_cvt_pk_bf16_f32 v220, v56, v57
  v_cvt_pk_bf16_f32 v221, v58, v59
  v_mul_f32 v60, v60, v28
  v_mul_f32 v61, v61, v28
  v_mul_f32 v62, v62, v28
  v_mul_f32 v63, v63, v28
  v_cvt_pk_bf16_f32 v224, v60, v61
  v_cvt_pk_bf16_f32 v225, v62, v63
  v_mul_f32 v64, v64, v30
  v_mul_f32 v65, v65, v30
  v_mul_f32 v66, v66, v30
  v_mul_f32 v67, v67, v30
  v_cvt_pk_bf16_f32 v228, v64, v65
  v_cvt_pk_bf16_f32 v229, v66, v67
  s_waitcnt lgkmcnt(6)
  v_mfma_f32_16x16x32_bf16 v[32:35], a[96:99], v[112:115], 0
  ds_read_b64_tr_b16 a[116:117], v81 offset:20480
  v_mfma_f32_16x16x32_bf16 v[36:39], a[96:99], v[116:119], 0
  ds_read_b64_tr_b16 a[118:119], v81 offset:22528
  v_mfma_f32_16x16x32_bf16 v[40:43], a[96:99], v[120:123], 0
  buffer_store_dwordx4 v[212:215], v92, s[48:51], s78 offen offset:1024 sc1
  v_mfma_f32_16x16x32_bf16 v[32:35], a[100:103], v[124:127], v[32:35]
  ds_read_b64_tr_b16 a[120:121], v81 offset:24576
  v_mul_f32 v68, v68, v26
  v_mfma_f32_16x16x32_bf16 v[36:39], a[100:103], v[128:131], v[36:39]
  ds_read_b64_tr_b16 a[122:123], v81 offset:26624
  v_mul_f32 v69, v69, v26
  v_mfma_f32_16x16x32_bf16 v[40:43], a[100:103], v[132:135], v[40:43]
  v_mul_f32 v70, v70, v26
  s_waitcnt lgkmcnt(6)
  v_mfma_f32_16x16x32_bf16 v[32:35], a[104:107], v[136:139], v[32:35]
  ds_read_b64_tr_b16 a[124:125], v81 offset:28672
  v_mul_f32 v71, v71, v26
  v_mfma_f32_16x16x32_bf16 v[36:39], a[104:107], v[140:143], v[36:39]
  ds_read_b64_tr_b16 a[126:127], v81 offset:30720
  v_cvt_pk_bf16_f32 v222, v68, v69
  v_mfma_f32_16x16x32_bf16 v[40:43], a[104:107], v[144:147], v[40:43]
  v_cvt_pk_bf16_f32 v223, v70, v71
  v_mul_f32 v72, v72, v28
  v_mfma_f32_16x16x32_bf16 v[32:35], a[108:111], v[148:151], v[32:35]
  ds_read_b64_tr_b16 a[96:97], v82 offset:16384
  v_mul_f32 v73, v73, v28
  v_mfma_f32_16x16x32_bf16 v[36:39], a[108:111], v[152:155], v[36:39]
  ds_read_b64_tr_b16 a[98:99], v82 offset:18432
  v_mul_f32 v74, v74, v28
  v_mfma_f32_16x16x32_bf16 v[40:43], a[108:111], v[156:159], v[40:43]
  v_mul_f32 v75, v75, v28
  s_waitcnt lgkmcnt(6)
  v_mfma_f32_16x16x32_bf16 v[44:47], a[112:115], v[112:115], 0
  ds_read_b64_tr_b16 a[100:101], v82 offset:20480
  v_cvt_pk_bf16_f32 v226, v72, v73
  v_mfma_f32_16x16x32_bf16 v[48:51], a[112:115], v[116:119], 0
  ds_read_b64_tr_b16 a[102:103], v82 offset:22528
  v_cvt_pk_bf16_f32 v227, v74, v75
  v_mfma_f32_16x16x32_bf16 v[52:55], a[112:115], v[120:123], 0
  v_mul_f32 v76, v76, v30
  v_mul_f32 v77, v77, v30
  v_mfma_f32_16x16x32_bf16 v[44:47], a[116:119], v[124:127], v[44:47]
  ds_read_b64_tr_b16 a[104:105], v82 offset:24576
  v_mul_f32 v78, v78, v30
  v_mfma_f32_16x16x32_bf16 v[48:51], a[116:119], v[128:131], v[48:51]
  ds_read_b64_tr_b16 a[106:107], v82 offset:26624
  v_mul_f32 v79, v79, v30
  v_mfma_f32_16x16x32_bf16 v[52:55], a[116:119], v[132:135], v[52:55]
  v_cvt_pk_bf16_f32 v230, v76, v77
  s_waitcnt lgkmcnt(6)
  v_mfma_f32_16x16x32_bf16 v[44:47], a[120:123], v[136:139], v[44:47]
  ds_read_b64_tr_b16 a[108:109], v82 offset:28672
  buffer_store_dwordx4 v[216:219], v92, s[48:51], s78 offen offset:2048 sc1
  v_mfma_f32_16x16x32_bf16 v[48:51], a[120:123], v[140:143], v[48:51]
  ds_read_b64_tr_b16 a[110:111], v82 offset:30720
  v_cvt_pk_bf16_f32 v231, v78, v79
  v_mfma_f32_16x16x32_bf16 v[52:55], a[120:123], v[144:147], v[52:55]
  v_mfma_f32_16x16x32_bf16 v[44:47], a[124:127], v[148:151], v[44:47]
  ds_read_b64_tr_b16 a[112:113], v83 offset:16384
  v_mfma_f32_16x16x32_bf16 v[48:51], a[124:127], v[152:155], v[48:51]
  ds_read_b64_tr_b16 a[114:115], v83 offset:18432
  v_mfma_f32_16x16x32_bf16 v[52:55], a[124:127], v[156:159], v[52:55]
  s_waitcnt lgkmcnt(6)
  v_mfma_f32_16x16x32_bf16 v[56:59], a[96:99], v[112:115], 0
  ds_read_b64_tr_b16 a[116:117], v83 offset:20480
  v_mfma_f32_16x16x32_bf16 v[60:63], a[96:99], v[116:119], 0
  ds_read_b64_tr_b16 a[118:119], v83 offset:22528
  v_mfma_f32_16x16x32_bf16 v[64:67], a[96:99], v[120:123], 0
  v_mfma_f32_16x16x32_bf16 v[56:59], a[100:103], v[124:127], v[56:59]
  ds_read_b64_tr_b16 a[120:121], v83 offset:24576
  v_mfma_f32_16x16x32_bf16 v[60:63], a[100:103], v[128:131], v[60:63]
  ds_read_b64_tr_b16 a[122:123], v83 offset:26624
  v_mfma_f32_16x16x32_bf16 v[64:67], a[100:103], v[132:135], v[64:67]
  s_waitcnt lgkmcnt(6)
  v_mfma_f32_16x16x32_bf16 v[56:59], a[104:107], v[136:139], v[56:59]
  ds_read_b64_tr_b16 a[124:125], v83 offset:28672
  v_mfma_f32_16x16x32_bf16 v[60:63], a[104:107], v[140:143], v[60:63]
  ds_read_b64_tr_b16 a[126:127], v83 offset:30720
  v_mfma_f32_16x16x32_bf16 v[64:67], a[104:107], v[144:147], v[64:67]
  v_mfma_f32_16x16x32_bf16 v[56:59], a[108:111], v[148:151], v[56:59]
  ds_read_b64_tr_b16 a[96:97], v84 offset:16384
  v_mfma_f32_16x16x32_bf16 v[60:63], a[108:111], v[152:155], v[60:63]
  ds_read_b64_tr_b16 a[98:99], v84 offset:18432
  buffer_store_dwordx4 v[220:223], v92, s[48:51], s99 offen offset:0 sc1
  v_mfma_f32_16x16x32_bf16 v[64:67], a[108:111], v[156:159], v[64:67]
  s_waitcnt lgkmcnt(6)
  v_mfma_f32_16x16x32_bf16 v[68:71], a[112:115], v[112:115], 0
  ds_read_b64_tr_b16 a[100:101], v84 offset:20480
  v_mfma_f32_16x16x32_bf16 v[72:75], a[112:115], v[116:119], 0
  ds_read_b64_tr_b16 a[102:103], v84 offset:22528
  v_mfma_f32_16x16x32_bf16 v[76:79], a[112:115], v[120:123], 0
  v_mfma_f32_16x16x32_bf16 v[68:71], a[116:119], v[124:127], v[68:71]
  ds_read_b64_tr_b16 a[104:105], v84 offset:24576
  v_mfma_f32_16x16x32_bf16 v[72:75], a[116:119], v[128:131], v[72:75]
  ds_read_b64_tr_b16 a[106:107], v84 offset:26624
  v_mfma_f32_16x16x32_bf16 v[76:79], a[116:119], v[132:135], v[76:79]
  s_waitcnt lgkmcnt(6)
  v_mfma_f32_16x16x32_bf16 v[68:71], a[120:123], v[136:139], v[68:71]
  ds_read_b64_tr_b16 a[108:109], v84 offset:28672
  v_mfma_f32_16x16x32_bf16 v[72:75], a[120:123], v[140:143], v[72:75]
  ds_read_b64_tr_b16 a[110:111], v84 offset:30720
  v_mfma_f32_16x16x32_bf16 v[76:79], a[120:123], v[144:147], v[76:79]
  v_mfma_f32_16x16x32_bf16 v[68:71], a[124:127], v[148:151], v[68:71]
  ds_read_b64_tr_b16 a[112:113], v85 offset:16384
  v_mfma_f32_16x16x32_bf16 v[72:75], a[124:127], v[152:155], v[72:75]
  ds_read_b64_tr_b16 a[114:115], v85 offset:18432
  v_mfma_f32_16x16x32_bf16 v[76:79], a[124:127], v[156:159], v[76:79]
  s_waitcnt lgkmcnt(6)
  v_mfma_f32_16x16x32_bf16 v[32:35], a[96:99], v[160:163], v[32:35]
  ds_read_b64_tr_b16 a[116:117], v85 offset:20480
  buffer_store_dwordx4 v[224:227], v92, s[48:51], s99 offen offset:1024 sc1
  v_mfma_f32_16x16x32_bf16 v[36:39], a[96:99], v[164:167], v[36:39]
  ds_read_b64_tr_b16 a[118:119], v85 offset:22528
  v_mfma_f32_16x16x32_bf16 v[40:43], a[96:99], v[168:171], v[40:43]
  v_mfma_f32_16x16x32_bf16 v[32:35], a[100:103], v[172:175], v[32:35]
  ds_read_b64_tr_b16 a[120:121], v85 offset:24576
  v_mfma_f32_16x16x32_bf16 v[36:39], a[100:103], v[176:179], v[36:39]
  ds_read_b64_tr_b16 a[122:123], v85 offset:26624
  v_mfma_f32_16x16x32_bf16 v[40:43], a[100:103], v[180:183], v[40:43]
  s_waitcnt lgkmcnt(6)
  v_mfma_f32_16x16x32_bf16 v[32:35], a[104:107], v[184:187], v[32:35]
  ds_read_b64_tr_b16 a[124:125], v85 offset:28672
  v_mfma_f32_16x16x32_bf16 v[36:39], a[104:107], v[188:191], v[36:39]
  ds_read_b64_tr_b16 a[126:127], v85 offset:30720
  v_mfma_f32_16x16x32_bf16 v[40:43], a[104:107], v[192:195], v[40:43]
  v_mfma_f32_16x16x32_bf16 v[32:35], a[108:111], v[196:199], v[32:35]
  ds_read_b64_tr_b16 a[96:97], v86 offset:16384
  v_mfma_f32_16x16x32_bf16 v[36:39], a[108:111], v[200:203], v[36:39]
  ds_read_b64_tr_b16 a[98:99], v86 offset:18432
  v_mfma_f32_16x16x32_bf16 v[40:43], a[108:111], v[204:207], v[40:43]
  s_waitcnt lgkmcnt(6)
  v_mfma_f32_16x16x32_bf16 v[44:47], a[112:115], v[160:163], v[44:47]
  ds_read_b64_tr_b16 a[100:101], v86 offset:20480
  v_mfma_f32_16x16x32_bf16 v[48:51], a[112:115], v[164:167], v[48:51]
  ds_read_b64_tr_b16 a[102:103], v86 offset:22528
  v_mfma_f32_16x16x32_bf16 v[52:55], a[112:115], v[168:171], v[52:55]
  buffer_store_dwordx4 v[228:231], v92, s[48:51], s99 offen offset:2048 sc1
  v_mfma_f32_16x16x32_bf16 v[44:47], a[116:119], v[172:175], v[44:47]
  ds_read_b64_tr_b16 a[104:105], v86 offset:24576
  v_mul_f32 v32, v32, v26
  v_mfma_f32_16x16x32_bf16 v[48:51], a[116:119], v[176:179], v[48:51]
  ds_read_b64_tr_b16 a[106:107], v86 offset:26624
  v_mul_f32 v33, v33, v26
  v_mfma_f32_16x16x32_bf16 v[52:55], a[116:119], v[180:183], v[52:55]
  v_mul_f32 v34, v34, v26
  s_waitcnt lgkmcnt(6)
  v_mfma_f32_16x16x32_bf16 v[44:47], a[120:123], v[184:187], v[44:47]
  ds_read_b64_tr_b16 a[108:109], v86 offset:28672
  v_mul_f32 v35, v35, v26
  v_mfma_f32_16x16x32_bf16 v[48:51], a[120:123], v[188:191], v[48:51]
  ds_read_b64_tr_b16 a[110:111], v86 offset:30720
  v_cvt_pk_bf16_f32 v208, v32, v33
  v_mfma_f32_16x16x32_bf16 v[52:55], a[120:123], v[192:195], v[52:55]
  v_cvt_pk_bf16_f32 v209, v34, v35
  v_mul_f32 v36, v36, v28
  v_mfma_f32_16x16x32_bf16 v[44:47], a[124:127], v[196:199], v[44:47]
  ds_read_b64_tr_b16 a[112:113], v87 offset:16384
  v_mul_f32 v37, v37, v28
  v_mfma_f32_16x16x32_bf16 v[48:51], a[124:127], v[200:203], v[48:51]
  ds_read_b64_tr_b16 a[114:115], v87 offset:18432
  v_mul_f32 v38, v38, v28
  v_mfma_f32_16x16x32_bf16 v[52:55], a[124:127], v[204:207], v[52:55]
  v_mul_f32 v39, v39, v28
  s_waitcnt lgkmcnt(6)
  v_mfma_f32_16x16x32_bf16 v[56:59], a[96:99], v[160:163], v[56:59]
  ds_read_b64_tr_b16 a[116:117], v87 offset:20480
  v_cvt_pk_bf16_f32 v212, v36, v37
  v_mfma_f32_16x16x32_bf16 v[60:63], a[96:99], v[164:167], v[60:63]
  ds_read_b64_tr_b16 a[118:119], v87 offset:22528
  v_cvt_pk_bf16_f32 v213, v38, v39
  v_mfma_f32_16x16x32_bf16 v[64:67], a[96:99], v[168:171], v[64:67]
  v_mul_f32 v40, v40, v30
  v_mul_f32 v41, v41, v30
  v_mfma_f32_16x16x32_bf16 v[56:59], a[100:103], v[172:175], v[56:59]
  ds_read_b64_tr_b16 a[120:121], v87 offset:24576
  v_mul_f32 v42, v42, v30
  v_mfma_f32_16x16x32_bf16 v[60:63], a[100:103], v[176:179], v[60:63]
  ds_read_b64_tr_b16 a[122:123], v87 offset:26624
  v_mul_f32 v43, v43, v30
  v_mfma_f32_16x16x32_bf16 v[64:67], a[100:103], v[180:183], v[64:67]
  v_cvt_pk_bf16_f32 v216, v40, v41
  s_waitcnt lgkmcnt(6)
  v_mfma_f32_16x16x32_bf16 v[56:59], a[104:107], v[184:187], v[56:59]
  ds_read_b64_tr_b16 a[124:125], v87 offset:28672
  v_cvt_pk_bf16_f32 v217, v42, v43
  v_mfma_f32_16x16x32_bf16 v[60:63], a[104:107], v[188:191], v[60:63]
  ds_read_b64_tr_b16 a[126:127], v87 offset:30720
  v_mul_f32 v44, v44, v26
  v_mfma_f32_16x16x32_bf16 v[64:67], a[104:107], v[192:195], v[64:67]
  v_mul_f32 v45, v45, v26
  v_mul_f32 v46, v46, v26
  v_mfma_f32_16x16x32_bf16 v[56:59], a[108:111], v[196:199], v[56:59]
  ds_read_b64_tr_b16 a[96:97], v80 offset:49152
  v_mul_f32 v47, v47, v26
  v_mfma_f32_16x16x32_bf16 v[60:63], a[108:111], v[200:203], v[60:63]
  ds_read_b64_tr_b16 a[98:99], v80 offset:51200
  v_cvt_pk_bf16_f32 v210, v44, v45
  v_mfma_f32_16x16x32_bf16 v[64:67], a[108:111], v[204:207], v[64:67]
  v_cvt_pk_bf16_f32 v211, v46, v47
  s_waitcnt lgkmcnt(6)
  v_mfma_f32_16x16x32_bf16 v[68:71], a[112:115], v[160:163], v[68:71]
  ds_read_b64_tr_b16 a[100:101], v80 offset:53248
  v_mul_f32 v48, v48, v28
  v_mfma_f32_16x16x32_bf16 v[72:75], a[112:115], v[164:167], v[72:75]
  ds_read_b64_tr_b16 a[102:103], v80 offset:55296
  v_mul_f32 v49, v49, v28
  v_mfma_f32_16x16x32_bf16 v[76:79], a[112:115], v[168:171], v[76:79]
  v_mul_f32 v50, v50, v28
  v_mul_f32 v51, v51, v28
  v_mfma_f32_16x16x32_bf16 v[68:71], a[116:119], v[172:175], v[68:71]
  ds_read_b64_tr_b16 a[104:105], v80 offset:57344
  v_cvt_pk_bf16_f32 v214, v48, v49
  v_mfma_f32_16x16x32_bf16 v[72:75], a[116:119], v[176:179], v[72:75]
  ds_read_b64_tr_b16 a[106:107], v80 offset:59392
  v_cvt_pk_bf16_f32 v215, v50, v51
  v_mfma_f32_16x16x32_bf16 v[76:79], a[116:119], v[180:183], v[76:79]
  v_mul_f32 v52, v52, v30
  s_waitcnt lgkmcnt(6)
  v_mfma_f32_16x16x32_bf16 v[68:71], a[120:123], v[184:187], v[68:71]
  ds_read_b64_tr_b16 a[108:109], v80 offset:61440
  v_mul_f32 v53, v53, v30
  v_mfma_f32_16x16x32_bf16 v[72:75], a[120:123], v[188:191], v[72:75]
  ds_read_b64_tr_b16 a[110:111], v80 offset:63488
  v_mul_f32 v54, v54, v30
  v_mfma_f32_16x16x32_bf16 v[76:79], a[120:123], v[192:195], v[76:79]
  v_mul_f32 v55, v55, v30
  v_cvt_pk_bf16_f32 v218, v52, v53
  v_mfma_f32_16x16x32_bf16 v[68:71], a[124:127], v[196:199], v[68:71]
  ds_read_b64_tr_b16 a[112:113], v81 offset:49152
  v_cvt_pk_bf16_f32 v219, v54, v55
  v_mfma_f32_16x16x32_bf16 v[72:75], a[124:127], v[200:203], v[72:75]
  ds_read_b64_tr_b16 a[114:115], v81 offset:51200
  s_mul_i32 s78, s79, 6144
  v_mfma_f32_16x16x32_bf16 v[76:79], a[124:127], v[204:207], v[76:79]
  s_add_u32 s79, s79, 1
  s_cmp_eq_u32 s79, 7
  s_cselect_b32 s79, 0, s79
  s_add_u32 s99, s78, 3072
  buffer_store_dwordx4 v[208:211], v92, s[48:51], s78 offen offset:0 sc1
  v_mul_f32 v56, v56, v26
  v_mul_f32 v57, v57, v26
  v_mul_f32 v58, v58, v26
  v_mul_f32 v59, v59, v26
  v_cvt_pk_bf16_f32 v220, v56, v57
  v_cvt_pk_bf16_f32 v221, v58, v59
  v_mul_f32 v60, v60, v28
  v_mul_f32 v61, v61, v28
  v_mul_f32 v62, v62, v28
  v_mul_f32 v63, v63, v28
  v_cvt_pk_bf16_f32 v224, v60, v61
  v_cvt_pk_bf16_f32 v225, v62, v63
  v_mul_f32 v64, v64, v30
  v_mul_f32 v65, v65, v30
  v_mul_f32 v66, v66, v30
  v_mul_f32 v67, v67, v30
  v_cvt_pk_bf16_f32 v228, v64, v65
  v_cvt_pk_bf16_f32 v229, v66, v67
  s_waitcnt lgkmcnt(6)
  v_mfma_f32_16x16x32_bf16 v[32:35], a[96:99], v[112:115], 0
  ds_read_b64_tr_b16 a[116:117], v81 offset:53248
  v_mfma_f32_16x16x32_bf16 v[36:39], a[96:99], v[116:119], 0
  ds_read_b64_tr_b16 a[118:119], v81 offset:55296
  v_mfma_f32_16x16x32_bf16 v[40:43], a[96:99], v[120:123], 0
  buffer_store_dwordx4 v[212:215], v92, s[48:51], s78 offen offset:1024 sc1
  v_mfma_f32_16x16x32_bf16 v[32:35], a[100:103], v[124:127], v[32:35]
  ds_read_b64_tr_b16 a[120:121], v81 offset:57344
  v_mul_f32 v68, v68, v26
  v_mfma_f32_16x16x32_bf16 v[36:39], a[100:103], v[128:131], v[36:39]
  ds_read_b64_tr_b16 a[122:123], v81 offset:59392
  v_mul_f32 v69, v69, v26
  v_mfma_f32_16x16x32_bf16 v[40:43], a[100:103], v[132:135], v[40:43]
  v_mul_f32 v70, v70, v26
  s_waitcnt lgkmcnt(6)
  v_mfma_f32_16x16x32_bf16 v[32:35], a[104:107], v[136:139], v[32:35]
  ds_read_b64_tr_b16 a[124:125], v81 offset:61440
  v_mul_f32 v71, v71, v26
  v_mfma_f32_16x16x32_bf16 v[36:39], a[104:107], v[140:143], v[36:39]
  ds_read_b64_tr_b16 a[126:127], v81 offset:63488
  v_cvt_pk_bf16_f32 v222, v68, v69
  v_mfma_f32_16x16x32_bf16 v[40:43], a[104:107], v[144:147], v[40:43]
  v_cvt_pk_bf16_f32 v223, v70, v71
  v_mul_f32 v72, v72, v28
  v_mfma_f32_16x16x32_bf16 v[32:35], a[108:111], v[148:151], v[32:35]
  ds_read_b64_tr_b16 a[96:97], v82 offset:49152
  v_mul_f32 v73, v73, v28
  v_mfma_f32_16x16x32_bf16 v[36:39], a[108:111], v[152:155], v[36:39]
  ds_read_b64_tr_b16 a[98:99], v82 offset:51200
  v_mul_f32 v74, v74, v28
  v_mfma_f32_16x16x32_bf16 v[40:43], a[108:111], v[156:159], v[40:43]
  v_mul_f32 v75, v75, v28
  s_waitcnt lgkmcnt(6)
  v_mfma_f32_16x16x32_bf16 v[44:47], a[112:115], v[112:115], 0
  ds_read_b64_tr_b16 a[100:101], v82 offset:53248
  v_cvt_pk_bf16_f32 v226, v72, v73
  v_mfma_f32_16x16x32_bf16 v[48:51], a[112:115], v[116:119], 0
  ds_read_b64_tr_b16 a[102:103], v82 offset:55296
  v_cvt_pk_bf16_f32 v227, v74, v75
  v_mfma_f32_16x16x32_bf16 v[52:55], a[112:115], v[120:123], 0
  v_mul_f32 v76, v76, v30
  v_mul_f32 v77, v77, v30
  v_mfma_f32_16x16x32_bf16 v[44:47], a[116:119], v[124:127], v[44:47]
  ds_read_b64_tr_b16 a[104:105], v82 offset:57344
  v_mul_f32 v78, v78, v30
  v_mfma_f32_16x16x32_bf16 v[48:51], a[116:119], v[128:131], v[48:51]
  ds_read_b64_tr_b16 a[106:107], v82 offset:59392
  v_mul_f32 v79, v79, v30
  v_mfma_f32_16x16x32_bf16 v[52:55], a[116:119], v[132:135], v[52:55]
  v_cvt_pk_bf16_f32 v230, v76, v77
  s_waitcnt lgkmcnt(6)
  v_mfma_f32_16x16x32_bf16 v[44:47], a[120:123], v[136:139], v[44:47]
  ds_read_b64_tr_b16 a[108:109], v82 offset:61440
  buffer_store_dwordx4 v[216:219], v92, s[48:51], s78 offen offset:2048 sc1
  v_mfma_f32_16x16x32_bf16 v[48:51], a[120:123], v[140:143], v[48:51]
  ds_read_b64_tr_b16 a[110:111], v82 offset:63488
  v_cvt_pk_bf16_f32 v231, v78, v79
  v_mfma_f32_16x16x32_bf16 v[52:55], a[120:123], v[144:147], v[52:55]
  v_mfma_f32_16x16x32_bf16 v[44:47], a[124:127], v[148:151], v[44:47]
  ds_read_b64_tr_b16 a[112:113], v83 offset:49152
  v_mfma_f32_16x16x32_bf16 v[48:51], a[124:127], v[152:155], v[48:51]
  ds_read_b64_tr_b16 a[114:115], v83 offset:51200
  v_mfma_f32_16x16x32_bf16 v[52:55], a[124:127], v[156:159], v[52:55]
  s_waitcnt lgkmcnt(6)
  v_mfma_f32_16x16x32_bf16 v[56:59], a[96:99], v[112:115], 0
  ds_read_b64_tr_b16 a[116:117], v83 offset:53248
  v_mfma_f32_16x16x32_bf16 v[60:63], a[96:99], v[116:119], 0
  ds_read_b64_tr_b16 a[118:119], v83 offset:55296
  v_mfma_f32_16x16x32_bf16 v[64:67], a[96:99], v[120:123], 0
  v_mfma_f32_16x16x32_bf16 v[56:59], a[100:103], v[124:127], v[56:59]
  ds_read_b64_tr_b16 a[120:121], v83 offset:57344
  v_mfma_f32_16x16x32_bf16 v[60:63], a[100:103], v[128:131], v[60:63]
  ds_read_b64_tr_b16 a[122:123], v83 offset:59392
  v_mfma_f32_16x16x32_bf16 v[64:67], a[100:103], v[132:135], v[64:67]
  s_waitcnt lgkmcnt(6)
  v_mfma_f32_16x16x32_bf16 v[56:59], a[104:107], v[136:139], v[56:59]
  ds_read_b64_tr_b16 a[124:125], v83 offset:61440
  v_mfma_f32_16x16x32_bf16 v[60:63], a[104:107], v[140:143], v[60:63]
  ds_read_b64_tr_b16 a[126:127], v83 offset:63488
  v_mfma_f32_16x16x32_bf16 v[64:67], a[104:107], v[144:147], v[64:67]
  v_mfma_f32_16x16x32_bf16 v[56:59], a[108:111], v[148:151], v[56:59]
  ds_read_b64_tr_b16 a[96:97], v84 offset:49152
  v_mfma_f32_16x16x32_bf16 v[60:63], a[108:111], v[152:155], v[60:63]
  ds_read_b64_tr_b16 a[98:99], v84 offset:51200
  buffer_store_dwordx4 v[220:223], v92, s[48:51], s99 offen offset:0 sc1
  v_mfma_f32_16x16x32_bf16 v[64:67], a[108:111], v[156:159], v[64:67]
  s_waitcnt lgkmcnt(6)
  v_mfma_f32_16x16x32_bf16 v[68:71], a[112:115], v[112:115], 0
  ds_read_b64_tr_b16 a[100:101], v84 offset:53248
  v_mfma_f32_16x16x32_bf16 v[72:75], a[112:115], v[116:119], 0
  ds_read_b64_tr_b16 a[102:103], v84 offset:55296
  v_mfma_f32_16x16x32_bf16 v[76:79], a[112:115], v[120:123], 0
  v_mfma_f32_16x16x32_bf16 v[68:71], a[116:119], v[124:127], v[68:71]
  ds_read_b64_tr_b16 a[104:105], v84 offset:57344
  v_mfma_f32_16x16x32_bf16 v[72:75], a[116:119], v[128:131], v[72:75]
  ds_read_b64_tr_b16 a[106:107], v84 offset:59392
  v_mfma_f32_16x16x32_bf16 v[76:79], a[116:119], v[132:135], v[76:79]
  s_waitcnt lgkmcnt(6)
  v_mfma_f32_16x16x32_bf16 v[68:71], a[120:123], v[136:139], v[68:71]
  ds_read_b64_tr_b16 a[108:109], v84 offset:61440
  v_mfma_f32_16x16x32_bf16 v[72:75], a[120:123], v[140:143], v[72:75]
  ds_read_b64_tr_b16 a[110:111], v84 offset:63488
  v_mfma_f32_16x16x32_bf16 v[76:79], a[120:123], v[144:147], v[76:79]
  v_mfma_f32_16x16x32_bf16 v[68:71], a[124:127], v[148:151], v[68:71]
  ds_read_b64_tr_b16 a[112:113], v85 offset:49152
  v_mfma_f32_16x16x32_bf16 v[72:75], a[124:127], v[152:155], v[72:75]
  ds_read_b64_tr_b16 a[114:115], v85 offset:51200
  v_mfma_f32_16x16x32_bf16 v[76:79], a[124:127], v[156:159], v[76:79]
  s_waitcnt lgkmcnt(6)
  v_mfma_f32_16x16x32_bf16 v[32:35], a[96:99], v[160:163], v[32:35]
  ds_read_b64_tr_b16 a[116:117], v85 offset:53248
  buffer_store_dwordx4 v[224:227], v92, s[48:51], s99 offen offset:1024 sc1
  v_mfma_f32_16x16x32_bf16 v[36:39], a[96:99], v[164:167], v[36:39]
  ds_read_b64_tr_b16 a[118:119], v85 offset:55296
  v_mfma_f32_16x16x32_bf16 v[40:43], a[96:99], v[168:171], v[40:43]
  v_mfma_f32_16x16x32_bf16 v[32:35], a[100:103], v[172:175], v[32:35]
  ds_read_b64_tr_b16 a[120:121], v85 offset:57344
  v_mfma_f32_16x16x32_bf16 v[36:39], a[100:103], v[176:179], v[36:39]
  ds_read_b64_tr_b16 a[122:123], v85 offset:59392
  v_mfma_f32_16x16x32_bf16 v[40:43], a[100:103], v[180:183], v[40:43]
  s_waitcnt lgkmcnt(6)
  v_mfma_f32_16x16x32_bf16 v[32:35], a[104:107], v[184:187], v[32:35]
  ds_read_b64_tr_b16 a[124:125], v85 offset:61440
  v_mfma_f32_16x16x32_bf16 v[36:39], a[104:107], v[188:191], v[36:39]
  ds_read_b64_tr_b16 a[126:127], v85 offset:63488
  v_mfma_f32_16x16x32_bf16 v[40:43], a[104:107], v[192:195], v[40:43]
  v_mfma_f32_16x16x32_bf16 v[32:35], a[108:111], v[196:199], v[32:35]
  ds_read_b64_tr_b16 a[96:97], v86 offset:49152
  v_mfma_f32_16x16x32_bf16 v[36:39], a[108:111], v[200:203], v[36:39]
  ds_read_b64_tr_b16 a[98:99], v86 offset:51200
  v_mfma_f32_16x16x32_bf16 v[40:43], a[108:111], v[204:207], v[40:43]
  s_waitcnt lgkmcnt(6)
  v_mfma_f32_16x16x32_bf16 v[44:47], a[112:115], v[160:163], v[44:47]
  ds_read_b64_tr_b16 a[100:101], v86 offset:53248
  v_mfma_f32_16x16x32_bf16 v[48:51], a[112:115], v[164:167], v[48:51]
  ds_read_b64_tr_b16 a[102:103], v86 offset:55296
  v_mfma_f32_16x16x32_bf16 v[52:55], a[112:115], v[168:171], v[52:55]
  buffer_store_dwordx4 v[228:231], v92, s[48:51], s99 offen offset:2048 sc1
  v_mfma_f32_16x16x32_bf16 v[44:47], a[116:119], v[172:175], v[44:47]
  ds_read_b64_tr_b16 a[104:105], v86 offset:57344
  v_mul_f32 v32, v32, v26
  v_mfma_f32_16x16x32_bf16 v[48:51], a[116:119], v[176:179], v[48:51]
  ds_read_b64_tr_b16 a[106:107], v86 offset:59392
  v_mul_f32 v33, v33, v26
  v_mfma_f32_16x16x32_bf16 v[52:55], a[116:119], v[180:183], v[52:55]
  v_mul_f32 v34, v34, v26
  s_waitcnt lgkmcnt(6)
  v_mfma_f32_16x16x32_bf16 v[44:47], a[120:123], v[184:187], v[44:47]
  ds_read_b64_tr_b16 a[108:109], v86 offset:61440
  v_mul_f32 v35, v35, v26
  v_mfma_f32_16x16x32_bf16 v[48:51], a[120:123], v[188:191], v[48:51]
  ds_read_b64_tr_b16 a[110:111], v86 offset:63488
  v_cvt_pk_bf16_f32 v208, v32, v33
  v_mfma_f32_16x16x32_bf16 v[52:55], a[120:123], v[192:195], v[52:55]
  v_cvt_pk_bf16_f32 v209, v34, v35
  v_mul_f32 v36, v36, v28
  v_mfma_f32_16x16x32_bf16 v[44:47], a[124:127], v[196:199], v[44:47]
  ds_read_b64_tr_b16 a[112:113], v87 offset:49152
  v_mul_f32 v37, v37, v28
  v_mfma_f32_16x16x32_bf16 v[48:51], a[124:127], v[200:203], v[48:51]
  ds_read_b64_tr_b16 a[114:115], v87 offset:51200
  v_mul_f32 v38, v38, v28
  v_mfma_f32_16x16x32_bf16 v[52:55], a[124:127], v[204:207], v[52:55]
  v_mul_f32 v39, v39, v28
  s_waitcnt lgkmcnt(6)
  v_mfma_f32_16x16x32_bf16 v[56:59], a[96:99], v[160:163], v[56:59]
  ds_read_b64_tr_b16 a[116:117], v87 offset:53248
  v_cvt_pk_bf16_f32 v212, v36, v37
  v_mfma_f32_16x16x32_bf16 v[60:63], a[96:99], v[164:167], v[60:63]
  ds_read_b64_tr_b16 a[118:119], v87 offset:55296
  v_cvt_pk_bf16_f32 v213, v38, v39
  v_mfma_f32_16x16x32_bf16 v[64:67], a[96:99], v[168:171], v[64:67]
  v_mul_f32 v40, v40, v30
  v_mul_f32 v41, v41, v30
  v_mfma_f32_16x16x32_bf16 v[56:59], a[100:103], v[172:175], v[56:59]
  ds_read_b64_tr_b16 a[120:121], v87 offset:57344
  v_mul_f32 v42, v42, v30
  v_mfma_f32_16x16x32_bf16 v[60:63], a[100:103], v[176:179], v[60:63]
  ds_read_b64_tr_b16 a[122:123], v87 offset:59392
  v_mul_f32 v43, v43, v30
  v_mfma_f32_16x16x32_bf16 v[64:67], a[100:103], v[180:183], v[64:67]
  v_cvt_pk_bf16_f32 v216, v40, v41
  s_waitcnt lgkmcnt(6)
  v_mfma_f32_16x16x32_bf16 v[56:59], a[104:107], v[184:187], v[56:59]
  ds_read_b64_tr_b16 a[124:125], v87 offset:61440
  v_cvt_pk_bf16_f32 v217, v42, v43
  v_mfma_f32_16x16x32_bf16 v[60:63], a[104:107], v[188:191], v[60:63]
  ds_read_b64_tr_b16 a[126:127], v87 offset:63488
  v_mul_f32 v44, v44, v26
  v_mfma_f32_16x16x32_bf16 v[64:67], a[104:107], v[192:195], v[64:67]
  v_mul_f32 v45, v45, v26
  v_mul_f32 v46, v46, v26
  v_mfma_f32_16x16x32_bf16 v[56:59], a[108:111], v[196:199], v[56:59]
  ds_read_b64_tr_b16 a[96:97], v80 offset:0
  v_mul_f32 v47, v47, v26
  v_mfma_f32_16x16x32_bf16 v[60:63], a[108:111], v[200:203], v[60:63]
  ds_read_b64_tr_b16 a[98:99], v80 offset:2048
  v_cvt_pk_bf16_f32 v210, v44, v45
  v_mfma_f32_16x16x32_bf16 v[64:67], a[108:111], v[204:207], v[64:67]
  v_cvt_pk_bf16_f32 v211, v46, v47
  s_waitcnt lgkmcnt(6)
  v_mfma_f32_16x16x32_bf16 v[68:71], a[112:115], v[160:163], v[68:71]
  ds_read_b64_tr_b16 a[100:101], v80 offset:4096
  v_mul_f32 v48, v48, v28
  v_mfma_f32_16x16x32_bf16 v[72:75], a[112:115], v[164:167], v[72:75]
  ds_read_b64_tr_b16 a[102:103], v80 offset:6144
  v_mul_f32 v49, v49, v28
  v_mfma_f32_16x16x32_bf16 v[76:79], a[112:115], v[168:171], v[76:79]
  v_mul_f32 v50, v50, v28
  v_mul_f32 v51, v51, v28
  v_mfma_f32_16x16x32_bf16 v[68:71], a[116:119], v[172:175], v[68:71]
  ds_read_b64_tr_b16 a[104:105], v80 offset:8192
  v_cvt_pk_bf16_f32 v214, v48, v49
  v_mfma_f32_16x16x32_bf16 v[72:75], a[116:119], v[176:179], v[72:75]
  ds_read_b64_tr_b16 a[106:107], v80 offset:10240
  v_cvt_pk_bf16_f32 v215, v50, v51
  v_mfma_f32_16x16x32_bf16 v[76:79], a[116:119], v[180:183], v[76:79]
  v_mul_f32 v52, v52, v30
  s_waitcnt lgkmcnt(6)
  v_mfma_f32_16x16x32_bf16 v[68:71], a[120:123], v[184:187], v[68:71]
  ds_read_b64_tr_b16 a[108:109], v80 offset:12288
  v_mul_f32 v53, v53, v30
  v_mfma_f32_16x16x32_bf16 v[72:75], a[120:123], v[188:191], v[72:75]
  ds_read_b64_tr_b16 a[110:111], v80 offset:14336
  v_mul_f32 v54, v54, v30
  v_mfma_f32_16x16x32_bf16 v[76:79], a[120:123], v[192:195], v[76:79]
  v_mul_f32 v55, v55, v30
  v_cvt_pk_bf16_f32 v218, v52, v53
  v_mfma_f32_16x16x32_bf16 v[68:71], a[124:127], v[196:199], v[68:71]
  ds_read_b64_tr_b16 a[112:113], v81 offset:0
  v_cvt_pk_bf16_f32 v219, v54, v55
  v_mfma_f32_16x16x32_bf16 v[72:75], a[124:127], v[200:203], v[72:75]
  ds_read_b64_tr_b16 a[114:115], v81 offset:2048
  s_mul_i32 s78, s79, 6144
  v_mfma_f32_16x16x32_bf16 v[76:79], a[124:127], v[204:207], v[76:79]
  s_add_u32 s79, s79, 1
  s_cmp_eq_u32 s79, 7
  s_cselect_b32 s79, 0, s79
  s_add_u32 s99, s78, 3072
  buffer_store_dwordx4 v[208:211], v92, s[48:51], s78 offen offset:0 sc1
  v_mul_f32 v56, v56, v26
  v_mul_f32 v57, v57, v26
  v_mul_f32 v58, v58, v26
  v_mul_f32 v59, v59, v26
  v_cvt_pk_bf16_f32 v220, v56, v57
  v_cvt_pk_bf16_f32 v221, v58, v59
  v_mul_f32 v60, v60, v28
  v_mul_f32 v61, v61, v28
  v_mul_f32 v62, v62, v28
  v_mul_f32 v63, v63, v28
  v_cvt_pk_bf16_f32 v224, v60, v61
  v_cvt_pk_bf16_f32 v225, v62, v63
  v_mul_f32 v64, v64, v30
  v_mul_f32 v65, v65, v30
  v_mul_f32 v66, v66, v30
  v_mul_f32 v67, v67, v30
  v_cvt_pk_bf16_f32 v228, v64, v65
  v_cvt_pk_bf16_f32 v229, v66, v67
  s_waitcnt lgkmcnt(6)
  v_mfma_f32_16x16x32_bf16 v[32:35], a[96:99], v[112:115], 0
  ds_read_b64_tr_b16 a[116:117], v81 offset:4096
  v_mfma_f32_16x16x32_bf16 v[36:39], a[96:99], v[116:119], 0
  ds_read_b64_tr_b16 a[118:119], v81 offset:6144
  v_mfma_f32_16x16x32_bf16 v[40:43], a[96:99], v[120:123], 0
  buffer_store_dwordx4 v[212:215], v92, s[48:51], s78 offen offset:1024 sc1
  v_mfma_f32_16x16x32_bf16 v[32:35], a[100:103], v[124:127], v[32:35]
  ds_read_b64_tr_b16 a[120:121], v81 offset:8192
  v_mul_f32 v68, v68, v26
  v_mfma_f32_16x16x32_bf16 v[36:39], a[100:103], v[128:131], v[36:39]
  ds_read_b64_tr_b16 a[122:123], v81 offset:10240
  v_mul_f32 v69, v69, v26
  v_mfma_f32_16x16x32_bf16 v[40:43], a[100:103], v[132:135], v[40:43]
  v_mul_f32 v70, v70, v26
  s_waitcnt lgkmcnt(6)
  v_mfma_f32_16x16x32_bf16 v[32:35], a[104:107], v[136:139], v[32:35]
  ds_read_b64_tr_b16 a[124:125], v81 offset:12288
  v_mul_f32 v71, v71, v26
  v_mfma_f32_16x16x32_bf16 v[36:39], a[104:107], v[140:143], v[36:39]
  ds_read_b64_tr_b16 a[126:127], v81 offset:14336
  v_cvt_pk_bf16_f32 v222, v68, v69
  v_mfma_f32_16x16x32_bf16 v[40:43], a[104:107], v[144:147], v[40:43]
  v_cvt_pk_bf16_f32 v223, v70, v71
  v_mul_f32 v72, v72, v28
  v_mfma_f32_16x16x32_bf16 v[32:35], a[108:111], v[148:151], v[32:35]
  ds_read_b64_tr_b16 a[96:97], v82 offset:0
  v_mul_f32 v73, v73, v28
  v_mfma_f32_16x16x32_bf16 v[36:39], a[108:111], v[152:155], v[36:39]
  ds_read_b64_tr_b16 a[98:99], v82 offset:2048
  v_mul_f32 v74, v74, v28
  v_mfma_f32_16x16x32_bf16 v[40:43], a[108:111], v[156:159], v[40:43]
  v_mul_f32 v75, v75, v28
  s_waitcnt lgkmcnt(6)
  v_mfma_f32_16x16x32_bf16 v[44:47], a[112:115], v[112:115], 0
  ds_read_b64_tr_b16 a[100:101], v82 offset:4096
  v_cvt_pk_bf16_f32 v226, v72, v73
  v_mfma_f32_16x16x32_bf16 v[48:51], a[112:115], v[116:119], 0
  ds_read_b64_tr_b16 a[102:103], v82 offset:6144
  v_cvt_pk_bf16_f32 v227, v74, v75
  v_mfma_f32_16x16x32_bf16 v[52:55], a[112:115], v[120:123], 0
  v_mul_f32 v76, v76, v30
  v_mul_f32 v77, v77, v30
  v_mfma_f32_16x16x32_bf16 v[44:47], a[116:119], v[124:127], v[44:47]
  ds_read_b64_tr_b16 a[104:105], v82 offset:8192
  v_mul_f32 v78, v78, v30
  v_mfma_f32_16x16x32_bf16 v[48:51], a[116:119], v[128:131], v[48:51]
  ds_read_b64_tr_b16 a[106:107], v82 offset:10240
  v_mul_f32 v79, v79, v30
  v_mfma_f32_16x16x32_bf16 v[52:55], a[116:119], v[132:135], v[52:55]
  v_cvt_pk_bf16_f32 v230, v76, v77
  s_waitcnt lgkmcnt(6)
  v_mfma_f32_16x16x32_bf16 v[44:47], a[120:123], v[136:139], v[44:47]
  ds_read_b64_tr_b16 a[108:109], v82 offset:12288
  buffer_store_dwordx4 v[216:219], v92, s[48:51], s78 offen offset:2048 sc1
  v_mfma_f32_16x16x32_bf16 v[48:51], a[120:123], v[140:143], v[48:51]
  ds_read_b64_tr_b16 a[110:111], v82 offset:14336
  v_cvt_pk_bf16_f32 v231, v78, v79
  v_mfma_f32_16x16x32_bf16 v[52:55], a[120:123], v[144:147], v[52:55]
  v_mfma_f32_16x16x32_bf16 v[44:47], a[124:127], v[148:151], v[44:47]
  ds_read_b64_tr_b16 a[112:113], v83 offset:0
  v_mfma_f32_16x16x32_bf16 v[48:51], a[124:127], v[152:155], v[48:51]
  ds_read_b64_tr_b16 a[114:115], v83 offset:2048
  v_mfma_f32_16x16x32_bf16 v[52:55], a[124:127], v[156:159], v[52:55]
  s_waitcnt lgkmcnt(6)
  v_mfma_f32_16x16x32_bf16 v[56:59], a[96:99], v[112:115], 0
  ds_read_b64_tr_b16 a[116:117], v83 offset:4096
  v_mfma_f32_16x16x32_bf16 v[60:63], a[96:99], v[116:119], 0
  ds_read_b64_tr_b16 a[118:119], v83 offset:6144
  v_mfma_f32_16x16x32_bf16 v[64:67], a[96:99], v[120:123], 0
  v_mfma_f32_16x16x32_bf16 v[56:59], a[100:103], v[124:127], v[56:59]
  ds_read_b64_tr_b16 a[120:121], v83 offset:8192
  v_mfma_f32_16x16x32_bf16 v[60:63], a[100:103], v[128:131], v[60:63]
  ds_read_b64_tr_b16 a[122:123], v83 offset:10240
  v_mfma_f32_16x16x32_bf16 v[64:67], a[100:103], v[132:135], v[64:67]
  s_waitcnt lgkmcnt(6)
  v_mfma_f32_16x16x32_bf16 v[56:59], a[104:107], v[136:139], v[56:59]
  ds_read_b64_tr_b16 a[124:125], v83 offset:12288
  v_mfma_f32_16x16x32_bf16 v[60:63], a[104:107], v[140:143], v[60:63]
  ds_read_b64_tr_b16 a[126:127], v83 offset:14336
  v_mfma_f32_16x16x32_bf16 v[64:67], a[104:107], v[144:147], v[64:67]
  v_mfma_f32_16x16x32_bf16 v[56:59], a[108:111], v[148:151], v[56:59]
  ds_read_b64_tr_b16 a[96:97], v84 offset:0
  v_mfma_f32_16x16x32_bf16 v[60:63], a[108:111], v[152:155], v[60:63]
  ds_read_b64_tr_b16 a[98:99], v84 offset:2048
  buffer_store_dwordx4 v[220:223], v92, s[48:51], s99 offen offset:0 sc1
  v_mfma_f32_16x16x32_bf16 v[64:67], a[108:111], v[156:159], v[64:67]
  s_waitcnt lgkmcnt(6)
  v_mfma_f32_16x16x32_bf16 v[68:71], a[112:115], v[112:115], 0
  ds_read_b64_tr_b16 a[100:101], v84 offset:4096
  v_mfma_f32_16x16x32_bf16 v[72:75], a[112:115], v[116:119], 0
  ds_read_b64_tr_b16 a[102:103], v84 offset:6144
  v_mfma_f32_16x16x32_bf16 v[76:79], a[112:115], v[120:123], 0
  v_mfma_f32_16x16x32_bf16 v[68:71], a[116:119], v[124:127], v[68:71]
  ds_read_b64_tr_b16 a[104:105], v84 offset:8192
  v_mfma_f32_16x16x32_bf16 v[72:75], a[116:119], v[128:131], v[72:75]
  ds_read_b64_tr_b16 a[106:107], v84 offset:10240
  v_mfma_f32_16x16x32_bf16 v[76:79], a[116:119], v[132:135], v[76:79]
  s_waitcnt lgkmcnt(6)
  v_mfma_f32_16x16x32_bf16 v[68:71], a[120:123], v[136:139], v[68:71]
  ds_read_b64_tr_b16 a[108:109], v84 offset:12288
  v_mfma_f32_16x16x32_bf16 v[72:75], a[120:123], v[140:143], v[72:75]
  ds_read_b64_tr_b16 a[110:111], v84 offset:14336
  v_mfma_f32_16x16x32_bf16 v[76:79], a[120:123], v[144:147], v[76:79]
  v_mfma_f32_16x16x32_bf16 v[68:71], a[124:127], v[148:151], v[68:71]
  ds_read_b64_tr_b16 a[112:113], v85 offset:0
  v_mfma_f32_16x16x32_bf16 v[72:75], a[124:127], v[152:155], v[72:75]
  ds_read_b64_tr_b16 a[114:115], v85 offset:2048
  v_mfma_f32_16x16x32_bf16 v[76:79], a[124:127], v[156:159], v[76:79]
  s_waitcnt lgkmcnt(6)
  v_mfma_f32_16x16x32_bf16 v[32:35], a[96:99], v[160:163], v[32:35]
  ds_read_b64_tr_b16 a[116:117], v85 offset:4096
  buffer_store_dwordx4 v[224:227], v92, s[48:51], s99 offen offset:1024 sc1
  v_mfma_f32_16x16x32_bf16 v[36:39], a[96:99], v[164:167], v[36:39]
  ds_read_b64_tr_b16 a[118:119], v85 offset:6144
  v_mfma_f32_16x16x32_bf16 v[40:43], a[96:99], v[168:171], v[40:43]
  v_mfma_f32_16x16x32_bf16 v[32:35], a[100:103], v[172:175], v[32:35]
  ds_read_b64_tr_b16 a[120:121], v85 offset:8192
  v_mfma_f32_16x16x32_bf16 v[36:39], a[100:103], v[176:179], v[36:39]
  ds_read_b64_tr_b16 a[122:123], v85 offset:10240
  v_mfma_f32_16x16x32_bf16 v[40:43], a[100:103], v[180:183], v[40:43]
  s_waitcnt lgkmcnt(6)
  v_mfma_f32_16x16x32_bf16 v[32:35], a[104:107], v[184:187], v[32:35]
  ds_read_b64_tr_b16 a[124:125], v85 offset:12288
  v_mfma_f32_16x16x32_bf16 v[36:39], a[104:107], v[188:191], v[36:39]
  ds_read_b64_tr_b16 a[126:127], v85 offset:14336
  v_mfma_f32_16x16x32_bf16 v[40:43], a[104:107], v[192:195], v[40:43]
  v_mfma_f32_16x16x32_bf16 v[32:35], a[108:111], v[196:199], v[32:35]
  ds_read_b64_tr_b16 a[96:97], v86 offset:0
  v_mfma_f32_16x16x32_bf16 v[36:39], a[108:111], v[200:203], v[36:39]
  ds_read_b64_tr_b16 a[98:99], v86 offset:2048
  v_mfma_f32_16x16x32_bf16 v[40:43], a[108:111], v[204:207], v[40:43]
  s_waitcnt lgkmcnt(6)
  v_mfma_f32_16x16x32_bf16 v[44:47], a[112:115], v[160:163], v[44:47]
  ds_read_b64_tr_b16 a[100:101], v86 offset:4096
  v_mfma_f32_16x16x32_bf16 v[48:51], a[112:115], v[164:167], v[48:51]
  ds_read_b64_tr_b16 a[102:103], v86 offset:6144
  v_mfma_f32_16x16x32_bf16 v[52:55], a[112:115], v[168:171], v[52:55]
  buffer_store_dwordx4 v[228:231], v92, s[48:51], s99 offen offset:2048 sc1
  v_mfma_f32_16x16x32_bf16 v[44:47], a[116:119], v[172:175], v[44:47]
  ds_read_b64_tr_b16 a[104:105], v86 offset:8192
  v_mul_f32 v32, v32, v26
  v_mfma_f32_16x16x32_bf16 v[48:51], a[116:119], v[176:179], v[48:51]
  ds_read_b64_tr_b16 a[106:107], v86 offset:10240
  v_mul_f32 v33, v33, v26
  v_mfma_f32_16x16x32_bf16 v[52:55], a[116:119], v[180:183], v[52:55]
  v_mul_f32 v34, v34, v26
  s_waitcnt lgkmcnt(6)
  v_mfma_f32_16x16x32_bf16 v[44:47], a[120:123], v[184:187], v[44:47]
  ds_read_b64_tr_b16 a[108:109], v86 offset:12288
  v_mul_f32 v35, v35, v26
  v_mfma_f32_16x16x32_bf16 v[48:51], a[120:123], v[188:191], v[48:51]
  ds_read_b64_tr_b16 a[110:111], v86 offset:14336
  v_cvt_pk_bf16_f32 v208, v32, v33
  v_mfma_f32_16x16x32_bf16 v[52:55], a[120:123], v[192:195], v[52:55]
  v_cvt_pk_bf16_f32 v209, v34, v35
  v_mul_f32 v36, v36, v28
  v_mfma_f32_16x16x32_bf16 v[44:47], a[124:127], v[196:199], v[44:47]
  ds_read_b64_tr_b16 a[112:113], v87 offset:0
  v_mul_f32 v37, v37, v28
  v_mfma_f32_16x16x32_bf16 v[48:51], a[124:127], v[200:203], v[48:51]
  ds_read_b64_tr_b16 a[114:115], v87 offset:2048
  v_mul_f32 v38, v38, v28
  v_mfma_f32_16x16x32_bf16 v[52:55], a[124:127], v[204:207], v[52:55]
  v_mul_f32 v39, v39, v28
  s_waitcnt lgkmcnt(6)
  v_mfma_f32_16x16x32_bf16 v[56:59], a[96:99], v[160:163], v[56:59]
  ds_read_b64_tr_b16 a[116:117], v87 offset:4096
  v_cvt_pk_bf16_f32 v212, v36, v37
  v_mfma_f32_16x16x32_bf16 v[60:63], a[96:99], v[164:167], v[60:63]
  ds_read_b64_tr_b16 a[118:119], v87 offset:6144
  v_cvt_pk_bf16_f32 v213, v38, v39
  v_mfma_f32_16x16x32_bf16 v[64:67], a[96:99], v[168:171], v[64:67]
  v_mul_f32 v40, v40, v30
  v_mul_f32 v41, v41, v30
  v_mfma_f32_16x16x32_bf16 v[56:59], a[100:103], v[172:175], v[56:59]
  ds_read_b64_tr_b16 a[120:121], v87 offset:8192
  v_mul_f32 v42, v42, v30
  v_mfma_f32_16x16x32_bf16 v[60:63], a[100:103], v[176:179], v[60:63]
  ds_read_b64_tr_b16 a[122:123], v87 offset:10240
  v_mul_f32 v43, v43, v30
  v_mfma_f32_16x16x32_bf16 v[64:67], a[100:103], v[180:183], v[64:67]
  v_cvt_pk_bf16_f32 v216, v40, v41
  s_waitcnt lgkmcnt(6)
  v_mfma_f32_16x16x32_bf16 v[56:59], a[104:107], v[184:187], v[56:59]
  ds_read_b64_tr_b16 a[124:125], v87 offset:12288
  v_cvt_pk_bf16_f32 v217, v42, v43
  v_mfma_f32_16x16x32_bf16 v[60:63], a[104:107], v[188:191], v[60:63]
  ds_read_b64_tr_b16 a[126:127], v87 offset:14336
  v_mul_f32 v44, v44, v26
  v_mfma_f32_16x16x32_bf16 v[64:67], a[104:107], v[192:195], v[64:67]
  v_mul_f32 v45, v45, v26
  v_mul_f32 v46, v46, v26
  v_mfma_f32_16x16x32_bf16 v[56:59], a[108:111], v[196:199], v[56:59]
  v_mul_f32 v47, v47, v26
  v_cvt_pk_bf16_f32 v210, v44, v45
  v_mfma_f32_16x16x32_bf16 v[60:63], a[108:111], v[200:203], v[60:63]
  v_cvt_pk_bf16_f32 v211, v46, v47
  v_mul_f32 v48, v48, v28
  v_mfma_f32_16x16x32_bf16 v[64:67], a[108:111], v[204:207], v[64:67]
  v_mul_f32 v49, v49, v28
  s_waitcnt lgkmcnt(4)
  v_mfma_f32_16x16x32_bf16 v[68:71], a[112:115], v[160:163], v[68:71]
  v_mul_f32 v50, v50, v28
  v_mul_f32 v51, v51, v28
  v_mfma_f32_16x16x32_bf16 v[72:75], a[112:115], v[164:167], v[72:75]
  v_cvt_pk_bf16_f32 v214, v48, v49
  v_cvt_pk_bf16_f32 v215, v50, v51
  v_mfma_f32_16x16x32_bf16 v[76:79], a[112:115], v[168:171], v[76:79]
  v_mul_f32 v52, v52, v30
  v_mul_f32 v53, v53, v30
  v_mfma_f32_16x16x32_bf16 v[68:71], a[116:119], v[172:175], v[68:71]
  v_mul_f32 v54, v54, v30
  v_mul_f32 v55, v55, v30
  v_mfma_f32_16x16x32_bf16 v[72:75], a[116:119], v[176:179], v[72:75]
  v_cvt_pk_bf16_f32 v218, v52, v53
  v_cvt_pk_bf16_f32 v219, v54, v55
  v_mfma_f32_16x16x32_bf16 v[76:79], a[116:119], v[180:183], v[76:79]
  s_mul_i32 s78, s79, 6144
  s_waitcnt lgkmcnt(0)
  v_mfma_f32_16x16x32_bf16 v[68:71], a[120:123], v[184:187], v[68:71]
  s_add_u32 s79, s79, 1
  v_mul_f32 v56, v56, v26
  v_mfma_f32_16x16x32_bf16 v[72:75], a[120:123], v[188:191], v[72:75]
  s_cmp_eq_u32 s79, 7
  s_cselect_b32 s79, 0, s79
  v_mfma_f32_16x16x32_bf16 v[76:79], a[120:123], v[192:195], v[76:79]
  s_add_u32 s99, s78, 3072
  buffer_store_dwordx4 v[208:211], v92, s[48:51], s78 offen offset:0 sc1
  v_mfma_f32_16x16x32_bf16 v[68:71], a[124:127], v[196:199], v[68:71]
  v_mul_f32 v57, v57, v26
  v_mul_f32 v58, v58, v26
  v_mfma_f32_16x16x32_bf16 v[72:75], a[124:127], v[200:203], v[72:75]
  v_mul_f32 v59, v59, v26
  v_cvt_pk_bf16_f32 v220, v56, v57
  v_mfma_f32_16x16x32_bf16 v[76:79], a[124:127], v[204:207], v[76:79]
  buffer_store_dwordx4 v[212:215], v92, s[48:51], s78 offen offset:1024 sc1
  buffer_store_dwordx4 v[216:219], v92, s[48:51], s78 offen offset:2048 sc1
  v_cvt_pk_bf16_f32 v221, v58, v59
  v_mul_f32 v60, v60, v28
  v_mul_f32 v61, v61, v28
  v_mul_f32 v62, v62, v28
  v_mul_f32 v63, v63, v28
  v_cvt_pk_bf16_f32 v224, v60, v61
  v_cvt_pk_bf16_f32 v225, v62, v63
  v_mul_f32 v64, v64, v30
  v_mul_f32 v65, v65, v30
  v_mul_f32 v66, v66, v30
  v_mul_f32 v67, v67, v30
  v_cvt_pk_bf16_f32 v228, v64, v65
  v_cvt_pk_bf16_f32 v229, v66, v67
  s_nop 7
  v_mul_f32 v68, v68, v26
  v_mul_f32 v69, v69, v26
  v_mul_f32 v70, v70, v26
  v_mul_f32 v71, v71, v26
  v_cvt_pk_bf16_f32 v222, v68, v69
  v_cvt_pk_bf16_f32 v223, v70, v71
  v_mul_f32 v72, v72, v28
  v_mul_f32 v73, v73, v28
  v_mul_f32 v74, v74, v28
  v_mul_f32 v75, v75, v28
  v_cvt_pk_bf16_f32 v226, v72, v73
  v_cvt_pk_bf16_f32 v227, v74, v75
  v_mul_f32 v76, v76, v30
  v_mul_f32 v77, v77, v30
  v_mul_f32 v78, v78, v30
  v_mul_f32 v79, v79, v30
  v_cvt_pk_bf16_f32 v230, v76, v77
  v_cvt_pk_bf16_f32 v231, v78, v79
  buffer_store_dwordx4 v[220:223], v92, s[48:51], s99 offen offset:0 sc1
  buffer_store_dwordx4 v[224:227], v92, s[48:51], s99 offen offset:1024 sc1
  buffer_store_dwordx4 v[228:231], v92, s[48:51], s99 offen offset:2048 sc1
  s_branch L_red
L_iniB:
  s_cmp_lg_u32 s52, 0
  s_cbranch_scc1 L_iniretB
  s_lshr_b32 s64, s27, 1
  s_lshl_b32 s64, s64, 2
  v_mov_b32 v30, s64
  v_mov_b32 v31, 1
  s_mov_b64 exec, 1
  global_atomic_add v30, v31, s[100:101] sc1
  s_mov_b64 exec, -1
  s_branch L_iniretB
L_warmB:
  s_getpc_b64 s[66:67]
L_cw2B:
  s_add_u32 s66, s66, L_tailB-L_cw2B
  s_addc_u32 s67, s67, -1
  s_lshl_b32 s64, s27, 2
  s_add_u32 s64, s64, s52
  s_lshl_b32 s64, s64, 9
  v_lshlrev_b32 v30, 3, v92
  v_add_u32 v30, s64, v30
  v_min_u32 v30, L_codeend-L_tailB, v30
  v_mov_b32 v31, s67
  v_add_co_u32 v30, vcc, s66, v30
  s_nop 1
  v_addc_co_u32 v31, vcc, 0, v31, vcc
  s_mov_b64 exec, 0xf
  global_load_dword v100, v[30:31], off
  s_mov_b64 exec, -1
  s_branch L_warmretB
L_flowA:
  s_mul_i32 s64, s52, 21504
  v_lshrrev_b32 v97, 3, v106
  v_mul_u32_u24 v97, 896, v97
  v_add_u32 v97, s64, v97
  v_and_b32 v0, 7, v106
  v_xor_b32 v0, v0, v107
  s_lshl_b32 s65, s54, 2
  v_xor_b32 v0, s65, v0
  v_lshl_add_u32 v20, v0, 4, v97
  v_xor_b32 v0, 4, v0
  v_lshl_add_u32 v1, v0, 4, v97
  v_add_u32 v21, 6144, v1
  v_add_u32 v22, 12288, v20
  v_lshlrev_b32 v0, 1, v107
  v_xor_b32 v0, v0, v108
  v_lshlrev_b32 v97, 13, v107
  s_lshl_b32 s65, s54, 17
  v_add_u32 v97, s65, v97
  v_lshl_add_u32 v88, v0, 4, v97
  v_add_u32 v89, 31744, v88
  v_xor_b32 v0, 8, v0
  v_lshl_add_u32 v90, v0, 4, v97
  v_add_u32 v91, 95232, v90
  v_add_u32 v90, 63488, v90
  s_lshl_b32 s64, s26, 1
  s_add_u32 s64, s64, s53
  s_mul_i32 s67, s27, 86016
  s_lshl_b32 s97, s52, 12
  s_lshl_b32 s65, s64, 9
  s_sub_u32 s60, 3670016, s65
  s_mul_i32 s77, s52, 3072
  s_lshl_b32 s78, s98, 7
  s_waitcnt lgkmcnt(0)
  s_add_u32 s36, s10, s65
  s_addc_u32 s37, s11, 0
  s_and_b32 s37, s37, 0xffff
  s_mov_b32 s38, s60
  s_mov_b32 s39, 0x20000
  s_add_u32 s44, s4, s67
  s_addc_u32 s45, s5, 0
  s_and_b32 s45, s45, 0xffff
  s_mov_b32 s46, 86016
  s_mov_b32 s47, 0x20000
  s_add_u32 m0, s97, 0
  s_nop 0
  buffer_load_dwordx4 v88, s[36:39], s61 offen offset:0 nt lds
  buffer_load_dwordx4 v89, s[36:39], s61 offen offset:1024 nt lds
  buffer_load_dwordx4 v90, s[36:39], s61 offen offset:2048 nt lds
  buffer_load_dwordx4 v91, s[36:39], s61 offen offset:3072 nt lds
  s_add_u32 s61, s61, 256
  s_add_u32 m0, s77, 131072
  s_nop 0
  buffer_load_dwordx4 v20, s[44:47], s78 offen offset:0  lds
  buffer_load_dwordx4 v21, s[44:47], s78 offen offset:1024  lds
  buffer_load_dwordx4 v22, s[44:47], s78 offen offset:2048  lds
  s_add_u32 s78, s78, 128
  s_cmp_eq_u32 s78, 896
  s_cselect_b32 s78, 0, s78
  s_add_u32 m0, s97, 16384
  s_nop 0
  buffer_load_dwordx4 v88, s[36:39], s61 offen offset:0 nt lds
  buffer_load_dwordx4 v89, s[36:39], s61 offen offset:1024 nt lds
  buffer_load_dwordx4 v90, s[36:39], s61 offen offset:2048 nt lds
  buffer_load_dwordx4 v91, s[36:39], s61 offen offset:3072 nt lds
  s_add_u32 s61, s61, 261888
  s_cmp_eq_u32 s61, 3670016
  s_cselect_b32 s61, 0, s61
  v_lshrrev_b32 v109, 2, v108
  v_and_b32 v110, 3, v106
  v_lshl_add_u32 v97, v107, 3, v109
  v_lshlrev_b32 v97, 8, v97
  v_lshl_add_u32 v97, v110, 3, v97
  s_lshl_b32 s66, s53, 13
  v_add_u32 v97, s66, v97
  v_and_b32 v0, 1, v107
  v_lshl_add_u32 v0, v0, 2, v109
  v_xor_b32 v1, 0, v0
  v_lshl_add_u32 v80, v1, 5, v97
  v_xor_b32 v1, 1, v0
  v_lshl_add_u32 v81, v1, 5, v97
  v_xor_b32 v1, 2, v0
  v_lshl_add_u32 v82, v1, 5, v97
  v_xor_b32 v1, 3, v0
  v_lshl_add_u32 v83, v1, 5, v97
  v_xor_b32 v1, 4, v0
  v_lshl_add_u32 v84, v1, 5, v97
  v_xor_b32 v1, 5, v0
  v_lshl_add_u32 v85, v1, 5, v97
  v_xor_b32 v1, 6, v0
  v_lshl_add_u32 v86, v1, 5, v97
  v_xor_b32 v1, 7, v0
  v_lshl_add_u32 v87, v1, 5, v97
  s_mul_i32 s66, s54, 6144
  s_add_u32 s66, s66, 131072
  v_lshlrev_b32 v97, 7, v108
  v_add_u32 v97, s66, v97
  v_lshrrev_b32 v0, 1, v108
  v_xor_b32 v0, v0, v107
  v_lshl_add_u32 v92, v0, 4, v97
  v_xor_b32 v0, 4, v0
  v_lshl_add_u32 v93, v0, 4, v97
  s_add_u32 m0, s97, 65536
  s_nop 0
  buffer_load_dwordx4 v88, s[36:39], s61 offen offset:0 nt lds
  buffer_load_dwordx4 v89, s[36:39], s61 offen offset:1024 nt lds
  buffer_load_dwordx4 v90, s[36:39], s61 offen offset:2048 nt lds
  buffer_load_dwordx4 v91, s[36:39], s61 offen offset:3072 nt lds
  s_add_u32 s61, s61, 256
  s_waitcnt vmcnt(8)
  s_barrier
  ds_read_b128 a[48:51], v92 offset:0
  ds_read_b128 a[52:55], v92 offset:2048
  ds_read_b128 a[56:59], v92 offset:4096
  ds_read_b64_tr_b16 a[96:97], v80 offset:0
  ds_read_b64_tr_b16 a[98:99], v80 offset:1024
  ds_read_b64_tr_b16 a[100:101], v81 offset:0
  ds_read_b64_tr_b16 a[102:103], v81 offset:1024
  ds_read_b64_tr_b16 a[104:105], v82 offset:0
  ds_read_b64_tr_b16 a[106:107], v82 offset:1024
  ds_read_b64_tr_b16 a[108:109], v83 offset:0
  ds_read_b64_tr_b16 a[110:111], v83 offset:1024
  ds_read_b64_tr_b16 a[112:113], v84 offset:0
  ds_read_b64_tr_b16 a[114:115], v84 offset:1024
  s_waitcnt lgkmcnt(10)
  v_add_u32 v98, 65536, v80
  v_add_u32 v99, 65536, v81
  v_add_u32 v100, 65536, v82
  v_add_u32 v101, 65536, v83
  v_add_u32 v102, 65536, v84
  v_add_u32 v103, 65536, v85
  v_add_u32 v104, 65536, v86
  v_add_u32 v105, 65536, v87
  v_add_u32 v94, 16384, v92
  v_add_u32 v95, 16384, v93
  s_lshl_b32 s65, s27, 3
  s_add_u32 s65, s65, s26
  s_lshl_b32 s65, s65, 19
  s_add_u32 s28, s6, s65
  s_addc_u32 s29, s7, 0
  s_and_b32 s29, s29, 0xffff
  s_mov_b32 s30, 524288
  s_mov_b32 s31, 0x20000
  v_lshrrev_b32 v111, 5, v106
  v_and_b32 v96, 31, v106
  s_lshl_b32 s66, s52, 12
  s_mov_b32 s58, s66
  s_mov_b32 s67, 0
  v_lshlrev_b32 v97, 1, v111
  v_xor_b32 v97, v97, v96
  v_lshlrev_b32 v0, 9, v111
  v_add_u32 v0, s66, v0
  v_xor_b32 v1, 0, v97
  v_lshl_add_u32 v16, v1, 4, v0
  v_xor_b32 v1, 4, v97
  v_lshl_add_u32 v17, v1, 4, v0
  v_xor_b32 v1, 8, v97
  v_lshl_add_u32 v18, v1, 4, v0
  v_xor_b32 v1, 12, v97
  v_lshl_add_u32 v19, v1, 4, v0
  s_add_u32 s32, s8, s65
  s_addc_u32 s33, s9, 0
  s_and_b32 s33, s33, 0xffff
  s_mov_b32 s34, 524288
  s_mov_b32 s35, 0x20000
  s_waitcnt lgkmcnt(6)
  v_mfma_f32_16x16x32_bf16 v[112:115], a[96:99], a[48:51], 0
  ds_read_b64_tr_b16 a[116:117], v85 offset:0
  s_add_u32 m0, s97, 81920
  s_nop 0
  buffer_load_dwordx4 v88, s[36:39], s61 offen offset:0 nt lds
  v_mfma_f32_16x16x32_bf16 v[116:119], a[96:99], a[52:55], 0
  ds_read_b64_tr_b16 a[118:119], v85 offset:1024
  v_and_b32 v97, 7, v108
  v_mfma_f32_16x16x32_bf16 v[120:123], a[96:99], a[56:59], 0
  v_lshlrev_b32 v97, 1, v97
  v_xor_b32 v97, v97, v107
  v_mfma_f32_16x16x32_bf16 v[124:127], a[100:103], a[48:51], 0
  ds_read_b64_tr_b16 a[120:121], v86 offset:0
  s_mov_b32 s67, 0x8000
  v_mfma_f32_16x16x32_bf16 v[128:131], a[100:103], a[52:55], 0
  ds_read_b64_tr_b16 a[122:123], v86 offset:1024
  buffer_load_dwordx4 v89, s[36:39], s61 offen offset:1024 nt lds
  v_mfma_f32_16x16x32_bf16 v[132:135], a[100:103], a[56:59], 0
  v_lshlrev_b32 v0, 9, v108
  s_waitcnt lgkmcnt(6)
  v_mfma_f32_16x16x32_bf16 v[136:139], a[104:107], a[48:51], 0
  ds_read_b64_tr_b16 a[124:125], v87 offset:0
  v_add_u32 v0, s67, v0
  v_mfma_f32_16x16x32_bf16 v[140:143], a[104:107], a[52:55], 0
  ds_read_b64_tr_b16 a[126:127], v87 offset:1024
  v_xor_b32 v1, 0, v97
  v_mfma_f32_16x16x32_bf16 v[144:147], a[104:107], a[56:59], 0
  buffer_load_dwordx4 v90, s[36:39], s61 offen offset:2048 nt lds
  v_mfma_f32_16x16x32_bf16 v[148:151], a[108:111], a[48:51], 0
  v_lshl_add_u32 v4, v1, 4, v0
  v_xor_b32 v1, 4, v97
  v_mfma_f32_16x16x32_bf16 v[152:155], a[108:111], a[52:55], 0
  v_lshl_add_u32 v5, v1, 4, v0
  v_xor_b32 v1, 8, v97
  v_mfma_f32_16x16x32_bf16 v[156:159], a[108:111], a[56:59], 0
  v_lshl_add_u32 v6, v1, 4, v0
  s_waitcnt lgkmcnt(4)
  v_mfma_f32_16x16x32_bf16 v[160:163], a[112:115], a[48:51], 0
  s_waitcnt vmcnt(7) lgkmcnt(0)
  s_barrier
  v_mfma_f32_16x16x32_bf16 v[164:167], a[112:115], a[52:55], 0
  ds_read_b64_tr_b16 a[96:97], v80 offset:16384
  buffer_load_dwordx4 v91, s[36:39], s61 offen offset:3072 nt lds
  v_mfma_f32_16x16x32_bf16 v[168:171], a[112:115], a[56:59], 0
  ds_read_b64_tr_b16 a[98:99], v80 offset:17408
  s_add_u32 s61, s61, 261888
  v_mfma_f32_16x16x32_bf16 v[172:175], a[116:119], a[48:51], 0
  ds_read_b64_tr_b16 a[100:101], v81 offset:16384
  ds_read_b128 a[60:63], v93 offset:0
  v_mfma_f32_16x16x32_bf16 v[176:179], a[116:119], a[52:55], 0
  ds_read_b64_tr_b16 a[102:103], v81 offset:17408
  ds_read_b128 a[64:67], v93 offset:2048
  v_mfma_f32_16x16x32_bf16 v[180:183], a[116:119], a[56:59], 0
  ds_read_b64_tr_b16 a[104:105], v82 offset:16384
  ds_read_b128 a[68:71], v93 offset:4096
  v_mfma_f32_16x16x32_bf16 v[184:187], a[120:123], a[48:51], 0
  ds_read_b64_tr_b16 a[106:107], v82 offset:17408
  v_xor_b32 v1, 12, v97
  v_mfma_f32_16x16x32_bf16 v[188:191], a[120:123], a[52:55], 0
  ds_read_b64_tr_b16 a[108:109], v83 offset:16384
  v_lshl_add_u32 v7, v1, 4, v0
  v_mfma_f32_16x16x32_bf16 v[192:195], a[120:123], a[56:59], 0
  ds_read_b64_tr_b16 a[110:111], v83 offset:17408
  v_lshl_add_u32 v97, v107, 2, v109
  v_mfma_f32_16x16x32_bf16 v[196:199], a[124:127], a[48:51], 0
  ds_read_b64_tr_b16 a[112:113], v84 offset:16384
  v_lshlrev_b32 v0, 9, v97
  v_mfma_f32_16x16x32_bf16 v[200:203], a[124:127], a[52:55], 0
  ds_read_b64_tr_b16 a[114:115], v84 offset:17408
  v_lshl_add_u32 v0, v110, 3, v0
  v_mfma_f32_16x16x32_bf16 v[204:207], a[124:127], a[56:59], 0
  s_mov_b32 s67, 0x18000
  s_cmp_eq_u32 s61, 3670016
  s_cselect_b32 s61, 0, s61
  s_add_u32 m0, s77, 147456
  s_nop 0
  buffer_load_dwordx4 v20, s[44:47], s78 offen offset:0  lds
  buffer_load_dwordx4 v21, s[44:47], s78 offen offset:1024  lds
  buffer_load_dwordx4 v22, s[44:47], s78 offen offset:2048  lds
  s_add_u32 s78, s78, 128
  s_cmp_eq_u32 s78, 896
  s_cselect_b32 s78, 0, s78
  s_add_u32 m0, s58, 32768
  s_mov_b32 s68, 0
  buffer_load_dwordx4 v16, s[28:31], s68 offen offset:0 nt lds
  buffer_load_dwordx4 v17, s[28:31], s68 offen offset:1024 nt lds
  buffer_load_dwordx4 v18, s[28:31], s68 offen offset:2048 nt lds
  buffer_load_dwordx4 v19, s[28:31], s68 offen offset:3072 nt lds
  s_add_u32 m0, s58, 49152
  s_mov_b32 s68, 16384
  buffer_load_dwordx4 v16, s[28:31], s68 offen offset:0 nt lds
  buffer_load_dwordx4 v17, s[28:31], s68 offen offset:1024 nt lds
  buffer_load_dwordx4 v18, s[28:31], s68 offen offset:2048 nt lds
  buffer_load_dwordx4 v19, s[28:31], s68 offen offset:3072 nt lds
  s_add_u32 m0, s58, 98304
  s_mov_b32 s68, 0
  buffer_load_dwordx4 v16, s[32:35], s68 offen offset:0 nt lds
  buffer_load_dwordx4 v17, s[32:35], s68 offen offset:1024 nt lds
  buffer_load_dwordx4 v18, s[32:35], s68 offen offset:2048 nt lds
  buffer_load_dwordx4 v19, s[32:35], s68 offen offset:3072 nt lds
  s_waitcnt lgkmcnt(8)
  v_mfma_f32_16x16x32_bf16 v[208:211], a[96:99], a[48:51], 0
  ds_read_b64_tr_b16 a[116:117], v85 offset:16384
  s_add_u32 m0, s97, 0
  s_nop 0
  buffer_load_dwordx4 v88, s[36:39], s61 offen offset:0  lds
  v_mfma_f32_16x16x32_bf16 v[212:215], a[96:99], a[52:55], 0
  ds_read_b64_tr_b16 a[118:119], v85 offset:17408
  v_add_u32 v0, s67, v0
  v_mfma_f32_16x16x32_bf16 v[216:219], a[96:99], a[56:59], 0
  v_and_b32 v97, 7, v97
  v_xor_b32 v1, 0, v97
  v_mfma_f32_16x16x32_bf16 v[220:223], a[100:103], a[48:51], 0
  ds_read_b64_tr_b16 a[120:121], v86 offset:16384
  v_lshl_add_u32 v8, v1, 5, v0
  v_mfma_f32_16x16x32_bf16 v[224:227], a[100:103], a[52:55], 0
  ds_read_b64_tr_b16 a[122:123], v86 offset:17408
  buffer_load_dwordx4 v89, s[36:39], s61 offen offset:1024  lds
  v_mfma_f32_16x16x32_bf16 v[228:231], a[100:103], a[56:59], 0
  v_xor_b32 v1, 1, v97
  s_waitcnt lgkmcnt(6)
  v_mfma_f32_16x16x32_bf16 v[232:235], a[104:107], a[48:51], 0
  ds_read_b64_tr_b16 a[124:125], v87 offset:16384
  v_lshl_add_u32 v9, v1, 5, v0
  v_mfma_f32_16x16x32_bf16 v[236:239], a[104:107], a[52:55], 0
  ds_read_b64_tr_b16 a[126:127], v87 offset:17408
  v_xor_b32 v1, 2, v97
  v_mfma_f32_16x16x32_bf16 v[240:243], a[104:107], a[56:59], 0
  buffer_load_dwordx4 v90, s[36:39], s61 offen offset:2048  lds
  v_mfma_f32_16x16x32_bf16 v[244:247], a[108:111], a[48:51], 0
  v_lshl_add_u32 v10, v1, 5, v0
  v_xor_b32 v1, 3, v97
  v_mfma_f32_16x16x32_bf16 v[248:251], a[108:111], a[52:55], 0
  v_lshl_add_u32 v11, v1, 5, v0
  v_xor_b32 v1, 4, v97
  v_mfma_f32_16x16x32_bf16 v[252:255], a[108:111], a[56:59], 0
  v_lshl_add_u32 v12, v1, 5, v0
  s_waitcnt lgkmcnt(4)
  v_mfma_f32_16x16x32_bf16 v[32:35], a[112:115], a[48:51], 0
  s_waitcnt vmcnt(22) lgkmcnt(0)
  s_barrier
  v_mfma_f32_16x16x32_bf16 v[36:39], a[112:115], a[52:55], 0
  ds_read_b64_tr_b16 a[96:97], v98 offset:0
  buffer_load_dwordx4 v91, s[36:39], s61 offen offset:3072  lds
  v_mfma_f32_16x16x32_bf16 v[40:43], a[112:115], a[56:59], 0
  ds_read_b64_tr_b16 a[98:99], v98 offset:1024
  s_add_u32 s61, s61, 256
  v_mfma_f32_16x16x32_bf16 v[44:47], a[116:119], a[48:51], 0
  ds_read_b64_tr_b16 a[100:101], v99 offset:0
  v_xor_b32 v1, 5, v97
  v_mfma_f32_16x16x32_bf16 v[48:51], a[116:119], a[52:55], 0
  ds_read_b64_tr_b16 a[102:103], v99 offset:1024
  v_lshl_add_u32 v13, v1, 5, v0
  v_mfma_f32_16x16x32_bf16 v[52:55], a[116:119], a[56:59], 0
  ds_read_b64_tr_b16 a[104:105], v100 offset:0
  s_add_u32 m0, s58, 114688
  s_mov_b32 s68, 32768
  buffer_load_dwordx4 v16, s[28:31], s68 offen offset:0 nt lds
  v_mfma_f32_16x16x32_bf16 v[56:59], a[120:123], a[48:51], 0
  ds_read_b64_tr_b16 a[106:107], v100 offset:1024
  v_xor_b32 v1, 6, v97
  v_mfma_f32_16x16x32_bf16 v[60:63], a[120:123], a[52:55], 0
  ds_read_b64_tr_b16 a[108:109], v101 offset:0
  v_lshl_add_u32 v14, v1, 5, v0
  v_mfma_f32_16x16x32_bf16 v[64:67], a[120:123], a[56:59], 0
  ds_read_b64_tr_b16 a[110:111], v101 offset:1024
  v_xor_b32 v1, 7, v97
  v_mfma_f32_16x16x32_bf16 v[68:71], a[124:127], a[48:51], 0
  ds_read_b64_tr_b16 a[112:113], v102 offset:0
  buffer_load_dwordx4 v17, s[28:31], s68 offen offset:1024 nt lds
  v_mfma_f32_16x16x32_bf16 v[72:75], a[124:127], a[52:55], 0
  ds_read_b64_tr_b16 a[114:115], v102 offset:1024
  v_lshl_add_u32 v15, v1, 5, v0
  v_mfma_f32_16x16x32_bf16 v[76:79], a[124:127], a[56:59], 0
  s_mul_i32 s65, s26, 458752
  buffer_load_dwordx4 v18, s[28:31], s68 offen offset:2048 nt lds
  buffer_load_dwordx4 v19, s[28:31], s68 offen offset:3072 nt lds
  s_add_u32 m0, s58, 0
  s_mov_b32 s68, 16384
  buffer_load_dwordx4 a[160:163], v16, s[32:35], s68 offen offset:0 nt
  buffer_load_dwordx4 a[164:167], v17, s[32:35], s68 offen offset:1024 nt
  buffer_load_dwordx4 a[168:171], v18, s[32:35], s68 offen offset:2048 nt
  buffer_load_dwordx4 a[172:175], v19, s[32:35], s68 offen offset:3072 nt
  s_add_u32 m0, s58, 16384
  s_mov_b32 s68, 49152
  buffer_load_dwordx4 a[176:179], v16, s[28:31], s68 offen offset:0 nt
  buffer_load_dwordx4 a[180:183], v17, s[28:31], s68 offen offset:1024 nt
  buffer_load_dwordx4 a[184:187], v18, s[28:31], s68 offen offset:2048 nt
  buffer_load_dwordx4 a[188:191], v19, s[28:31], s68 offen offset:3072 nt
  s_waitcnt lgkmcnt(6)
  v_mfma_f32_16x16x32_bf16 v[112:115], a[96:99], a[60:63], v[112:115]
  ds_read_b64_tr_b16 a[116:117], v103 offset:0
  v_mfma_f32_16x16x32_bf16 v[116:119], a[96:99], a[64:67], v[116:119]
  ds_read_b64_tr_b16 a[118:119], v103 offset:1024
  s_add_u32 m0, s97, 16384
  s_nop 0
  buffer_load_dwordx4 v88, s[36:39], s61 offen offset:0  lds
  v_mfma_f32_16x16x32_bf16 v[120:123], a[96:99], a[68:71], v[120:123]
  s_add_u32 s40, s12, s65
  s_addc_u32 s41, s13, 0
  v_mfma_f32_16x16x32_bf16 v[124:127], a[100:103], a[60:63], v[124:127]
  ds_read_b64_tr_b16 a[120:121], v104 offset:0
  s_and_b32 s41, s41, 0xffff
  v_mfma_f32_16x16x32_bf16 v[128:131], a[100:103], a[64:67], v[128:131]
  ds_read_b64_tr_b16 a[122:123], v104 offset:1024
  s_mov_b32 s42, 458752
  v_mfma_f32_16x16x32_bf16 v[132:135], a[100:103], a[68:71], v[132:135]
  buffer_load_dwordx4 v89, s[36:39], s61 offen offset:1024  lds
  s_waitcnt lgkmcnt(6)
  v_mfma_f32_16x16x32_bf16 v[136:139], a[104:107], a[60:63], v[136:139]
  ds_read_b64_tr_b16 a[124:125], v105 offset:0
  s_mov_b32 s43, 0x20000
  v_mfma_f32_16x16x32_bf16 v[140:143], a[104:107], a[64:67], v[140:143]
  ds_read_b64_tr_b16 a[126:127], v105 offset:1024
  s_lshl_b32 s65, s27, 3
  v_mfma_f32_16x16x32_bf16 v[144:147], a[104:107], a[68:71], v[144:147]
  s_add_u32 s65, s65, s26
  s_lshl_b32 s65, s65, 2
  v_mfma_f32_16x16x32_bf16 v[148:151], a[108:111], a[60:63], v[148:151]
  buffer_load_dwordx4 v90, s[36:39], s61 offen offset:2048  lds
  v_mfma_f32_16x16x32_bf16 v[152:155], a[108:111], a[64:67], v[152:155]
  s_add_u32 s65, s65, s52
  s_mul_i32 s65, s65, 21504
  v_mfma_f32_16x16x32_bf16 v[156:159], a[108:111], a[68:71], v[156:159]
  s_waitcnt lgkmcnt(4)
  v_mfma_f32_16x16x32_bf16 v[160:163], a[112:115], a[60:63], v[160:163]
  s_waitcnt vmcnt(34) lgkmcnt(0)
  s_barrier
  v_mfma_f32_16x16x32_bf16 v[164:167], a[112:115], a[64:67], v[164:167]
  ds_read_b64_tr_b16 a[96:97], v98 offset:16384
  buffer_load_dwordx4 v91, s[36:39], s61 offen offset:3072  lds
  v_mfma_f32_16x16x32_bf16 v[168:171], a[112:115], a[68:71], v[168:171]
  ds_read_b64_tr_b16 a[98:99], v98 offset:17408
  s_add_u32 s61, s61, 261888
  v_mfma_f32_16x16x32_bf16 v[172:175], a[116:119], a[60:63], v[172:175]
  ds_read_b64_tr_b16 a[100:101], v99 offset:16384
  v_mfma_f32_16x16x32_bf16 v[176:179], a[116:119], a[64:67], v[176:179]
  ds_read_b64_tr_b16 a[102:103], v99 offset:17408
  v_mfma_f32_16x16x32_bf16 v[180:183], a[116:119], a[68:71], v[180:183]
  ds_read_b64_tr_b16 a[104:105], v100 offset:16384
  v_mfma_f32_16x16x32_bf16 v[184:187], a[120:123], a[60:63], v[184:187]
  ds_read_b64_tr_b16 a[106:107], v100 offset:17408
  v_mfma_f32_16x16x32_bf16 v[188:191], a[120:123], a[64:67], v[188:191]
  ds_read_b64_tr_b16 a[108:109], v101 offset:16384
  v_mfma_f32_16x16x32_bf16 v[192:195], a[120:123], a[68:71], v[192:195]
  ds_read_b64_tr_b16 a[110:111], v101 offset:17408
  v_mfma_f32_16x16x32_bf16 v[196:199], a[124:127], a[60:63], v[196:199]
  ds_read_b64_tr_b16 a[112:113], v102 offset:16384
  v_mfma_f32_16x16x32_bf16 v[200:203], a[124:127], a[64:67], v[200:203]
  ds_read_b64_tr_b16 a[114:115], v102 offset:17408
  v_mfma_f32_16x16x32_bf16 v[204:207], a[124:127], a[68:71], v[204:207]
  s_cmp_eq_u32 s61, 3670016
  s_cselect_b32 s61, 0, s61
  s_add_u32 m0, s77, 131072
  s_nop 0
  buffer_load_dwordx4 v20, s[44:47], s78 offen offset:0  lds
  buffer_load_dwordx4 v21, s[44:47], s78 offen offset:1024  lds
  buffer_load_dwordx4 v22, s[44:47], s78 offen offset:2048  lds
  s_add_u32 s78, s78, 128
  s_cmp_eq_u32 s78, 896
  s_cselect_b32 s78, 0, s78
  s_add_u32 m0, s58, 65536
  s_mov_b32 s68, 32768
  buffer_load_dwordx4 a[192:195], v16, s[32:35], s68 offen offset:0 nt
  buffer_load_dwordx4 a[196:199], v17, s[32:35], s68 offen offset:1024 nt
  buffer_load_dwordx4 a[200:203], v18, s[32:35], s68 offen offset:2048 nt
  buffer_load_dwordx4 a[204:207], v19, s[32:35], s68 offen offset:3072 nt
  s_add_u32 m0, s58, 81920
  s_mov_b32 s68, 65536
  buffer_load_dwordx4 a[128:131], v16, s[28:31], s68 offen offset:0 nt
  buffer_load_dwordx4 a[132:135], v17, s[28:31], s68 offen offset:1024 nt
  buffer_load_dwordx4 a[136:139], v18, s[28:31], s68 offen offset:2048 nt
  buffer_load_dwordx4 a[140:143], v19, s[28:31], s68 offen offset:3072 nt
  s_add_u32 m0, s58, 32768
  s_mov_b32 s68, 475136
  buffer_load_dwordx4 a[144:147], v16, s[32:35], s68 offen offset:0 nt
  buffer_load_dwordx4 a[148:151], v17, s[32:35], s68 offen offset:1024 nt
  buffer_load_dwordx4 a[152:155], v18, s[32:35], s68 offen offset:2048 nt
  buffer_load_dwordx4 a[156:159], v19, s[32:35], s68 offen offset:3072 nt
  s_waitcnt lgkmcnt(6)
  v_mfma_f32_16x16x32_bf16 v[208:211], a[96:99], a[60:63], v[208:211]
  ds_read_b64_tr_b16 a[116:117], v103 offset:16384
  s_add_u32 m0, s97, 65536
  s_nop 0
  buffer_load_dwordx4 v88, s[36:39], s61 offen offset:0  lds
  v_mfma_f32_16x16x32_bf16 v[212:215], a[96:99], a[64:67], v[212:215]
  ds_read_b64_tr_b16 a[118:119], v103 offset:17408
  v_mfma_f32_16x16x32_bf16 v[216:219], a[96:99], a[68:71], v[216:219]
  s_add_u32 s48, s24, s65
  s_addc_u32 s49, s25, 0
  v_mfma_f32_16x16x32_bf16 v[220:223], a[100:103], a[60:63], v[220:223]
  ds_read_b64_tr_b16 a[120:121], v104 offset:16384
  s_and_b32 s49, s49, 0xffff
  v_mfma_f32_16x16x32_bf16 v[224:227], a[100:103], a[64:67], v[224:227]
  ds_read_b64_tr_b16 a[122:123], v104 offset:17408
  buffer_load_dwordx4 v89, s[36:39], s61 offen offset:1024  lds
  v_mfma_f32_16x16x32_bf16 v[228:231], a[100:103], a[68:71], v[228:231]
  s_mov_b32 s50, 21504
  s_waitcnt lgkmcnt(6)
  v_mfma_f32_16x16x32_bf16 v[232:235], a[104:107], a[60:63], v[232:235]
  ds_read_b64_tr_b16 a[124:125], v105 offset:16384
  s_mov_b32 s51, 0x20000
  v_mfma_f32_16x16x32_bf16 v[236:239], a[104:107], a[64:67], v[236:239]
  ds_read_b64_tr_b16 a[126:127], v105 offset:17408
  v_mfma_f32_16x16x32_bf16 v[240:243], a[104:107], a[68:71], v[240:243]
  buffer_load_dwordx4 v90, s[36:39], s61 offen offset:2048  lds
  v_mfma_f32_16x16x32_bf16 v[244:247], a[108:111], a[60:63], v[244:247]
  s_add_u32 s20, s24, 33554432
  s_addc_u32 s21, s25, 0
  v_mfma_f32_16x16x32_bf16 v[248:251], a[108:111], a[64:67], v[248:251]
  v_mov_b32 v3, 0
  s_add_u32 s79, s2, 64
  v_mfma_f32_16x16x32_bf16 v[252:255], a[108:111], a[68:71], v[252:255]
  s_lshl_b32 s79, s79, 8
  s_waitcnt lgkmcnt(4)
  v_mfma_f32_16x16x32_bf16 v[32:35], a[112:115], a[60:63], v[32:35]
  s_waitcnt vmcnt(34) lgkmcnt(0)
  s_barrier
  v_mfma_f32_16x16x32_bf16 v[36:39], a[112:115], a[64:67], v[36:39]
  ds_read_b64_tr_b16 a[96:97], v80 offset:0
  ds_read_b128 a[72:75], v94 offset:0
  v_mfma_f32_16x16x32_bf16 v[40:43], a[112:115], a[68:71], v[40:43]
  ds_read_b64_tr_b16 a[98:99], v80 offset:1024
  ds_read_b128 a[76:79], v94 offset:2048
  v_mfma_f32_16x16x32_bf16 v[44:47], a[116:119], a[60:63], v[44:47]
  ds_read_b64_tr_b16 a[100:101], v81 offset:0
  ds_read_b128 a[80:83], v94 offset:4096
  v_mfma_f32_16x16x32_bf16 v[48:51], a[116:119], a[64:67], v[48:51]
  ds_read_b64_tr_b16 a[102:103], v81 offset:1024
  buffer_load_dwordx4 v91, s[36:39], s61 offen offset:3072  lds
  v_mfma_f32_16x16x32_bf16 v[52:55], a[116:119], a[68:71], v[52:55]
  ds_read_b64_tr_b16 a[104:105], v82 offset:0
  s_add_u32 s61, s61, 256
  v_mfma_f32_16x16x32_bf16 v[56:59], a[120:123], a[60:63], v[56:59]
  ds_read_b64_tr_b16 a[106:107], v82 offset:1024
  v_and_b32 v2, 31, v106
  v_mfma_f32_16x16x32_bf16 v[60:63], a[120:123], a[64:67], v[60:63]
  ds_read_b64_tr_b16 a[108:109], v83 offset:0
  v_lshl_add_u32 v2, v2, 2, s79
  v_mfma_f32_16x16x32_bf16 v[64:67], a[120:123], a[68:71], v[64:67]
  ds_read_b64_tr_b16 a[110:111], v83 offset:1024
  s_add_u32 m0, s58, 49152
  s_mov_b32 s68, 507904
  buffer_load_dwordx4 a[208:211], v16, s[28:31], s68 offen offset:0 nt
  v_mfma_f32_16x16x32_bf16 v[68:71], a[124:127], a[60:63], v[68:71]
  ds_read_b64_tr_b16 a[112:113], v84 offset:0
  global_store_dword v2, v3, s[20:21] sc1
  v_mfma_f32_16x16x32_bf16 v[72:75], a[124:127], a[64:67], v[72:75]
  ds_read_b64_tr_b16 a[114:115], v84 offset:1024
  s_mov_b32 s63, 0x3db8aa3b
  v_mfma_f32_16x16x32_bf16 v[76:79], a[124:127], a[68:71], v[76:79]
  s_mov_b32 s56, 81920
  buffer_load_dwordx4 a[212:215], v17, s[28:31], s68 offen offset:1024 nt
  buffer_load_dwordx4 a[216:219], v18, s[28:31], s68 offen offset:2048 nt
  buffer_load_dwordx4 a[220:223], v19, s[28:31], s68 offen offset:3072 nt
  s_add_u32 m0, s58, 98304
  s_mov_b32 s68, 491520
  buffer_load_dwordx4 a[224:227], v16, s[32:35], s68 offen offset:0 nt
  buffer_load_dwordx4 a[228:231], v17, s[32:35], s68 offen offset:1024 nt
  buffer_load_dwordx4 a[232:235], v18, s[32:35], s68 offen offset:2048 nt
  buffer_load_dwordx4 a[236:239], v19, s[32:35], s68 offen offset:3072 nt
  s_add_u32 m0, s58, 114688
  s_mov_b32 s68, 507904
  buffer_load_dwordx4 a[240:243], v16, s[32:35], s68 offen offset:0 nt
  buffer_load_dwordx4 a[244:247], v17, s[32:35], s68 offen offset:1024 nt
  buffer_load_dwordx4 a[248:251], v18, s[32:35], s68 offen offset:2048 nt
  buffer_load_dwordx4 a[252:255], v19, s[32:35], s68 offen offset:3072 nt
  s_waitcnt lgkmcnt(7)
  s_waitcnt lgkmcnt(6)
  v_mfma_f32_16x16x32_bf16 v[112:115], a[96:99], a[72:75], v[112:115]
  ds_read_b64_tr_b16 a[116:117], v85 offset:0
  s_add_u32 m0, s97, 81920
  s_nop 0
  buffer_load_dwordx4 v88, s[36:39], s61 offen offset:0  lds
  v_mfma_f32_16x16x32_bf16 v[116:119], a[96:99], a[76:79], v[116:119]
  ds_read_b64_tr_b16 a[118:119], v85 offset:1024
  ds_read_b128 a[84:87], v95 offset:0
  v_mfma_f32_16x16x32_bf16 v[120:123], a[96:99], a[80:83], v[120:123]
  ds_read_b128 a[88:91], v95 offset:2048
  s_mov_b32 s57, 49152
  v_mfma_f32_16x16x32_bf16 v[124:127], a[100:103], a[72:75], v[124:127]
  ds_read_b64_tr_b16 a[120:121], v86 offset:0
  s_add_u32 s14, s58, 49152
  v_mfma_f32_16x16x32_bf16 v[128:131], a[100:103], a[76:79], v[128:131]
  ds_read_b64_tr_b16 a[122:123], v86 offset:1024
  buffer_load_dwordx4 v89, s[36:39], s61 offen offset:1024  lds
  v_mfma_f32_16x16x32_bf16 v[132:135], a[100:103], a[80:83], v[132:135]
  s_add_u32 s15, s58, 32768
  s_waitcnt lgkmcnt(8)
  v_mfma_f32_16x16x32_bf16 v[136:139], a[104:107], a[72:75], v[136:139]
  ds_read_b64_tr_b16 a[124:125], v87 offset:0
  ds_read_b128 a[92:95], v95 offset:4096
  v_mfma_f32_16x16x32_bf16 v[140:143], a[104:107], a[76:79], v[140:143]
  ds_read_b64_tr_b16 a[126:127], v87 offset:1024
  s_lshl_b32 s66, s54, 13
  v_mfma_f32_16x16x32_bf16 v[144:147], a[104:107], a[80:83], v[144:147]
  buffer_load_dwordx4 v90, s[36:39], s61 offen offset:2048  lds
  v_mfma_f32_16x16x32_bf16 v[148:151], a[108:111], a[72:75], v[148:151]
  s_add_u32 s59, s55, s66
  v_mfma_f32_16x16x32_bf16 v[152:155], a[108:111], a[76:79], v[152:155]
  s_getpc_b64 s[72:73]
L_pcA0:
  s_add_u32 s72, s72, L_slow0-L_pcA0
  s_addc_u32 s73, s73, 0
  v_mfma_f32_16x16x32_bf16 v[156:159], a[108:111], a[80:83], v[156:159]
  s_waitcnt lgkmcnt(7)
  v_mfma_f32_16x16x32_bf16 v[160:163], a[112:115], a[72:75], v[160:163]
  s_waitcnt vmcnt(34) lgkmcnt(0)
  s_barrier
  v_mfma_f32_16x16x32_bf16 v[164:167], a[112:115], a[76:79], v[164:167]
  ds_read_b64_tr_b16 a[96:97], v80 offset:16384
  buffer_load_dwordx4 v91, s[36:39], s61 offen offset:3072  lds
  v_mfma_f32_16x16x32_bf16 v[168:171], a[112:115], a[80:83], v[168:171]
  ds_read_b64_tr_b16 a[98:99], v80 offset:17408
  s_add_u32 s61, s61, 261888
  v_mfma_f32_16x16x32_bf16 v[172:175], a[116:119], a[72:75], v[172:175]
  ds_read_b64_tr_b16 a[100:101], v81 offset:16384
  v_mfma_f32_16x16x32_bf16 v[176:179], a[116:119], a[76:79], v[176:179]
  ds_read_b64_tr_b16 a[102:103], v81 offset:17408
  v_mfma_f32_16x16x32_bf16 v[180:183], a[116:119], a[80:83], v[180:183]
  ds_read_b64_tr_b16 a[104:105], v82 offset:16384
  v_mfma_f32_16x16x32_bf16 v[184:187], a[120:123], a[72:75], v[184:187]
  ds_read_b64_tr_b16 a[106:107], v82 offset:17408
  v_mfma_f32_16x16x32_bf16 v[188:191], a[120:123], a[76:79], v[188:191]
  ds_read_b64_tr_b16 a[108:109], v83 offset:16384
  v_mfma_f32_16x16x32_bf16 v[192:195], a[120:123], a[80:83], v[192:195]
  ds_read_b64_tr_b16 a[110:111], v83 offset:17408
  v_mfma_f32_16x16x32_bf16 v[196:199], a[124:127], a[72:75], v[196:199]
  ds_read_b64_tr_b16 a[112:113], v84 offset:16384
  v_mfma_f32_16x16x32_bf16 v[200:203], a[124:127], a[76:79], v[200:203]
  ds_read_b64_tr_b16 a[114:115], v84 offset:17408
  v_mfma_f32_16x16x32_bf16 v[204:207], a[124:127], a[80:83], v[204:207]
  s_cmp_eq_u32 s61, 3670016
  s_cselect_b32 s61, 0, s61
  s_waitcnt lgkmcnt(6)
  v_mfma_f32_16x16x32_bf16 v[208:211], a[96:99], a[72:75], v[208:211]
  ds_read_b64_tr_b16 a[116:117], v85 offset:16384
  s_add_u32 m0, s97, 0
  s_nop 0
  buffer_load_dwordx4 v88, s[36:39], s61 offen offset:0  lds
  v_mfma_f32_16x16x32_bf16 v[212:215], a[96:99], a[76:79], v[212:215]
  ds_read_b64_tr_b16 a[118:119], v85 offset:17408
  v_mfma_f32_16x16x32_bf16 v[216:219], a[96:99], a[80:83], v[216:219]
  s_getpc_b64 s[74:75]
L_pcA1:
  s_add_u32 s74, s74, L_slow1-L_pcA1
  s_addc_u32 s75, s75, 0
  v_mfma_f32_16x16x32_bf16 v[220:223], a[100:103], a[72:75], v[220:223]
  ds_read_b64_tr_b16 a[120:121], v86 offset:16384
  v_mfma_f32_16x16x32_bf16 v[224:227], a[100:103], a[76:79], v[224:227]
  ds_read_b64_tr_b16 a[122:123], v86 offset:17408
  buffer_load_dwordx4 v89, s[36:39], s61 offen offset:1024  lds
  v_mfma_f32_16x16x32_bf16 v[228:231], a[100:103], a[80:83], v[228:231]
  s_waitcnt lgkmcnt(6)
  v_mfma_f32_16x16x32_bf16 v[232:235], a[104:107], a[72:75], v[232:235]
  ds_read_b64_tr_b16 a[124:125], v87 offset:16384
  v_mfma_f32_16x16x32_bf16 v[236:239], a[104:107], a[76:79], v[236:239]
  ds_read_b64_tr_b16 a[126:127], v87 offset:17408
  v_mfma_f32_16x16x32_bf16 v[240:243], a[104:107], a[80:83], v[240:243]
  buffer_load_dwordx4 v90, s[36:39], s61 offen offset:2048  lds
  v_mfma_f32_16x16x32_bf16 v[244:247], a[108:111], a[72:75], v[244:247]
  v_mfma_f32_16x16x32_bf16 v[248:251], a[108:111], a[76:79], v[248:251]
  v_mfma_f32_16x16x32_bf16 v[252:255], a[108:111], a[80:83], v[252:255]
  s_waitcnt lgkmcnt(4)
  v_mfma_f32_16x16x32_bf16 v[32:35], a[112:115], a[72:75], v[32:35]
  s_waitcnt vmcnt(19) lgkmcnt(0)
  s_barrier
  v_mfma_f32_16x16x32_bf16 v[36:39], a[112:115], a[76:79], v[36:39]
  ds_read_b64_tr_b16 a[96:97], v98 offset:0
  buffer_load_dwordx4 v91, s[36:39], s61 offen offset:3072  lds
  v_mfma_f32_16x16x32_bf16 v[40:43], a[112:115], a[80:83], v[40:43]
  ds_read_b64_tr_b16 a[98:99], v98 offset:1024
  s_add_u32 s61, s61, 256
  v_mfma_f32_16x16x32_bf16 v[44:47], a[116:119], a[72:75], v[44:47]
  ds_read_b64_tr_b16 a[100:101], v99 offset:0
  v_mfma_f32_16x16x32_bf16 v[48:51], a[116:119], a[76:79], v[48:51]
  ds_read_b64_tr_b16 a[102:103], v99 offset:1024
  v_mfma_f32_16x16x32_bf16 v[52:55], a[116:119], a[80:83], v[52:55]
  ds_read_b64_tr_b16 a[104:105], v100 offset:0
  s_add_u32 m0, s77, 147456
  s_nop 0
  buffer_load_dwordx4 v20, s[44:47], s78 offen offset:0  lds
  v_mfma_f32_16x16x32_bf16 v[56:59], a[120:123], a[72:75], v[56:59]
  ds_read_b64_tr_b16 a[106:107], v100 offset:1024
  v_mfma_f32_16x16x32_bf16 v[60:63], a[120:123], a[76:79], v[60:63]
  ds_read_b64_tr_b16 a[108:109], v101 offset:0
  v_mfma_f32_16x16x32_bf16 v[64:67], a[120:123], a[80:83], v[64:67]
  ds_read_b64_tr_b16 a[110:111], v101 offset:1024
  v_mfma_f32_16x16x32_bf16 v[68:71], a[124:127], a[72:75], v[68:71]
  ds_read_b64_tr_b16 a[112:113], v102 offset:0
  buffer_load_dwordx4 v21, s[44:47], s78 offen offset:1024  lds
  v_mfma_f32_16x16x32_bf16 v[72:75], a[124:127], a[76:79], v[72:75]
  ds_read_b64_tr_b16 a[114:115], v102 offset:1024
  v_mfma_f32_16x16x32_bf16 v[76:79], a[124:127], a[80:83], v[76:79]
  buffer_load_dwordx4 v22, s[44:47], s78 offen offset:2048  lds
  s_add_u32 s78, s78, 128
  s_cmp_eq_u32 s78, 896
  s_cselect_b32 s78, 0, s78
  s_waitcnt lgkmcnt(6)
  v_mfma_f32_16x16x32_bf16 v[112:115], a[96:99], a[84:87], v[112:115]
  ds_read_b64_tr_b16 a[116:117], v103 offset:0
  v_mfma_f32_16x16x32_bf16 v[116:119], a[96:99], a[88:91], v[116:119]
  ds_read_b64_tr_b16 a[118:119], v103 offset:1024
  s_add_u32 m0, s97, 16384
  s_nop 0
  buffer_load_dwordx4 v88, s[36:39], s61 offen offset:0  lds
  v_mfma_f32_16x16x32_bf16 v[120:123], a[96:99], a[92:95], v[120:123]
  v_mfma_f32_16x16x32_bf16 v[124:127], a[100:103], a[84:87], v[124:127]
  ds_read_b64_tr_b16 a[120:121], v104 offset:0
  v_mfma_f32_16x16x32_bf16 v[128:131], a[100:103], a[88:91], v[128:131]
  ds_read_b64_tr_b16 a[122:123], v104 offset:1024
  v_mfma_f32_16x16x32_bf16 v[132:135], a[100:103], a[92:95], v[132:135]
  buffer_load_dwordx4 v89, s[36:39], s61 offen offset:1024  lds
  s_waitcnt lgkmcnt(6)
  v_mfma_f32_16x16x32_bf16 v[136:139], a[104:107], a[84:87], v[136:139]
  ds_read_b64_tr_b16 a[124:125], v105 offset:0
  v_mfma_f32_16x16x32_bf16 v[140:143], a[104:107], a[88:91], v[140:143]
  ds_read_b64_tr_b16 a[126:127], v105 offset:1024
  v_mfma_f32_16x16x32_bf16 v[144:147], a[104:107], a[92:95], v[144:147]
  v_mfma_f32_16x16x32_bf16 v[148:151], a[108:111], a[84:87], v[148:151]
  buffer_load_dwordx4 v90, s[36:39], s61 offen offset:2048  lds
  v_mfma_f32_16x16x32_bf16 v[152:155], a[108:111], a[88:91], v[152:155]
  v_mfma_f32_16x16x32_bf16 v[156:159], a[108:111], a[92:95], v[156:159]
  s_waitcnt lgkmcnt(4)
  v_mfma_f32_16x16x32_bf16 v[160:163], a[112:115], a[84:87], v[160:163]
  s_waitcnt vmcnt(10) lgkmcnt(0)
  s_barrier
  v_mfma_f32_16x16x32_bf16 v[164:167], a[112:115], a[88:91], v[164:167]
  ds_read_b64_tr_b16 a[96:97], v98 offset:16384
  buffer_load_dwordx4 v91, s[36:39], s61 offen offset:3072  lds
  v_mfma_f32_16x16x32_bf16 v[168:171], a[112:115], a[92:95], v[168:171]
  ds_read_b64_tr_b16 a[98:99], v98 offset:17408
  s_add_u32 s61, s61, 261888
  v_mfma_f32_16x16x32_bf16 v[172:175], a[116:119], a[84:87], v[172:175]
  ds_read_b64_tr_b16 a[100:101], v99 offset:16384
  v_mfma_f32_16x16x32_bf16 v[176:179], a[116:119], a[88:91], v[176:179]
  ds_read_b64_tr_b16 a[102:103], v99 offset:17408
  v_mfma_f32_16x16x32_bf16 v[180:183], a[116:119], a[92:95], v[180:183]
  ds_read_b64_tr_b16 a[104:105], v100 offset:16384
  v_mfma_f32_16x16x32_bf16 v[184:187], a[120:123], a[84:87], v[184:187]
  ds_read_b64_tr_b16 a[106:107], v100 offset:17408
  v_mfma_f32_16x16x32_bf16 v[188:191], a[120:123], a[88:91], v[188:191]
  ds_read_b64_tr_b16 a[108:109], v101 offset:16384
  v_mfma_f32_16x16x32_bf16 v[192:195], a[120:123], a[92:95], v[192:195]
  ds_read_b64_tr_b16 a[110:111], v101 offset:17408
  v_mfma_f32_16x16x32_bf16 v[196:199], a[124:127], a[84:87], v[196:199]
  ds_read_b64_tr_b16 a[112:113], v102 offset:16384
  v_mfma_f32_16x16x32_bf16 v[200:203], a[124:127], a[88:91], v[200:203]
  ds_read_b64_tr_b16 a[114:115], v102 offset:17408
  v_mfma_f32_16x16x32_bf16 v[204:207], a[124:127], a[92:95], v[204:207]
  s_cmp_eq_u32 s61, 3670016
  s_cselect_b32 s61, 0, s61
  s_waitcnt lgkmcnt(6)
  v_mfma_f32_16x16x32_bf16 v[208:211], a[96:99], a[84:87], v[208:211]
  ds_read_b64_tr_b16 a[116:117], v103 offset:16384
  s_add_u32 m0, s97, 65536
  s_nop 0
  buffer_load_dwordx4 v88, s[36:39], s61 offen offset:0  lds
  v_mfma_f32_16x16x32_bf16 v[212:215], a[96:99], a[88:91], v[212:215]
  ds_read_b64_tr_b16 a[118:119], v103 offset:17408
  v_mfma_f32_16x16x32_bf16 v[216:219], a[96:99], a[92:95], v[216:219]
  v_mfma_f32_16x16x32_bf16 v[220:223], a[100:103], a[84:87], v[220:223]
  ds_read_b64_tr_b16 a[120:121], v104 offset:16384
  v_mfma_f32_16x16x32_bf16 v[224:227], a[100:103], a[88:91], v[224:227]
  ds_read_b64_tr_b16 a[122:123], v104 offset:17408
  buffer_load_dwordx4 v89, s[36:39], s61 offen offset:1024  lds
  v_mfma_f32_16x16x32_bf16 v[228:231], a[100:103], a[92:95], v[228:231]
  s_waitcnt lgkmcnt(6)
  v_mfma_f32_16x16x32_bf16 v[232:235], a[104:107], a[84:87], v[232:235]
  ds_read_b64_tr_b16 a[124:125], v105 offset:16384
  v_mfma_f32_16x16x32_bf16 v[236:239], a[104:107], a[88:91], v[236:239]
  ds_read_b64_tr_b16 a[126:127], v105 offset:17408
  v_mfma_f32_16x16x32_bf16 v[240:243], a[104:107], a[92:95], v[240:243]
  buffer_load_dwordx4 v90, s[36:39], s61 offen offset:2048  lds
  v_mfma_f32_16x16x32_bf16 v[244:247], a[108:111], a[84:87], v[244:247]
  v_mfma_f32_16x16x32_bf16 v[248:251], a[108:111], a[88:91], v[248:251]
  v_mfma_f32_16x16x32_bf16 v[252:255], a[108:111], a[92:95], v[252:255]
  s_waitcnt lgkmcnt(4)
  v_mfma_f32_16x16x32_bf16 v[32:35], a[112:115], a[84:87], v[32:35]
  s_waitcnt vmcnt(10) lgkmcnt(0)
  s_barrier
  v_mfma_f32_16x16x32_bf16 v[36:39], a[112:115], a[88:91], v[36:39]
  ds_read_b64_tr_b16 a[96:97], v80 offset:0
  ds_read_b128 a[48:51], v92 offset:0
  v_mfma_f32_16x16x32_bf16 v[40:43], a[112:115], a[92:95], v[40:43]
  ds_read_b64_tr_b16 a[98:99], v80 offset:1024
  ds_read_b128 a[52:55], v92 offset:2048
  v_mfma_f32_16x16x32_bf16 v[44:47], a[116:119], a[84:87], v[44:47]
  ds_read_b64_tr_b16 a[100:101], v81 offset:0
  ds_read_b128 a[56:59], v92 offset:4096
  v_mfma_f32_16x16x32_bf16 v[48:51], a[116:119], a[88:91], v[48:51]
  ds_read_b64_tr_b16 a[102:103], v81 offset:1024
  buffer_load_dwordx4 v91, s[36:39], s61 offen offset:3072  lds
  v_mfma_f32_16x16x32_bf16 v[52:55], a[116:119], a[92:95], v[52:55]
  ds_read_b64_tr_b16 a[104:105], v82 offset:0
  s_add_u32 s61, s61, 256
  v_mfma_f32_16x16x32_bf16 v[56:59], a[120:123], a[84:87], v[56:59]
  ds_read_b64_tr_b16 a[106:107], v82 offset:1024
  v_mfma_f32_16x16x32_bf16 v[60:63], a[120:123], a[88:91], v[60:63]
  ds_read_b64_tr_b16 a[108:109], v83 offset:0
  v_mfma_f32_16x16x32_bf16 v[64:67], a[120:123], a[92:95], v[64:67]
  ds_read_b64_tr_b16 a[110:111], v83 offset:1024
  v_mfma_f32_16x16x32_bf16 v[68:71], a[124:127], a[84:87], v[68:71]
  ds_read_b64_tr_b16 a[112:113], v84 offset:0
  v_mfma_f32_16x16x32_bf16 v[72:75], a[124:127], a[88:91], v[72:75]
  ds_read_b64_tr_b16 a[114:115], v84 offset:1024
  v_mfma_f32_16x16x32_bf16 v[76:79], a[124:127], a[92:95], v[76:79]
  s_waitcnt lgkmcnt(7)
L_h8A:
  s_waitcnt lgkmcnt(6)
  v_mfma_f32_16x16x32_bf16 v[112:115], a[96:99], a[48:51], v[112:115]
  ds_read_b64_tr_b16 a[116:117], v85 offset:0
  s_add_u32 m0, s97, 81920
  s_nop 0
  buffer_load_dwordx4 v88, s[36:39], s61 offen offset:0  lds
  v_mfma_f32_16x16x32_bf16 v[116:119], a[96:99], a[52:55], v[116:119]
  ds_read_b64_tr_b16 a[118:119], v85 offset:1024
  ds_read_b128 a[60:63], v93 offset:0
  v_mfma_f32_16x16x32_bf16 v[120:123], a[96:99], a[56:59], v[120:123]
  ds_read_b128 a[64:67], v93 offset:2048
  v_mfma_f32_16x16x32_bf16 v[124:127], a[100:103], a[48:51], v[124:127]
  ds_read_b64_tr_b16 a[120:121], v86 offset:0
  v_mfma_f32_16x16x32_bf16 v[128:131], a[100:103], a[52:55], v[128:131]
  ds_read_b64_tr_b16 a[122:123], v86 offset:1024
  buffer_load_dwordx4 v89, s[36:39], s61 offen offset:1024  lds
  v_mfma_f32_16x16x32_bf16 v[132:135], a[100:103], a[56:59], v[132:135]
  s_waitcnt lgkmcnt(8)
  v_mfma_f32_16x16x32_bf16 v[136:139], a[104:107], a[48:51], v[136:139]
  ds_read_b64_tr_b16 a[124:125], v87 offset:0
  ds_read_b128 a[68:71], v93 offset:4096
  v_mfma_f32_16x16x32_bf16 v[140:143], a[104:107], a[52:55], v[140:143]
  ds_read_b64_tr_b16 a[126:127], v87 offset:1024
  v_mfma_f32_16x16x32_bf16 v[144:147], a[104:107], a[56:59], v[144:147]
  buffer_load_dwordx4 v90, s[36:39], s61 offen offset:2048  lds
  v_mfma_f32_16x16x32_bf16 v[148:151], a[108:111], a[48:51], v[148:151]
  v_mfma_f32_16x16x32_bf16 v[152:155], a[108:111], a[52:55], v[152:155]
  v_mfma_f32_16x16x32_bf16 v[156:159], a[108:111], a[56:59], v[156:159]
  s_waitcnt lgkmcnt(7)
  v_mfma_f32_16x16x32_bf16 v[160:163], a[112:115], a[48:51], v[160:163]
  s_waitcnt vmcnt(7) lgkmcnt(0)
  s_barrier
  v_mfma_f32_16x16x32_bf16 v[164:167], a[112:115], a[52:55], v[164:167]
  ds_read_b64_tr_b16 a[96:97], v80 offset:16384
  buffer_load_dwordx4 v91, s[36:39], s61 offen offset:3072  lds
  v_mfma_f32_16x16x32_bf16 v[168:171], a[112:115], a[56:59], v[168:171]
  ds_read_b64_tr_b16 a[98:99], v80 offset:17408
  s_add_u32 s61, s61, 261888
  v_mfma_f32_16x16x32_bf16 v[172:175], a[116:119], a[48:51], v[172:175]
  ds_read_b64_tr_b16 a[100:101], v81 offset:16384
  v_mfma_f32_16x16x32_bf16 v[176:179], a[116:119], a[52:55], v[176:179]
  ds_read_b64_tr_b16 a[102:103], v81 offset:17408
  v_mfma_f32_16x16x32_bf16 v[180:183], a[116:119], a[56:59], v[180:183]
  ds_read_b64_tr_b16 a[104:105], v82 offset:16384
  v_mfma_f32_16x16x32_bf16 v[184:187], a[120:123], a[48:51], v[184:187]
  ds_read_b64_tr_b16 a[106:107], v82 offset:17408
  v_mfma_f32_16x16x32_bf16 v[188:191], a[120:123], a[52:55], v[188:191]
  ds_read_b64_tr_b16 a[108:109], v83 offset:16384
  v_mfma_f32_16x16x32_bf16 v[192:195], a[120:123], a[56:59], v[192:195]
  ds_read_b64_tr_b16 a[110:111], v83 offset:17408
  v_mfma_f32_16x16x32_bf16 v[196:199], a[124:127], a[48:51], v[196:199]
  ds_read_b64_tr_b16 a[112:113], v84 offset:16384
  v_mfma_f32_16x16x32_bf16 v[200:203], a[124:127], a[52:55], v[200:203]
  ds_read_b64_tr_b16 a[114:115], v84 offset:17408
  v_mfma_f32_16x16x32_bf16 v[204:207], a[124:127], a[56:59], v[204:207]
  s_cmp_eq_u32 s61, 3670016
  s_cselect_b32 s61, 0, s61
  s_waitcnt lgkmcnt(6)
  v_mfma_f32_16x16x32_bf16 v[208:211], a[96:99], a[48:51], v[208:211]
  ds_read_b64_tr_b16 a[116:117], v85 offset:16384
  s_add_u32 m0, s97, 0
  s_nop 0
  buffer_load_dwordx4 v88, s[36:39], s61 offen offset:0  lds
  v_mfma_f32_16x16x32_bf16 v[212:215], a[96:99], a[52:55], v[212:215]
  ds_read_b64_tr_b16 a[118:119], v85 offset:17408
  v_mfma_f32_16x16x32_bf16 v[216:219], a[96:99], a[56:59], v[216:219]
  v_mfma_f32_16x16x32_bf16 v[220:223], a[100:103], a[48:51], v[220:223]
  ds_read_b64_tr_b16 a[120:121], v86 offset:16384
  v_mfma_f32_16x16x32_bf16 v[224:227], a[100:103], a[52:55], v[224:227]
  ds_read_b64_tr_b16 a[122:123], v86 offset:17408
  buffer_load_dwordx4 v89, s[36:39], s61 offen offset:1024  lds
  v_mfma_f32_16x16x32_bf16 v[228:231], a[100:103], a[56:59], v[228:231]
  s_waitcnt lgkmcnt(6)
  v_mfma_f32_16x16x32_bf16 v[232:235], a[104:107], a[48:51], v[232:235]
  ds_read_b64_tr_b16 a[124:125], v87 offset:16384
  v_mfma_f32_16x16x32_bf16 v[236:239], a[104:107], a[52:55], v[236:239]
  ds_read_b64_tr_b16 a[126:127], v87 offset:17408
  v_mfma_f32_16x16x32_bf16 v[240:243], a[104:107], a[56:59], v[240:243]
  buffer_load_dwordx4 v90, s[36:39], s61 offen offset:2048  lds
  v_mfma_f32_16x16x32_bf16 v[244:247], a[108:111], a[48:51], v[244:247]
  v_mfma_f32_16x16x32_bf16 v[248:251], a[108:111], a[52:55], v[248:251]
  v_mfma_f32_16x16x32_bf16 v[252:255], a[108:111], a[56:59], v[252:255]
  s_waitcnt lgkmcnt(4)
  v_mfma_f32_16x16x32_bf16 v[32:35], a[112:115], a[48:51], v[32:35]
  s_waitcnt vmcnt(7) lgkmcnt(0)
  s_barrier
  v_mfma_f32_16x16x32_bf16 v[36:39], a[112:115], a[52:55], v[36:39]
  ds_read_b64_tr_b16 a[96:97], v98 offset:0
  buffer_load_dwordx4 v91, s[36:39], s61 offen offset:3072  lds
  v_mfma_f32_16x16x32_bf16 v[40:43], a[112:115], a[56:59], v[40:43]
  ds_read_b64_tr_b16 a[98:99], v98 offset:1024
  s_add_u32 s61, s61, 256
  v_mfma_f32_16x16x32_bf16 v[44:47], a[116:119], a[48:51], v[44:47]
  ds_read_b64_tr_b16 a[100:101], v99 offset:0
  v_mfma_f32_16x16x32_bf16 v[48:51], a[116:119], a[52:55], v[48:51]
  ds_read_b64_tr_b16 a[102:103], v99 offset:1024
  v_mfma_f32_16x16x32_bf16 v[52:55], a[116:119], a[56:59], v[52:55]
  ds_read_b64_tr_b16 a[104:105], v100 offset:0
  s_add_u32 m0, s77, 131072
  s_nop 0
  buffer_load_dwordx4 v20, s[44:47], s78 offen offset:0  lds
  v_mfma_f32_16x16x32_bf16 v[56:59], a[120:123], a[48:51], v[56:59]
  ds_read_b64_tr_b16 a[106:107], v100 offset:1024
  v_mfma_f32_16x16x32_bf16 v[60:63], a[120:123], a[52:55], v[60:63]
  ds_read_b64_tr_b16 a[108:109], v101 offset:0
  v_mfma_f32_16x16x32_bf16 v[64:67], a[120:123], a[56:59], v[64:67]
  ds_read_b64_tr_b16 a[110:111], v101 offset:1024
  v_mfma_f32_16x16x32_bf16 v[68:71], a[124:127], a[48:51], v[68:71]
  ds_read_b64_tr_b16 a[112:113], v102 offset:0
  buffer_load_dwordx4 v21, s[44:47], s78 offen offset:1024  lds
  v_mfma_f32_16x16x32_bf16 v[72:75], a[124:127], a[52:55], v[72:75]
  ds_read_b64_tr_b16 a[114:115], v102 offset:1024
  v_mfma_f32_16x16x32_bf16 v[76:79], a[124:127], a[56:59], v[76:79]
  buffer_load_dwordx4 v22, s[44:47], s78 offen offset:2048  lds
  s_add_u32 s78, s78, 128
  s_cmp_eq_u32 s78, 896
  s_cselect_b32 s78, 0, s78
  s_waitcnt lgkmcnt(6)
  v_mfma_f32_16x16x32_bf16 v[112:115], a[96:99], a[60:63], v[112:115]
  ds_read_b64_tr_b16 a[116:117], v103 offset:0
  v_mfma_f32_16x16x32_bf16 v[116:119], a[96:99], a[64:67], v[116:119]
  ds_read_b64_tr_b16 a[118:119], v103 offset:1024
  s_add_u32 m0, s97, 16384
  s_nop 0
  buffer_load_dwordx4 v88, s[36:39], s61 offen offset:0  lds
  v_mfma_f32_16x16x32_bf16 v[120:123], a[96:99], a[68:71], v[120:123]
  v_mfma_f32_16x16x32_bf16 v[124:127], a[100:103], a[60:63], v[124:127]
  ds_read_b64_tr_b16 a[120:121], v104 offset:0
  v_mfma_f32_16x16x32_bf16 v[128:131], a[100:103], a[64:67], v[128:131]
  ds_read_b64_tr_b16 a[122:123], v104 offset:1024
  v_mfma_f32_16x16x32_bf16 v[132:135], a[100:103], a[68:71], v[132:135]
  buffer_load_dwordx4 v89, s[36:39], s61 offen offset:1024  lds
  s_waitcnt lgkmcnt(6)
  v_mfma_f32_16x16x32_bf16 v[136:139], a[104:107], a[60:63], v[136:139]
  ds_read_b64_tr_b16 a[124:125], v105 offset:0
  v_mfma_f32_16x16x32_bf16 v[140:143], a[104:107], a[64:67], v[140:143]
  ds_read_b64_tr_b16 a[126:127], v105 offset:1024
  v_mfma_f32_16x16x32_bf16 v[144:147], a[104:107], a[68:71], v[144:147]
  v_mfma_f32_16x16x32_bf16 v[148:151], a[108:111], a[60:63], v[148:151]
  buffer_load_dwordx4 v90, s[36:39], s61 offen offset:2048  lds
  v_mfma_f32_16x16x32_bf16 v[152:155], a[108:111], a[64:67], v[152:155]
  v_mfma_f32_16x16x32_bf16 v[156:159], a[108:111], a[68:71], v[156:159]
  s_waitcnt lgkmcnt(4)
  v_mfma_f32_16x16x32_bf16 v[160:163], a[112:115], a[60:63], v[160:163]
  s_waitcnt vmcnt(10) lgkmcnt(0)
  s_barrier
  v_mfma_f32_16x16x32_bf16 v[164:167], a[112:115], a[64:67], v[164:167]
  ds_read_b64_tr_b16 a[96:97], v98 offset:16384
  buffer_load_dwordx4 v91, s[36:39], s61 offen offset:3072  lds
  v_mfma_f32_16x16x32_bf16 v[168:171], a[112:115], a[68:71], v[168:171]
  ds_read_b64_tr_b16 a[98:99], v98 offset:17408
  s_add_u32 s61, s61, 261888
  v_mfma_f32_16x16x32_bf16 v[172:175], a[116:119], a[60:63], v[172:175]
  ds_read_b64_tr_b16 a[100:101], v99 offset:16384
  v_mfma_f32_16x16x32_bf16 v[176:179], a[116:119], a[64:67], v[176:179]
  ds_read_b64_tr_b16 a[102:103], v99 offset:17408
  v_mfma_f32_16x16x32_bf16 v[180:183], a[116:119], a[68:71], v[180:183]
  ds_read_b64_tr_b16 a[104:105], v100 offset:16384
  v_mfma_f32_16x16x32_bf16 v[184:187], a[120:123], a[60:63], v[184:187]
  ds_read_b64_tr_b16 a[106:107], v100 offset:17408
  v_mfma_f32_16x16x32_bf16 v[188:191], a[120:123], a[64:67], v[188:191]
  ds_read_b64_tr_b16 a[108:109], v101 offset:16384
  v_mfma_f32_16x16x32_bf16 v[192:195], a[120:123], a[68:71], v[192:195]
  ds_read_b64_tr_b16 a[110:111], v101 offset:17408
  v_mfma_f32_16x16x32_bf16 v[196:199], a[124:127], a[60:63], v[196:199]
  ds_read_b64_tr_b16 a[112:113], v102 offset:16384
  v_mfma_f32_16x16x32_bf16 v[200:203], a[124:127], a[64:67], v[200:203]
  ds_read_b64_tr_b16 a[114:115], v102 offset:17408
  v_mfma_f32_16x16x32_bf16 v[204:207], a[124:127], a[68:71], v[204:207]
  s_cmp_eq_u32 s61, 3670016
  s_cselect_b32 s61, 0, s61
  s_waitcnt lgkmcnt(6)
  v_mfma_f32_16x16x32_bf16 v[208:211], a[96:99], a[60:63], v[208:211]
  ds_read_b64_tr_b16 a[116:117], v103 offset:16384
  s_add_u32 m0, s97, 65536
  s_nop 0
  buffer_load_dwordx4 v88, s[36:39], s61 offen offset:0  lds
  v_mfma_f32_16x16x32_bf16 v[212:215], a[96:99], a[64:67], v[212:215]
  ds_read_b64_tr_b16 a[118:119], v103 offset:17408
  v_mfma_f32_16x16x32_bf16 v[216:219], a[96:99], a[68:71], v[216:219]
  v_mfma_f32_16x16x32_bf16 v[220:223], a[100:103], a[60:63], v[220:223]
  ds_read_b64_tr_b16 a[120:121], v104 offset:16384
  v_mfma_f32_16x16x32_bf16 v[224:227], a[100:103], a[64:67], v[224:227]
  ds_read_b64_tr_b16 a[122:123], v104 offset:17408
  buffer_load_dwordx4 v89, s[36:39], s61 offen offset:1024  lds
  v_mfma_f32_16x16x32_bf16 v[228:231], a[100:103], a[68:71], v[228:231]
  s_waitcnt lgkmcnt(6)
  v_mfma_f32_16x16x32_bf16 v[232:235], a[104:107], a[60:63], v[232:235]
  ds_read_b64_tr_b16 a[124:125], v105 offset:16384
  v_mfma_f32_16x16x32_bf16 v[236:239], a[104:107], a[64:67], v[236:239]
  ds_read_b64_tr_b16 a[126:127], v105 offset:17408
  v_mfma_f32_16x16x32_bf16 v[240:243], a[104:107], a[68:71], v[240:243]
  buffer_load_dwordx4 v90, s[36:39], s61 offen offset:2048  lds
  v_mfma_f32_16x16x32_bf16 v[244:247], a[108:111], a[60:63], v[244:247]
  v_mfma_f32_16x16x32_bf16 v[248:251], a[108:111], a[64:67], v[248:251]
  v_mfma_f32_16x16x32_bf16 v[252:255], a[108:111], a[68:71], v[252:255]
  s_waitcnt lgkmcnt(4)
  v_mfma_f32_16x16x32_bf16 v[32:35], a[112:115], a[60:63], v[32:35]
  s_waitcnt vmcnt(10) lgkmcnt(0)
  s_barrier
  v_mfma_f32_16x16x32_bf16 v[36:39], a[112:115], a[64:67], v[36:39]
  ds_read_b64_tr_b16 a[96:97], v80 offset:0
  ds_read_b128 a[72:75], v94 offset:0
  v_mfma_f32_16x16x32_bf16 v[40:43], a[112:115], a[68:71], v[40:43]
  ds_read_b64_tr_b16 a[98:99], v80 offset:1024
  ds_read_b128 a[76:79], v94 offset:2048
  v_mfma_f32_16x16x32_bf16 v[44:47], a[116:119], a[60:63], v[44:47]
  ds_read_b64_tr_b16 a[100:101], v81 offset:0
  ds_read_b128 a[80:83], v94 offset:4096
  v_mfma_f32_16x16x32_bf16 v[48:51], a[116:119], a[64:67], v[48:51]
  ds_read_b64_tr_b16 a[102:103], v81 offset:1024
  buffer_load_dwordx4 v91, s[36:39], s61 offen offset:3072  lds
  v_mfma_f32_16x16x32_bf16 v[52:55], a[116:119], a[68:71], v[52:55]
  ds_read_b64_tr_b16 a[104:105], v82 offset:0
  s_add_u32 s61, s61, 256
  v_mfma_f32_16x16x32_bf16 v[56:59], a[120:123], a[60:63], v[56:59]
  ds_read_b64_tr_b16 a[106:107], v82 offset:1024
  v_mfma_f32_16x16x32_bf16 v[60:63], a[120:123], a[64:67], v[60:63]
  ds_read_b64_tr_b16 a[108:109], v83 offset:0
  v_mfma_f32_16x16x32_bf16 v[64:67], a[120:123], a[68:71], v[64:67]
  ds_read_b64_tr_b16 a[110:111], v83 offset:1024
  v_mfma_f32_16x16x32_bf16 v[68:71], a[124:127], a[60:63], v[68:71]
  ds_read_b64_tr_b16 a[112:113], v84 offset:0
  v_mfma_f32_16x16x32_bf16 v[72:75], a[124:127], a[64:67], v[72:75]
  ds_read_b64_tr_b16 a[114:115], v84 offset:1024
  v_mfma_f32_16x16x32_bf16 v[76:79], a[124:127], a[68:71], v[76:79]
  s_waitcnt lgkmcnt(7)
  s_waitcnt lgkmcnt(6)
  v_mfma_f32_16x16x32_bf16 v[112:115], a[96:99], a[72:75], v[112:115]
  ds_read_b64_tr_b16 a[116:117], v85 offset:0
  s_add_u32 m0, s97, 81920
  s_nop 0
  buffer_load_dwordx4 v88, s[36:39], s61 offen offset:0  lds
  v_mfma_f32_16x16x32_bf16 v[116:119], a[96:99], a[76:79], v[116:119]
  ds_read_b64_tr_b16 a[118:119], v85 offset:1024
  ds_read_b128 a[84:87], v95 offset:0
  v_mfma_f32_16x16x32_bf16 v[120:123], a[96:99], a[80:83], v[120:123]
  ds_read_b128 a[88:91], v95 offset:2048
  v_mfma_f32_16x16x32_bf16 v[124:127], a[100:103], a[72:75], v[124:127]
  ds_read_b64_tr_b16 a[120:121], v86 offset:0
  v_mfma_f32_16x16x32_bf16 v[128:131], a[100:103], a[76:79], v[128:131]
  ds_read_b64_tr_b16 a[122:123], v86 offset:1024
  buffer_load_dwordx4 v89, s[36:39], s61 offen offset:1024  lds
  v_mfma_f32_16x16x32_bf16 v[132:135], a[100:103], a[80:83], v[132:135]
  s_waitcnt lgkmcnt(8)
  v_mfma_f32_16x16x32_bf16 v[136:139], a[104:107], a[72:75], v[136:139]
  ds_read_b64_tr_b16 a[124:125], v87 offset:0
  ds_read_b128 a[92:95], v95 offset:4096
  v_mfma_f32_16x16x32_bf16 v[140:143], a[104:107], a[76:79], v[140:143]
  ds_read_b64_tr_b16 a[126:127], v87 offset:1024
  v_mfma_f32_16x16x32_bf16 v[144:147], a[104:107], a[80:83], v[144:147]
  buffer_load_dwordx4 v90, s[36:39], s61 offen offset:2048  lds
  v_mfma_f32_16x16x32_bf16 v[148:151], a[108:111], a[72:75], v[148:151]
  v_mfma_f32_16x16x32_bf16 v[152:155], a[108:111], a[76:79], v[152:155]
  v_mfma_f32_16x16x32_bf16 v[156:159], a[108:111], a[80:83], v[156:159]
  s_waitcnt lgkmcnt(7)
  v_mfma_f32_16x16x32_bf16 v[160:163], a[112:115], a[72:75], v[160:163]
  s_waitcnt vmcnt(7) lgkmcnt(0)
  s_barrier
  v_mfma_f32_16x16x32_bf16 v[164:167], a[112:115], a[76:79], v[164:167]
  ds_read_b64_tr_b16 a[96:97], v80 offset:16384
  buffer_load_dwordx4 v91, s[36:39], s61 offen offset:3072  lds
  v_mfma_f32_16x16x32_bf16 v[168:171], a[112:115], a[80:83], v[168:171]
  ds_read_b64_tr_b16 a[98:99], v80 offset:17408
  s_add_u32 s61, s61, 261888
  v_mfma_f32_16x16x32_bf16 v[172:175], a[116:119], a[72:75], v[172:175]
  ds_read_b64_tr_b16 a[100:101], v81 offset:16384
  v_mfma_f32_16x16x32_bf16 v[176:179], a[116:119], a[76:79], v[176:179]
  ds_read_b64_tr_b16 a[102:103], v81 offset:17408
  v_mfma_f32_16x16x32_bf16 v[180:183], a[116:119], a[80:83], v[180:183]
  ds_read_b64_tr_b16 a[104:105], v82 offset:16384
  v_mfma_f32_16x16x32_bf16 v[184:187], a[120:123], a[72:75], v[184:187]
  ds_read_b64_tr_b16 a[106:107], v82 offset:17408
  v_mfma_f32_16x16x32_bf16 v[188:191], a[120:123], a[76:79], v[188:191]
  ds_read_b64_tr_b16 a[108:109], v83 offset:16384
  v_mfma_f32_16x16x32_bf16 v[192:195], a[120:123], a[80:83], v[192:195]
  ds_read_b64_tr_b16 a[110:111], v83 offset:17408
  v_mfma_f32_16x16x32_bf16 v[196:199], a[124:127], a[72:75], v[196:199]
  ds_read_b64_tr_b16 a[112:113], v84 offset:16384
  v_mfma_f32_16x16x32_bf16 v[200:203], a[124:127], a[76:79], v[200:203]
  ds_read_b64_tr_b16 a[114:115], v84 offset:17408
  v_mfma_f32_16x16x32_bf16 v[204:207], a[124:127], a[80:83], v[204:207]
  s_cmp_eq_u32 s61, 3670016
  s_cselect_b32 s61, 0, s61
  s_waitcnt lgkmcnt(6)
  v_mfma_f32_16x16x32_bf16 v[208:211], a[96:99], a[72:75], v[208:211]
  ds_read_b64_tr_b16 a[116:117], v85 offset:16384
  s_add_u32 m0, s97, 0
  s_nop 0
  buffer_load_dwordx4 v88, s[36:39], s61 offen offset:0  lds
  v_mfma_f32_16x16x32_bf16 v[212:215], a[96:99], a[76:79], v[212:215]
  ds_read_b64_tr_b16 a[118:119], v85 offset:17408
  v_mfma_f32_16x16x32_bf16 v[216:219], a[96:99], a[80:83], v[216:219]
  v_mfma_f32_16x16x32_bf16 v[220:223], a[100:103], a[72:75], v[220:223]
  ds_read_b64_tr_b16 a[120:121], v86 offset:16384
  v_mfma_f32_16x16x32_bf16 v[224:227], a[100:103], a[76:79], v[224:227]
  ds_read_b64_tr_b16 a[122:123], v86 offset:17408
  buffer_load_dwordx4 v89, s[36:39], s61 offen offset:1024  lds
  v_mfma_f32_16x16x32_bf16 v[228:231], a[100:103], a[80:83], v[228:231]
  s_waitcnt lgkmcnt(6)
  v_mfma_f32_16x16x32_bf16 v[232:235], a[104:107], a[72:75], v[232:235]
  ds_read_b64_tr_b16 a[124:125], v87 offset:16384
  v_mfma_f32_16x16x32_bf16 v[236:239], a[104:107], a[76:79], v[236:239]
  ds_read_b64_tr_b16 a[126:127], v87 offset:17408
  v_mfma_f32_16x16x32_bf16 v[240:243], a[104:107], a[80:83], v[240:243]
  buffer_load_dwordx4 v90, s[36:39], s61 offen offset:2048  lds
  v_mfma_f32_16x16x32_bf16 v[244:247], a[108:111], a[72:75], v[244:247]
  v_mfma_f32_16x16x32_bf16 v[248:251], a[108:111], a[76:79], v[248:251]
  v_mfma_f32_16x16x32_bf16 v[252:255], a[108:111], a[80:83], v[252:255]
  s_waitcnt lgkmcnt(4)
  v_mfma_f32_16x16x32_bf16 v[32:35], a[112:115], a[72:75], v[32:35]
  s_waitcnt vmcnt(7) lgkmcnt(0)
  s_barrier
  v_mfma_f32_16x16x32_bf16 v[36:39], a[112:115], a[76:79], v[36:39]
  ds_read_b64_tr_b16 a[96:97], v98 offset:0
  buffer_load_dwordx4 v91, s[36:39], s61 offen offset:3072  lds
  v_mfma_f32_16x16x32_bf16 v[40:43], a[112:115], a[80:83], v[40:43]
  ds_read_b64_tr_b16 a[98:99], v98 offset:1024
  s_add_u32 s61, s61, 256
  v_mfma_f32_16x16x32_bf16 v[44:47], a[116:119], a[72:75], v[44:47]
  ds_read_b64_tr_b16 a[100:101], v99 offset:0
  v_mfma_f32_16x16x32_bf16 v[48:51], a[116:119], a[76:79], v[48:51]
  ds_read_b64_tr_b16 a[102:103], v99 offset:1024
  v_mfma_f32_16x16x32_bf16 v[52:55], a[116:119], a[80:83], v[52:55]
  ds_read_b64_tr_b16 a[104:105], v100 offset:0
  s_add_u32 m0, s77, 147456
  s_nop 0
  buffer_load_dwordx4 v20, s[44:47], s78 offen offset:0  lds
  v_mfma_f32_16x16x32_bf16 v[56:59], a[120:123], a[72:75], v[56:59]
  ds_read_b64_tr_b16 a[106:107], v100 offset:1024
  v_mfma_f32_16x16x32_bf16 v[60:63], a[120:123], a[76:79], v[60:63]
  ds_read_b64_tr_b16 a[108:109], v101 offset:0
  v_mfma_f32_16x16x32_bf16 v[64:67], a[120:123], a[80:83], v[64:67]
  ds_read_b64_tr_b16 a[110:111], v101 offset:1024
  v_mfma_f32_16x16x32_bf16 v[68:71], a[124:127], a[72:75], v[68:71]
  ds_read_b64_tr_b16 a[112:113], v102 offset:0
  buffer_load_dwordx4 v21, s[44:47], s78 offen offset:1024  lds
  v_mfma_f32_16x16x32_bf16 v[72:75], a[124:127], a[76:79], v[72:75]
  ds_read_b64_tr_b16 a[114:115], v102 offset:1024
  v_mfma_f32_16x16x32_bf16 v[76:79], a[124:127], a[80:83], v[76:79]
  buffer_load_dwordx4 v22, s[44:47], s78 offen offset:2048  lds
  s_add_u32 s78, s78, 128
  s_cmp_eq_u32 s78, 896
  s_cselect_b32 s78, 0, s78
  s_waitcnt lgkmcnt(6)
  v_mfma_f32_16x16x32_bf16 v[112:115], a[96:99], a[84:87], v[112:115]
  ds_read_b64_tr_b16 a[116:117], v103 offset:0
  v_mfma_f32_16x16x32_bf16 v[116:119], a[96:99], a[88:91], v[116:119]
  ds_read_b64_tr_b16 a[118:119], v103 offset:1024
  s_add_u32 m0, s97, 16384
  s_nop 0
  buffer_load_dwordx4 v88, s[36:39], s61 offen offset:0  lds
  v_mfma_f32_16x16x32_bf16 v[120:123], a[96:99], a[92:95], v[120:123]
  v_mfma_f32_16x16x32_bf16 v[124:127], a[100:103], a[84:87], v[124:127]
  ds_read_b64_tr_b16 a[120:121], v104 offset:0
  v_mfma_f32_16x16x32_bf16 v[128:131], a[100:103], a[88:91], v[128:131]
  ds_read_b64_tr_b16 a[122:123], v104 offset:1024
  v_mfma_f32_16x16x32_bf16 v[132:135], a[100:103], a[92:95], v[132:135]
  buffer_load_dwordx4 v89, s[36:39], s61 offen offset:1024  lds
  s_waitcnt lgkmcnt(6)
  v_mfma_f32_16x16x32_bf16 v[136:139], a[104:107], a[84:87], v[136:139]
  ds_read_b64_tr_b16 a[124:125], v105 offset:0
  v_mfma_f32_16x16x32_bf16 v[140:143], a[104:107], a[88:91], v[140:143]
  ds_read_b64_tr_b16 a[126:127], v105 offset:1024
  v_mfma_f32_16x16x32_bf16 v[144:147], a[104:107], a[92:95], v[144:147]
  v_mfma_f32_16x16x32_bf16 v[148:151], a[108:111], a[84:87], v[148:151]
  buffer_load_dwordx4 v90, s[36:39], s61 offen offset:2048  lds
  v_mfma_f32_16x16x32_bf16 v[152:155], a[108:111], a[88:91], v[152:155]
  v_mfma_f32_16x16x32_bf16 v[156:159], a[108:111], a[92:95], v[156:159]
  s_waitcnt lgkmcnt(4)
  v_mfma_f32_16x16x32_bf16 v[160:163], a[112:115], a[84:87], v[160:163]
  s_waitcnt vmcnt(10) lgkmcnt(0)
  s_barrier
  v_mfma_f32_16x16x32_bf16 v[164:167], a[112:115], a[88:91], v[164:167]
  ds_read_b64_tr_b16 a[96:97], v98 offset:16384
  buffer_load_dwordx4 v91, s[36:39], s61 offen offset:3072  lds
  v_mfma_f32_16x16x32_bf16 v[168:171], a[112:115], a[92:95], v[168:171]
  ds_read_b64_tr_b16 a[98:99], v98 offset:17408
  s_add_u32 s61, s61, 261888
  v_mfma_f32_16x16x32_bf16 v[172:175], a[116:119], a[84:87], v[172:175]
  ds_read_b64_tr_b16 a[100:101], v99 offset:16384
  v_mfma_f32_16x16x32_bf16 v[176:179], a[116:119], a[88:91], v[176:179]
  ds_read_b64_tr_b16 a[102:103], v99 offset:17408
  v_mfma_f32_16x16x32_bf16 v[180:183], a[116:119], a[92:95], v[180:183]
  ds_read_b64_tr_b16 a[104:105], v100 offset:16384
  v_mfma_f32_16x16x32_bf16 v[184:187], a[120:123], a[84:87], v[184:187]
  ds_read_b64_tr_b16 a[106:107], v100 offset:17408
  v_mfma_f32_16x16x32_bf16 v[188:191], a[120:123], a[88:91], v[188:191]
  ds_read_b64_tr_b16 a[108:109], v101 offset:16384
  v_mfma_f32_16x16x32_bf16 v[192:195], a[120:123], a[92:95], v[192:195]
  ds_read_b64_tr_b16 a[110:111], v101 offset:17408
  v_mfma_f32_16x16x32_bf16 v[196:199], a[124:127], a[84:87], v[196:199]
  ds_read_b64_tr_b16 a[112:113], v102 offset:16384
  v_mfma_f32_16x16x32_bf16 v[200:203], a[124:127], a[88:91], v[200:203]
  ds_read_b64_tr_b16 a[114:115], v102 offset:17408
  v_mfma_f32_16x16x32_bf16 v[204:207], a[124:127], a[92:95], v[204:207]
  s_cmp_eq_u32 s61, 3670016
  s_cselect_b32 s61, 0, s61
  s_waitcnt lgkmcnt(6)
  v_mfma_f32_16x16x32_bf16 v[208:211], a[96:99], a[84:87], v[208:211]
  ds_read_b64_tr_b16 a[116:117], v103 offset:16384
  s_add_u32 m0, s97, 65536
  s_nop 0
  buffer_load_dwordx4 v88, s[36:39], s61 offen offset:0  lds
  v_mfma_f32_16x16x32_bf16 v[212:215], a[96:99], a[88:91], v[212:215]
  ds_read_b64_tr_b16 a[118:119], v103 offset:17408
  v_mfma_f32_16x16x32_bf16 v[216:219], a[96:99], a[92:95], v[216:219]
  v_mfma_f32_16x16x32_bf16 v[220:223], a[100:103], a[84:87], v[220:223]
  ds_read_b64_tr_b16 a[120:121], v104 offset:16384
  v_mfma_f32_16x16x32_bf16 v[224:227], a[100:103], a[88:91], v[224:227]
  ds_read_b64_tr_b16 a[122:123], v104 offset:17408
  buffer_load_dwordx4 v89, s[36:39], s61 offen offset:1024  lds
  v_mfma_f32_16x16x32_bf16 v[228:231], a[100:103], a[92:95], v[228:231]
  s_waitcnt lgkmcnt(6)
  v_mfma_f32_16x16x32_bf16 v[232:235], a[104:107], a[84:87], v[232:235]
  ds_read_b64_tr_b16 a[124:125], v105 offset:16384
  v_mfma_f32_16x16x32_bf16 v[236:239], a[104:107], a[88:91], v[236:239]
  ds_read_b64_tr_b16 a[126:127], v105 offset:17408
  v_mfma_f32_16x16x32_bf16 v[240:243], a[104:107], a[92:95], v[240:243]
  buffer_load_dwordx4 v90, s[36:39], s61 offen offset:2048  lds
  v_mfma_f32_16x16x32_bf16 v[244:247], a[108:111], a[84:87], v[244:247]
  v_mfma_f32_16x16x32_bf16 v[248:251], a[108:111], a[88:91], v[248:251]
  v_mfma_f32_16x16x32_bf16 v[252:255], a[108:111], a[92:95], v[252:255]
  s_waitcnt lgkmcnt(4)
  v_mfma_f32_16x16x32_bf16 v[32:35], a[112:115], a[84:87], v[32:35]
  s_waitcnt vmcnt(10) lgkmcnt(0)
  s_barrier
  v_mfma_f32_16x16x32_bf16 v[36:39], a[112:115], a[88:91], v[36:39]
  ds_read_b64_tr_b16 a[96:97], v80 offset:0
  ds_read_b128 a[48:51], v92 offset:0
  v_mfma_f32_16x16x32_bf16 v[40:43], a[112:115], a[92:95], v[40:43]
  ds_read_b64_tr_b16 a[98:99], v80 offset:1024
  ds_read_b128 a[52:55], v92 offset:2048
  v_mfma_f32_16x16x32_bf16 v[44:47], a[116:119], a[84:87], v[44:47]
  ds_read_b64_tr_b16 a[100:101], v81 offset:0
  ds_read_b128 a[56:59], v92 offset:4096
  v_mfma_f32_16x16x32_bf16 v[48:51], a[116:119], a[88:91], v[48:51]
  ds_read_b64_tr_b16 a[102:103], v81 offset:1024
  buffer_load_dwordx4 v91, s[36:39], s61 offen offset:3072  lds
  v_mfma_f32_16x16x32_bf16 v[52:55], a[116:119], a[92:95], v[52:55]
  ds_read_b64_tr_b16 a[104:105], v82 offset:0
  s_add_u32 s61, s61, 256
  v_mfma_f32_16x16x32_bf16 v[56:59], a[120:123], a[84:87], v[56:59]
  ds_read_b64_tr_b16 a[106:107], v82 offset:1024
  v_mfma_f32_16x16x32_bf16 v[60:63], a[120:123], a[88:91], v[60:63]
  ds_read_b64_tr_b16 a[108:109], v83 offset:0
  v_mfma_f32_16x16x32_bf16 v[64:67], a[120:123], a[92:95], v[64:67]
  ds_read_b64_tr_b16 a[110:111], v83 offset:1024
  v_mfma_f32_16x16x32_bf16 v[68:71], a[124:127], a[84:87], v[68:71]
  ds_read_b64_tr_b16 a[112:113], v84 offset:0
  v_mfma_f32_16x16x32_bf16 v[72:75], a[124:127], a[88:91], v[72:75]
  ds_read_b64_tr_b16 a[114:115], v84 offset:1024
  v_mfma_f32_16x16x32_bf16 v[76:79], a[124:127], a[92:95], v[76:79]
  s_waitcnt lgkmcnt(7)
  s_getpc_b64 s[70:71]
L_cw3A:
  s_add_u32 s70, s70, L_postA-L_cw3A
  s_addc_u32 s71, s71, 0
  s_lshl_b32 s60, s27, 2
  s_add_u32 s60, s60, s52
  s_lshl_b32 s60, s60, 8
  v_lshl_add_u32 v28, v106, 7, s60
  v_mov_b32 v29, s71
  v_add_co_u32 v28, vcc, s70, v28
  s_nop 1
  v_addc_co_u32 v29, vcc, 0, v29, vcc
  s_mov_b64 exec, 3
  global_load_dword v31, v[28:29], off
  s_mov_b64 exec, -1
  s_waitcnt lgkmcnt(6)
  v_mfma_f32_16x16x32_bf16 v[112:115], a[96:99], a[48:51], v[112:115]
  ds_read_b64_tr_b16 a[116:117], v85 offset:0
  s_add_u32 m0, s97, 81920
  s_nop 0
  buffer_load_dwordx4 v88, s[36:39], s61 offen offset:0  lds
  v_mfma_f32_16x16x32_bf16 v[116:119], a[96:99], a[52:55], v[116:119]
  ds_read_b64_tr_b16 a[118:119], v85 offset:1024
  ds_read_b128 a[60:63], v93 offset:0
  v_mfma_f32_16x16x32_bf16 v[120:123], a[96:99], a[56:59], v[120:123]
  ds_read_b128 a[64:67], v93 offset:2048
  v_mfma_f32_16x16x32_bf16 v[124:127], a[100:103], a[48:51], v[124:127]
  ds_read_b64_tr_b16 a[120:121], v86 offset:0
  v_mfma_f32_16x16x32_bf16 v[128:131], a[100:103], a[52:55], v[128:131]
  ds_read_b64_tr_b16 a[122:123], v86 offset:1024
  buffer_load_dwordx4 v89, s[36:39], s61 offen offset:1024  lds
  v_mfma_f32_16x16x32_bf16 v[132:135], a[100:103], a[56:59], v[132:135]
  s_waitcnt lgkmcnt(8)
  v_mfma_f32_16x16x32_bf16 v[136:139], a[104:107], a[48:51], v[136:139]
  ds_read_b64_tr_b16 a[124:125], v87 offset:0
  ds_read_b128 a[68:71], v93 offset:4096
  v_mfma_f32_16x16x32_bf16 v[140:143], a[104:107], a[52:55], v[140:143]
  ds_read_b64_tr_b16 a[126:127], v87 offset:1024
  v_mfma_f32_16x16x32_bf16 v[144:147], a[104:107], a[56:59], v[144:147]
  buffer_load_dwordx4 v90, s[36:39], s61 offen offset:2048  lds
  v_mfma_f32_16x16x32_bf16 v[148:151], a[108:111], a[48:51], v[148:151]
  v_mfma_f32_16x16x32_bf16 v[152:155], a[108:111], a[52:55], v[152:155]
  v_mfma_f32_16x16x32_bf16 v[156:159], a[108:111], a[56:59], v[156:159]
  s_waitcnt lgkmcnt(7)
  v_mfma_f32_16x16x32_bf16 v[160:163], a[112:115], a[48:51], v[160:163]
  s_waitcnt vmcnt(8) lgkmcnt(0)
  s_barrier
  v_mfma_f32_16x16x32_bf16 v[164:167], a[112:115], a[52:55], v[164:167]
  ds_read_b64_tr_b16 a[96:97], v80 offset:16384
  buffer_load_dwordx4 v91, s[36:39], s61 offen offset:3072  lds
  v_mfma_f32_16x16x32_bf16 v[168:171], a[112:115], a[56:59], v[168:171]
  ds_read_b64_tr_b16 a[98:99], v80 offset:17408
  s_add_u32 s61, s61, 261888
  v_mfma_f32_16x16x32_bf16 v[172:175], a[116:119], a[48:51], v[172:175]
  ds_read_b64_tr_b16 a[100:101], v81 offset:16384
  v_mfma_f32_16x16x32_bf16 v[176:179], a[116:119], a[52:55], v[176:179]
  ds_read_b64_tr_b16 a[102:103], v81 offset:17408
  v_mfma_f32_16x16x32_bf16 v[180:183], a[116:119], a[56:59], v[180:183]
  ds_read_b64_tr_b16 a[104:105], v82 offset:16384
  v_mfma_f32_16x16x32_bf16 v[184:187], a[120:123], a[48:51], v[184:187]
  ds_read_b64_tr_b16 a[106:107], v82 offset:17408
  v_mfma_f32_16x16x32_bf16 v[188:191], a[120:123], a[52:55], v[188:191]
  ds_read_b64_tr_b16 a[108:109], v83 offset:16384
  v_mfma_f32_16x16x32_bf16 v[192:195], a[120:123], a[56:59], v[192:195]
  ds_read_b64_tr_b16 a[110:111], v83 offset:17408
  v_mfma_f32_16x16x32_bf16 v[196:199], a[124:127], a[48:51], v[196:199]
  ds_read_b64_tr_b16 a[112:113], v84 offset:16384
  v_mfma_f32_16x16x32_bf16 v[200:203], a[124:127], a[52:55], v[200:203]
  ds_read_b64_tr_b16 a[114:115], v84 offset:17408
  v_mfma_f32_16x16x32_bf16 v[204:207], a[124:127], a[56:59], v[204:207]
  s_cmp_eq_u32 s61, 3670016
  s_cselect_b32 s61, 0, s61
  s_waitcnt lgkmcnt(6)
  v_mfma_f32_16x16x32_bf16 v[208:211], a[96:99], a[48:51], v[208:211]
  ds_read_b64_tr_b16 a[116:117], v85 offset:16384
  s_add_u32 m0, s97, 0
  s_nop 0
  buffer_load_dwordx4 v88, s[36:39], s61 offen offset:0  lds
  v_mfma_f32_16x16x32_bf16 v[212:215], a[96:99], a[52:55], v[212:215]
  ds_read_b64_tr_b16 a[118:119], v85 offset:17408
  v_mfma_f32_16x16x32_bf16 v[216:219], a[96:99], a[56:59], v[216:219]
  v_mfma_f32_16x16x32_bf16 v[220:223], a[100:103], a[48:51], v[220:223]
  ds_read_b64_tr_b16 a[120:121], v86 offset:16384
  v_mfma_f32_16x16x32_bf16 v[224:227], a[100:103], a[52:55], v[224:227]
  ds_read_b64_tr_b16 a[122:123], v86 offset:17408
  buffer_load_dwordx4 v89, s[36:39], s61 offen offset:1024  lds
  v_mfma_f32_16x16x32_bf16 v[228:231], a[100:103], a[56:59], v[228:231]
  s_waitcnt lgkmcnt(6)
  v_mfma_f32_16x16x32_bf16 v[232:235], a[104:107], a[48:51], v[232:235]
  ds_read_b64_tr_b16 a[124:125], v87 offset:16384
  v_mfma_f32_16x16x32_bf16 v[236:239], a[104:107], a[52:55], v[236:239]
  ds_read_b64_tr_b16 a[126:127], v87 offset:17408
  v_mfma_f32_16x16x32_bf16 v[240:243], a[104:107], a[56:59], v[240:243]
  buffer_load_dwordx4 v90, s[36:39], s61 offen offset:2048  lds
  v_mfma_f32_16x16x32_bf16 v[244:247], a[108:111], a[48:51], v[244:247]
  v_mfma_f32_16x16x32_bf16 v[248:251], a[108:111], a[52:55], v[248:251]
  v_mfma_f32_16x16x32_bf16 v[252:255], a[108:111], a[56:59], v[252:255]
  s_waitcnt lgkmcnt(4)
  v_mfma_f32_16x16x32_bf16 v[32:35], a[112:115], a[48:51], v[32:35]
  s_waitcnt vmcnt(8) lgkmcnt(0)
  s_barrier
  v_mfma_f32_16x16x32_bf16 v[36:39], a[112:115], a[52:55], v[36:39]
  ds_read_b64_tr_b16 a[96:97], v98 offset:0
  buffer_load_dwordx4 v91, s[36:39], s61 offen offset:3072  lds
  v_mfma_f32_16x16x32_bf16 v[40:43], a[112:115], a[56:59], v[40:43]
  ds_read_b64_tr_b16 a[98:99], v98 offset:1024
  s_add_u32 s61, s61, 256
  v_mfma_f32_16x16x32_bf16 v[44:47], a[116:119], a[48:51], v[44:47]
  ds_read_b64_tr_b16 a[100:101], v99 offset:0
  v_mfma_f32_16x16x32_bf16 v[48:51], a[116:119], a[52:55], v[48:51]
  ds_read_b64_tr_b16 a[102:103], v99 offset:1024
  v_mfma_f32_16x16x32_bf16 v[52:55], a[116:119], a[56:59], v[52:55]
  ds_read_b64_tr_b16 a[104:105], v100 offset:0
  s_add_u32 m0, s77, 131072
  s_nop 0
  buffer_load_dwordx4 v20, s[44:47], s78 offen offset:0  lds
  v_mfma_f32_16x16x32_bf16 v[56:59], a[120:123], a[48:51], v[56:59]
  ds_read_b64_tr_b16 a[106:107], v100 offset:1024
  v_mfma_f32_16x16x32_bf16 v[60:63], a[120:123], a[52:55], v[60:63]
  ds_read_b64_tr_b16 a[108:109], v101 offset:0
  v_mfma_f32_16x16x32_bf16 v[64:67], a[120:123], a[56:59], v[64:67]
  ds_read_b64_tr_b16 a[110:111], v101 offset:1024
  v_mfma_f32_16x16x32_bf16 v[68:71], a[124:127], a[48:51], v[68:71]
  ds_read_b64_tr_b16 a[112:113], v102 offset:0
  buffer_load_dwordx4 v21, s[44:47], s78 offen offset:1024  lds
  v_mfma_f32_16x16x32_bf16 v[72:75], a[124:127], a[52:55], v[72:75]
  ds_read_b64_tr_b16 a[114:115], v102 offset:1024
  v_mfma_f32_16x16x32_bf16 v[76:79], a[124:127], a[56:59], v[76:79]
  buffer_load_dwordx4 v22, s[44:47], s78 offen offset:2048  lds
  s_add_u32 s78, s78, 128
  s_cmp_eq_u32 s78, 896
  s_cselect_b32 s78, 0, s78
  s_waitcnt lgkmcnt(6)
  v_mfma_f32_16x16x32_bf16 v[112:115], a[96:99], a[60:63], v[112:115]
  ds_read_b64_tr_b16 a[116:117], v103 offset:0
  v_mfma_f32_16x16x32_bf16 v[116:119], a[96:99], a[64:67], v[116:119]
  ds_read_b64_tr_b16 a[118:119], v103 offset:1024
  s_add_u32 m0, s97, 16384
  s_nop 0
  buffer_load_dwordx4 v88, s[36:39], s61 offen offset:0  lds
  v_mfma_f32_16x16x32_bf16 v[120:123], a[96:99], a[68:71], v[120:123]
  v_mfma_f32_16x16x32_bf16 v[124:127], a[100:103], a[60:63], v[124:127]
  ds_read_b64_tr_b16 a[120:121], v104 offset:0
  v_mfma_f32_16x16x32_bf16 v[128:131], a[100:103], a[64:67], v[128:131]
  ds_read_b64_tr_b16 a[122:123], v104 offset:1024
  v_mfma_f32_16x16x32_bf16 v[132:135], a[100:103], a[68:71], v[132:135]
  buffer_load_dwordx4 v89, s[36:39], s61 offen offset:1024  lds
  s_waitcnt lgkmcnt(6)
  v_mfma_f32_16x16x32_bf16 v[136:139], a[104:107], a[60:63], v[136:139]
  ds_read_b64_tr_b16 a[124:125], v105 offset:0
  v_mfma_f32_16x16x32_bf16 v[140:143], a[104:107], a[64:67], v[140:143]
  ds_read_b64_tr_b16 a[126:127], v105 offset:1024
  v_mfma_f32_16x16x32_bf16 v[144:147], a[104:107], a[68:71], v[144:147]
  v_mfma_f32_16x16x32_bf16 v[148:151], a[108:111], a[60:63], v[148:151]
  buffer_load_dwordx4 v90, s[36:39], s61 offen offset:2048  lds
  v_mfma_f32_16x16x32_bf16 v[152:155], a[108:111], a[64:67], v[152:155]
  v_mfma_f32_16x16x32_bf16 v[156:159], a[108:111], a[68:71], v[156:159]
  s_waitcnt lgkmcnt(4)
  v_mfma_f32_16x16x32_bf16 v[160:163], a[112:115], a[60:63], v[160:163]
  s_waitcnt vmcnt(10) lgkmcnt(0)
  s_barrier
  v_mfma_f32_16x16x32_bf16 v[164:167], a[112:115], a[64:67], v[164:167]
  ds_read_b64_tr_b16 a[96:97], v98 offset:16384
  buffer_load_dwordx4 v91, s[36:39], s61 offen offset:3072  lds
  v_mfma_f32_16x16x32_bf16 v[168:171], a[112:115], a[68:71], v[168:171]
  ds_read_b64_tr_b16 a[98:99], v98 offset:17408
  s_add_u32 s61, s61, 261888
  v_mfma_f32_16x16x32_bf16 v[172:175], a[116:119], a[60:63], v[172:175]
  ds_read_b64_tr_b16 a[100:101], v99 offset:16384
  v_mfma_f32_16x16x32_bf16 v[176:179], a[116:119], a[64:67], v[176:179]
  ds_read_b64_tr_b16 a[102:103], v99 offset:17408
  v_mfma_f32_16x16x32_bf16 v[180:183], a[116:119], a[68:71], v[180:183]
  ds_read_b64_tr_b16 a[104:105], v100 offset:16384
  v_mfma_f32_16x16x32_bf16 v[184:187], a[120:123], a[60:63], v[184:187]
  ds_read_b64_tr_b16 a[106:107], v100 offset:17408
  v_mfma_f32_16x16x32_bf16 v[188:191], a[120:123], a[64:67], v[188:191]
  ds_read_b64_tr_b16 a[108:109], v101 offset:16384
  v_mfma_f32_16x16x32_bf16 v[192:195], a[120:123], a[68:71], v[192:195]
  ds_read_b64_tr_b16 a[110:111], v101 offset:17408
  v_mfma_f32_16x16x32_bf16 v[196:199], a[124:127], a[60:63], v[196:199]
  ds_read_b64_tr_b16 a[112:113], v102 offset:16384
  v_mfma_f32_16x16x32_bf16 v[200:203], a[124:127], a[64:67], v[200:203]
  ds_read_b64_tr_b16 a[114:115], v102 offset:17408
  v_mfma_f32_16x16x32_bf16 v[204:207], a[124:127], a[68:71], v[204:207]
  s_cmp_eq_u32 s61, 3670016
  s_cselect_b32 s61, 0, s61
  s_waitcnt lgkmcnt(6)
  v_mfma_f32_16x16x32_bf16 v[208:211], a[96:99], a[60:63], v[208:211]
  ds_read_b64_tr_b16 a[116:117], v103 offset:16384
  s_add_u32 m0, s97, 65536
  s_nop 0
  buffer_load_dwordx4 v88, s[36:39], s61 offen offset:0  lds
  v_mfma_f32_16x16x32_bf16 v[212:215], a[96:99], a[64:67], v[212:215]
  ds_read_b64_tr_b16 a[118:119], v103 offset:17408
  v_mfma_f32_16x16x32_bf16 v[216:219], a[96:99], a[68:71], v[216:219]
  v_mfma_f32_16x16x32_bf16 v[220:223], a[100:103], a[60:63], v[220:223]
  ds_read_b64_tr_b16 a[120:121], v104 offset:16384
  v_mfma_f32_16x16x32_bf16 v[224:227], a[100:103], a[64:67], v[224:227]
  ds_read_b64_tr_b16 a[122:123], v104 offset:17408
  buffer_load_dwordx4 v89, s[36:39], s61 offen offset:1024  lds
  v_mfma_f32_16x16x32_bf16 v[228:231], a[100:103], a[68:71], v[228:231]
  s_waitcnt lgkmcnt(6)
  v_mfma_f32_16x16x32_bf16 v[232:235], a[104:107], a[60:63], v[232:235]
  ds_read_b64_tr_b16 a[124:125], v105 offset:16384
  v_mfma_f32_16x16x32_bf16 v[236:239], a[104:107], a[64:67], v[236:239]
  ds_read_b64_tr_b16 a[126:127], v105 offset:17408
  v_mfma_f32_16x16x32_bf16 v[240:243], a[104:107], a[68:71], v[240:243]
  buffer_load_dwordx4 v90, s[36:39], s61 offen offset:2048  lds
  v_mfma_f32_16x16x32_bf16 v[244:247], a[108:111], a[60:63], v[244:247]
  v_mfma_f32_16x16x32_bf16 v[248:251], a[108:111], a[64:67], v[248:251]
  v_mfma_f32_16x16x32_bf16 v[252:255], a[108:111], a[68:71], v[252:255]
  s_waitcnt lgkmcnt(4)
  v_mfma_f32_16x16x32_bf16 v[32:35], a[112:115], a[60:63], v[32:35]
  s_waitcnt vmcnt(10) lgkmcnt(0)
  s_barrier
  v_mfma_f32_16x16x32_bf16 v[36:39], a[112:115], a[64:67], v[36:39]
  ds_read_b64_tr_b16 a[96:97], v80 offset:0
  ds_read_b128 a[72:75], v94 offset:0
  v_mfma_f32_16x16x32_bf16 v[40:43], a[112:115], a[68:71], v[40:43]
  ds_read_b64_tr_b16 a[98:99], v80 offset:1024
  ds_read_b128 a[76:79], v94 offset:2048
  v_mfma_f32_16x16x32_bf16 v[44:47], a[116:119], a[60:63], v[44:47]
  ds_read_b64_tr_b16 a[100:101], v81 offset:0
  ds_read_b128 a[80:83], v94 offset:4096
  v_mfma_f32_16x16x32_bf16 v[48:51], a[116:119], a[64:67], v[48:51]
  ds_read_b64_tr_b16 a[102:103], v81 offset:1024
  buffer_load_dwordx4 v91, s[36:39], s61 offen offset:3072  lds
  v_mfma_f32_16x16x32_bf16 v[52:55], a[116:119], a[68:71], v[52:55]
  ds_read_b64_tr_b16 a[104:105], v82 offset:0
  s_add_u32 s61, s61, 256
  v_mfma_f32_16x16x32_bf16 v[56:59], a[120:123], a[60:63], v[56:59]
  ds_read_b64_tr_b16 a[106:107], v82 offset:1024
  v_mfma_f32_16x16x32_bf16 v[60:63], a[120:123], a[64:67], v[60:63]
  ds_read_b64_tr_b16 a[108:109], v83 offset:0
  v_mfma_f32_16x16x32_bf16 v[64:67], a[120:123], a[68:71], v[64:67]
  ds_read_b64_tr_b16 a[110:111], v83 offset:1024
  v_mfma_f32_16x16x32_bf16 v[68:71], a[124:127], a[60:63], v[68:71]
  ds_read_b64_tr_b16 a[112:113], v84 offset:0
  v_mfma_f32_16x16x32_bf16 v[72:75], a[124:127], a[64:67], v[72:75]
  ds_read_b64_tr_b16 a[114:115], v84 offset:1024
  v_mfma_f32_16x16x32_bf16 v[76:79], a[124:127], a[68:71], v[76:79]
  s_waitcnt lgkmcnt(7)
  s_waitcnt lgkmcnt(6)
  v_mfma_f32_16x16x32_bf16 v[112:115], a[96:99], a[72:75], v[112:115]
  ds_read_b64_tr_b16 a[116:117], v85 offset:0
  s_add_u32 m0, s97, 81920
  s_nop 0
  buffer_load_dwordx4 v88, s[36:39], s61 offen offset:0  lds
  v_mfma_f32_16x16x32_bf16 v[116:119], a[96:99], a[76:79], v[116:119]
  ds_read_b64_tr_b16 a[118:119], v85 offset:1024
  ds_read_b128 a[84:87], v95 offset:0
  v_mfma_f32_16x16x32_bf16 v[120:123], a[96:99], a[80:83], v[120:123]
  ds_read_b128 a[88:91], v95 offset:2048
  v_mfma_f32_16x16x32_bf16 v[124:127], a[100:103], a[72:75], v[124:127]
  ds_read_b64_tr_b16 a[120:121], v86 offset:0
  v_mfma_f32_16x16x32_bf16 v[128:131], a[100:103], a[76:79], v[128:131]
  ds_read_b64_tr_b16 a[122:123], v86 offset:1024
  buffer_load_dwordx4 v89, s[36:39], s61 offen offset:1024  lds
  v_mfma_f32_16x16x32_bf16 v[132:135], a[100:103], a[80:83], v[132:135]
  s_waitcnt lgkmcnt(8)
  v_mfma_f32_16x16x32_bf16 v[136:139], a[104:107], a[72:75], v[136:139]
  ds_read_b64_tr_b16 a[124:125], v87 offset:0
  ds_read_b128 a[92:95], v95 offset:4096
  v_mfma_f32_16x16x32_bf16 v[140:143], a[104:107], a[76:79], v[140:143]
  ds_read_b64_tr_b16 a[126:127], v87 offset:1024
  v_mfma_f32_16x16x32_bf16 v[144:147], a[104:107], a[80:83], v[144:147]
  buffer_load_dwordx4 v90, s[36:39], s61 offen offset:2048  lds
  v_mfma_f32_16x16x32_bf16 v[148:151], a[108:111], a[72:75], v[148:151]
  v_mfma_f32_16x16x32_bf16 v[152:155], a[108:111], a[76:79], v[152:155]
  v_mfma_f32_16x16x32_bf16 v[156:159], a[108:111], a[80:83], v[156:159]
  s_waitcnt lgkmcnt(7)
  v_mfma_f32_16x16x32_bf16 v[160:163], a[112:115], a[72:75], v[160:163]
  s_waitcnt vmcnt(7) lgkmcnt(0)
  s_barrier
  v_mfma_f32_16x16x32_bf16 v[164:167], a[112:115], a[76:79], v[164:167]
  ds_read_b64_tr_b16 a[96:97], v80 offset:16384
  buffer_load_dwordx4 v91, s[36:39], s61 offen offset:3072  lds
  v_mfma_f32_16x16x32_bf16 v[168:171], a[112:115], a[80:83], v[168:171]
  ds_read_b64_tr_b16 a[98:99], v80 offset:17408
  s_add_u32 s61, s61, 261888
  v_mfma_f32_16x16x32_bf16 v[172:175], a[116:119], a[72:75], v[172:175]
  ds_read_b64_tr_b16 a[100:101], v81 offset:16384
  v_mfma_f32_16x16x32_bf16 v[176:179], a[116:119], a[76:79], v[176:179]
  ds_read_b64_tr_b16 a[102:103], v81 offset:17408
  v_mfma_f32_16x16x32_bf16 v[180:183], a[116:119], a[80:83], v[180:183]
  ds_read_b64_tr_b16 a[104:105], v82 offset:16384
  v_mfma_f32_16x16x32_bf16 v[184:187], a[120:123], a[72:75], v[184:187]
  ds_read_b64_tr_b16 a[106:107], v82 offset:17408
  v_mfma_f32_16x16x32_bf16 v[188:191], a[120:123], a[76:79], v[188:191]
  ds_read_b64_tr_b16 a[108:109], v83 offset:16384
  v_mfma_f32_16x16x32_bf16 v[192:195], a[120:123], a[80:83], v[192:195]
  ds_read_b64_tr_b16 a[110:111], v83 offset:17408
  v_mfma_f32_16x16x32_bf16 v[196:199], a[124:127], a[72:75], v[196:199]
  ds_read_b64_tr_b16 a[112:113], v84 offset:16384
  v_mfma_f32_16x16x32_bf16 v[200:203], a[124:127], a[76:79], v[200:203]
  ds_read_b64_tr_b16 a[114:115], v84 offset:17408
  v_mfma_f32_16x16x32_bf16 v[204:207], a[124:127], a[80:83], v[204:207]
  s_cmp_eq_u32 s61, 3670016
  s_cselect_b32 s61, 0, s61
  s_waitcnt lgkmcnt(6)
  v_mfma_f32_16x16x32_bf16 v[208:211], a[96:99], a[72:75], v[208:211]
  ds_read_b64_tr_b16 a[116:117], v85 offset:16384
  s_add_u32 m0, s97, 0
  s_nop 0
  buffer_load_dwordx4 v88, s[36:39], s61 offen offset:0  lds
  v_mfma_f32_16x16x32_bf16 v[212:215], a[96:99], a[76:79], v[212:215]
  ds_read_b64_tr_b16 a[118:119], v85 offset:17408
  v_mfma_f32_16x16x32_bf16 v[216:219], a[96:99], a[80:83], v[216:219]
  v_mfma_f32_16x16x32_bf16 v[220:223], a[100:103], a[72:75], v[220:223]
  ds_read_b64_tr_b16 a[120:121], v86 offset:16384
  v_mfma_f32_16x16x32_bf16 v[224:227], a[100:103], a[76:79], v[224:227]
  ds_read_b64_tr_b16 a[122:123], v86 offset:17408
  buffer_load_dwordx4 v89, s[36:39], s61 offen offset:1024  lds
  v_mfma_f32_16x16x32_bf16 v[228:231], a[100:103], a[80:83], v[228:231]
  s_waitcnt lgkmcnt(6)
  v_mfma_f32_16x16x32_bf16 v[232:235], a[104:107], a[72:75], v[232:235]
  ds_read_b64_tr_b16 a[124:125], v87 offset:16384
  v_mfma_f32_16x16x32_bf16 v[236:239], a[104:107], a[76:79], v[236:239]
  ds_read_b64_tr_b16 a[126:127], v87 offset:17408
  v_mfma_f32_16x16x32_bf16 v[240:243], a[104:107], a[80:83], v[240:243]
  buffer_load_dwordx4 v90, s[36:39], s61 offen offset:2048  lds
  v_mfma_f32_16x16x32_bf16 v[244:247], a[108:111], a[72:75], v[244:247]
  v_mfma_f32_16x16x32_bf16 v[248:251], a[108:111], a[76:79], v[248:251]
  v_mfma_f32_16x16x32_bf16 v[252:255], a[108:111], a[80:83], v[252:255]
  s_waitcnt lgkmcnt(4)
  v_mfma_f32_16x16x32_bf16 v[32:35], a[112:115], a[72:75], v[32:35]
  s_waitcnt vmcnt(7) lgkmcnt(0)
  s_barrier
  v_mfma_f32_16x16x32_bf16 v[36:39], a[112:115], a[76:79], v[36:39]
  ds_read_b64_tr_b16 a[96:97], v98 offset:0
  buffer_load_dwordx4 v91, s[36:39], s61 offen offset:3072  lds
  v_mfma_f32_16x16x32_bf16 v[40:43], a[112:115], a[80:83], v[40:43]
  ds_read_b64_tr_b16 a[98:99], v98 offset:1024
  s_add_u32 s61, s61, 256
  v_mfma_f32_16x16x32_bf16 v[44:47], a[116:119], a[72:75], v[44:47]
  ds_read_b64_tr_b16 a[100:101], v99 offset:0
  v_mfma_f32_16x16x32_bf16 v[48:51], a[116:119], a[76:79], v[48:51]
  ds_read_b64_tr_b16 a[102:103], v99 offset:1024
  v_mfma_f32_16x16x32_bf16 v[52:55], a[116:119], a[80:83], v[52:55]
  ds_read_b64_tr_b16 a[104:105], v100 offset:0
  v_mfma_f32_16x16x32_bf16 v[56:59], a[120:123], a[72:75], v[56:59]
  ds_read_b64_tr_b16 a[106:107], v100 offset:1024
  v_mfma_f32_16x16x32_bf16 v[60:63], a[120:123], a[76:79], v[60:63]
  ds_read_b64_tr_b16 a[108:109], v101 offset:0
  v_mfma_f32_16x16x32_bf16 v[64:67], a[120:123], a[80:83], v[64:67]
  ds_read_b64_tr_b16 a[110:111], v101 offset:1024
  v_mfma_f32_16x16x32_bf16 v[68:71], a[124:127], a[72:75], v[68:71]
  ds_read_b64_tr_b16 a[112:113], v102 offset:0
  v_mfma_f32_16x16x32_bf16 v[72:75], a[124:127], a[76:79], v[72:75]
  ds_read_b64_tr_b16 a[114:115], v102 offset:1024
  v_mfma_f32_16x16x32_bf16 v[76:79], a[124:127], a[80:83], v[76:79]
  s_waitcnt lgkmcnt(6)
  v_mfma_f32_16x16x32_bf16 v[112:115], a[96:99], a[84:87], v[112:115]
  ds_read_b64_tr_b16 a[116:117], v103 offset:0
  s_add_u32 m0, s97, 16384
  s_nop 0
  buffer_load_dwordx4 v88, s[36:39], s61 offen offset:0  lds
  v_mfma_f32_16x16x32_bf16 v[116:119], a[96:99], a[88:91], v[116:119]
  ds_read_b64_tr_b16 a[118:119], v103 offset:1024
  v_mfma_f32_16x16x32_bf16 v[120:123], a[96:99], a[92:95], v[120:123]
  v_mfma_f32_16x16x32_bf16 v[124:127], a[100:103], a[84:87], v[124:127]
  ds_read_b64_tr_b16 a[120:121], v104 offset:0
  v_mfma_f32_16x16x32_bf16 v[128:131], a[100:103], a[88:91], v[128:131]
  ds_read_b64_tr_b16 a[122:123], v104 offset:1024
  buffer_load_dwordx4 v89, s[36:39], s61 offen offset:1024  lds
  v_mfma_f32_16x16x32_bf16 v[132:135], a[100:103], a[92:95], v[132:135]
  s_waitcnt lgkmcnt(6)
  v_mfma_f32_16x16x32_bf16 v[136:139], a[104:107], a[84:87], v[136:139]
  ds_read_b64_tr_b16 a[124:125], v105 offset:0
  v_mfma_f32_16x16x32_bf16 v[140:143], a[104:107], a[88:91], v[140:143]
  ds_read_b64_tr_b16 a[126:127], v105 offset:1024
  v_mfma_f32_16x16x32_bf16 v[144:147], a[104:107], a[92:95], v[144:147]
  buffer_load_dwordx4 v90, s[36:39], s61 offen offset:2048  lds
  v_mfma_f32_16x16x32_bf16 v[148:151], a[108:111], a[84:87], v[148:151]
  v_mfma_f32_16x16x32_bf16 v[152:155], a[108:111], a[88:91], v[152:155]
  v_mfma_f32_16x16x32_bf16 v[156:159], a[108:111], a[92:95], v[156:159]
  s_waitcnt lgkmcnt(4)
  v_mfma_f32_16x16x32_bf16 v[160:163], a[112:115], a[84:87], v[160:163]
  s_waitcnt vmcnt(7) lgkmcnt(0)
  s_barrier
  v_mfma_f32_16x16x32_bf16 v[164:167], a[112:115], a[88:91], v[164:167]
  ds_read_b64_tr_b16 a[96:97], v98 offset:16384
  buffer_load_dwordx4 v91, s[36:39], s61 offen offset:3072  lds
  v_mfma_f32_16x16x32_bf16 v[168:171], a[112:115], a[92:95], v[168:171]
  ds_read_b64_tr_b16 a[98:99], v98 offset:17408
  s_add_u32 s61, s61, 261888
  v_mfma_f32_16x16x32_bf16 v[172:175], a[116:119], a[84:87], v[172:175]
  ds_read_b64_tr_b16 a[100:101], v99 offset:16384
  v_mfma_f32_16x16x32_bf16 v[176:179], a[116:119], a[88:91], v[176:179]
  ds_read_b64_tr_b16 a[102:103], v99 offset:17408
  v_mfma_f32_16x16x32_bf16 v[180:183], a[116:119], a[92:95], v[180:183]
  ds_read_b64_tr_b16 a[104:105], v100 offset:16384
  v_mfma_f32_16x16x32_bf16 v[184:187], a[120:123], a[84:87], v[184:187]
  ds_read_b64_tr_b16 a[106:107], v100 offset:17408
  v_mfma_f32_16x16x32_bf16 v[188:191], a[120:123], a[88:91], v[188:191]
  ds_read_b64_tr_b16 a[108:109], v101 offset:16384
  v_mfma_f32_16x16x32_bf16 v[192:195], a[120:123], a[92:95], v[192:195]
  ds_read_b64_tr_b16 a[110:111], v101 offset:17408
  v_mfma_f32_16x16x32_bf16 v[196:199], a[124:127], a[84:87], v[196:199]
  ds_read_b64_tr_b16 a[112:113], v102 offset:16384
  v_mfma_f32_16x16x32_bf16 v[200:203], a[124:127], a[88:91], v[200:203]
  ds_read_b64_tr_b16 a[114:115], v102 offset:17408
  v_mfma_f32_16x16x32_bf16 v[204:207], a[124:127], a[92:95], v[204:207]
  s_cmp_eq_u32 s61, 3670016
  s_cselect_b32 s61, 0, s61
  s_waitcnt lgkmcnt(6)
  v_mfma_f32_16x16x32_bf16 v[208:211], a[96:99], a[84:87], v[208:211]
  ds_read_b64_tr_b16 a[116:117], v103 offset:16384
  s_add_u32 m0, s97, 65536
  s_nop 0
  buffer_load_dwordx4 v88, s[36:39], s61 offen offset:0  lds
  v_mfma_f32_16x16x32_bf16 v[212:215], a[96:99], a[88:91], v[212:215]
  ds_read_b64_tr_b16 a[118:119], v103 offset:17408
  v_mfma_f32_16x16x32_bf16 v[216:219], a[96:99], a[92:95], v[216:219]
  v_mfma_f32_16x16x32_bf16 v[220:223], a[100:103], a[84:87], v[220:223]
  ds_read_b64_tr_b16 a[120:121], v104 offset:16384
  v_mfma_f32_16x16x32_bf16 v[224:227], a[100:103], a[88:91], v[224:227]
  ds_read_b64_tr_b16 a[122:123], v104 offset:17408
  buffer_load_dwordx4 v89, s[36:39], s61 offen offset:1024  lds
  v_mfma_f32_16x16x32_bf16 v[228:231], a[100:103], a[92:95], v[228:231]
  s_waitcnt lgkmcnt(6)
  v_mfma_f32_16x16x32_bf16 v[232:235], a[104:107], a[84:87], v[232:235]
  ds_read_b64_tr_b16 a[124:125], v105 offset:16384
  v_mfma_f32_16x16x32_bf16 v[236:239], a[104:107], a[88:91], v[236:239]
  ds_read_b64_tr_b16 a[126:127], v105 offset:17408
  v_mfma_f32_16x16x32_bf16 v[240:243], a[104:107], a[92:95], v[240:243]
  buffer_load_dwordx4 v90, s[36:39], s61 offen offset:2048  lds
  v_mfma_f32_16x16x32_bf16 v[244:247], a[108:111], a[84:87], v[244:247]
  v_mfma_f32_16x16x32_bf16 v[248:251], a[108:111], a[88:91], v[248:251]
  v_mfma_f32_16x16x32_bf16 v[252:255], a[108:111], a[92:95], v[252:255]
  s_waitcnt lgkmcnt(4)
  v_mfma_f32_16x16x32_bf16 v[32:35], a[112:115], a[84:87], v[32:35]
  s_waitcnt vmcnt(7) lgkmcnt(0)
  s_barrier
  v_mfma_f32_16x16x32_bf16 v[36:39], a[112:115], a[88:91], v[36:39]
  ds_read_b64_tr_b16 a[96:97], v80 offset:0
  ds_read_b128 a[48:51], v92 offset:0
  v_mfma_f32_16x16x32_bf16 v[40:43], a[112:115], a[92:95], v[40:43]
  ds_read_b64_tr_b16 a[98:99], v80 offset:1024
  ds_read_b128 a[52:55], v92 offset:2048
  v_mfma_f32_16x16x32_bf16 v[44:47], a[116:119], a[84:87], v[44:47]
  ds_read_b64_tr_b16 a[100:101], v81 offset:0
  ds_read_b128 a[56:59], v92 offset:4096
  v_mfma_f32_16x16x32_bf16 v[48:51], a[116:119], a[88:91], v[48:51]
  ds_read_b64_tr_b16 a[102:103], v81 offset:1024
  buffer_load_dwordx4 v91, s[36:39], s61 offen offset:3072  lds
  v_mfma_f32_16x16x32_bf16 v[52:55], a[116:119], a[92:95], v[52:55]
  ds_read_b64_tr_b16 a[104:105], v82 offset:0
  s_add_u32 s61, s61, 256
  v_mfma_f32_16x16x32_bf16 v[56:59], a[120:123], a[84:87], v[56:59]
  ds_read_b64_tr_b16 a[106:107], v82 offset:1024
  v_mfma_f32_16x16x32_bf16 v[60:63], a[120:123], a[88:91], v[60:63]
  ds_read_b64_tr_b16 a[108:109], v83 offset:0
  v_mfma_f32_16x16x32_bf16 v[64:67], a[120:123], a[92:95], v[64:67]
  ds_read_b64_tr_b16 a[110:111], v83 offset:1024
  v_mfma_f32_16x16x32_bf16 v[68:71], a[124:127], a[84:87], v[68:71]
  ds_read_b64_tr_b16 a[112:113], v84 offset:0
  v_mfma_f32_16x16x32_bf16 v[72:75], a[124:127], a[88:91], v[72:75]
  ds_read_b64_tr_b16 a[114:115], v84 offset:1024
  v_mfma_f32_16x16x32_bf16 v[76:79], a[124:127], a[92:95], v[76:79]
  s_waitcnt lgkmcnt(7)
  s_waitcnt lgkmcnt(6)
  v_mfma_f32_16x16x32_bf16 v[112:115], a[96:99], a[48:51], v[112:115]
  ds_read_b64_tr_b16 a[116:117], v85 offset:0
  s_add_u32 m0, s97, 81920
  s_nop 0
  buffer_load_dwordx4 v88, s[36:39], s61 offen offset:0  lds
  v_mfma_f32_16x16x32_bf16 v[116:119], a[96:99], a[52:55], v[116:119]
  ds_read_b64_tr_b16 a[118:119], v85 offset:1024
  ds_read_b128 a[60:63], v93 offset:0
  v_mfma_f32_16x16x32_bf16 v[120:123], a[96:99], a[56:59], v[120:123]
  ds_read_b128 a[64:67], v93 offset:2048
  v_mfma_f32_16x16x32_bf16 v[124:127], a[100:103], a[48:51], v[124:127]
  ds_read_b64_tr_b16 a[120:121], v86 offset:0
  v_mfma_f32_16x16x32_bf16 v[128:131], a[100:103], a[52:55], v[128:131]
  ds_read_b64_tr_b16 a[122:123], v86 offset:1024
  buffer_load_dwordx4 v89, s[36:39], s61 offen offset:1024  lds
  v_mfma_f32_16x16x32_bf16 v[132:135], a[100:103], a[56:59], v[132:135]
  s_waitcnt lgkmcnt(8)
  v_mfma_f32_16x16x32_bf16 v[136:139], a[104:107], a[48:51], v[136:139]
  ds_read_b64_tr_b16 a[124:125], v87 offset:0
  ds_read_b128 a[68:71], v93 offset:4096
  v_mfma_f32_16x16x32_bf16 v[140:143], a[104:107], a[52:55], v[140:143]
  ds_read_b64_tr_b16 a[126:127], v87 offset:1024
  v_mfma_f32_16x16x32_bf16 v[144:147], a[104:107], a[56:59], v[144:147]
  buffer_load_dwordx4 v90, s[36:39], s61 offen offset:2048  lds
  v_mfma_f32_16x16x32_bf16 v[148:151], a[108:111], a[48:51], v[148:151]
  v_mfma_f32_16x16x32_bf16 v[152:155], a[108:111], a[52:55], v[152:155]
  v_mfma_f32_16x16x32_bf16 v[156:159], a[108:111], a[56:59], v[156:159]
  s_waitcnt lgkmcnt(7)
  v_mfma_f32_16x16x32_bf16 v[160:163], a[112:115], a[48:51], v[160:163]
  s_waitcnt vmcnt(7) lgkmcnt(0)
  s_barrier
  v_mfma_f32_16x16x32_bf16 v[164:167], a[112:115], a[52:55], v[164:167]
  ds_read_b64_tr_b16 a[96:97], v80 offset:16384
  buffer_load_dwordx4 v91, s[36:39], s61 offen offset:3072  lds
  v_mfma_f32_16x16x32_bf16 v[168:171], a[112:115], a[56:59], v[168:171]
  ds_read_b64_tr_b16 a[98:99], v80 offset:17408
  s_add_u32 s61, s61, 261888
  v_mfma_f32_16x16x32_bf16 v[172:175], a[116:119], a[48:51], v[172:175]
  ds_read_b64_tr_b16 a[100:101], v81 offset:16384
  v_mfma_f32_16x16x32_bf16 v[176:179], a[116:119], a[52:55], v[176:179]
  ds_read_b64_tr_b16 a[102:103], v81 offset:17408
  v_mfma_f32_16x16x32_bf16 v[180:183], a[116:119], a[56:59], v[180:183]
  ds_read_b64_tr_b16 a[104:105], v82 offset:16384
  v_mfma_f32_16x16x32_bf16 v[184:187], a[120:123], a[48:51], v[184:187]
  ds_read_b64_tr_b16 a[106:107], v82 offset:17408
  v_mfma_f32_16x16x32_bf16 v[188:191], a[120:123], a[52:55], v[188:191]
  ds_read_b64_tr_b16 a[108:109], v83 offset:16384
  v_mfma_f32_16x16x32_bf16 v[192:195], a[120:123], a[56:59], v[192:195]
  ds_read_b64_tr_b16 a[110:111], v83 offset:17408
  v_mfma_f32_16x16x32_bf16 v[196:199], a[124:127], a[48:51], v[196:199]
  ds_read_b64_tr_b16 a[112:113], v84 offset:16384
  v_mfma_f32_16x16x32_bf16 v[200:203], a[124:127], a[52:55], v[200:203]
  ds_read_b64_tr_b16 a[114:115], v84 offset:17408
  v_mfma_f32_16x16x32_bf16 v[204:207], a[124:127], a[56:59], v[204:207]
  s_cmp_eq_u32 s61, 3670016
  s_cselect_b32 s61, 0, s61
  v_lshlrev_b32 v93, 4, v106
  v_add_u32 v93, s58, v93
  v_add_u32 v94, 0x10000, v93
  s_waitcnt lgkmcnt(6)
  v_mfma_f32_16x16x32_bf16 v[208:211], a[96:99], a[48:51], v[208:211]
  ds_read_b64_tr_b16 a[116:117], v85 offset:16384
  s_add_u32 m0, s58, 147456
  s_mov_b32 s68, 491520
  buffer_load_dwordx4 v16, s[28:31], s68 offen offset:0 nt lds
  v_mfma_f32_16x16x32_bf16 v[212:215], a[96:99], a[52:55], v[212:215]
  ds_read_b64_tr_b16 a[118:119], v85 offset:17408
  v_mfma_f32_16x16x32_bf16 v[216:219], a[96:99], a[56:59], v[216:219]
  ds_write_b128 v93, a[160:163] offset:0
  v_mfma_f32_16x16x32_bf16 v[220:223], a[100:103], a[48:51], v[220:223]
  ds_read_b64_tr_b16 a[120:121], v86 offset:16384
  v_mfma_f32_16x16x32_bf16 v[224:227], a[100:103], a[52:55], v[224:227]
  ds_read_b64_tr_b16 a[122:123], v86 offset:17408
  buffer_load_dwordx4 v17, s[28:31], s68 offen offset:1024 nt lds
  v_mfma_f32_16x16x32_bf16 v[228:231], a[100:103], a[56:59], v[228:231]
  s_waitcnt lgkmcnt(7)
  v_mfma_f32_16x16x32_bf16 v[232:235], a[104:107], a[48:51], v[232:235]
  ds_read_b64_tr_b16 a[124:125], v87 offset:16384
  v_mfma_f32_16x16x32_bf16 v[236:239], a[104:107], a[52:55], v[236:239]
  ds_read_b64_tr_b16 a[126:127], v87 offset:17408
  v_mfma_f32_16x16x32_bf16 v[240:243], a[104:107], a[56:59], v[240:243]
  buffer_load_dwordx4 v18, s[28:31], s68 offen offset:2048 nt lds
  v_mfma_f32_16x16x32_bf16 v[244:247], a[108:111], a[48:51], v[244:247]
  ds_write_b128 v93, a[164:167] offset:1024
  v_mfma_f32_16x16x32_bf16 v[248:251], a[108:111], a[52:55], v[248:251]
  v_mfma_f32_16x16x32_bf16 v[252:255], a[108:111], a[56:59], v[252:255]
  s_waitcnt lgkmcnt(6)
  v_mfma_f32_16x16x32_bf16 v[32:35], a[112:115], a[48:51], v[32:35]
  ds_write_b128 v93, a[168:171] offset:2048
  ds_write_b128 v93, a[172:175] offset:3072
  s_waitcnt vmcnt(7) lgkmcnt(0)
  s_barrier
  v_mfma_f32_16x16x32_bf16 v[36:39], a[112:115], a[52:55], v[36:39]
  ds_read_b64_tr_b16 a[96:97], v98 offset:0
  buffer_load_dwordx4 v19, s[28:31], s68 offen offset:3072 nt lds
  v_mfma_f32_16x16x32_bf16 v[40:43], a[112:115], a[56:59], v[40:43]
  ds_read_b64_tr_b16 a[98:99], v98 offset:1024
  v_mfma_f32_16x16x32_bf16 v[44:47], a[116:119], a[48:51], v[44:47]
  ds_read_b64_tr_b16 a[100:101], v99 offset:0
  v_mfma_f32_16x16x32_bf16 v[48:51], a[116:119], a[52:55], v[48:51]
  ds_read_b64_tr_b16 a[102:103], v99 offset:1024
  v_mfma_f32_16x16x32_bf16 v[52:55], a[116:119], a[56:59], v[52:55]
  ds_read_b64_tr_b16 a[104:105], v100 offset:0
  v_mfma_f32_16x16x32_bf16 v[56:59], a[120:123], a[48:51], v[56:59]
  ds_read_b64_tr_b16 a[106:107], v100 offset:1024
  v_mfma_f32_16x16x32_bf16 v[60:63], a[120:123], a[52:55], v[60:63]
  ds_read_b64_tr_b16 a[108:109], v101 offset:0
  v_mfma_f32_16x16x32_bf16 v[64:67], a[120:123], a[56:59], v[64:67]
  ds_read_b64_tr_b16 a[110:111], v101 offset:1024
  v_mfma_f32_16x16x32_bf16 v[68:71], a[124:127], a[48:51], v[68:71]
  ds_read_b64_tr_b16 a[112:113], v102 offset:0
  v_mfma_f32_16x16x32_bf16 v[72:75], a[124:127], a[52:55], v[72:75]
  ds_read_b64_tr_b16 a[114:115], v102 offset:1024
  v_mfma_f32_16x16x32_bf16 v[76:79], a[124:127], a[56:59], v[76:79]
  s_waitcnt lgkmcnt(6)
  v_mfma_f32_16x16x32_bf16 v[112:115], a[96:99], a[60:63], v[112:115]
  ds_read_b64_tr_b16 a[116:117], v103 offset:0
  s_add_u32 m0, s58, 131072
  s_mov_b32 s68, 458752
  buffer_load_dwordx4 v16, s[32:35], s68 offen offset:0 nt lds
  v_mfma_f32_16x16x32_bf16 v[116:119], a[96:99], a[64:67], v[116:119]
  ds_read_b64_tr_b16 a[118:119], v103 offset:1024
  v_mfma_f32_16x16x32_bf16 v[120:123], a[96:99], a[68:71], v[120:123]
  ds_write_b128 v93, a[176:179] offset:16384
  v_mfma_f32_16x16x32_bf16 v[124:127], a[100:103], a[60:63], v[124:127]
  ds_read_b64_tr_b16 a[120:121], v104 offset:0
  v_mfma_f32_16x16x32_bf16 v[128:131], a[100:103], a[64:67], v[128:131]
  ds_read_b64_tr_b16 a[122:123], v104 offset:1024
  buffer_load_dwordx4 v17, s[32:35], s68 offen offset:1024 nt lds
  v_mfma_f32_16x16x32_bf16 v[132:135], a[100:103], a[68:71], v[132:135]
  s_waitcnt lgkmcnt(7)
  v_mfma_f32_16x16x32_bf16 v[136:139], a[104:107], a[60:63], v[136:139]
  ds_read_b64_tr_b16 a[124:125], v105 offset:0
  v_mfma_f32_16x16x32_bf16 v[140:143], a[104:107], a[64:67], v[140:143]
  ds_read_b64_tr_b16 a[126:127], v105 offset:1024
  v_mfma_f32_16x16x32_bf16 v[144:147], a[104:107], a[68:71], v[144:147]
  buffer_load_dwordx4 v18, s[32:35], s68 offen offset:2048 nt lds
  v_mfma_f32_16x16x32_bf16 v[148:151], a[108:111], a[60:63], v[148:151]
  ds_write_b128 v93, a[180:183] offset:17408
  v_mfma_f32_16x16x32_bf16 v[152:155], a[108:111], a[64:67], v[152:155]
  v_mfma_f32_16x16x32_bf16 v[156:159], a[108:111], a[68:71], v[156:159]
  s_waitcnt lgkmcnt(6)
  v_mfma_f32_16x16x32_bf16 v[160:163], a[112:115], a[60:63], v[160:163]
  ds_write_b128 v93, a[184:187] offset:18432
  ds_write_b128 v93, a[188:191] offset:19456
  s_waitcnt vmcnt(7) lgkmcnt(0)
  s_barrier
  v_mfma_f32_16x16x32_bf16 v[164:167], a[112:115], a[64:67], v[164:167]
  ds_read_b64_tr_b16 a[96:97], v98 offset:16384
  buffer_load_dwordx4 v19, s[32:35], s68 offen offset:3072 nt lds
  v_mfma_f32_16x16x32_bf16 v[168:171], a[112:115], a[68:71], v[168:171]
  ds_read_b64_tr_b16 a[98:99], v98 offset:17408
  v_mfma_f32_16x16x32_bf16 v[172:175], a[116:119], a[60:63], v[172:175]
  ds_read_b64_tr_b16 a[100:101], v99 offset:16384
  v_mfma_f32_16x16x32_bf16 v[176:179], a[116:119], a[64:67], v[176:179]
  ds_read_b64_tr_b16 a[102:103], v99 offset:17408
  v_mfma_f32_16x16x32_bf16 v[180:183], a[116:119], a[68:71], v[180:183]
  ds_read_b64_tr_b16 a[104:105], v100 offset:16384
  v_mfma_f32_16x16x32_bf16 v[184:187], a[120:123], a[60:63], v[184:187]
  ds_read_b64_tr_b16 a[106:107], v100 offset:17408
  v_mfma_f32_16x16x32_bf16 v[188:191], a[120:123], a[64:67], v[188:191]
  ds_read_b64_tr_b16 a[108:109], v101 offset:16384
  v_mfma_f32_16x16x32_bf16 v[192:195], a[120:123], a[68:71], v[192:195]
  ds_read_b64_tr_b16 a[110:111], v101 offset:17408
  v_mfma_f32_16x16x32_bf16 v[196:199], a[124:127], a[60:63], v[196:199]
  ds_read_b64_tr_b16 a[112:113], v102 offset:16384
  v_mfma_f32_16x16x32_bf16 v[200:203], a[124:127], a[64:67], v[200:203]
  ds_read_b64_tr_b16 a[114:115], v102 offset:17408
  v_mfma_f32_16x16x32_bf16 v[204:207], a[124:127], a[68:71], v[204:207]
  s_waitcnt lgkmcnt(6)
  v_mfma_f32_16x16x32_bf16 v[208:211], a[96:99], a[60:63], v[208:211]
  ds_read_b64_tr_b16 a[116:117], v103 offset:16384
  v_mfma_f32_16x16x32_bf16 v[212:215], a[96:99], a[64:67], v[212:215]
  ds_read_b64_tr_b16 a[118:119], v103 offset:17408
  v_mfma_f32_16x16x32_bf16 v[216:219], a[96:99], a[68:71], v[216:219]
  ds_write_b128 v94, a[192:195] offset:0
  v_mfma_f32_16x16x32_bf16 v[220:223], a[100:103], a[60:63], v[220:223]
  ds_read_b64_tr_b16 a[120:121], v104 offset:16384
  v_cvt_pk_bf16_f32 v0, v112, v113
  v_mfma_f32_16x16x32_bf16 v[224:227], a[100:103], a[64:67], v[224:227]
  ds_read_b64_tr_b16 a[122:123], v104 offset:17408
  v_cvt_pk_bf16_f32 v1, v114, v115
  v_mfma_f32_16x16x32_bf16 v[228:231], a[100:103], a[68:71], v[228:231]
  v_cvt_pk_bf16_f32 v2, v124, v125
  s_waitcnt lgkmcnt(7)
  v_mfma_f32_16x16x32_bf16 v[232:235], a[104:107], a[60:63], v[232:235]
  ds_read_b64_tr_b16 a[124:125], v105 offset:16384
  v_cvt_pk_bf16_f32 v3, v126, v127
  v_mfma_f32_16x16x32_bf16 v[236:239], a[104:107], a[64:67], v[236:239]
  ds_read_b64_tr_b16 a[126:127], v105 offset:17408
  v_cvt_pk_bf16_f32 v108, v116, v117
  v_mfma_f32_16x16x32_bf16 v[240:243], a[104:107], a[68:71], v[240:243]
  ds_write_b128 v94, a[196:199] offset:1024
  v_mfma_f32_16x16x32_bf16 v[244:247], a[108:111], a[60:63], v[244:247]
  ds_write_b128 v94, a[200:203] offset:2048
  v_mfma_f32_16x16x32_bf16 v[248:251], a[108:111], a[64:67], v[248:251]
  v_cvt_pk_bf16_f32 v109, v118, v119
  v_cvt_pk_bf16_f32 v110, v128, v129
  v_mfma_f32_16x16x32_bf16 v[252:255], a[108:111], a[68:71], v[252:255]
  v_cvt_pk_bf16_f32 v111, v130, v131
  s_waitcnt lgkmcnt(7)
  v_mfma_f32_16x16x32_bf16 v[32:35], a[112:115], a[60:63], v[32:35]
  ds_write_b128 v94, a[204:207] offset:3072
  s_waitcnt lgkmcnt(0)
  s_barrier
  v_mfma_f32_16x16x32_bf16 v[36:39], a[112:115], a[64:67], v[36:39]
  ds_read_b128 a[96:99], v4 offset:0
  v_cvt_pk_bf16_f32 v24, v120, v121
  v_mfma_f32_16x16x32_bf16 v[40:43], a[112:115], a[68:71], v[40:43]
  ds_read_b128 a[100:103], v4 offset:8192
  v_cvt_pk_bf16_f32 v25, v122, v123
  v_mfma_f32_16x16x32_bf16 v[44:47], a[116:119], a[60:63], v[44:47]
  ds_read_b128 a[104:107], v5 offset:0
  v_cvt_pk_bf16_f32 v26, v132, v133
  v_mfma_f32_16x16x32_bf16 v[48:51], a[116:119], a[64:67], v[48:51]
  ds_read_b128 a[108:111], v5 offset:8192
  v_cvt_pk_bf16_f32 v27, v134, v135
  v_mfma_f32_16x16x32_bf16 v[52:55], a[116:119], a[68:71], v[52:55]
  ds_read_b128 a[112:115], v6 offset:0
  v_permlane32_swap_b32 v0, v2
  v_mfma_f32_16x16x32_bf16 v[56:59], a[120:123], a[60:63], v[56:59]
  v_permlane32_swap_b32 v1, v3
  v_permlane32_swap_b32 v108, v110
  v_mfma_f32_16x16x32_bf16 v[60:63], a[120:123], a[64:67], v[60:63]
  v_permlane32_swap_b32 v109, v111
  v_permlane32_swap_b32 v24, v26
  v_mfma_f32_16x16x32_bf16 v[64:67], a[120:123], a[68:71], v[64:67]
  v_permlane32_swap_b32 v25, v27
  v_permlane16_swap_b32 v0, v2
  v_mfma_f32_16x16x32_bf16 v[68:71], a[124:127], a[60:63], v[68:71]
  v_permlane16_swap_b32 v1, v3
  v_permlane16_swap_b32 v108, v110
  v_mfma_f32_16x16x32_bf16 v[72:75], a[124:127], a[64:67], v[72:75]
  v_permlane16_swap_b32 v109, v111
  v_permlane16_swap_b32 v24, v26
  v_mfma_f32_16x16x32_bf16 v[76:79], a[124:127], a[68:71], v[76:79]
  v_permlane16_swap_b32 v25, v27
L_postA:
  v_accvgpr_write_b32 a0, v0
  v_accvgpr_write_b32 a1, v1
  v_accvgpr_write_b32 a2, v2
  v_accvgpr_write_b32 a3, v3
  v_accvgpr_write_b32 a4, v108
  v_accvgpr_write_b32 a5, v109
  v_accvgpr_write_b32 a6, v110
  v_accvgpr_write_b32 a7, v111
  v_accvgpr_write_b32 a8, v24
  v_accvgpr_write_b32 a9, v25
  v_accvgpr_write_b32 a10, v26
  v_accvgpr_write_b32 a11, v27
  v_cvt_pk_bf16_f32 v0, v136, v137
  v_cvt_pk_bf16_f32 v1, v138, v139
  v_cvt_pk_bf16_f32 v2, v148, v149
  v_cvt_pk_bf16_f32 v3, v150, v151
  v_cvt_pk_bf16_f32 v108, v140, v141
  v_cvt_pk_bf16_f32 v109, v142, v143
  v_cvt_pk_bf16_f32 v110, v152, v153
  v_cvt_pk_bf16_f32 v111, v154, v155
  v_cvt_pk_bf16_f32 v24, v144, v145
  v_cvt_pk_bf16_f32 v25, v146, v147
  v_cvt_pk_bf16_f32 v26, v156, v157
  v_cvt_pk_bf16_f32 v27, v158, v159
  v_permlane32_swap_b32 v0, v2
  v_permlane32_swap_b32 v1, v3
  v_permlane32_swap_b32 v108, v110
  v_permlane32_swap_b32 v109, v111
  v_permlane32_swap_b32 v24, v26
  v_permlane32_swap_b32 v25, v27
  v_permlane16_swap_b32 v0, v2
  v_permlane16_swap_b32 v1, v3
  v_permlane16_swap_b32 v108, v110
  v_permlane16_swap_b32 v109, v111
  v_permlane16_swap_b32 v24, v26
  v_permlane16_swap_b32 v25, v27
  v_accvgpr_write_b32 a12, v0
  v_accvgpr_write_b32 a13, v1
  v_accvgpr_write_b32 a14, v2
  v_accvgpr_write_b32 a15, v3
  v_accvgpr_write_b32 a16, v108
  v_accvgpr_write_b32 a17, v109
  v_accvgpr_write_b32 a18, v110
  v_accvgpr_write_b32 a19, v111
  v_accvgpr_write_b32 a20, v24
  v_accvgpr_write_b32 a21, v25
  v_accvgpr_write_b32 a22, v26
  v_accvgpr_write_b32 a23, v27
  s_nop 1
  s_mov_b32 s76, 0
  s_waitcnt lgkmcnt(3)
  v_mfma_f32_16x16x32_bf16 v[112:115], a[96:99], a[0:3], 0
  ds_read_b128 a[116:119], v6 offset:8192
  v_mfma_f32_16x16x32_bf16 v[116:119], a[96:99], a[4:7], 0
  ds_write_b128 v94, a[128:131] offset:16384
  v_mfma_f32_16x16x32_bf16 v[120:123], a[96:99], a[8:11], 0
  ds_write_b128 v94, a[132:135] offset:17408
  v_mfma_f32_16x16x32_bf16 v[124:127], a[100:103], a[0:3], 0
  ds_read_b128 a[120:123], v7 offset:0
  v_cvt_pk_bf16_f32 v0, v160, v161
  v_mfma_f32_16x16x32_bf16 v[128:131], a[100:103], a[4:7], 0
  ds_write_b128 v94, a[136:139] offset:18432
  v_mfma_f32_16x16x32_bf16 v[132:135], a[100:103], a[8:11], 0
  v_cvt_pk_bf16_f32 v1, v162, v163
  s_waitcnt lgkmcnt(6)
  v_mfma_f32_16x16x32_bf16 v[112:115], a[104:107], a[12:15], v[112:115]
  ds_read_b128 a[124:127], v7 offset:8192
  v_cvt_pk_bf16_f32 v2, v172, v173
  v_mfma_f32_16x16x32_bf16 v[116:119], a[104:107], a[16:19], v[116:119]
  ds_write_b128 v94, a[140:143] offset:19456
  v_mfma_f32_16x16x32_bf16 v[120:123], a[104:107], a[20:23], v[120:123]
  v_cvt_pk_bf16_f32 v3, v174, v175
  v_cvt_pk_bf16_f32 v108, v164, v165
  v_mfma_f32_16x16x32_bf16 v[124:127], a[108:111], a[12:15], v[124:127]
  ds_read_b128 a[96:99], v4 offset:256
  v_cvt_pk_bf16_f32 v109, v166, v167
  v_mfma_f32_16x16x32_bf16 v[128:131], a[108:111], a[16:19], v[128:131]
  v_cvt_pk_bf16_f32 v110, v176, v177
  v_cvt_pk_bf16_f32 v111, v178, v179
  v_cvt_pk_bf16_f32 v24, v168, v169
  v_cvt_pk_bf16_f32 v25, v170, v171
  v_cvt_pk_bf16_f32 v26, v180, v181
  v_cvt_pk_bf16_f32 v27, v182, v183
  v_permlane32_swap_b32 v0, v2
  v_permlane32_swap_b32 v1, v3
  v_permlane32_swap_b32 v108, v110
  v_permlane32_swap_b32 v109, v111
  v_permlane32_swap_b32 v24, v26
  v_permlane32_swap_b32 v25, v27
  v_permlane16_swap_b32 v0, v2
  v_permlane16_swap_b32 v1, v3
  v_permlane16_swap_b32 v108, v110
  v_permlane16_swap_b32 v109, v111
  v_permlane16_swap_b32 v24, v26
  v_permlane16_swap_b32 v25, v27
  v_accvgpr_write_b32 a24, v0
  v_accvgpr_write_b32 a25, v1
  v_accvgpr_write_b32 a26, v2
  v_accvgpr_write_b32 a27, v3
  v_accvgpr_write_b32 a28, v108
  v_accvgpr_write_b32 a29, v109
  v_accvgpr_write_b32 a30, v110
  v_accvgpr_write_b32 a31, v111
  v_accvgpr_write_b32 a32, v24
  v_accvgpr_write_b32 a33, v25
  v_accvgpr_write_b32 a34, v26
  v_accvgpr_write_b32 a35, v27
  v_mfma_f32_16x16x32_bf16 v[132:135], a[108:111], a[20:23], v[132:135]
  v_cvt_pk_bf16_f32 v0, v184, v185
  s_waitcnt lgkmcnt(7)
  v_mfma_f32_16x16x32_bf16 v[112:115], a[112:115], a[24:27], v[112:115]
  ds_read_b128 a[100:103], v4 offset:8448
  v_cvt_pk_bf16_f32 v1, v186, v187
  v_mfma_f32_16x16x32_bf16 v[116:119], a[112:115], a[28:31], v[116:119]
  v_cvt_pk_bf16_f32 v2, v196, v197
  v_cvt_pk_bf16_f32 v3, v198, v199
  v_mfma_f32_16x16x32_bf16 v[120:123], a[112:115], a[32:35], v[120:123]
  v_cvt_pk_bf16_f32 v108, v188, v189
  v_cvt_pk_bf16_f32 v109, v190, v191
  v_mfma_f32_16x16x32_bf16 v[124:127], a[116:119], a[24:27], v[124:127]
  ds_read_b128 a[104:107], v5 offset:256
  v_cvt_pk_bf16_f32 v110, v200, v201
  v_mfma_f32_16x16x32_bf16 v[128:131], a[116:119], a[28:31], v[128:131]
  v_cvt_pk_bf16_f32 v111, v202, v203
  v_cvt_pk_bf16_f32 v24, v192, v193
  v_cvt_pk_bf16_f32 v25, v194, v195
  v_cvt_pk_bf16_f32 v26, v204, v205
  v_cvt_pk_bf16_f32 v27, v206, v207
  v_permlane32_swap_b32 v0, v2
  v_permlane32_swap_b32 v1, v3
  v_permlane32_swap_b32 v108, v110
  v_permlane32_swap_b32 v109, v111
  v_permlane32_swap_b32 v24, v26
  v_permlane32_swap_b32 v25, v27
  v_permlane16_swap_b32 v0, v2
  v_permlane16_swap_b32 v1, v3
  v_permlane16_swap_b32 v108, v110
  v_permlane16_swap_b32 v109, v111
  v_permlane16_swap_b32 v24, v26
  v_permlane16_swap_b32 v25, v27
  v_accvgpr_write_b32 a36, v0
  v_accvgpr_write_b32 a37, v1
  v_accvgpr_write_b32 a38, v2
  v_accvgpr_write_b32 a39, v3
  v_accvgpr_write_b32 a40, v108
  v_accvgpr_write_b32 a41, v109
  v_accvgpr_write_b32 a42, v110
  v_accvgpr_write_b32 a43, v111
  v_accvgpr_write_b32 a44, v24
  v_accvgpr_write_b32 a45, v25
  v_accvgpr_write_b32 a46, v26
  v_accvgpr_write_b32 a47, v27
  v_mfma_f32_16x16x32_bf16 v[132:135], a[116:119], a[32:35], v[132:135]
  v_cvt_pk_bf16_f32 v0, v208, v209
  s_waitcnt lgkmcnt(4)
  v_mfma_f32_16x16x32_bf16 v[112:115], a[120:123], a[36:39], v[112:115]
  ds_read_b128 a[108:111], v5 offset:8448
  v_cvt_pk_bf16_f32 v1, v210, v211
  v_mfma_f32_16x16x32_bf16 v[116:119], a[120:123], a[40:43], v[116:119]
  v_cvt_pk_bf16_f32 v2, v220, v221
  v_cvt_pk_bf16_f32 v3, v222, v223
  v_mfma_f32_16x16x32_bf16 v[120:123], a[120:123], a[44:47], v[120:123]
  v_cvt_pk_bf16_f32 v108, v212, v213
  v_cvt_pk_bf16_f32 v109, v214, v215
  v_mfma_f32_16x16x32_bf16 v[124:127], a[124:127], a[36:39], v[124:127]
  ds_read_b128 a[112:115], v6 offset:256
  v_cvt_pk_bf16_f32 v110, v224, v225
  v_mfma_f32_16x16x32_bf16 v[128:131], a[124:127], a[40:43], v[128:131]
  v_cvt_pk_bf16_f32 v111, v226, v227
  v_cvt_pk_bf16_f32 v24, v216, v217
  v_cvt_pk_bf16_f32 v25, v218, v219
  v_cvt_pk_bf16_f32 v26, v228, v229
  v_cvt_pk_bf16_f32 v27, v230, v231
  v_permlane32_swap_b32 v0, v2
  v_permlane32_swap_b32 v1, v3
  v_permlane32_swap_b32 v108, v110
  v_permlane32_swap_b32 v109, v111
  v_permlane32_swap_b32 v24, v26
  v_permlane32_swap_b32 v25, v27
  v_permlane16_swap_b32 v0, v2
  v_permlane16_swap_b32 v1, v3
  v_permlane16_swap_b32 v108, v110
  v_permlane16_swap_b32 v109, v111
  v_permlane16_swap_b32 v24, v26
  v_permlane16_swap_b32 v25, v27
  v_accvgpr_write_b32 a48, v0
  v_accvgpr_write_b32 a49, v1
  v_accvgpr_write_b32 a50, v2
  v_accvgpr_write_b32 a51, v3
  v_accvgpr_write_b32 a52, v108
  v_accvgpr_write_b32 a53, v109
  v_accvgpr_write_b32 a54, v110
  v_accvgpr_write_b32 a55, v111
  v_accvgpr_write_b32 a56, v24
  v_accvgpr_write_b32 a57, v25
  v_accvgpr_write_b32 a58, v26
  v_accvgpr_write_b32 a59, v27
  v_mfma_f32_16x16x32_bf16 v[132:135], a[124:127], a[44:47], v[132:135]
  v_cvt_pk_bf16_f32 v0, v232, v233
  s_waitcnt lgkmcnt(3)
  v_mfma_f32_16x16x32_bf16 v[112:115], a[96:99], a[48:51], v[112:115]
  ds_read_b128 a[116:119], v6 offset:8448
  v_cvt_pk_bf16_f32 v1, v234, v235
  v_mfma_f32_16x16x32_bf16 v[116:119], a[96:99], a[52:55], v[116:119]
  v_cvt_pk_bf16_f32 v2, v244, v245
  v_cvt_pk_bf16_f32 v3, v246, v247
  v_mfma_f32_16x16x32_bf16 v[120:123], a[96:99], a[56:59], v[120:123]
  v_cvt_pk_bf16_f32 v108, v236, v237
  v_cvt_pk_bf16_f32 v109, v238, v239
  v_mfma_f32_16x16x32_bf16 v[124:127], a[100:103], a[48:51], v[124:127]
  ds_read_b128 a[120:123], v7 offset:256
  v_cvt_pk_bf16_f32 v110, v248, v249
  v_mfma_f32_16x16x32_bf16 v[128:131], a[100:103], a[52:55], v[128:131]
  v_cvt_pk_bf16_f32 v111, v250, v251
  v_cvt_pk_bf16_f32 v24, v240, v241
  v_cvt_pk_bf16_f32 v25, v242, v243
  v_cvt_pk_bf16_f32 v26, v252, v253
  v_cvt_pk_bf16_f32 v27, v254, v255
  v_permlane32_swap_b32 v0, v2
  v_permlane32_swap_b32 v1, v3
  v_permlane32_swap_b32 v108, v110
  v_permlane32_swap_b32 v109, v111
  v_permlane32_swap_b32 v24, v26
  v_permlane32_swap_b32 v25, v27
  v_permlane16_swap_b32 v0, v2
  v_permlane16_swap_b32 v1, v3
  v_permlane16_swap_b32 v108, v110
  v_permlane16_swap_b32 v109, v111
  v_permlane16_swap_b32 v24, v26
  v_permlane16_swap_b32 v25, v27
  v_accvgpr_write_b32 a60, v0
  v_accvgpr_write_b32 a61, v1
  v_accvgpr_write_b32 a62, v2
  v_accvgpr_write_b32 a63, v3
  v_accvgpr_write_b32 a64, v108
  v_accvgpr_write_b32 a65, v109
  v_accvgpr_write_b32 a66, v110
  v_accvgpr_write_b32 a67, v111
  v_accvgpr_write_b32 a68, v24
  v_accvgpr_write_b32 a69, v25
  v_accvgpr_write_b32 a70, v26
  v_accvgpr_write_b32 a71, v27
  v_mfma_f32_16x16x32_bf16 v[132:135], a[100:103], a[56:59], v[132:135]
  v_cvt_pk_bf16_f32 v0, v32, v33
  s_waitcnt lgkmcnt(3)
  v_mfma_f32_16x16x32_bf16 v[112:115], a[104:107], a[60:63], v[112:115]
  ds_read_b128 a[124:127], v7 offset:8448
  v_cvt_pk_bf16_f32 v1, v34, v35
  v_mfma_f32_16x16x32_bf16 v[116:119], a[104:107], a[64:67], v[116:119]
  v_cvt_pk_bf16_f32 v2, v44, v45
  v_cvt_pk_bf16_f32 v3, v46, v47
  v_mfma_f32_16x16x32_bf16 v[120:123], a[104:107], a[68:71], v[120:123]
  v_cvt_pk_bf16_f32 v108, v36, v37
  v_cvt_pk_bf16_f32 v109, v38, v39
  v_mfma_f32_16x16x32_bf16 v[124:127], a[108:111], a[60:63], v[124:127]
  v_xor_b32 v4, 0x4000, v4
  v_xor_b32 v5, 0x4000, v5
  v_mfma_f32_16x16x32_bf16 v[128:131], a[108:111], a[64:67], v[128:131]
  v_cvt_pk_bf16_f32 v110, v48, v49
  v_cvt_pk_bf16_f32 v111, v50, v51
  v_cvt_pk_bf16_f32 v24, v40, v41
  v_cvt_pk_bf16_f32 v25, v42, v43
  v_cvt_pk_bf16_f32 v26, v52, v53
  v_cvt_pk_bf16_f32 v27, v54, v55
  v_permlane32_swap_b32 v0, v2
  v_permlane32_swap_b32 v1, v3
  v_permlane32_swap_b32 v108, v110
  v_permlane32_swap_b32 v109, v111
  v_permlane32_swap_b32 v24, v26
  v_permlane32_swap_b32 v25, v27
  v_permlane16_swap_b32 v0, v2
  v_permlane16_swap_b32 v1, v3
  v_permlane16_swap_b32 v108, v110
  v_permlane16_swap_b32 v109, v111
  v_permlane16_swap_b32 v24, v26
  v_permlane16_swap_b32 v25, v27
  v_accvgpr_write_b32 a72, v0
  v_accvgpr_write_b32 a73, v1
  v_accvgpr_write_b32 a74, v2
  v_accvgpr_write_b32 a75, v3
  v_accvgpr_write_b32 a76, v108
  v_accvgpr_write_b32 a77, v109
  v_accvgpr_write_b32 a78, v110
  v_accvgpr_write_b32 a79, v111
  v_accvgpr_write_b32 a80, v24
  v_accvgpr_write_b32 a81, v25
  v_accvgpr_write_b32 a82, v26
  v_accvgpr_write_b32 a83, v27
  v_mfma_f32_16x16x32_bf16 v[132:135], a[108:111], a[68:71], v[132:135]
  v_xor_b32 v6, 0x4000, v6
  s_waitcnt lgkmcnt(2)
  v_mfma_f32_16x16x32_bf16 v[112:115], a[112:115], a[72:75], v[112:115]
  v_xor_b32 v7, 0x4000, v7
  s_waitcnt lgkmcnt(0)
  s_barrier
  v_mfma_f32_16x16x32_bf16 v[116:119], a[112:115], a[76:79], v[116:119]
  ds_read_b128 a[96:99], v4 offset:0
  v_cvt_pk_bf16_f32 v0, v56, v57
  v_mfma_f32_16x16x32_bf16 v[120:123], a[112:115], a[80:83], v[120:123]
  ds_read_b128 a[100:103], v5 offset:0
  v_cvt_pk_bf16_f32 v1, v58, v59
  v_mfma_f32_16x16x32_bf16 v[124:127], a[116:119], a[72:75], v[124:127]
  ds_read_b128 a[104:107], v6 offset:0
  v_cvt_pk_bf16_f32 v2, v68, v69
  v_mfma_f32_16x16x32_bf16 v[128:131], a[116:119], a[76:79], v[128:131]
  ds_read_b128 a[108:111], v7 offset:0
  v_cvt_pk_bf16_f32 v3, v70, v71
  v_cvt_pk_bf16_f32 v108, v60, v61
  v_cvt_pk_bf16_f32 v109, v62, v63
  v_cvt_pk_bf16_f32 v110, v72, v73
  v_cvt_pk_bf16_f32 v111, v74, v75
  v_cvt_pk_bf16_f32 v24, v64, v65
  v_cvt_pk_bf16_f32 v25, v66, v67
  v_cvt_pk_bf16_f32 v26, v76, v77
  v_cvt_pk_bf16_f32 v27, v78, v79
  v_permlane32_swap_b32 v0, v2
  v_permlane32_swap_b32 v1, v3
  v_permlane32_swap_b32 v108, v110
  v_permlane32_swap_b32 v109, v111
  v_permlane32_swap_b32 v24, v26
  v_permlane32_swap_b32 v25, v27
  v_permlane16_swap_b32 v0, v2
  v_permlane16_swap_b32 v1, v3
  v_permlane16_swap_b32 v108, v110
  v_permlane16_swap_b32 v109, v111
  v_permlane16_swap_b32 v24, v26
  v_permlane16_swap_b32 v25, v27
  v_accvgpr_write_b32 a84, v0
  v_accvgpr_write_b32 a85, v1
  v_accvgpr_write_b32 a86, v2
  v_accvgpr_write_b32 a87, v3
  v_accvgpr_write_b32 a88, v108
  v_accvgpr_write_b32 a89, v109
  v_accvgpr_write_b32 a90, v110
  v_accvgpr_write_b32 a91, v111
  v_accvgpr_write_b32 a92, v24
  v_accvgpr_write_b32 a93, v25
  v_accvgpr_write_b32 a94, v26
  v_accvgpr_write_b32 a95, v27
  v_mfma_f32_16x16x32_bf16 v[132:135], a[116:119], a[80:83], v[132:135]
  ds_read_b128 a[112:115], v4 offset:256
  v_mfma_f32_16x16x32_bf16 v[112:115], a[120:123], a[84:87], v[112:115]
  v_mfma_f32_16x16x32_bf16 v[116:119], a[120:123], a[88:91], v[116:119]
  v_mfma_f32_16x16x32_bf16 v[120:123], a[120:123], a[92:95], v[120:123]
  v_mfma_f32_16x16x32_bf16 v[124:127], a[124:127], a[84:87], v[124:127]
  v_mfma_f32_16x16x32_bf16 v[128:131], a[124:127], a[88:91], v[128:131]
  v_mfma_f32_16x16x32_bf16 v[132:135], a[124:127], a[92:95], v[132:135]
  s_waitcnt lgkmcnt(3)
  v_mfma_f32_16x16x32_bf16 v[32:35], a[96:99], a[0:3], 0
  ds_read_b128 a[116:119], v5 offset:256
  s_mov_b32 m0, s15
  v_mfma_f32_16x16x32_bf16 v[36:39], a[96:99], a[4:7], 0
  s_xor_b32 s15, s15, 0x10000
  buffer_load_dwordx4 v16, s[32:35], s57 offen offset:0 nt lds
  v_mfma_f32_16x16x32_bf16 v[40:43], a[96:99], a[8:11], 0
  v_mfma_f32_16x16x32_bf16 v[32:35], a[100:103], a[12:15], v[32:35]
  ds_read_b128 a[120:123], v6 offset:256
  v_mfma_f32_16x16x32_bf16 v[36:39], a[100:103], a[16:19], v[36:39]
  v_mfma_f32_16x16x32_bf16 v[40:43], a[100:103], a[20:23], v[40:43]
  buffer_load_dwordx4 v17, s[32:35], s57 offen offset:1024 nt lds
  s_waitcnt lgkmcnt(3)
  v_mfma_f32_16x16x32_bf16 v[32:35], a[104:107], a[24:27], v[32:35]
  ds_read_b128 a[124:127], v7 offset:256
  v_max3_f32 v136, v112, v113, v114
  v_mfma_f32_16x16x32_bf16 v[36:39], a[104:107], a[28:31], v[36:39]
  v_max3_f32 v136, v136, v115, v124
  v_max3_f32 v136, v136, v125, v126
  v_mfma_f32_16x16x32_bf16 v[40:43], a[104:107], a[32:35], v[40:43]
  v_max_f32 v136, v136, v127
  v_max3_f32 v138, v116, v117, v118
  v_mfma_f32_16x16x32_bf16 v[32:35], a[108:111], a[36:39], v[32:35]
  ds_read_b128 a[96:99], v4 offset:8192
  buffer_load_dwordx4 v18, s[32:35], s57 offen offset:2048 nt lds
  v_mfma_f32_16x16x32_bf16 v[36:39], a[108:111], a[40:43], v[36:39]
  v_mov_b32 v137, v136
  s_nop 1
  v_permlane32_swap_b32 v136, v137
  v_mfma_f32_16x16x32_bf16 v[40:43], a[108:111], a[44:47], v[40:43]
  v_max_f32 v136, v136, v137
  s_waitcnt lgkmcnt(3)
  v_mfma_f32_16x16x32_bf16 v[32:35], a[112:115], a[48:51], v[32:35]
  ds_read_b128 a[100:103], v5 offset:8192
  v_max3_f32 v138, v138, v119, v128
  v_mfma_f32_16x16x32_bf16 v[36:39], a[112:115], a[52:55], v[36:39]
  v_mov_b32 v137, v136
  s_nop 1
  v_permlane16_swap_b32 v136, v137
  v_mfma_f32_16x16x32_bf16 v[40:43], a[112:115], a[56:59], v[40:43]
  v_max_f32 v136, v136, v137
  v_mul_f32 v23, s63, v136
  v_mfma_f32_16x16x32_bf16 v[32:35], a[116:119], a[60:63], v[32:35]
  ds_read_b128 a[104:107], v6 offset:8192
  v_fma_f32 v144, v112, s63, -v23
  v_mfma_f32_16x16x32_bf16 v[36:39], a[116:119], a[64:67], v[36:39]
  v_fma_f32 v145, v113, s63, -v23
  v_fma_f32 v146, v114, s63, -v23
  v_mfma_f32_16x16x32_bf16 v[40:43], a[116:119], a[68:71], v[40:43]
  v_fma_f32 v147, v115, s63, -v23
  s_waitcnt lgkmcnt(3)
  v_mfma_f32_16x16x32_bf16 v[32:35], a[120:123], a[72:75], v[32:35]
  ds_read_b128 a[108:111], v7 offset:8192
  v_max3_f32 v138, v138, v129, v130
  v_mfma_f32_16x16x32_bf16 v[36:39], a[120:123], a[76:79], v[36:39]
  v_exp_f32 v144, v144
  v_mfma_f32_16x16x32_bf16 v[40:43], a[120:123], a[80:83], v[40:43]
  v_exp_f32 v145, v145
  v_mfma_f32_16x16x32_bf16 v[32:35], a[124:127], a[84:87], v[32:35]
  ds_read_b128 a[112:115], v4 offset:8448
  v_max_f32 v138, v138, v131
  v_mfma_f32_16x16x32_bf16 v[36:39], a[124:127], a[88:91], v[36:39]
  v_exp_f32 v146, v146
  v_mfma_f32_16x16x32_bf16 v[40:43], a[124:127], a[92:95], v[40:43]
  v_max3_f32 v140, v120, v121, v122
  s_waitcnt lgkmcnt(3)
  v_mfma_f32_16x16x32_bf16 v[44:47], a[96:99], a[0:3], 0
  ds_read_b128 a[116:119], v5 offset:8448
  v_max3_f32 v140, v140, v123, v132
  v_mfma_f32_16x16x32_bf16 v[48:51], a[96:99], a[4:7], 0
  v_exp_f32 v147, v147
  v_mfma_f32_16x16x32_bf16 v[52:55], a[96:99], a[8:11], 0
  v_add_f32 v20, v144, v145
  v_cvt_pk_bf16_f32 v56, v144, v145
  v_mfma_f32_16x16x32_bf16 v[44:47], a[100:103], a[12:15], v[44:47]
  ds_read_b128 a[120:123], v6 offset:8448
  v_add_f32 v20, v20, v146
  v_cvt_pk_bf16_f32 v57, v146, v147
  v_add_f32 v20, v20, v147
  v_fma_f32 v144, v124, s63, -v23
  v_fma_f32 v145, v125, s63, -v23
  v_fma_f32 v146, v126, s63, -v23
  v_fma_f32 v147, v127, s63, -v23
  v_exp_f32 v144, v144
  v_exp_f32 v145, v145
  v_exp_f32 v146, v146
  v_exp_f32 v147, v147
  v_add_f32 v20, v20, v144
  v_cvt_pk_bf16_f32 v58, v144, v145
  v_add_f32 v20, v20, v145
  v_add_f32 v20, v20, v146
  v_cvt_pk_bf16_f32 v59, v146, v147
  v_add_f32 v20, v20, v147
  v_mov_b32 v139, v138
  s_nop 1
  v_permlane32_swap_b32 v138, v139
  v_max_f32 v138, v138, v139
  v_mov_b32 v139, v138
  s_nop 1
  v_permlane16_swap_b32 v138, v139
  v_max_f32 v138, v138, v139
  v_mul_f32 v24, s63, v138
  v_fma_f32 v148, v116, s63, -v24
  v_fma_f32 v149, v117, s63, -v24
  v_fma_f32 v150, v118, s63, -v24
  v_fma_f32 v151, v119, s63, -v24
  v_exp_f32 v148, v148
  v_exp_f32 v149, v149
  v_exp_f32 v150, v150
  v_exp_f32 v151, v151
  v_add_f32 v21, v148, v149
  v_cvt_pk_bf16_f32 v60, v148, v149
  v_add_f32 v21, v21, v150
  v_cvt_pk_bf16_f32 v61, v150, v151
  v_add_f32 v21, v21, v151
  v_fma_f32 v148, v128, s63, -v24
  v_fma_f32 v149, v129, s63, -v24
  v_fma_f32 v150, v130, s63, -v24
  v_fma_f32 v151, v131, s63, -v24
  v_exp_f32 v148, v148
  v_exp_f32 v149, v149
  v_exp_f32 v150, v150
  v_exp_f32 v151, v151
  v_add_f32 v21, v21, v148
  v_cvt_pk_bf16_f32 v62, v148, v149
  v_add_f32 v21, v21, v149
  v_add_f32 v21, v21, v150
  v_cvt_pk_bf16_f32 v63, v150, v151
  v_add_f32 v21, v21, v151
  v_max3_f32 v140, v140, v133, v134
  v_max_f32 v140, v140, v135
  v_mov_b32 v141, v140
  s_nop 1
  v_permlane32_swap_b32 v140, v141
  v_max_f32 v140, v140, v141
  v_mov_b32 v141, v140
  s_nop 1
  v_permlane16_swap_b32 v140, v141
  v_max_f32 v140, v140, v141
  v_mul_f32 v25, s63, v140
  v_fma_f32 v152, v120, s63, -v25
  v_fma_f32 v153, v121, s63, -v25
  v_fma_f32 v154, v122, s63, -v25
  v_fma_f32 v155, v123, s63, -v25
  v_exp_f32 v152, v152
  v_exp_f32 v153, v153
  v_exp_f32 v154, v154
  v_exp_f32 v155, v155
  v_add_f32 v22, v152, v153
  v_cvt_pk_bf16_f32 v64, v152, v153
  v_add_f32 v22, v22, v154
  v_cvt_pk_bf16_f32 v65, v154, v155
  v_add_f32 v22, v22, v155
  v_fma_f32 v152, v132, s63, -v25
  v_fma_f32 v153, v133, s63, -v25
  v_fma_f32 v154, v134, s63, -v25
  v_fma_f32 v155, v135, s63, -v25
  v_exp_f32 v152, v152
  v_exp_f32 v153, v153
  v_exp_f32 v154, v154
  v_exp_f32 v155, v155
  v_add_f32 v22, v22, v152
  v_cvt_pk_bf16_f32 v66, v152, v153
  v_add_f32 v22, v22, v153
  v_add_f32 v22, v22, v154
  v_cvt_pk_bf16_f32 v67, v154, v155
  v_add_f32 v22, v22, v155
  v_mfma_f32_16x16x32_bf16 v[48:51], a[100:103], a[16:19], v[48:51]
  v_fma_f32 v0, v32, s63, -v23
  v_fma_f32 v1, v33, s63, -v23
  v_mfma_f32_16x16x32_bf16 v[52:55], a[100:103], a[20:23], v[52:55]
  v_fma_f32 v2, v34, s63, -v23
  s_waitcnt lgkmcnt(3)
  v_mfma_f32_16x16x32_bf16 v[44:47], a[104:107], a[24:27], v[44:47]
  ds_read_b128 a[124:127], v7 offset:8448
  v_fma_f32 v3, v35, s63, -v23
  v_mfma_f32_16x16x32_bf16 v[48:51], a[104:107], a[28:31], v[48:51]
  v_exp_f32 v0, v0
  v_mfma_f32_16x16x32_bf16 v[52:55], a[104:107], a[32:35], v[52:55]
  v_exp_f32 v1, v1
  v_mfma_f32_16x16x32_bf16 v[44:47], a[108:111], a[36:39], v[44:47]
  v_xor_b32 v4, 0x10000, v4
  v_xor_b32 v5, 0x10000, v5
  v_mfma_f32_16x16x32_bf16 v[48:51], a[108:111], a[40:43], v[48:51]
  v_xor_b32 v6, 0x10000, v6
  v_xor_b32 v7, 0x10000, v7
  v_mfma_f32_16x16x32_bf16 v[52:55], a[108:111], a[44:47], v[52:55]
  v_fma_f32 v96, v36, s63, -v24
  s_waitcnt lgkmcnt(2)
  v_mfma_f32_16x16x32_bf16 v[44:47], a[112:115], a[48:51], v[44:47]
  s_waitcnt lgkmcnt(0)
  s_barrier
  v_mfma_f32_16x16x32_bf16 v[48:51], a[112:115], a[52:55], v[48:51]
  ds_read_b64_tr_b16 a[96:97], v8 offset:0
  buffer_load_dwordx4 v19, s[32:35], s57 offen offset:3072 nt lds
  v_mfma_f32_16x16x32_bf16 v[52:55], a[112:115], a[56:59], v[52:55]
  ds_read_b64_tr_b16 a[98:99], v8 offset:8192
  s_add_u32 s57, s57, 16384
  v_mfma_f32_16x16x32_bf16 v[44:47], a[116:119], a[60:63], v[44:47]
  ds_read_b64_tr_b16 a[100:101], v9 offset:0
  v_fma_f32 v97, v37, s63, -v24
  v_mfma_f32_16x16x32_bf16 v[48:51], a[116:119], a[64:67], v[48:51]
  ds_read_b64_tr_b16 a[102:103], v9 offset:8192
  v_fma_f32 v98, v38, s63, -v24
  v_mfma_f32_16x16x32_bf16 v[52:55], a[116:119], a[68:71], v[52:55]
  ds_read_b64_tr_b16 a[104:105], v10 offset:0
  v_fma_f32 v99, v39, s63, -v24
  v_mfma_f32_16x16x32_bf16 v[44:47], a[120:123], a[72:75], v[44:47]
  ds_read_b64_tr_b16 a[106:107], v10 offset:8192
  v_fma_f32 v108, v40, s63, -v25
  v_mfma_f32_16x16x32_bf16 v[48:51], a[120:123], a[76:79], v[48:51]
  ds_read_b64_tr_b16 a[108:109], v11 offset:0
  v_fma_f32 v109, v41, s63, -v25
  v_mfma_f32_16x16x32_bf16 v[52:55], a[120:123], a[80:83], v[52:55]
  ds_read_b64_tr_b16 a[110:111], v11 offset:8192
  v_fma_f32 v110, v42, s63, -v25
  v_mfma_f32_16x16x32_bf16 v[44:47], a[124:127], a[84:87], v[44:47]
  ds_read_b64_tr_b16 a[112:113], v12 offset:0
  v_fma_f32 v111, v43, s63, -v25
  v_mfma_f32_16x16x32_bf16 v[48:51], a[124:127], a[88:91], v[48:51]
  ds_read_b64_tr_b16 a[114:115], v12 offset:8192
  v_mfma_f32_16x16x32_bf16 v[52:55], a[124:127], a[92:95], v[52:55]
  v_exp_f32 v2, v2
  v_exp_f32 v3, v3
  v_add_f32 v26, v0, v1
  v_cvt_pk_bf16_f32 v68, v0, v1
  v_add_f32 v26, v26, v2
  v_cvt_pk_bf16_f32 v69, v2, v3
  v_add_f32 v26, v26, v3
  v_exp_f32 v96, v96
  v_exp_f32 v97, v97
  v_exp_f32 v98, v98
  v_exp_f32 v99, v99
  v_add_f32 v27, v96, v97
  v_cvt_pk_bf16_f32 v72, v96, v97
  v_add_f32 v27, v27, v98
  v_cvt_pk_bf16_f32 v73, v98, v99
  v_add_f32 v27, v27, v99
  v_exp_f32 v108, v108
  v_exp_f32 v109, v109
  v_exp_f32 v110, v110
  v_exp_f32 v111, v111
  v_add_f32 v28, v108, v109
  v_cvt_pk_bf16_f32 v76, v108, v109
  v_add_f32 v28, v28, v110
  v_cvt_pk_bf16_f32 v77, v110, v111
  v_add_f32 v28, v28, v111
  s_waitcnt lgkmcnt(6)
  v_mfma_f32_16x16x32_bf16 v[112:115], a[96:99], v[56:59], 0
  ds_read_b64_tr_b16 a[116:117], v13 offset:0
  s_mov_b32 m0, s14
  v_mfma_f32_16x16x32_bf16 v[116:119], a[96:99], v[60:63], 0
  ds_read_b64_tr_b16 a[118:119], v13 offset:8192
  s_xor_b32 s14, s14, 0x10000
  v_mfma_f32_16x16x32_bf16 v[120:123], a[96:99], v[64:67], 0
  buffer_load_dwordx4 v16, s[28:31], s56 offen offset:0 nt lds
  v_mfma_f32_16x16x32_bf16 v[124:127], a[100:103], v[56:59], 0
  ds_read_b64_tr_b16 a[120:121], v14 offset:0
  v_fma_f32 v0, v44, s63, -v23
  v_mfma_f32_16x16x32_bf16 v[128:131], a[100:103], v[60:63], 0
  ds_read_b64_tr_b16 a[122:123], v14 offset:8192
  v_fma_f32 v1, v45, s63, -v23
  v_mfma_f32_16x16x32_bf16 v[132:135], a[100:103], v[64:67], 0
  v_fma_f32 v2, v46, s63, -v23
  s_waitcnt lgkmcnt(6)
  v_mfma_f32_16x16x32_bf16 v[136:139], a[104:107], v[56:59], 0
  ds_read_b64_tr_b16 a[124:125], v15 offset:0
  buffer_load_dwordx4 v17, s[28:31], s56 offen offset:1024 nt lds
  v_mfma_f32_16x16x32_bf16 v[140:143], a[104:107], v[60:63], 0
  ds_read_b64_tr_b16 a[126:127], v15 offset:8192
  v_fma_f32 v3, v47, s63, -v23
  v_mfma_f32_16x16x32_bf16 v[144:147], a[104:107], v[64:67], 0
  v_exp_f32 v0, v0
  v_mfma_f32_16x16x32_bf16 v[148:151], a[108:111], v[56:59], 0
  ds_read_b64_tr_b16 a[96:97], v8 offset:256
  v_fma_f32 v96, v48, s63, -v24
  v_mfma_f32_16x16x32_bf16 v[152:155], a[108:111], v[60:63], 0
  ds_read_b64_tr_b16 a[98:99], v8 offset:8448
  buffer_load_dwordx4 v18, s[28:31], s56 offen offset:2048 nt lds
  v_mfma_f32_16x16x32_bf16 v[156:159], a[108:111], v[64:67], 0
  v_fma_f32 v97, v49, s63, -v24
  s_waitcnt lgkmcnt(6)
  v_mfma_f32_16x16x32_bf16 v[160:163], a[112:115], v[56:59], 0
  ds_read_b64_tr_b16 a[100:101], v9 offset:256
  v_fma_f32 v98, v50, s63, -v24
  v_mfma_f32_16x16x32_bf16 v[164:167], a[112:115], v[60:63], 0
  ds_read_b64_tr_b16 a[102:103], v9 offset:8448
  v_fma_f32 v99, v51, s63, -v24
  v_mfma_f32_16x16x32_bf16 v[168:171], a[112:115], v[64:67], 0
  buffer_load_dwordx4 v19, s[28:31], s56 offen offset:3072 nt lds
  v_mfma_f32_16x16x32_bf16 v[172:175], a[116:119], v[56:59], 0
  ds_read_b64_tr_b16 a[104:105], v10 offset:256
  v_fma_f32 v108, v52, s63, -v25
  v_mfma_f32_16x16x32_bf16 v[176:179], a[116:119], v[60:63], 0
  ds_read_b64_tr_b16 a[106:107], v10 offset:8448
  v_fma_f32 v109, v53, s63, -v25
  v_mfma_f32_16x16x32_bf16 v[180:183], a[116:119], v[64:67], 0
  v_fma_f32 v110, v54, s63, -v25
  s_waitcnt lgkmcnt(6)
  v_mfma_f32_16x16x32_bf16 v[184:187], a[120:123], v[56:59], 0
  ds_read_b64_tr_b16 a[108:109], v11 offset:256
  v_fma_f32 v111, v55, s63, -v25
  v_mfma_f32_16x16x32_bf16 v[188:191], a[120:123], v[60:63], 0
  ds_read_b64_tr_b16 a[110:111], v11 offset:8448
  v_mfma_f32_16x16x32_bf16 v[192:195], a[120:123], v[64:67], 0
  v_exp_f32 v1, v1
  v_mfma_f32_16x16x32_bf16 v[196:199], a[124:127], v[56:59], 0
  ds_read_b64_tr_b16 a[112:113], v12 offset:256
  v_mfma_f32_16x16x32_bf16 v[200:203], a[124:127], v[60:63], 0
  ds_read_b64_tr_b16 a[114:115], v12 offset:8448
  v_mfma_f32_16x16x32_bf16 v[204:207], a[124:127], v[64:67], 0
  s_waitcnt lgkmcnt(6)
  v_mfma_f32_16x16x32_bf16 v[208:211], a[96:99], v[56:59], 0
  ds_read_b64_tr_b16 a[116:117], v13 offset:256
  v_mfma_f32_16x16x32_bf16 v[212:215], a[96:99], v[60:63], 0
  ds_read_b64_tr_b16 a[118:119], v13 offset:8448
  v_mfma_f32_16x16x32_bf16 v[216:219], a[96:99], v[64:67], 0
  v_exp_f32 v2, v2
  v_mfma_f32_16x16x32_bf16 v[220:223], a[100:103], v[56:59], 0
  ds_read_b64_tr_b16 a[120:121], v14 offset:256
  v_mfma_f32_16x16x32_bf16 v[224:227], a[100:103], v[60:63], 0
  ds_read_b64_tr_b16 a[122:123], v14 offset:8448
  v_mfma_f32_16x16x32_bf16 v[228:231], a[100:103], v[64:67], 0
  s_waitcnt lgkmcnt(6)
  v_mfma_f32_16x16x32_bf16 v[232:235], a[104:107], v[56:59], 0
  ds_read_b64_tr_b16 a[124:125], v15 offset:256
  v_mfma_f32_16x16x32_bf16 v[236:239], a[104:107], v[60:63], 0
  ds_read_b64_tr_b16 a[126:127], v15 offset:8448
  v_mfma_f32_16x16x32_bf16 v[240:243], a[104:107], v[64:67], 0
  v_exp_f32 v3, v3
  v_mfma_f32_16x16x32_bf16 v[244:247], a[108:111], v[56:59], 0
  v_xor_b32 v8, 0x18000, v8
  v_xor_b32 v9, 0x18000, v9
  v_mfma_f32_16x16x32_bf16 v[248:251], a[108:111], v[60:63], 0
  v_xor_b32 v10, 0x18000, v10
  v_xor_b32 v11, 0x18000, v11
  v_mfma_f32_16x16x32_bf16 v[252:255], a[108:111], v[64:67], 0
  v_xor_b32 v12, 0x18000, v12
  s_waitcnt lgkmcnt(4)
  v_mfma_f32_16x16x32_bf16 a[160:163], a[112:115], v[56:59], 0
  v_xor_b32 v13, 0x18000, v13
  v_xor_b32 v14, 0x18000, v14
  v_xor_b32 v15, 0x18000, v15
  s_waitcnt vmcnt(4) lgkmcnt(0)
  s_barrier
  v_mfma_f32_16x16x32_bf16 a[164:167], a[112:115], v[60:63], 0
  ds_read_b128 a[96:99], v4 offset:0
  s_add_u32 s56, s56, 16384
  v_mfma_f32_16x16x32_bf16 a[168:171], a[112:115], v[64:67], 0
  ds_read_b128 a[100:103], v5 offset:0
  v_add_f32 v26, v26, v0
  v_mfma_f32_16x16x32_bf16 a[172:175], a[116:119], v[56:59], 0
  ds_read_b128 a[104:107], v6 offset:0
  v_cvt_pk_bf16_f32 v70, v0, v1
  v_mfma_f32_16x16x32_bf16 a[176:179], a[116:119], v[60:63], 0
  ds_read_b128 a[108:111], v7 offset:0
  v_add_f32 v26, v26, v1
  v_mfma_f32_16x16x32_bf16 a[180:183], a[116:119], v[64:67], 0
  ds_read_b128 a[112:115], v4 offset:256
  v_add_f32 v26, v26, v2
  v_mfma_f32_16x16x32_bf16 a[184:187], a[120:123], v[56:59], 0
  v_cvt_pk_bf16_f32 v71, v2, v3
  v_add_f32 v26, v26, v3
  v_mfma_f32_16x16x32_bf16 a[188:191], a[120:123], v[60:63], 0
  v_exp_f32 v96, v96
  v_mfma_f32_16x16x32_bf16 a[192:195], a[120:123], v[64:67], 0
  v_exp_f32 v97, v97
  v_mfma_f32_16x16x32_bf16 a[196:199], a[124:127], v[56:59], 0
  v_exp_f32 v98, v98
  v_mfma_f32_16x16x32_bf16 a[200:203], a[124:127], v[60:63], 0
  v_exp_f32 v99, v99
  v_mfma_f32_16x16x32_bf16 a[204:207], a[124:127], v[64:67], 0
  v_add_f32 v27, v27, v96
  v_cvt_pk_bf16_f32 v74, v96, v97
  v_add_f32 v27, v27, v97
  v_add_f32 v27, v27, v98
  v_cvt_pk_bf16_f32 v75, v98, v99
  v_add_f32 v27, v27, v99
  v_exp_f32 v108, v108
  v_exp_f32 v109, v109
  v_exp_f32 v110, v110
  v_exp_f32 v111, v111
  v_add_f32 v28, v28, v108
  v_cvt_pk_bf16_f32 v78, v108, v109
  v_add_f32 v28, v28, v109
  v_add_f32 v28, v28, v110
  v_cvt_pk_bf16_f32 v79, v110, v111
  v_add_f32 v28, v28, v111
  v_max3_f32 v29, v26, v27, v28
  v_cmp_lt_f32 vcc, 0x44800000, v29
  s_nop 0
  s_cbranch_vccz L_ok14
  s_swappc_b64 s[70:71], s[74:75]
L_ok14:
  v_add_f32 v20, v20, v26
  v_add_f32 v21, v21, v27
  v_add_f32 v22, v22, v28
  s_waitcnt lgkmcnt(3)
  v_mfma_f32_16x16x32_bf16 v[32:35], a[96:99], a[0:3], 0
  ds_read_b128 a[116:119], v5 offset:256
  s_mov_b32 m0, s15
  v_mfma_f32_16x16x32_bf16 v[36:39], a[96:99], a[4:7], 0
  s_xor_b32 s15, s15, 0x18000
  buffer_load_dwordx4 v16, s[32:35], s57 offen offset:0 nt lds
  v_mfma_f32_16x16x32_bf16 v[40:43], a[96:99], a[8:11], 0
  v_mfma_f32_16x16x32_bf16 v[32:35], a[100:103], a[12:15], v[32:35]
  ds_read_b128 a[120:123], v6 offset:256
  v_mfma_f32_16x16x32_bf16 v[36:39], a[100:103], a[16:19], v[36:39]
  v_mfma_f32_16x16x32_bf16 v[40:43], a[100:103], a[20:23], v[40:43]
  buffer_load_dwordx4 v17, s[32:35], s57 offen offset:1024 nt lds
  s_waitcnt lgkmcnt(3)
  v_mfma_f32_16x16x32_bf16 v[32:35], a[104:107], a[24:27], v[32:35]
  ds_read_b128 a[124:127], v7 offset:256
  v_mfma_f32_16x16x32_bf16 v[36:39], a[104:107], a[28:31], v[36:39]
  v_mfma_f32_16x16x32_bf16 v[40:43], a[104:107], a[32:35], v[40:43]
  v_mfma_f32_16x16x32_bf16 v[32:35], a[108:111], a[36:39], v[32:35]
  ds_read_b128 a[96:99], v4 offset:8192
  buffer_load_dwordx4 v18, s[32:35], s57 offen offset:2048 nt lds
  v_mfma_f32_16x16x32_bf16 v[36:39], a[108:111], a[40:43], v[36:39]
  v_mfma_f32_16x16x32_bf16 v[40:43], a[108:111], a[44:47], v[40:43]
  s_waitcnt lgkmcnt(3)
  v_mfma_f32_16x16x32_bf16 v[32:35], a[112:115], a[48:51], v[32:35]
  ds_read_b128 a[100:103], v5 offset:8192
  v_mfma_f32_16x16x32_bf16 v[36:39], a[112:115], a[52:55], v[36:39]
  v_mfma_f32_16x16x32_bf16 v[40:43], a[112:115], a[56:59], v[40:43]
  v_mfma_f32_16x16x32_bf16 v[32:35], a[116:119], a[60:63], v[32:35]
  ds_read_b128 a[104:107], v6 offset:8192
  v_mfma_f32_16x16x32_bf16 v[36:39], a[116:119], a[64:67], v[36:39]
  v_mfma_f32_16x16x32_bf16 v[40:43], a[116:119], a[68:71], v[40:43]
  s_waitcnt lgkmcnt(3)
  v_mfma_f32_16x16x32_bf16 v[32:35], a[120:123], a[72:75], v[32:35]
  ds_read_b128 a[108:111], v7 offset:8192
  v_mfma_f32_16x16x32_bf16 v[36:39], a[120:123], a[76:79], v[36:39]
  v_mfma_f32_16x16x32_bf16 v[40:43], a[120:123], a[80:83], v[40:43]
  v_mfma_f32_16x16x32_bf16 v[32:35], a[124:127], a[84:87], v[32:35]
  ds_read_b128 a[112:115], v4 offset:8448
  v_mfma_f32_16x16x32_bf16 v[36:39], a[124:127], a[88:91], v[36:39]
  v_mfma_f32_16x16x32_bf16 v[40:43], a[124:127], a[92:95], v[40:43]
  s_waitcnt lgkmcnt(3)
  v_mfma_f32_16x16x32_bf16 v[44:47], a[96:99], a[0:3], 0
  ds_read_b128 a[116:119], v5 offset:8448
  v_mfma_f32_16x16x32_bf16 v[48:51], a[96:99], a[4:7], 0
  v_mfma_f32_16x16x32_bf16 v[52:55], a[96:99], a[8:11], 0
  v_mfma_f32_16x16x32_bf16 v[44:47], a[100:103], a[12:15], v[44:47]
  ds_read_b128 a[120:123], v6 offset:8448
  v_fma_f32 v0, v32, s63, -v23
  v_mfma_f32_16x16x32_bf16 v[48:51], a[100:103], a[16:19], v[48:51]
  v_fma_f32 v1, v33, s63, -v23
  v_fma_f32 v2, v34, s63, -v23
  v_mfma_f32_16x16x32_bf16 v[52:55], a[100:103], a[20:23], v[52:55]
  v_fma_f32 v3, v35, s63, -v23
  s_waitcnt lgkmcnt(3)
  v_mfma_f32_16x16x32_bf16 v[44:47], a[104:107], a[24:27], v[44:47]
  ds_read_b128 a[124:127], v7 offset:8448
  v_fma_f32 v96, v36, s63, -v24
  v_mfma_f32_16x16x32_bf16 v[48:51], a[104:107], a[28:31], v[48:51]
  v_exp_f32 v0, v0
  v_mfma_f32_16x16x32_bf16 v[52:55], a[104:107], a[32:35], v[52:55]
  v_exp_f32 v1, v1
  v_mfma_f32_16x16x32_bf16 v[44:47], a[108:111], a[36:39], v[44:47]
  v_xor_b32 v4, 0x18000, v4
  v_xor_b32 v5, 0x18000, v5
  v_mfma_f32_16x16x32_bf16 v[48:51], a[108:111], a[40:43], v[48:51]
  v_xor_b32 v6, 0x18000, v6
  v_xor_b32 v7, 0x18000, v7
  v_mfma_f32_16x16x32_bf16 v[52:55], a[108:111], a[44:47], v[52:55]
  v_fma_f32 v97, v37, s63, -v24
  s_waitcnt lgkmcnt(2)
  v_mfma_f32_16x16x32_bf16 v[44:47], a[112:115], a[48:51], v[44:47]
  s_waitcnt vmcnt(3) lgkmcnt(0)
  s_barrier
  v_mfma_f32_16x16x32_bf16 v[48:51], a[112:115], a[52:55], v[48:51]
  ds_read_b64_tr_b16 a[96:97], v8 offset:0
  buffer_load_dwordx4 v19, s[32:35], s57 offen offset:3072 nt lds
  v_mfma_f32_16x16x32_bf16 v[52:55], a[112:115], a[56:59], v[52:55]
  ds_read_b64_tr_b16 a[98:99], v8 offset:8192
  s_add_u32 s57, s57, 16384
  v_mfma_f32_16x16x32_bf16 v[44:47], a[116:119], a[60:63], v[44:47]
  ds_read_b64_tr_b16 a[100:101], v9 offset:0
  v_fma_f32 v98, v38, s63, -v24
  v_mfma_f32_16x16x32_bf16 v[48:51], a[116:119], a[64:67], v[48:51]
  ds_read_b64_tr_b16 a[102:103], v9 offset:8192
  v_fma_f32 v99, v39, s63, -v24
  v_mfma_f32_16x16x32_bf16 v[52:55], a[116:119], a[68:71], v[52:55]
  ds_read_b64_tr_b16 a[104:105], v10 offset:0
  v_fma_f32 v108, v40, s63, -v25
  v_mfma_f32_16x16x32_bf16 v[44:47], a[120:123], a[72:75], v[44:47]
  ds_read_b64_tr_b16 a[106:107], v10 offset:8192
  v_fma_f32 v109, v41, s63, -v25
  v_mfma_f32_16x16x32_bf16 v[48:51], a[120:123], a[76:79], v[48:51]
  ds_read_b64_tr_b16 a[108:109], v11 offset:0
  v_fma_f32 v110, v42, s63, -v25
  v_mfma_f32_16x16x32_bf16 v[52:55], a[120:123], a[80:83], v[52:55]
  ds_read_b64_tr_b16 a[110:111], v11 offset:8192
  v_fma_f32 v111, v43, s63, -v25
  v_mfma_f32_16x16x32_bf16 v[44:47], a[124:127], a[84:87], v[44:47]
  ds_read_b64_tr_b16 a[112:113], v12 offset:0
  v_mfma_f32_16x16x32_bf16 v[48:51], a[124:127], a[88:91], v[48:51]
  ds_read_b64_tr_b16 a[114:115], v12 offset:8192
  v_mfma_f32_16x16x32_bf16 v[52:55], a[124:127], a[92:95], v[52:55]
  v_exp_f32 v2, v2
  v_exp_f32 v3, v3
  v_add_f32 v26, v0, v1
  v_cvt_pk_bf16_f32 v56, v0, v1
  v_add_f32 v26, v26, v2
  v_cvt_pk_bf16_f32 v57, v2, v3
  v_add_f32 v26, v26, v3
  v_exp_f32 v96, v96
  v_exp_f32 v97, v97
  v_exp_f32 v98, v98
  v_exp_f32 v99, v99
  v_add_f32 v27, v96, v97
  v_cvt_pk_bf16_f32 v60, v96, v97
  v_add_f32 v27, v27, v98
  v_cvt_pk_bf16_f32 v61, v98, v99
  v_add_f32 v27, v27, v99
  v_exp_f32 v108, v108
  v_exp_f32 v109, v109
  v_exp_f32 v110, v110
  v_exp_f32 v111, v111
  v_add_f32 v28, v108, v109
  v_cvt_pk_bf16_f32 v64, v108, v109
  v_add_f32 v28, v28, v110
  v_cvt_pk_bf16_f32 v65, v110, v111
  v_add_f32 v28, v28, v111
  s_waitcnt lgkmcnt(6)
  v_mfma_f32_16x16x32_bf16 v[112:115], a[96:99], v[68:71], v[112:115]
  ds_read_b64_tr_b16 a[116:117], v13 offset:0
  s_mov_b32 m0, s14
  v_mfma_f32_16x16x32_bf16 v[116:119], a[96:99], v[72:75], v[116:119]
  ds_read_b64_tr_b16 a[118:119], v13 offset:8192
  s_xor_b32 s14, s14, 0x18000
  v_mfma_f32_16x16x32_bf16 v[120:123], a[96:99], v[76:79], v[120:123]
  buffer_load_dwordx4 v16, s[28:31], s56 offen offset:0 nt lds
  v_mfma_f32_16x16x32_bf16 v[124:127], a[100:103], v[68:71], v[124:127]
  ds_read_b64_tr_b16 a[120:121], v14 offset:0
  v_fma_f32 v0, v44, s63, -v23
  v_mfma_f32_16x16x32_bf16 v[128:131], a[100:103], v[72:75], v[128:131]
  ds_read_b64_tr_b16 a[122:123], v14 offset:8192
  v_fma_f32 v1, v45, s63, -v23
  v_mfma_f32_16x16x32_bf16 v[132:135], a[100:103], v[76:79], v[132:135]
  v_fma_f32 v2, v46, s63, -v23
  s_waitcnt lgkmcnt(6)
  v_mfma_f32_16x16x32_bf16 v[136:139], a[104:107], v[68:71], v[136:139]
  ds_read_b64_tr_b16 a[124:125], v15 offset:0
  buffer_load_dwordx4 v17, s[28:31], s56 offen offset:1024 nt lds
  v_mfma_f32_16x16x32_bf16 v[140:143], a[104:107], v[72:75], v[140:143]
  ds_read_b64_tr_b16 a[126:127], v15 offset:8192
  v_fma_f32 v3, v47, s63, -v23
  v_mfma_f32_16x16x32_bf16 v[144:147], a[104:107], v[76:79], v[144:147]
  v_exp_f32 v0, v0
  v_mfma_f32_16x16x32_bf16 v[148:151], a[108:111], v[68:71], v[148:151]
  ds_read_b64_tr_b16 a[96:97], v8 offset:256
  v_fma_f32 v96, v48, s63, -v24
  v_mfma_f32_16x16x32_bf16 v[152:155], a[108:111], v[72:75], v[152:155]
  ds_read_b64_tr_b16 a[98:99], v8 offset:8448
  buffer_load_dwordx4 v18, s[28:31], s56 offen offset:2048 nt lds
  v_mfma_f32_16x16x32_bf16 v[156:159], a[108:111], v[76:79], v[156:159]
  v_fma_f32 v97, v49, s63, -v24
  s_waitcnt lgkmcnt(6)
  v_mfma_f32_16x16x32_bf16 v[160:163], a[112:115], v[68:71], v[160:163]
  ds_read_b64_tr_b16 a[100:101], v9 offset:256
  v_fma_f32 v98, v50, s63, -v24
  v_mfma_f32_16x16x32_bf16 v[164:167], a[112:115], v[72:75], v[164:167]
  ds_read_b64_tr_b16 a[102:103], v9 offset:8448
  v_fma_f32 v99, v51, s63, -v24
  v_mfma_f32_16x16x32_bf16 v[168:171], a[112:115], v[76:79], v[168:171]
  buffer_load_dwordx4 v19, s[28:31], s56 offen offset:3072 nt lds
  v_mfma_f32_16x16x32_bf16 v[172:175], a[116:119], v[68:71], v[172:175]
  ds_read_b64_tr_b16 a[104:105], v10 offset:256
  v_fma_f32 v108, v52, s63, -v25
  v_mfma_f32_16x16x32_bf16 v[176:179], a[116:119], v[72:75], v[176:179]
  ds_read_b64_tr_b16 a[106:107], v10 offset:8448
  v_fma_f32 v109, v53, s63, -v25
  v_mfma_f32_16x16x32_bf16 v[180:183], a[116:119], v[76:79], v[180:183]
  v_fma_f32 v110, v54, s63, -v25
  s_waitcnt lgkmcnt(6)
  v_mfma_f32_16x16x32_bf16 v[184:187], a[120:123], v[68:71], v[184:187]
  ds_read_b64_tr_b16 a[108:109], v11 offset:256
  v_fma_f32 v111, v55, s63, -v25
  v_mfma_f32_16x16x32_bf16 v[188:191], a[120:123], v[72:75], v[188:191]
  ds_read_b64_tr_b16 a[110:111], v11 offset:8448
  v_mfma_f32_16x16x32_bf16 v[192:195], a[120:123], v[76:79], v[192:195]
  v_exp_f32 v1, v1
  v_mfma_f32_16x16x32_bf16 v[196:199], a[124:127], v[68:71], v[196:199]
  ds_read_b64_tr_b16 a[112:113], v12 offset:256
  v_mfma_f32_16x16x32_bf16 v[200:203], a[124:127], v[72:75], v[200:203]
  ds_read_b64_tr_b16 a[114:115], v12 offset:8448
  v_mfma_f32_16x16x32_bf16 v[204:207], a[124:127], v[76:79], v[204:207]
  s_waitcnt lgkmcnt(6)
  v_mfma_f32_16x16x32_bf16 v[208:211], a[96:99], v[68:71], v[208:211]
  ds_read_b64_tr_b16 a[116:117], v13 offset:256
  v_mfma_f32_16x16x32_bf16 v[212:215], a[96:99], v[72:75], v[212:215]
  ds_read_b64_tr_b16 a[118:119], v13 offset:8448
  v_mfma_f32_16x16x32_bf16 v[216:219], a[96:99], v[76:79], v[216:219]
  v_exp_f32 v2, v2
  v_mfma_f32_16x16x32_bf16 v[220:223], a[100:103], v[68:71], v[220:223]
  ds_read_b64_tr_b16 a[120:121], v14 offset:256
  v_mfma_f32_16x16x32_bf16 v[224:227], a[100:103], v[72:75], v[224:227]
  ds_read_b64_tr_b16 a[122:123], v14 offset:8448
  v_mfma_f32_16x16x32_bf16 v[228:231], a[100:103], v[76:79], v[228:231]
  s_waitcnt lgkmcnt(6)
  v_mfma_f32_16x16x32_bf16 v[232:235], a[104:107], v[68:71], v[232:235]
  ds_read_b64_tr_b16 a[124:125], v15 offset:256
  v_mfma_f32_16x16x32_bf16 v[236:239], a[104:107], v[72:75], v[236:239]
  ds_read_b64_tr_b16 a[126:127], v15 offset:8448
  v_mfma_f32_16x16x32_bf16 v[240:243], a[104:107], v[76:79], v[240:243]
  v_exp_f32 v3, v3
  v_mfma_f32_16x16x32_bf16 v[244:247], a[108:111], v[68:71], v[244:247]
  v_xor_b32 v8, 0x10000, v8
  v_xor_b32 v9, 0x10000, v9
  v_mfma_f32_16x16x32_bf16 v[248:251], a[108:111], v[72:75], v[248:251]
  v_xor_b32 v10, 0x10000, v10
  v_xor_b32 v11, 0x10000, v11
  v_mfma_f32_16x16x32_bf16 v[252:255], a[108:111], v[76:79], v[252:255]
  v_xor_b32 v12, 0x10000, v12
  s_waitcnt lgkmcnt(4)
  v_mfma_f32_16x16x32_bf16 a[160:163], a[112:115], v[68:71], a[160:163]
  v_xor_b32 v13, 0x10000, v13
  v_xor_b32 v14, 0x10000, v14
  v_xor_b32 v15, 0x10000, v15
  s_waitcnt vmcnt(4) lgkmcnt(0)
  s_barrier
  v_mfma_f32_16x16x32_bf16 a[164:167], a[112:115], v[72:75], a[164:167]
  ds_read_b128 a[96:99], v4 offset:0
  s_add_u32 s56, s56, 16384
  v_mfma_f32_16x16x32_bf16 a[168:171], a[112:115], v[76:79], a[168:171]
  ds_read_b128 a[100:103], v5 offset:0
  v_add_f32 v26, v26, v0
  v_mfma_f32_16x16x32_bf16 a[172:175], a[116:119], v[68:71], a[172:175]
  ds_read_b128 a[104:107], v6 offset:0
  v_cvt_pk_bf16_f32 v58, v0, v1
  v_mfma_f32_16x16x32_bf16 a[176:179], a[116:119], v[72:75], a[176:179]
  ds_read_b128 a[108:111], v7 offset:0
  v_add_f32 v26, v26, v1
  v_mfma_f32_16x16x32_bf16 a[180:183], a[116:119], v[76:79], a[180:183]
  ds_read_b128 a[112:115], v4 offset:256
  v_add_f32 v26, v26, v2
  v_mfma_f32_16x16x32_bf16 a[184:187], a[120:123], v[68:71], a[184:187]
  v_cvt_pk_bf16_f32 v59, v2, v3
  v_add_f32 v26, v26, v3
  v_mfma_f32_16x16x32_bf16 a[188:191], a[120:123], v[72:75], a[188:191]
  v_exp_f32 v96, v96
  v_mfma_f32_16x16x32_bf16 a[192:195], a[120:123], v[76:79], a[192:195]
  v_exp_f32 v97, v97
  v_mfma_f32_16x16x32_bf16 a[196:199], a[124:127], v[68:71], a[196:199]
  v_exp_f32 v98, v98
  v_mfma_f32_16x16x32_bf16 a[200:203], a[124:127], v[72:75], a[200:203]
  v_exp_f32 v99, v99
  v_mfma_f32_16x16x32_bf16 a[204:207], a[124:127], v[76:79], a[204:207]
  v_add_f32 v27, v27, v96
  v_cvt_pk_bf16_f32 v62, v96, v97
  v_add_f32 v27, v27, v97
  v_add_f32 v27, v27, v98
  v_cvt_pk_bf16_f32 v63, v98, v99
  v_add_f32 v27, v27, v99
  v_exp_f32 v108, v108
  v_exp_f32 v109, v109
  v_exp_f32 v110, v110
  v_exp_f32 v111, v111
  v_add_f32 v28, v28, v108
  v_cvt_pk_bf16_f32 v66, v108, v109
  v_add_f32 v28, v28, v109
  v_add_f32 v28, v28, v110
  v_cvt_pk_bf16_f32 v67, v110, v111
  v_add_f32 v28, v28, v111
  v_max3_f32 v29, v26, v27, v28
  v_cmp_lt_f32 vcc, 0x44800000, v29
  s_nop 0
  s_cbranch_vccz L_ok15
  s_swappc_b64 s[70:71], s[72:73]
L_ok15:
  v_add_f32 v20, v20, v26
  v_add_f32 v21, v21, v27
  v_add_f32 v22, v22, v28
  s_mov_b32 s30, 491520
  s_mov_b32 s34, 458752
  v_mbcnt_lo_u32_b32 v107, -1, 0
  v_mbcnt_hi_u32_b32 v107, -1, v107
  v_lshrrev_b32 v100, 4, v107
  v_and_b32 v95, 15, v107
  v_lshrrev_b32 v101, 2, v95
  v_and_b32 v102, 3, v107
  v_lshrrev_b32 v103, 5, v107
  v_and_b32 v104, 31, v107
  v_lshl_add_u32 v105, v100, 2, v101
  v_bfe_u32 v106, v105, 1, 2
  v_lshlrev_b32 v105, 7, v105
  v_lshl_add_u32 v105, v102, 3, v105
  s_lshl_b32 s64, s53, 1
  v_xor_b32 v106, s64, v106
  v_xor_b32 v88, 0, v106
  v_lshl_add_u32 v88, v88, 5, v105
  v_add_u32 v89, 0x10000, v88
  v_xor_b32 v90, 1, v106
  v_lshl_add_u32 v90, v90, 5, v105
  v_add_u32 v91, 0x10000, v90
  v_lshrrev_b32 v105, 3, v107
  v_mul_u32_u24 v105, 896, v105
  v_lshlrev_b32 v106, 1, v100
  v_and_b32 v102, 7, v107
  v_xor_b32 v106, v106, v102
  v_lshl_add_u32 v105, v106, 4, v105
  s_mul_i32 s64, s52, 57344
  v_add_u32 v105, s64, v105
  v_add_u32 v80, 0, v105
  v_add_u32 v81, 6144, v105
  v_add_u32 v82, 12288, v105
  v_add_u32 v83, 18432, v105
  v_add_u32 v84, 28672, v105
  v_add_u32 v85, 34816, v105
  v_add_u32 v86, 40960, v105
  v_add_u32 v87, 47104, v105
  v_lshlrev_b32 v92, 4, v107
  s_mov_b32 s60, 2
.p2align 3
L_attA0:
  s_waitcnt lgkmcnt(3)
  v_mfma_f32_16x16x32_bf16 v[32:35], a[96:99], a[0:3], 0
  ds_read_b128 a[116:119], v5 offset:256
  s_mov_b32 m0, s15
  v_mfma_f32_16x16x32_bf16 v[36:39], a[96:99], a[4:7], 0
  s_xor_b32 s15, s15, 0x10000
  v_mfma_f32_16x16x32_bf16 v[40:43], a[96:99], a[8:11], 0
  buffer_load_dwordx4 v16, s[32:35], s57 offen offset:0 nt lds
  v_mfma_f32_16x16x32_bf16 v[32:35], a[100:103], a[12:15], v[32:35]
  ds_read_b128 a[120:123], v6 offset:256
  v_mfma_f32_16x16x32_bf16 v[36:39], a[100:103], a[16:19], v[36:39]
  v_mfma_f32_16x16x32_bf16 v[40:43], a[100:103], a[20:23], v[40:43]
  s_waitcnt lgkmcnt(3)
  v_mfma_f32_16x16x32_bf16 v[32:35], a[104:107], a[24:27], v[32:35]
  ds_read_b128 a[124:127], v7 offset:256
  buffer_load_dwordx4 v17, s[32:35], s57 offen offset:1024 nt lds
  v_mfma_f32_16x16x32_bf16 v[36:39], a[104:107], a[28:31], v[36:39]
  v_mfma_f32_16x16x32_bf16 v[40:43], a[104:107], a[32:35], v[40:43]
  v_mfma_f32_16x16x32_bf16 v[32:35], a[108:111], a[36:39], v[32:35]
  ds_read_b128 a[96:99], v4 offset:8192
  v_mfma_f32_16x16x32_bf16 v[36:39], a[108:111], a[40:43], v[36:39]
  buffer_load_dwordx4 v18, s[32:35], s57 offen offset:2048 nt lds
  v_mfma_f32_16x16x32_bf16 v[40:43], a[108:111], a[44:47], v[40:43]
  s_waitcnt lgkmcnt(3)
  v_mfma_f32_16x16x32_bf16 v[32:35], a[112:115], a[48:51], v[32:35]
  ds_read_b128 a[100:103], v5 offset:8192
  v_mfma_f32_16x16x32_bf16 v[36:39], a[112:115], a[52:55], v[36:39]
  v_mfma_f32_16x16x32_bf16 v[40:43], a[112:115], a[56:59], v[40:43]
  v_mfma_f32_16x16x32_bf16 v[32:35], a[116:119], a[60:63], v[32:35]
  ds_read_b128 a[104:107], v6 offset:8192
  v_mfma_f32_16x16x32_bf16 v[36:39], a[116:119], a[64:67], v[36:39]
  v_mfma_f32_16x16x32_bf16 v[40:43], a[116:119], a[68:71], v[40:43]
  s_waitcnt lgkmcnt(3)
  v_mfma_f32_16x16x32_bf16 v[32:35], a[120:123], a[72:75], v[32:35]
  ds_read_b128 a[108:111], v7 offset:8192
  v_mfma_f32_16x16x32_bf16 v[36:39], a[120:123], a[76:79], v[36:39]
  v_mfma_f32_16x16x32_bf16 v[40:43], a[120:123], a[80:83], v[40:43]
  v_mfma_f32_16x16x32_bf16 v[32:35], a[124:127], a[84:87], v[32:35]
  ds_read_b128 a[112:115], v4 offset:8448
  v_mfma_f32_16x16x32_bf16 v[36:39], a[124:127], a[88:91], v[36:39]
  v_mfma_f32_16x16x32_bf16 v[40:43], a[124:127], a[92:95], v[40:43]
  s_waitcnt lgkmcnt(3)
  v_mfma_f32_16x16x32_bf16 v[44:47], a[96:99], a[0:3], 0
  ds_read_b128 a[116:119], v5 offset:8448
  v_mfma_f32_16x16x32_bf16 v[48:51], a[96:99], a[4:7], 0
  v_mfma_f32_16x16x32_bf16 v[52:55], a[96:99], a[8:11], 0
  v_mfma_f32_16x16x32_bf16 v[44:47], a[100:103], a[12:15], v[44:47]
  ds_read_b128 a[120:123], v6 offset:8448
  v_fma_f32 v0, v32, s63, -v23
  v_mfma_f32_16x16x32_bf16 v[48:51], a[100:103], a[16:19], v[48:51]
  v_fma_f32 v1, v33, s63, -v23
  v_fma_f32 v2, v34, s63, -v23
  v_mfma_f32_16x16x32_bf16 v[52:55], a[100:103], a[20:23], v[52:55]
  v_fma_f32 v3, v35, s63, -v23
  s_waitcnt lgkmcnt(3)
  v_mfma_f32_16x16x32_bf16 v[44:47], a[104:107], a[24:27], v[44:47]
  ds_read_b128 a[124:127], v7 offset:8448
  v_fma_f32 v96, v36, s63, -v24
  v_mfma_f32_16x16x32_bf16 v[48:51], a[104:107], a[28:31], v[48:51]
  v_exp_f32 v0, v0
  v_mfma_f32_16x16x32_bf16 v[52:55], a[104:107], a[32:35], v[52:55]
  v_exp_f32 v1, v1
  v_mfma_f32_16x16x32_bf16 v[44:47], a[108:111], a[36:39], v[44:47]
  v_xor_b32 v4, 0x10000, v4
  v_xor_b32 v5, 0x10000, v5
  v_mfma_f32_16x16x32_bf16 v[48:51], a[108:111], a[40:43], v[48:51]
  v_xor_b32 v6, 0x10000, v6
  v_xor_b32 v7, 0x10000, v7
  v_mfma_f32_16x16x32_bf16 v[52:55], a[108:111], a[44:47], v[52:55]
  v_fma_f32 v97, v37, s63, -v24
  s_waitcnt lgkmcnt(2)
  v_mfma_f32_16x16x32_bf16 v[44:47], a[112:115], a[48:51], v[44:47]
  s_waitcnt vmcnt(3) lgkmcnt(0)
  s_barrier
  v_mfma_f32_16x16x32_bf16 v[48:51], a[112:115], a[52:55], v[48:51]
  ds_read_b64_tr_b16 a[96:97], v8 offset:0
  buffer_load_dwordx4 v19, s[32:35], s57 offen offset:3072 nt lds
  v_mfma_f32_16x16x32_bf16 v[52:55], a[112:115], a[56:59], v[52:55]
  ds_read_b64_tr_b16 a[98:99], v8 offset:8192
  s_add_u32 s57, s57, 16384
  v_mfma_f32_16x16x32_bf16 v[44:47], a[116:119], a[60:63], v[44:47]
  ds_read_b64_tr_b16 a[100:101], v9 offset:0
  v_fma_f32 v98, v38, s63, -v24
  v_mfma_f32_16x16x32_bf16 v[48:51], a[116:119], a[64:67], v[48:51]
  ds_read_b64_tr_b16 a[102:103], v9 offset:8192
  v_fma_f32 v99, v39, s63, -v24
  v_mfma_f32_16x16x32_bf16 v[52:55], a[116:119], a[68:71], v[52:55]
  ds_read_b64_tr_b16 a[104:105], v10 offset:0
  v_fma_f32 v108, v40, s63, -v25
  v_mfma_f32_16x16x32_bf16 v[44:47], a[120:123], a[72:75], v[44:47]
  ds_read_b64_tr_b16 a[106:107], v10 offset:8192
  v_fma_f32 v109, v41, s63, -v25
  v_mfma_f32_16x16x32_bf16 v[48:51], a[120:123], a[76:79], v[48:51]
  ds_read_b64_tr_b16 a[108:109], v11 offset:0
  v_fma_f32 v110, v42, s63, -v25
  v_mfma_f32_16x16x32_bf16 v[52:55], a[120:123], a[80:83], v[52:55]
  ds_read_b64_tr_b16 a[110:111], v11 offset:8192
  v_fma_f32 v111, v43, s63, -v25
  v_mfma_f32_16x16x32_bf16 v[44:47], a[124:127], a[84:87], v[44:47]
  ds_read_b64_tr_b16 a[112:113], v12 offset:0
  v_mfma_f32_16x16x32_bf16 v[48:51], a[124:127], a[88:91], v[48:51]
  ds_read_b64_tr_b16 a[114:115], v12 offset:8192
  v_mfma_f32_16x16x32_bf16 v[52:55], a[124:127], a[92:95], v[52:55]
  v_exp_f32 v2, v2
  v_exp_f32 v3, v3
  v_add_f32 v26, v0, v1
  v_cvt_pk_bf16_f32 v68, v0, v1
  v_add_f32 v26, v26, v2
  v_cvt_pk_bf16_f32 v69, v2, v3
  v_add_f32 v26, v26, v3
  v_exp_f32 v96, v96
  v_exp_f32 v97, v97
  v_exp_f32 v98, v98
  v_exp_f32 v99, v99
  v_add_f32 v27, v96, v97
  v_cvt_pk_bf16_f32 v72, v96, v97
  v_add_f32 v27, v27, v98
  v_cvt_pk_bf16_f32 v73, v98, v99
  v_add_f32 v27, v27, v99
  v_exp_f32 v108, v108
  v_exp_f32 v109, v109
  v_exp_f32 v110, v110
  v_exp_f32 v111, v111
  v_add_f32 v28, v108, v109
  v_cvt_pk_bf16_f32 v76, v108, v109
  v_add_f32 v28, v28, v110
  v_cvt_pk_bf16_f32 v77, v110, v111
  v_add_f32 v28, v28, v111
  s_waitcnt lgkmcnt(6)
  v_mfma_f32_16x16x32_bf16 v[112:115], a[96:99], v[56:59], v[112:115]
  ds_read_b64_tr_b16 a[116:117], v13 offset:0
  s_mov_b32 m0, s14
  v_mfma_f32_16x16x32_bf16 v[116:119], a[96:99], v[60:63], v[116:119]
  ds_read_b64_tr_b16 a[118:119], v13 offset:8192
  s_xor_b32 s14, s14, 0x10000
  v_mfma_f32_16x16x32_bf16 v[120:123], a[96:99], v[64:67], v[120:123]
  buffer_load_dwordx4 v16, s[28:31], s56 offen offset:0 nt lds
  v_mfma_f32_16x16x32_bf16 v[124:127], a[100:103], v[56:59], v[124:127]
  ds_read_b64_tr_b16 a[120:121], v14 offset:0
  v_fma_f32 v0, v44, s63, -v23
  v_mfma_f32_16x16x32_bf16 v[128:131], a[100:103], v[60:63], v[128:131]
  ds_read_b64_tr_b16 a[122:123], v14 offset:8192
  v_fma_f32 v1, v45, s63, -v23
  v_mfma_f32_16x16x32_bf16 v[132:135], a[100:103], v[64:67], v[132:135]
  v_fma_f32 v2, v46, s63, -v23
  s_waitcnt lgkmcnt(6)
  v_mfma_f32_16x16x32_bf16 v[136:139], a[104:107], v[56:59], v[136:139]
  ds_read_b64_tr_b16 a[124:125], v15 offset:0
  buffer_load_dwordx4 v17, s[28:31], s56 offen offset:1024 nt lds
  v_mfma_f32_16x16x32_bf16 v[140:143], a[104:107], v[60:63], v[140:143]
  ds_read_b64_tr_b16 a[126:127], v15 offset:8192
  v_fma_f32 v3, v47, s63, -v23
  v_mfma_f32_16x16x32_bf16 v[144:147], a[104:107], v[64:67], v[144:147]
  v_exp_f32 v0, v0
  v_mfma_f32_16x16x32_bf16 v[148:151], a[108:111], v[56:59], v[148:151]
  ds_read_b64_tr_b16 a[96:97], v8 offset:256
  v_fma_f32 v96, v48, s63, -v24
  v_mfma_f32_16x16x32_bf16 v[152:155], a[108:111], v[60:63], v[152:155]
  ds_read_b64_tr_b16 a[98:99], v8 offset:8448
  buffer_load_dwordx4 v18, s[28:31], s56 offen offset:2048 nt lds
  v_mfma_f32_16x16x32_bf16 v[156:159], a[108:111], v[64:67], v[156:159]
  v_fma_f32 v97, v49, s63, -v24
  s_waitcnt lgkmcnt(6)
  v_mfma_f32_16x16x32_bf16 v[160:163], a[112:115], v[56:59], v[160:163]
  ds_read_b64_tr_b16 a[100:101], v9 offset:256
  v_fma_f32 v98, v50, s63, -v24
  v_mfma_f32_16x16x32_bf16 v[164:167], a[112:115], v[60:63], v[164:167]
  ds_read_b64_tr_b16 a[102:103], v9 offset:8448
  v_fma_f32 v99, v51, s63, -v24
  v_mfma_f32_16x16x32_bf16 v[168:171], a[112:115], v[64:67], v[168:171]
  buffer_load_dwordx4 v19, s[28:31], s56 offen offset:3072 nt lds
  v_mfma_f32_16x16x32_bf16 v[172:175], a[116:119], v[56:59], v[172:175]
  ds_read_b64_tr_b16 a[104:105], v10 offset:256
  v_fma_f32 v108, v52, s63, -v25
  v_mfma_f32_16x16x32_bf16 v[176:179], a[116:119], v[60:63], v[176:179]
  ds_read_b64_tr_b16 a[106:107], v10 offset:8448
  v_fma_f32 v109, v53, s63, -v25
  v_mfma_f32_16x16x32_bf16 v[180:183], a[116:119], v[64:67], v[180:183]
  v_fma_f32 v110, v54, s63, -v25
  s_waitcnt lgkmcnt(6)
  v_mfma_f32_16x16x32_bf16 v[184:187], a[120:123], v[56:59], v[184:187]
  ds_read_b64_tr_b16 a[108:109], v11 offset:256
  v_fma_f32 v111, v55, s63, -v25
  v_mfma_f32_16x16x32_bf16 v[188:191], a[120:123], v[60:63], v[188:191]
  ds_read_b64_tr_b16 a[110:111], v11 offset:8448
  v_mfma_f32_16x16x32_bf16 v[192:195], a[120:123], v[64:67], v[192:195]
  v_exp_f32 v1, v1
  v_mfma_f32_16x16x32_bf16 v[196:199], a[124:127], v[56:59], v[196:199]
  ds_read_b64_tr_b16 a[112:113], v12 offset:256
  v_mfma_f32_16x16x32_bf16 v[200:203], a[124:127], v[60:63], v[200:203]
  ds_read_b64_tr_b16 a[114:115], v12 offset:8448
  v_mfma_f32_16x16x32_bf16 v[204:207], a[124:127], v[64:67], v[204:207]
  s_waitcnt lgkmcnt(6)
  v_mfma_f32_16x16x32_bf16 v[208:211], a[96:99], v[56:59], v[208:211]
  ds_read_b64_tr_b16 a[116:117], v13 offset:256
  v_mfma_f32_16x16x32_bf16 v[212:215], a[96:99], v[60:63], v[212:215]
  ds_read_b64_tr_b16 a[118:119], v13 offset:8448
  v_mfma_f32_16x16x32_bf16 v[216:219], a[96:99], v[64:67], v[216:219]
  v_exp_f32 v2, v2
  v_mfma_f32_16x16x32_bf16 v[220:223], a[100:103], v[56:59], v[220:223]
  ds_read_b64_tr_b16 a[120:121], v14 offset:256
  v_mfma_f32_16x16x32_bf16 v[224:227], a[100:103], v[60:63], v[224:227]
  ds_read_b64_tr_b16 a[122:123], v14 offset:8448
  v_mfma_f32_16x16x32_bf16 v[228:231], a[100:103], v[64:67], v[228:231]
  s_waitcnt lgkmcnt(6)
  v_mfma_f32_16x16x32_bf16 v[232:235], a[104:107], v[56:59], v[232:235]
  ds_read_b64_tr_b16 a[124:125], v15 offset:256
  v_mfma_f32_16x16x32_bf16 v[236:239], a[104:107], v[60:63], v[236:239]
  ds_read_b64_tr_b16 a[126:127], v15 offset:8448
  v_mfma_f32_16x16x32_bf16 v[240:243], a[104:107], v[64:67], v[240:243]
  v_exp_f32 v3, v3
  v_mfma_f32_16x16x32_bf16 v[244:247], a[108:111], v[56:59], v[244:247]
  v_xor_b32 v8, 0x18000, v8
  v_xor_b32 v9, 0x18000, v9
  v_mfma_f32_16x16x32_bf16 v[248:251], a[108:111], v[60:63], v[248:251]
  v_xor_b32 v10, 0x18000, v10
  v_xor_b32 v11, 0x18000, v11
  v_mfma_f32_16x16x32_bf16 v[252:255], a[108:111], v[64:67], v[252:255]
  v_xor_b32 v12, 0x18000, v12
  s_waitcnt lgkmcnt(4)
  v_mfma_f32_16x16x32_bf16 a[160:163], a[112:115], v[56:59], a[160:163]
  v_xor_b32 v13, 0x18000, v13
  v_xor_b32 v14, 0x18000, v14
  v_xor_b32 v15, 0x18000, v15
  s_waitcnt vmcnt(4) lgkmcnt(0)
  s_barrier
  v_mfma_f32_16x16x32_bf16 a[164:167], a[112:115], v[60:63], a[164:167]
  ds_read_b128 a[96:99], v4 offset:0
  s_add_u32 s56, s56, 16384
  v_mfma_f32_16x16x32_bf16 a[168:171], a[112:115], v[64:67], a[168:171]
  ds_read_b128 a[100:103], v5 offset:0
  v_add_f32 v26, v26, v0
  v_mfma_f32_16x16x32_bf16 a[172:175], a[116:119], v[56:59], a[172:175]
  ds_read_b128 a[104:107], v6 offset:0
  v_cvt_pk_bf16_f32 v70, v0, v1
  v_mfma_f32_16x16x32_bf16 a[176:179], a[116:119], v[60:63], a[176:179]
  ds_read_b128 a[108:111], v7 offset:0
  v_add_f32 v26, v26, v1
  v_mfma_f32_16x16x32_bf16 a[180:183], a[116:119], v[64:67], a[180:183]
  ds_read_b128 a[112:115], v4 offset:256
  v_add_f32 v26, v26, v2
  v_mfma_f32_16x16x32_bf16 a[184:187], a[120:123], v[56:59], a[184:187]
  v_cvt_pk_bf16_f32 v71, v2, v3
  v_add_f32 v26, v26, v3
  v_mfma_f32_16x16x32_bf16 a[188:191], a[120:123], v[60:63], a[188:191]
  v_exp_f32 v96, v96
  v_mfma_f32_16x16x32_bf16 a[192:195], a[120:123], v[64:67], a[192:195]
  v_exp_f32 v97, v97
  v_mfma_f32_16x16x32_bf16 a[196:199], a[124:127], v[56:59], a[196:199]
  v_exp_f32 v98, v98
  v_mfma_f32_16x16x32_bf16 a[200:203], a[124:127], v[60:63], a[200:203]
  v_exp_f32 v99, v99
  v_mfma_f32_16x16x32_bf16 a[204:207], a[124:127], v[64:67], a[204:207]
  v_add_f32 v27, v27, v96
  v_cvt_pk_bf16_f32 v74, v96, v97
  v_add_f32 v27, v27, v97
  v_add_f32 v27, v27, v98
  v_cvt_pk_bf16_f32 v75, v98, v99
  v_add_f32 v27, v27, v99
  v_exp_f32 v108, v108
  v_exp_f32 v109, v109
  v_exp_f32 v110, v110
  v_exp_f32 v111, v111
  v_add_f32 v28, v28, v108
  v_cvt_pk_bf16_f32 v78, v108, v109
  v_add_f32 v28, v28, v109
  v_add_f32 v28, v28, v110
  v_cvt_pk_bf16_f32 v79, v110, v111
  v_add_f32 v28, v28, v111
  v_max3_f32 v29, v26, v27, v28
  v_cmp_lt_f32 vcc, 0x44800000, v29
  s_nop 0
  s_cbranch_vccz L_ok24
  s_swappc_b64 s[70:71], s[74:75]
L_ok24:
  v_add_f32 v20, v20, v26
  v_add_f32 v21, v21, v27
  v_add_f32 v22, v22, v28
  s_waitcnt lgkmcnt(3)
  v_mfma_f32_16x16x32_bf16 v[32:35], a[96:99], a[0:3], 0
  ds_read_b128 a[116:119], v5 offset:256
  s_mov_b32 m0, s15
  v_mfma_f32_16x16x32_bf16 v[36:39], a[96:99], a[4:7], 0
  s_xor_b32 s15, s15, 0x18000
  buffer_load_dwordx4 v16, s[32:35], s57 offen offset:0 nt lds
  v_mfma_f32_16x16x32_bf16 v[40:43], a[96:99], a[8:11], 0
  v_mfma_f32_16x16x32_bf16 v[32:35], a[100:103], a[12:15], v[32:35]
  ds_read_b128 a[120:123], v6 offset:256
  v_mfma_f32_16x16x32_bf16 v[36:39], a[100:103], a[16:19], v[36:39]
  v_mfma_f32_16x16x32_bf16 v[40:43], a[100:103], a[20:23], v[40:43]
  buffer_load_dwordx4 v17, s[32:35], s57 offen offset:1024 nt lds
  s_waitcnt lgkmcnt(3)
  v_mfma_f32_16x16x32_bf16 v[32:35], a[104:107], a[24:27], v[32:35]
  ds_read_b128 a[124:127], v7 offset:256
  v_mfma_f32_16x16x32_bf16 v[36:39], a[104:107], a[28:31], v[36:39]
  v_mfma_f32_16x16x32_bf16 v[40:43], a[104:107], a[32:35], v[40:43]
  v_mfma_f32_16x16x32_bf16 v[32:35], a[108:111], a[36:39], v[32:35]
  ds_read_b128 a[96:99], v4 offset:8192
  buffer_load_dwordx4 v18, s[32:35], s57 offen offset:2048 nt lds
  v_mfma_f32_16x16x32_bf16 v[36:39], a[108:111], a[40:43], v[36:39]
  v_mfma_f32_16x16x32_bf16 v[40:43], a[108:111], a[44:47], v[40:43]
  s_waitcnt lgkmcnt(3)
  v_mfma_f32_16x16x32_bf16 v[32:35], a[112:115], a[48:51], v[32:35]
  ds_read_b128 a[100:103], v5 offset:8192
  v_mfma_f32_16x16x32_bf16 v[36:39], a[112:115], a[52:55], v[36:39]
  v_mfma_f32_16x16x32_bf16 v[40:43], a[112:115], a[56:59], v[40:43]
  v_mfma_f32_16x16x32_bf16 v[32:35], a[116:119], a[60:63], v[32:35]
  ds_read_b128 a[104:107], v6 offset:8192
  v_mfma_f32_16x16x32_bf16 v[36:39], a[116:119], a[64:67], v[36:39]
  v_mfma_f32_16x16x32_bf16 v[40:43], a[116:119], a[68:71], v[40:43]
  s_waitcnt lgkmcnt(3)
  v_mfma_f32_16x16x32_bf16 v[32:35], a[120:123], a[72:75], v[32:35]
  ds_read_b128 a[108:111], v7 offset:8192
  v_mfma_f32_16x16x32_bf16 v[36:39], a[120:123], a[76:79], v[36:39]
  v_mfma_f32_16x16x32_bf16 v[40:43], a[120:123], a[80:83], v[40:43]
  v_mfma_f32_16x16x32_bf16 v[32:35], a[124:127], a[84:87], v[32:35]
  ds_read_b128 a[112:115], v4 offset:8448
  v_mfma_f32_16x16x32_bf16 v[36:39], a[124:127], a[88:91], v[36:39]
  v_mfma_f32_16x16x32_bf16 v[40:43], a[124:127], a[92:95], v[40:43]
  s_waitcnt lgkmcnt(3)
  v_mfma_f32_16x16x32_bf16 v[44:47], a[96:99], a[0:3], 0
  ds_read_b128 a[116:119], v5 offset:8448
  v_mfma_f32_16x16x32_bf16 v[48:51], a[96:99], a[4:7], 0
  v_mfma_f32_16x16x32_bf16 v[52:55], a[96:99], a[8:11], 0
  v_mfma_f32_16x16x32_bf16 v[44:47], a[100:103], a[12:15], v[44:47]
  ds_read_b128 a[120:123], v6 offset:8448
  v_fma_f32 v0, v32, s63, -v23
  v_mfma_f32_16x16x32_bf16 v[48:51], a[100:103], a[16:19], v[48:51]
  v_fma_f32 v1, v33, s63, -v23
  v_fma_f32 v2, v34, s63, -v23
  v_mfma_f32_16x16x32_bf16 v[52:55], a[100:103], a[20:23], v[52:55]
  v_fma_f32 v3, v35, s63, -v23
  s_waitcnt lgkmcnt(3)
  v_mfma_f32_16x16x32_bf16 v[44:47], a[104:107], a[24:27], v[44:47]
  ds_read_b128 a[124:127], v7 offset:8448
  v_fma_f32 v96, v36, s63, -v24
  v_mfma_f32_16x16x32_bf16 v[48:51], a[104:107], a[28:31], v[48:51]
  v_exp_f32 v0, v0
  v_mfma_f32_16x16x32_bf16 v[52:55], a[104:107], a[32:35], v[52:55]
  v_exp_f32 v1, v1
  v_mfma_f32_16x16x32_bf16 v[44:47], a[108:111], a[36:39], v[44:47]
  v_xor_b32 v4, 0x18000, v4
  v_xor_b32 v5, 0x18000, v5
  v_mfma_f32_16x16x32_bf16 v[48:51], a[108:111], a[40:43], v[48:51]
  v_xor_b32 v6, 0x18000, v6
  v_xor_b32 v7, 0x18000, v7
  v_mfma_f32_16x16x32_bf16 v[52:55], a[108:111], a[44:47], v[52:55]
  v_fma_f32 v97, v37, s63, -v24
  s_waitcnt lgkmcnt(2)
  v_mfma_f32_16x16x32_bf16 v[44:47], a[112:115], a[48:51], v[44:47]
  s_waitcnt vmcnt(3) lgkmcnt(0)
  s_barrier
  v_mfma_f32_16x16x32_bf16 v[48:51], a[112:115], a[52:55], v[48:51]
  ds_read_b64_tr_b16 a[96:97], v8 offset:0
  buffer_load_dwordx4 v19, s[32:35], s57 offen offset:3072 nt lds
  v_mfma_f32_16x16x32_bf16 v[52:55], a[112:115], a[56:59], v[52:55]
  ds_read_b64_tr_b16 a[98:99], v8 offset:8192
  s_add_u32 s57, s57, 16384
  v_mfma_f32_16x16x32_bf16 v[44:47], a[116:119], a[60:63], v[44:47]
  ds_read_b64_tr_b16 a[100:101], v9 offset:0
  v_fma_f32 v98, v38, s63, -v24
  v_mfma_f32_16x16x32_bf16 v[48:51], a[116:119], a[64:67], v[48:51]
  ds_read_b64_tr_b16 a[102:103], v9 offset:8192
  v_fma_f32 v99, v39, s63, -v24
  v_mfma_f32_16x16x32_bf16 v[52:55], a[116:119], a[68:71], v[52:55]
  ds_read_b64_tr_b16 a[104:105], v10 offset:0
  v_fma_f32 v108, v40, s63, -v25
  v_mfma_f32_16x16x32_bf16 v[44:47], a[120:123], a[72:75], v[44:47]
  ds_read_b64_tr_b16 a[106:107], v10 offset:8192
  v_fma_f32 v109, v41, s63, -v25
  v_mfma_f32_16x16x32_bf16 v[48:51], a[120:123], a[76:79], v[48:51]
  ds_read_b64_tr_b16 a[108:109], v11 offset:0
  v_fma_f32 v110, v42, s63, -v25
  v_mfma_f32_16x16x32_bf16 v[52:55], a[120:123], a[80:83], v[52:55]
  ds_read_b64_tr_b16 a[110:111], v11 offset:8192
  v_fma_f32 v111, v43, s63, -v25
  v_mfma_f32_16x16x32_bf16 v[44:47], a[124:127], a[84:87], v[44:47]
  ds_read_b64_tr_b16 a[112:113], v12 offset:0
  v_mfma_f32_16x16x32_bf16 v[48:51], a[124:127], a[88:91], v[48:51]
  ds_read_b64_tr_b16 a[114:115], v12 offset:8192
  v_mfma_f32_16x16x32_bf16 v[52:55], a[124:127], a[92:95], v[52:55]
  v_exp_f32 v2, v2
  v_exp_f32 v3, v3
  v_add_f32 v26, v0, v1
  v_cvt_pk_bf16_f32 v56, v0, v1
  v_add_f32 v26, v26, v2
  v_cvt_pk_bf16_f32 v57, v2, v3
  v_add_f32 v26, v26, v3
  v_exp_f32 v96, v96
  v_exp_f32 v97, v97
  v_exp_f32 v98, v98
  v_exp_f32 v99, v99
  v_add_f32 v27, v96, v97
  v_cvt_pk_bf16_f32 v60, v96, v97
  v_add_f32 v27, v27, v98
  v_cvt_pk_bf16_f32 v61, v98, v99
  v_add_f32 v27, v27, v99
  v_exp_f32 v108, v108
  v_exp_f32 v109, v109
  v_exp_f32 v110, v110
  v_exp_f32 v111, v111
  v_add_f32 v28, v108, v109
  v_cvt_pk_bf16_f32 v64, v108, v109
  v_add_f32 v28, v28, v110
  v_cvt_pk_bf16_f32 v65, v110, v111
  v_add_f32 v28, v28, v111
  s_waitcnt lgkmcnt(6)
  v_mfma_f32_16x16x32_bf16 v[112:115], a[96:99], v[68:71], v[112:115]
  ds_read_b64_tr_b16 a[116:117], v13 offset:0
  s_mov_b32 m0, s14
  v_mfma_f32_16x16x32_bf16 v[116:119], a[96:99], v[72:75], v[116:119]
  ds_read_b64_tr_b16 a[118:119], v13 offset:8192
  s_xor_b32 s14, s14, 0x18000
  v_mfma_f32_16x16x32_bf16 v[120:123], a[96:99], v[76:79], v[120:123]
  buffer_load_dwordx4 v16, s[28:31], s56 offen offset:0 nt lds
  v_mfma_f32_16x16x32_bf16 v[124:127], a[100:103], v[68:71], v[124:127]
  ds_read_b64_tr_b16 a[120:121], v14 offset:0
  v_fma_f32 v0, v44, s63, -v23
  v_mfma_f32_16x16x32_bf16 v[128:131], a[100:103], v[72:75], v[128:131]
  ds_read_b64_tr_b16 a[122:123], v14 offset:8192
  v_fma_f32 v1, v45, s63, -v23
  v_mfma_f32_16x16x32_bf16 v[132:135], a[100:103], v[76:79], v[132:135]
  v_fma_f32 v2, v46, s63, -v23
  s_waitcnt lgkmcnt(6)
  v_mfma_f32_16x16x32_bf16 v[136:139], a[104:107], v[68:71], v[136:139]
  ds_read_b64_tr_b16 a[124:125], v15 offset:0
  buffer_load_dwordx4 v17, s[28:31], s56 offen offset:1024 nt lds
  v_mfma_f32_16x16x32_bf16 v[140:143], a[104:107], v[72:75], v[140:143]
  ds_read_b64_tr_b16 a[126:127], v15 offset:8192
  v_fma_f32 v3, v47, s63, -v23
  v_mfma_f32_16x16x32_bf16 v[144:147], a[104:107], v[76:79], v[144:147]
  v_exp_f32 v0, v0
  v_mfma_f32_16x16x32_bf16 v[148:151], a[108:111], v[68:71], v[148:151]
  ds_read_b64_tr_b16 a[96:97], v8 offset:256
  v_fma_f32 v96, v48, s63, -v24
  v_mfma_f32_16x16x32_bf16 v[152:155], a[108:111], v[72:75], v[152:155]
  ds_read_b64_tr_b16 a[98:99], v8 offset:8448
  buffer_load_dwordx4 v18, s[28:31], s56 offen offset:2048 nt lds
  v_mfma_f32_16x16x32_bf16 v[156:159], a[108:111], v[76:79], v[156:159]
  v_fma_f32 v97, v49, s63, -v24
  s_waitcnt lgkmcnt(6)
  v_mfma_f32_16x16x32_bf16 v[160:163], a[112:115], v[68:71], v[160:163]
  ds_read_b64_tr_b16 a[100:101], v9 offset:256
  v_fma_f32 v98, v50, s63, -v24
  v_mfma_f32_16x16x32_bf16 v[164:167], a[112:115], v[72:75], v[164:167]
  ds_read_b64_tr_b16 a[102:103], v9 offset:8448
  v_fma_f32 v99, v51, s63, -v24
  v_mfma_f32_16x16x32_bf16 v[168:171], a[112:115], v[76:79], v[168:171]
  buffer_load_dwordx4 v19, s[28:31], s56 offen offset:3072 nt lds
  v_mfma_f32_16x16x32_bf16 v[172:175], a[116:119], v[68:71], v[172:175]
  ds_read_b64_tr_b16 a[104:105], v10 offset:256
  v_fma_f32 v108, v52, s63, -v25
  v_mfma_f32_16x16x32_bf16 v[176:179], a[116:119], v[72:75], v[176:179]
  ds_read_b64_tr_b16 a[106:107], v10 offset:8448
  v_fma_f32 v109, v53, s63, -v25
  v_mfma_f32_16x16x32_bf16 v[180:183], a[116:119], v[76:79], v[180:183]
  v_fma_f32 v110, v54, s63, -v25
  s_waitcnt lgkmcnt(6)
  v_mfma_f32_16x16x32_bf16 v[184:187], a[120:123], v[68:71], v[184:187]
  ds_read_b64_tr_b16 a[108:109], v11 offset:256
  v_fma_f32 v111, v55, s63, -v25
  v_mfma_f32_16x16x32_bf16 v[188:191], a[120:123], v[72:75], v[188:191]
  ds_read_b64_tr_b16 a[110:111], v11 offset:8448
  v_mfma_f32_16x16x32_bf16 v[192:195], a[120:123], v[76:79], v[192:195]
  v_exp_f32 v1, v1
  v_mfma_f32_16x16x32_bf16 v[196:199], a[124:127], v[68:71], v[196:199]
  ds_read_b64_tr_b16 a[112:113], v12 offset:256
  v_mfma_f32_16x16x32_bf16 v[200:203], a[124:127], v[72:75], v[200:203]
  ds_read_b64_tr_b16 a[114:115], v12 offset:8448
  v_mfma_f32_16x16x32_bf16 v[204:207], a[124:127], v[76:79], v[204:207]
  s_waitcnt lgkmcnt(6)
  v_mfma_f32_16x16x32_bf16 v[208:211], a[96:99], v[68:71], v[208:211]
  ds_read_b64_tr_b16 a[116:117], v13 offset:256
  v_mfma_f32_16x16x32_bf16 v[212:215], a[96:99], v[72:75], v[212:215]
  ds_read_b64_tr_b16 a[118:119], v13 offset:8448
  v_mfma_f32_16x16x32_bf16 v[216:219], a[96:99], v[76:79], v[216:219]
  v_exp_f32 v2, v2
  v_mfma_f32_16x16x32_bf16 v[220:223], a[100:103], v[68:71], v[220:223]
  ds_read_b64_tr_b16 a[120:121], v14 offset:256
  v_mfma_f32_16x16x32_bf16 v[224:227], a[100:103], v[72:75], v[224:227]
  ds_read_b64_tr_b16 a[122:123], v14 offset:8448
  v_mfma_f32_16x16x32_bf16 v[228:231], a[100:103], v[76:79], v[228:231]
  s_waitcnt lgkmcnt(6)
  v_mfma_f32_16x16x32_bf16 v[232:235], a[104:107], v[68:71], v[232:235]
  ds_read_b64_tr_b16 a[124:125], v15 offset:256
  v_mfma_f32_16x16x32_bf16 v[236:239], a[104:107], v[72:75], v[236:239]
  ds_read_b64_tr_b16 a[126:127], v15 offset:8448
  v_mfma_f32_16x16x32_bf16 v[240:243], a[104:107], v[76:79], v[240:243]
  v_exp_f32 v3, v3
  v_mfma_f32_16x16x32_bf16 v[244:247], a[108:111], v[68:71], v[244:247]
  v_xor_b32 v8, 0x10000, v8
  v_xor_b32 v9, 0x10000, v9
  v_mfma_f32_16x16x32_bf16 v[248:251], a[108:111], v[72:75], v[248:251]
  v_xor_b32 v10, 0x10000, v10
  v_xor_b32 v11, 0x10000, v11
  v_mfma_f32_16x16x32_bf16 v[252:255], a[108:111], v[76:79], v[252:255]
  v_xor_b32 v12, 0x10000, v12
  s_waitcnt lgkmcnt(4)
  v_mfma_f32_16x16x32_bf16 a[160:163], a[112:115], v[68:71], a[160:163]
  v_xor_b32 v13, 0x10000, v13
  v_xor_b32 v14, 0x10000, v14
  v_xor_b32 v15, 0x10000, v15
  s_waitcnt vmcnt(4) lgkmcnt(0)
  s_barrier
  v_mfma_f32_16x16x32_bf16 a[164:167], a[112:115], v[72:75], a[164:167]
  ds_read_b128 a[96:99], v4 offset:0
  s_add_u32 s56, s56, 16384
  v_mfma_f32_16x16x32_bf16 a[168:171], a[112:115], v[76:79], a[168:171]
  ds_read_b128 a[100:103], v5 offset:0
  v_add_f32 v26, v26, v0
  v_mfma_f32_16x16x32_bf16 a[172:175], a[116:119], v[68:71], a[172:175]
  ds_read_b128 a[104:107], v6 offset:0
  v_cvt_pk_bf16_f32 v58, v0, v1
  v_mfma_f32_16x16x32_bf16 a[176:179], a[116:119], v[72:75], a[176:179]
  ds_read_b128 a[108:111], v7 offset:0
  v_add_f32 v26, v26, v1
  v_mfma_f32_16x16x32_bf16 a[180:183], a[116:119], v[76:79], a[180:183]
  ds_read_b128 a[112:115], v4 offset:256
  v_add_f32 v26, v26, v2
  v_mfma_f32_16x16x32_bf16 a[184:187], a[120:123], v[68:71], a[184:187]
  v_cvt_pk_bf16_f32 v59, v2, v3
  v_add_f32 v26, v26, v3
  v_mfma_f32_16x16x32_bf16 a[188:191], a[120:123], v[72:75], a[188:191]
  v_exp_f32 v96, v96
  v_mfma_f32_16x16x32_bf16 a[192:195], a[120:123], v[76:79], a[192:195]
  v_exp_f32 v97, v97
  v_mfma_f32_16x16x32_bf16 a[196:199], a[124:127], v[68:71], a[196:199]
  v_exp_f32 v98, v98
  v_mfma_f32_16x16x32_bf16 a[200:203], a[124:127], v[72:75], a[200:203]
  v_exp_f32 v99, v99
  v_mfma_f32_16x16x32_bf16 a[204:207], a[124:127], v[76:79], a[204:207]
  v_add_f32 v27, v27, v96
  v_cvt_pk_bf16_f32 v62, v96, v97
  v_add_f32 v27, v27, v97
  v_add_f32 v27, v27, v98
  v_cvt_pk_bf16_f32 v63, v98, v99
  v_add_f32 v27, v27, v99
  v_exp_f32 v108, v108
  v_exp_f32 v109, v109
  v_exp_f32 v110, v110
  v_exp_f32 v111, v111
  v_add_f32 v28, v28, v108
  v_cvt_pk_bf16_f32 v66, v108, v109
  v_add_f32 v28, v28, v109
  v_add_f32 v28, v28, v110
  v_cvt_pk_bf16_f32 v67, v110, v111
  v_add_f32 v28, v28, v111
  v_max3_f32 v29, v26, v27, v28
  v_cmp_lt_f32 vcc, 0x44800000, v29
  s_nop 0
  s_cbranch_vccz L_ok25
  s_swappc_b64 s[70:71], s[72:73]
L_ok25:
  v_add_f32 v20, v20, v26
  v_add_f32 v21, v21, v27
  v_add_f32 v22, v22, v28
  s_sub_u32 s60, s60, 1
  s_cmp_lg_u32 s60, 0
  s_cbranch_scc1 L_attA0
  s_mov_b32 s60, 10
.p2align 3
L_attA:
  s_cmp_eq_u32 s60, 2
  s_cbranch_scc1 L_warmA
L_warmretA:
  s_cmp_eq_u32 s60, 7
  s_cbranch_scc1 L_iniA
L_iniretA:
  s_waitcnt lgkmcnt(3)
  v_mfma_f32_16x16x32_bf16 v[32:35], a[96:99], a[0:3], 0
  ds_read_b128 a[116:119], v5 offset:256
  s_mov_b32 m0, s15
  v_mfma_f32_16x16x32_bf16 v[36:39], a[96:99], a[4:7], 0
  s_xor_b32 s15, s15, 0x10000
  v_mfma_f32_16x16x32_bf16 v[40:43], a[96:99], a[8:11], 0
  buffer_load_dwordx4 v16, s[32:35], s57 offen offset:0 nt lds
  v_mfma_f32_16x16x32_bf16 v[32:35], a[100:103], a[12:15], v[32:35]
  ds_read_b128 a[120:123], v6 offset:256
  v_mfma_f32_16x16x32_bf16 v[36:39], a[100:103], a[16:19], v[36:39]
  v_mfma_f32_16x16x32_bf16 v[40:43], a[100:103], a[20:23], v[40:43]
  s_waitcnt lgkmcnt(3)
  v_mfma_f32_16x16x32_bf16 v[32:35], a[104:107], a[24:27], v[32:35]
  ds_read_b128 a[124:127], v7 offset:256
  buffer_load_dwordx4 v17, s[32:35], s57 offen offset:1024 nt lds
  v_mfma_f32_16x16x32_bf16 v[36:39], a[104:107], a[28:31], v[36:39]
  v_mfma_f32_16x16x32_bf16 v[40:43], a[104:107], a[32:35], v[40:43]
  v_mfma_f32_16x16x32_bf16 v[32:35], a[108:111], a[36:39], v[32:35]
  ds_read_b128 a[96:99], v4 offset:8192
  v_mfma_f32_16x16x32_bf16 v[36:39], a[108:111], a[40:43], v[36:39]
  buffer_load_dwordx4 v18, s[32:35], s57 offen offset:2048 nt lds
  v_mfma_f32_16x16x32_bf16 v[40:43], a[108:111], a[44:47], v[40:43]
  s_waitcnt lgkmcnt(3)
  v_mfma_f32_16x16x32_bf16 v[32:35], a[112:115], a[48:51], v[32:35]
  ds_read_b128 a[100:103], v5 offset:8192
  v_mfma_f32_16x16x32_bf16 v[36:39], a[112:115], a[52:55], v[36:39]
  v_mfma_f32_16x16x32_bf16 v[40:43], a[112:115], a[56:59], v[40:43]
  v_mfma_f32_16x16x32_bf16 v[32:35], a[116:119], a[60:63], v[32:35]
  ds_read_b128 a[104:107], v6 offset:8192
  v_mfma_f32_16x16x32_bf16 v[36:39], a[116:119], a[64:67], v[36:39]
  v_mfma_f32_16x16x32_bf16 v[40:43], a[116:119], a[68:71], v[40:43]
  s_waitcnt lgkmcnt(3)
  v_mfma_f32_16x16x32_bf16 v[32:35], a[120:123], a[72:75], v[32:35]
  ds_read_b128 a[108:111], v7 offset:8192
  v_mfma_f32_16x16x32_bf16 v[36:39], a[120:123], a[76:79], v[36:39]
  v_mfma_f32_16x16x32_bf16 v[40:43], a[120:123], a[80:83], v[40:43]
  v_mfma_f32_16x16x32_bf16 v[32:35], a[124:127], a[84:87], v[32:35]
  ds_read_b128 a[112:115], v4 offset:8448
  v_mfma_f32_16x16x32_bf16 v[36:39], a[124:127], a[88:91], v[36:39]
  v_mfma_f32_16x16x32_bf16 v[40:43], a[124:127], a[92:95], v[40:43]
  s_waitcnt lgkmcnt(3)
  v_mfma_f32_16x16x32_bf16 v[44:47], a[96:99], a[0:3], 0
  ds_read_b128 a[116:119], v5 offset:8448
  v_mfma_f32_16x16x32_bf16 v[48:51], a[96:99], a[4:7], 0
  v_mfma_f32_16x16x32_bf16 v[52:55], a[96:99], a[8:11], 0
  v_mfma_f32_16x16x32_bf16 v[44:47], a[100:103], a[12:15], v[44:47]
  ds_read_b128 a[120:123], v6 offset:8448
  v_fma_f32 v0, v32, s63, -v23
  v_mfma_f32_16x16x32_bf16 v[48:51], a[100:103], a[16:19], v[48:51]
  v_fma_f32 v1, v33, s63, -v23
  v_fma_f32 v2, v34, s63, -v23
  v_mfma_f32_16x16x32_bf16 v[52:55], a[100:103], a[20:23], v[52:55]
  v_fma_f32 v3, v35, s63, -v23
  s_waitcnt lgkmcnt(3)
  v_mfma_f32_16x16x32_bf16 v[44:47], a[104:107], a[24:27], v[44:47]
  ds_read_b128 a[124:127], v7 offset:8448
  v_fma_f32 v96, v36, s63, -v24
  v_mfma_f32_16x16x32_bf16 v[48:51], a[104:107], a[28:31], v[48:51]
  v_exp_f32 v0, v0
  v_mfma_f32_16x16x32_bf16 v[52:55], a[104:107], a[32:35], v[52:55]
  v_exp_f32 v1, v1
  v_mfma_f32_16x16x32_bf16 v[44:47], a[108:111], a[36:39], v[44:47]
  v_xor_b32 v4, 0x10000, v4
  v_xor_b32 v5, 0x10000, v5
  v_mfma_f32_16x16x32_bf16 v[48:51], a[108:111], a[40:43], v[48:51]
  v_xor_b32 v6, 0x10000, v6
  v_xor_b32 v7, 0x10000, v7
  v_mfma_f32_16x16x32_bf16 v[52:55], a[108:111], a[44:47], v[52:55]
  v_fma_f32 v97, v37, s63, -v24
  s_waitcnt lgkmcnt(2)
  v_mfma_f32_16x16x32_bf16 v[44:47], a[112:115], a[48:51], v[44:47]
  s_waitcnt vmcnt(3) lgkmcnt(0)
  s_barrier
  v_mfma_f32_16x16x32_bf16 v[48:51], a[112:115], a[52:55], v[48:51]
  ds_read_b64_tr_b16 a[96:97], v8 offset:0
  buffer_load_dwordx4 v19, s[32:35], s57 offen offset:3072 nt lds
  v_mfma_f32_16x16x32_bf16 v[52:55], a[112:115], a[56:59], v[52:55]
  ds_read_b64_tr_b16 a[98:99], v8 offset:8192
  s_add_u32 s57, s57, 16384
  v_mfma_f32_16x16x32_bf16 v[44:47], a[116:119], a[60:63], v[44:47]
  ds_read_b64_tr_b16 a[100:101], v9 offset:0
  v_fma_f32 v98, v38, s63, -v24
  v_mfma_f32_16x16x32_bf16 v[48:51], a[116:119], a[64:67], v[48:51]
  ds_read_b64_tr_b16 a[102:103], v9 offset:8192
  v_fma_f32 v99, v39, s63, -v24
  v_mfma_f32_16x16x32_bf16 v[52:55], a[116:119], a[68:71], v[52:55]
  ds_read_b64_tr_b16 a[104:105], v10 offset:0
  v_fma_f32 v108, v40, s63, -v25
  v_mfma_f32_16x16x32_bf16 v[44:47], a[120:123], a[72:75], v[44:47]
  ds_read_b64_tr_b16 a[106:107], v10 offset:8192
  v_fma_f32 v109, v41, s63, -v25
  v_mfma_f32_16x16x32_bf16 v[48:51], a[120:123], a[76:79], v[48:51]
  ds_read_b64_tr_b16 a[108:109], v11 offset:0
  v_fma_f32 v110, v42, s63, -v25
  v_mfma_f32_16x16x32_bf16 v[52:55], a[120:123], a[80:83], v[52:55]
  ds_read_b64_tr_b16 a[110:111], v11 offset:8192
  v_fma_f32 v111, v43, s63, -v25
  v_mfma_f32_16x16x32_bf16 v[44:47], a[124:127], a[84:87], v[44:47]
  ds_read_b64_tr_b16 a[112:113], v12 offset:0
  v_mfma_f32_16x16x32_bf16 v[48:51], a[124:127], a[88:91], v[48:51]
  ds_read_b64_tr_b16 a[114:115], v12 offset:8192
  v_mfma_f32_16x16x32_bf16 v[52:55], a[124:127], a[92:95], v[52:55]
  v_exp_f32 v2, v2
  v_exp_f32 v3, v3
  v_add_f32 v26, v0, v1
  v_cvt_pk_bf16_f32 v68, v0, v1
  v_add_f32 v26, v26, v2
  v_cvt_pk_bf16_f32 v69, v2, v3
  v_add_f32 v26, v26, v3
  v_exp_f32 v96, v96
  v_exp_f32 v97, v97
  v_exp_f32 v98, v98
  v_exp_f32 v99, v99
  v_add_f32 v27, v96, v97
  v_cvt_pk_bf16_f32 v72, v96, v97
  v_add_f32 v27, v27, v98
  v_cvt_pk_bf16_f32 v73, v98, v99
  v_add_f32 v27, v27, v99
  v_exp_f32 v108, v108
  v_exp_f32 v109, v109
  v_exp_f32 v110, v110
  v_exp_f32 v111, v111
  v_add_f32 v28, v108, v109
  v_cvt_pk_bf16_f32 v76, v108, v109
  v_add_f32 v28, v28, v110
  v_cvt_pk_bf16_f32 v77, v110, v111
  v_add_f32 v28, v28, v111
  s_waitcnt lgkmcnt(6)
  v_mfma_f32_16x16x32_bf16 v[112:115], a[96:99], v[56:59], v[112:115]
  ds_read_b64_tr_b16 a[116:117], v13 offset:0
  s_mov_b32 m0, s14
  v_mfma_f32_16x16x32_bf16 v[116:119], a[96:99], v[60:63], v[116:119]
  ds_read_b64_tr_b16 a[118:119], v13 offset:8192
  s_xor_b32 s14, s14, 0x10000
  v_mfma_f32_16x16x32_bf16 v[120:123], a[96:99], v[64:67], v[120:123]
  buffer_load_dwordx4 v16, s[28:31], s56 offen offset:0 nt lds
  v_mfma_f32_16x16x32_bf16 v[124:127], a[100:103], v[56:59], v[124:127]
  ds_read_b64_tr_b16 a[120:121], v14 offset:0
  v_fma_f32 v0, v44, s63, -v23
  v_mfma_f32_16x16x32_bf16 v[128:131], a[100:103], v[60:63], v[128:131]
  ds_read_b64_tr_b16 a[122:123], v14 offset:8192
  v_fma_f32 v1, v45, s63, -v23
  v_mfma_f32_16x16x32_bf16 v[132:135], a[100:103], v[64:67], v[132:135]
  v_fma_f32 v2, v46, s63, -v23
  s_waitcnt lgkmcnt(6)
  v_mfma_f32_16x16x32_bf16 v[136:139], a[104:107], v[56:59], v[136:139]
  ds_read_b64_tr_b16 a[124:125], v15 offset:0
  buffer_load_dwordx4 v17, s[28:31], s56 offen offset:1024 nt lds
  v_mfma_f32_16x16x32_bf16 v[140:143], a[104:107], v[60:63], v[140:143]
  ds_read_b64_tr_b16 a[126:127], v15 offset:8192
  v_fma_f32 v3, v47, s63, -v23
  v_mfma_f32_16x16x32_bf16 v[144:147], a[104:107], v[64:67], v[144:147]
  v_exp_f32 v0, v0
  v_mfma_f32_16x16x32_bf16 v[148:151], a[108:111], v[56:59], v[148:151]
  ds_read_b64_tr_b16 a[96:97], v8 offset:256
  v_fma_f32 v96, v48, s63, -v24
  v_mfma_f32_16x16x32_bf16 v[152:155], a[108:111], v[60:63], v[152:155]
  ds_read_b64_tr_b16 a[98:99], v8 offset:8448
  buffer_load_dwordx4 v18, s[28:31], s56 offen offset:2048 nt lds
  v_mfma_f32_16x16x32_bf16 v[156:159], a[108:111], v[64:67], v[156:159]
  v_fma_f32 v97, v49, s63, -v24
  s_waitcnt lgkmcnt(6)
  v_mfma_f32_16x16x32_bf16 v[160:163], a[112:115], v[56:59], v[160:163]
  ds_read_b64_tr_b16 a[100:101], v9 offset:256
  v_fma_f32 v98, v50, s63, -v24
  v_mfma_f32_16x16x32_bf16 v[164:167], a[112:115], v[60:63], v[164:167]
  ds_read_b64_tr_b16 a[102:103], v9 offset:8448
  v_fma_f32 v99, v51, s63, -v24
  v_mfma_f32_16x16x32_bf16 v[168:171], a[112:115], v[64:67], v[168:171]
  v_exp_f32 v1, v1
  v_mfma_f32_16x16x32_bf16 v[172:175], a[116:119], v[56:59], v[172:175]
  ds_read_b64_tr_b16 a[104:105], v10 offset:256
  v_fma_f32 v108, v52, s63, -v25
  v_mfma_f32_16x16x32_bf16 v[176:179], a[116:119], v[60:63], v[176:179]
  ds_read_b64_tr_b16 a[106:107], v10 offset:8448
  v_fma_f32 v109, v53, s63, -v25
  v_mfma_f32_16x16x32_bf16 v[180:183], a[116:119], v[64:67], v[180:183]
  v_fma_f32 v110, v54, s63, -v25
  s_waitcnt lgkmcnt(6)
  v_mfma_f32_16x16x32_bf16 v[184:187], a[120:123], v[56:59], v[184:187]
  ds_read_b64_tr_b16 a[108:109], v11 offset:256
  v_fma_f32 v111, v55, s63, -v25
  v_mfma_f32_16x16x32_bf16 v[188:191], a[120:123], v[60:63], v[188:191]
  ds_read_b64_tr_b16 a[110:111], v11 offset:8448
  v_mfma_f32_16x16x32_bf16 v[192:195], a[120:123], v[64:67], v[192:195]
  v_exp_f32 v2, v2
  v_mfma_f32_16x16x32_bf16 v[196:199], a[124:127], v[56:59], v[196:199]
  ds_read_b64_tr_b16 a[112:113], v12 offset:256
  v_mfma_f32_16x16x32_bf16 v[200:203], a[124:127], v[60:63], v[200:203]
  ds_read_b64_tr_b16 a[114:115], v12 offset:8448
  v_mfma_f32_16x16x32_bf16 v[204:207], a[124:127], v[64:67], v[204:207]
  s_waitcnt lgkmcnt(6)
  v_mfma_f32_16x16x32_bf16 v[208:211], a[96:99], v[56:59], v[208:211]
  ds_read_b64_tr_b16 a[116:117], v13 offset:256
  v_mfma_f32_16x16x32_bf16 v[212:215], a[96:99], v[60:63], v[212:215]
  ds_read_b64_tr_b16 a[118:119], v13 offset:8448
  v_mfma_f32_16x16x32_bf16 v[216:219], a[96:99], v[64:67], v[216:219]
  v_exp_f32 v3, v3
  v_mfma_f32_16x16x32_bf16 v[220:223], a[100:103], v[56:59], v[220:223]
  ds_read_b64_tr_b16 a[120:121], v14 offset:256
  v_add_f32 v26, v26, v0
  v_mfma_f32_16x16x32_bf16 v[224:227], a[100:103], v[60:63], v[224:227]
  ds_read_b64_tr_b16 a[122:123], v14 offset:8448
  v_cvt_pk_bf16_f32 v70, v0, v1
  v_mfma_f32_16x16x32_bf16 v[228:231], a[100:103], v[64:67], v[228:231]
  v_add_f32 v26, v26, v1
  s_waitcnt lgkmcnt(6)
  v_mfma_f32_16x16x32_bf16 v[232:235], a[104:107], v[56:59], v[232:235]
  ds_read_b64_tr_b16 a[124:125], v15 offset:256
  v_add_f32 v26, v26, v2
  v_mfma_f32_16x16x32_bf16 v[236:239], a[104:107], v[60:63], v[236:239]
  ds_read_b64_tr_b16 a[126:127], v15 offset:8448
  v_cvt_pk_bf16_f32 v71, v2, v3
  v_mfma_f32_16x16x32_bf16 v[240:243], a[104:107], v[64:67], v[240:243]
  v_add_f32 v26, v26, v3
  v_mfma_f32_16x16x32_bf16 v[244:247], a[108:111], v[56:59], v[244:247]
  v_xor_b32 v8, 0x18000, v8
  v_xor_b32 v9, 0x18000, v9
  v_mfma_f32_16x16x32_bf16 v[248:251], a[108:111], v[60:63], v[248:251]
  v_xor_b32 v10, 0x18000, v10
  v_xor_b32 v11, 0x18000, v11
  v_mfma_f32_16x16x32_bf16 v[252:255], a[108:111], v[64:67], v[252:255]
  v_xor_b32 v12, 0x18000, v12
  s_waitcnt lgkmcnt(4)
  v_mfma_f32_16x16x32_bf16 a[160:163], a[112:115], v[56:59], a[160:163]
  v_xor_b32 v13, 0x18000, v13
  v_xor_b32 v14, 0x18000, v14
  v_xor_b32 v15, 0x18000, v15
  s_waitcnt vmcnt(3) lgkmcnt(0)
  s_barrier
  v_mfma_f32_16x16x32_bf16 a[164:167], a[112:115], v[60:63], a[164:167]
  ds_read_b128 a[96:99], v4 offset:0
  buffer_load_dwordx4 v19, s[28:31], s56 offen offset:3072 nt lds
  v_mfma_f32_16x16x32_bf16 a[168:171], a[112:115], v[64:67], a[168:171]
  ds_read_b128 a[100:103], v5 offset:0
  s_add_u32 s56, s56, 16384
  v_mfma_f32_16x16x32_bf16 a[172:175], a[116:119], v[56:59], a[172:175]
  ds_read_b128 a[104:107], v6 offset:0
  v_mfma_f32_16x16x32_bf16 a[176:179], a[116:119], v[60:63], a[176:179]
  ds_read_b128 a[108:111], v7 offset:0
  v_mfma_f32_16x16x32_bf16 a[180:183], a[116:119], v[64:67], a[180:183]
  ds_read_b128 a[112:115], v4 offset:256
  v_mfma_f32_16x16x32_bf16 a[184:187], a[120:123], v[56:59], a[184:187]
  v_exp_f32 v96, v96
  v_mfma_f32_16x16x32_bf16 a[188:191], a[120:123], v[60:63], a[188:191]
  v_exp_f32 v97, v97
  v_mfma_f32_16x16x32_bf16 a[192:195], a[120:123], v[64:67], a[192:195]
  v_exp_f32 v98, v98
  v_mfma_f32_16x16x32_bf16 a[196:199], a[124:127], v[56:59], a[196:199]
  v_exp_f32 v99, v99
  v_mfma_f32_16x16x32_bf16 a[200:203], a[124:127], v[60:63], a[200:203]
  v_add_f32 v27, v27, v96
  v_cvt_pk_bf16_f32 v74, v96, v97
  v_mfma_f32_16x16x32_bf16 a[204:207], a[124:127], v[64:67], a[204:207]
  v_add_f32 v27, v27, v97
  v_add_f32 v27, v27, v98
  v_cvt_pk_bf16_f32 v75, v98, v99
  v_add_f32 v27, v27, v99
  v_exp_f32 v108, v108
  v_exp_f32 v109, v109
  v_exp_f32 v110, v110
  v_exp_f32 v111, v111
  v_add_f32 v28, v28, v108
  v_cvt_pk_bf16_f32 v78, v108, v109
  v_add_f32 v28, v28, v109
  v_add_f32 v28, v28, v110
  v_cvt_pk_bf16_f32 v79, v110, v111
  v_add_f32 v28, v28, v111
  v_max3_f32 v29, v26, v27, v28
  v_cmp_lt_f32 vcc, 0x44800000, v29
  s_nop 0
  s_cbranch_vccz L_ok34
  s_swappc_b64 s[70:71], s[74:75]
L_ok34:
  v_add_f32 v20, v20, v26
  v_add_f32 v21, v21, v27
  v_add_f32 v22, v22, v28
  s_waitcnt lgkmcnt(3)
  v_mfma_f32_16x16x32_bf16 v[32:35], a[96:99], a[0:3], 0
  ds_read_b128 a[116:119], v5 offset:256
  s_mov_b32 m0, s15
  v_mfma_f32_16x16x32_bf16 v[36:39], a[96:99], a[4:7], 0
  s_xor_b32 s15, s15, 0x18000
  buffer_load_dwordx4 v16, s[32:35], s57 offen offset:0 nt lds
  v_mfma_f32_16x16x32_bf16 v[40:43], a[96:99], a[8:11], 0
  v_mfma_f32_16x16x32_bf16 v[32:35], a[100:103], a[12:15], v[32:35]
  ds_read_b128 a[120:123], v6 offset:256
  v_mfma_f32_16x16x32_bf16 v[36:39], a[100:103], a[16:19], v[36:39]
  v_mfma_f32_16x16x32_bf16 v[40:43], a[100:103], a[20:23], v[40:43]
  buffer_load_dwordx4 v17, s[32:35], s57 offen offset:1024 nt lds
  s_waitcnt lgkmcnt(3)
  v_mfma_f32_16x16x32_bf16 v[32:35], a[104:107], a[24:27], v[32:35]
  ds_read_b128 a[124:127], v7 offset:256
  v_mfma_f32_16x16x32_bf16 v[36:39], a[104:107], a[28:31], v[36:39]
  v_mfma_f32_16x16x32_bf16 v[40:43], a[104:107], a[32:35], v[40:43]
  v_mfma_f32_16x16x32_bf16 v[32:35], a[108:111], a[36:39], v[32:35]
  ds_read_b128 a[96:99], v4 offset:8192
  buffer_load_dwordx4 v18, s[32:35], s57 offen offset:2048 nt lds
  v_mfma_f32_16x16x32_bf16 v[36:39], a[108:111], a[40:43], v[36:39]
  v_mfma_f32_16x16x32_bf16 v[40:43], a[108:111], a[44:47], v[40:43]
  s_waitcnt lgkmcnt(3)
  v_mfma_f32_16x16x32_bf16 v[32:35], a[112:115], a[48:51], v[32:35]
  ds_read_b128 a[100:103], v5 offset:8192
  v_mfma_f32_16x16x32_bf16 v[36:39], a[112:115], a[52:55], v[36:39]
  v_mfma_f32_16x16x32_bf16 v[40:43], a[112:115], a[56:59], v[40:43]
  v_mfma_f32_16x16x32_bf16 v[32:35], a[116:119], a[60:63], v[32:35]
  ds_read_b128 a[104:107], v6 offset:8192
  v_mfma_f32_16x16x32_bf16 v[36:39], a[116:119], a[64:67], v[36:39]
  v_mfma_f32_16x16x32_bf16 v[40:43], a[116:119], a[68:71], v[40:43]
  s_waitcnt lgkmcnt(3)
  v_mfma_f32_16x16x32_bf16 v[32:35], a[120:123], a[72:75], v[32:35]
  ds_read_b128 a[108:111], v7 offset:8192
  v_mfma_f32_16x16x32_bf16 v[36:39], a[120:123], a[76:79], v[36:39]
  v_mfma_f32_16x16x32_bf16 v[40:43], a[120:123], a[80:83], v[40:43]
  v_mfma_f32_16x16x32_bf16 v[32:35], a[124:127], a[84:87], v[32:35]
  ds_read_b128 a[112:115], v4 offset:8448
  v_mfma_f32_16x16x32_bf16 v[36:39], a[124:127], a[88:91], v[36:39]
  v_mfma_f32_16x16x32_bf16 v[40:43], a[124:127], a[92:95], v[40:43]
  s_waitcnt lgkmcnt(3)
  v_mfma_f32_16x16x32_bf16 v[44:47], a[96:99], a[0:3], 0
  ds_read_b128 a[116:119], v5 offset:8448
  v_mfma_f32_16x16x32_bf16 v[48:51], a[96:99], a[4:7], 0
  v_mfma_f32_16x16x32_bf16 v[52:55], a[96:99], a[8:11], 0
  v_mfma_f32_16x16x32_bf16 v[44:47], a[100:103], a[12:15], v[44:47]
  ds_read_b128 a[120:123], v6 offset:8448
  v_fma_f32 v0, v32, s63, -v23
  v_mfma_f32_16x16x32_bf16 v[48:51], a[100:103], a[16:19], v[48:51]
  v_fma_f32 v1, v33, s63, -v23
  v_fma_f32 v2, v34, s63, -v23
  v_mfma_f32_16x16x32_bf16 v[52:55], a[100:103], a[20:23], v[52:55]
  v_fma_f32 v3, v35, s63, -v23
  s_waitcnt lgkmcnt(3)
  v_mfma_f32_16x16x32_bf16 v[44:47], a[104:107], a[24:27], v[44:47]
  ds_read_b128 a[124:127], v7 offset:8448
  v_fma_f32 v96, v36, s63, -v24
  v_mfma_f32_16x16x32_bf16 v[48:51], a[104:107], a[28:31], v[48:51]
  v_exp_f32 v0, v0
  v_mfma_f32_16x16x32_bf16 v[52:55], a[104:107], a[32:35], v[52:55]
  v_exp_f32 v1, v1
  v_mfma_f32_16x16x32_bf16 v[44:47], a[108:111], a[36:39], v[44:47]
  v_xor_b32 v4, 0x18000, v4
  v_xor_b32 v5, 0x18000, v5
  v_mfma_f32_16x16x32_bf16 v[48:51], a[108:111], a[40:43], v[48:51]
  v_xor_b32 v6, 0x18000, v6
  v_xor_b32 v7, 0x18000, v7
  v_mfma_f32_16x16x32_bf16 v[52:55], a[108:111], a[44:47], v[52:55]
  v_fma_f32 v97, v37, s63, -v24
  s_waitcnt lgkmcnt(2)
  v_mfma_f32_16x16x32_bf16 v[44:47], a[112:115], a[48:51], v[44:47]
  s_waitcnt vmcnt(3) lgkmcnt(0)
  s_barrier
  v_mfma_f32_16x16x32_bf16 v[48:51], a[112:115], a[52:55], v[48:51]
  ds_read_b64_tr_b16 a[96:97], v8 offset:0
  buffer_load_dwordx4 v19, s[32:35], s57 offen offset:3072 nt lds
  v_mfma_f32_16x16x32_bf16 v[52:55], a[112:115], a[56:59], v[52:55]
  ds_read_b64_tr_b16 a[98:99], v8 offset:8192
  s_add_u32 s57, s57, 16384
  v_mfma_f32_16x16x32_bf16 v[44:47], a[116:119], a[60:63], v[44:47]
  ds_read_b64_tr_b16 a[100:101], v9 offset:0
  v_fma_f32 v98, v38, s63, -v24
  v_mfma_f32_16x16x32_bf16 v[48:51], a[116:119], a[64:67], v[48:51]
  ds_read_b64_tr_b16 a[102:103], v9 offset:8192
  v_fma_f32 v99, v39, s63, -v24
  v_mfma_f32_16x16x32_bf16 v[52:55], a[116:119], a[68:71], v[52:55]
  ds_read_b64_tr_b16 a[104:105], v10 offset:0
  v_fma_f32 v108, v40, s63, -v25
  v_mfma_f32_16x16x32_bf16 v[44:47], a[120:123], a[72:75], v[44:47]
  ds_read_b64_tr_b16 a[106:107], v10 offset:8192
  v_fma_f32 v109, v41, s63, -v25
  v_mfma_f32_16x16x32_bf16 v[48:51], a[120:123], a[76:79], v[48:51]
  ds_read_b64_tr_b16 a[108:109], v11 offset:0
  v_fma_f32 v110, v42, s63, -v25
  v_mfma_f32_16x16x32_bf16 v[52:55], a[120:123], a[80:83], v[52:55]
  ds_read_b64_tr_b16 a[110:111], v11 offset:8192
  v_fma_f32 v111, v43, s63, -v25
  v_mfma_f32_16x16x32_bf16 v[44:47], a[124:127], a[84:87], v[44:47]
  ds_read_b64_tr_b16 a[112:113], v12 offset:0
  v_mfma_f32_16x16x32_bf16 v[48:51], a[124:127], a[88:91], v[48:51]
  ds_read_b64_tr_b16 a[114:115], v12 offset:8192
  v_mfma_f32_16x16x32_bf16 v[52:55], a[124:127], a[92:95], v[52:55]
  v_exp_f32 v2, v2
  v_exp_f32 v3, v3
  v_add_f32 v26, v0, v1
  v_cvt_pk_bf16_f32 v56, v0, v1
  v_add_f32 v26, v26, v2
  v_cvt_pk_bf16_f32 v57, v2, v3
  v_add_f32 v26, v26, v3
  v_exp_f32 v96, v96
  v_exp_f32 v97, v97
  v_exp_f32 v98, v98
  v_exp_f32 v99, v99
  v_add_f32 v27, v96, v97
  v_cvt_pk_bf16_f32 v60, v96, v97
  v_add_f32 v27, v27, v98
  v_cvt_pk_bf16_f32 v61, v98, v99
  v_add_f32 v27, v27, v99
  v_exp_f32 v108, v108
  v_exp_f32 v109, v109
  v_exp_f32 v110, v110
  v_exp_f32 v111, v111
  v_add_f32 v28, v108, v109
  v_cvt_pk_bf16_f32 v64, v108, v109
  v_add_f32 v28, v28, v110
  v_cvt_pk_bf16_f32 v65, v110, v111
  v_add_f32 v28, v28, v111
  s_waitcnt lgkmcnt(6)
  v_mfma_f32_16x16x32_bf16 v[112:115], a[96:99], v[68:71], v[112:115]
  ds_read_b64_tr_b16 a[116:117], v13 offset:0
  s_mov_b32 m0, s14
  v_mfma_f32_16x16x32_bf16 v[116:119], a[96:99], v[72:75], v[116:119]
  ds_read_b64_tr_b16 a[118:119], v13 offset:8192
  s_xor_b32 s14, s14, 0x18000
  v_mfma_f32_16x16x32_bf16 v[120:123], a[96:99], v[76:79], v[120:123]
  buffer_load_dwordx4 v16, s[28:31], s56 offen offset:0 nt lds
  v_mfma_f32_16x16x32_bf16 v[124:127], a[100:103], v[68:71], v[124:127]
  ds_read_b64_tr_b16 a[120:121], v14 offset:0
  v_fma_f32 v0, v44, s63, -v23
  v_mfma_f32_16x16x32_bf16 v[128:131], a[100:103], v[72:75], v[128:131]
  ds_read_b64_tr_b16 a[122:123], v14 offset:8192
  v_fma_f32 v1, v45, s63, -v23
  v_mfma_f32_16x16x32_bf16 v[132:135], a[100:103], v[76:79], v[132:135]
  v_fma_f32 v2, v46, s63, -v23
  s_waitcnt lgkmcnt(6)
  v_mfma_f32_16x16x32_bf16 v[136:139], a[104:107], v[68:71], v[136:139]
  ds_read_b64_tr_b16 a[124:125], v15 offset:0
  buffer_load_dwordx4 v17, s[28:31], s56 offen offset:1024 nt lds
  v_mfma_f32_16x16x32_bf16 v[140:143], a[104:107], v[72:75], v[140:143]
  ds_read_b64_tr_b16 a[126:127], v15 offset:8192
  v_fma_f32 v3, v47, s63, -v23
  v_mfma_f32_16x16x32_bf16 v[144:147], a[104:107], v[76:79], v[144:147]
  v_exp_f32 v0, v0
  v_mfma_f32_16x16x32_bf16 v[148:151], a[108:111], v[68:71], v[148:151]
  ds_read_b64_tr_b16 a[96:97], v8 offset:256
  v_fma_f32 v96, v48, s63, -v24
  v_mfma_f32_16x16x32_bf16 v[152:155], a[108:111], v[72:75], v[152:155]
  ds_read_b64_tr_b16 a[98:99], v8 offset:8448
  buffer_load_dwordx4 v18, s[28:31], s56 offen offset:2048 nt lds
  v_mfma_f32_16x16x32_bf16 v[156:159], a[108:111], v[76:79], v[156:159]
  v_fma_f32 v97, v49, s63, -v24
  s_waitcnt lgkmcnt(6)
  v_mfma_f32_16x16x32_bf16 v[160:163], a[112:115], v[68:71], v[160:163]
  ds_read_b64_tr_b16 a[100:101], v9 offset:256
  v_fma_f32 v98, v50, s63, -v24
  v_mfma_f32_16x16x32_bf16 v[164:167], a[112:115], v[72:75], v[164:167]
  ds_read_b64_tr_b16 a[102:103], v9 offset:8448
  v_fma_f32 v99, v51, s63, -v24
  v_mfma_f32_16x16x32_bf16 v[168:171], a[112:115], v[76:79], v[168:171]
  buffer_load_dwordx4 v19, s[28:31], s56 offen offset:3072 nt lds
  v_mfma_f32_16x16x32_bf16 v[172:175], a[116:119], v[68:71], v[172:175]
  ds_read_b64_tr_b16 a[104:105], v10 offset:256
  v_fma_f32 v108, v52, s63, -v25
  v_mfma_f32_16x16x32_bf16 v[176:179], a[116:119], v[72:75], v[176:179]
  ds_read_b64_tr_b16 a[106:107], v10 offset:8448
  v_fma_f32 v109, v53, s63, -v25
  v_mfma_f32_16x16x32_bf16 v[180:183], a[116:119], v[76:79], v[180:183]
  v_fma_f32 v110, v54, s63, -v25
  s_waitcnt lgkmcnt(6)
  v_mfma_f32_16x16x32_bf16 v[184:187], a[120:123], v[68:71], v[184:187]
  ds_read_b64_tr_b16 a[108:109], v11 offset:256
  v_fma_f32 v111, v55, s63, -v25
  v_mfma_f32_16x16x32_bf16 v[188:191], a[120:123], v[72:75], v[188:191]
  ds_read_b64_tr_b16 a[110:111], v11 offset:8448
  v_mfma_f32_16x16x32_bf16 v[192:195], a[120:123], v[76:79], v[192:195]
  v_exp_f32 v1, v1
  v_mfma_f32_16x16x32_bf16 v[196:199], a[124:127], v[68:71], v[196:199]
  ds_read_b64_tr_b16 a[112:113], v12 offset:256
  v_mfma_f32_16x16x32_bf16 v[200:203], a[124:127], v[72:75], v[200:203]
  ds_read_b64_tr_b16 a[114:115], v12 offset:8448
  v_mfma_f32_16x16x32_bf16 v[204:207], a[124:127], v[76:79], v[204:207]
  s_waitcnt lgkmcnt(6)
  v_mfma_f32_16x16x32_bf16 v[208:211], a[96:99], v[68:71], v[208:211]
  ds_read_b64_tr_b16 a[116:117], v13 offset:256
  v_mfma_f32_16x16x32_bf16 v[212:215], a[96:99], v[72:75], v[212:215]
  ds_read_b64_tr_b16 a[118:119], v13 offset:8448
  v_mfma_f32_16x16x32_bf16 v[216:219], a[96:99], v[76:79], v[216:219]
  v_exp_f32 v2, v2
  v_mfma_f32_16x16x32_bf16 v[220:223], a[100:103], v[68:71], v[220:223]
  ds_read_b64_tr_b16 a[120:121], v14 offset:256
  v_mfma_f32_16x16x32_bf16 v[224:227], a[100:103], v[72:75], v[224:227]
  ds_read_b64_tr_b16 a[122:123], v14 offset:8448
  v_mfma_f32_16x16x32_bf16 v[228:231], a[100:103], v[76:79], v[228:231]
  s_waitcnt lgkmcnt(6)
  v_mfma_f32_16x16x32_bf16 v[232:235], a[104:107], v[68:71], v[232:235]
  ds_read_b64_tr_b16 a[124:125], v15 offset:256
  v_mfma_f32_16x16x32_bf16 v[236:239], a[104:107], v[72:75], v[236:239]
  ds_read_b64_tr_b16 a[126:127], v15 offset:8448
  v_mfma_f32_16x16x32_bf16 v[240:243], a[104:107], v[76:79], v[240:243]
  v_exp_f32 v3, v3
  v_mfma_f32_16x16x32_bf16 v[244:247], a[108:111], v[68:71], v[244:247]
  v_xor_b32 v8, 0x10000, v8
  v_xor_b32 v9, 0x10000, v9
  v_mfma_f32_16x16x32_bf16 v[248:251], a[108:111], v[72:75], v[248:251]
  v_xor_b32 v10, 0x10000, v10
  v_xor_b32 v11, 0x10000, v11
  v_mfma_f32_16x16x32_bf16 v[252:255], a[108:111], v[76:79], v[252:255]
  v_xor_b32 v12, 0x10000, v12
  s_waitcnt lgkmcnt(4)
  v_mfma_f32_16x16x32_bf16 a[160:163], a[112:115], v[68:71], a[160:163]
  v_xor_b32 v13, 0x10000, v13
  v_xor_b32 v14, 0x10000, v14
  v_xor_b32 v15, 0x10000, v15
  s_waitcnt vmcnt(4) lgkmcnt(0)
  s_barrier
  v_mfma_f32_16x16x32_bf16 a[164:167], a[112:115], v[72:75], a[164:167]
  ds_read_b128 a[96:99], v4 offset:0
  s_add_u32 s56, s56, 16384
  v_mfma_f32_16x16x32_bf16 a[168:171], a[112:115], v[76:79], a[168:171]
  ds_read_b128 a[100:103], v5 offset:0
  v_add_f32 v26, v26, v0
  v_mfma_f32_16x16x32_bf16 a[172:175], a[116:119], v[68:71], a[172:175]
  ds_read_b128 a[104:107], v6 offset:0
  v_cvt_pk_bf16_f32 v58, v0, v1
  v_mfma_f32_16x16x32_bf16 a[176:179], a[116:119], v[72:75], a[176:179]
  ds_read_b128 a[108:111], v7 offset:0
  v_add_f32 v26, v26, v1
  v_mfma_f32_16x16x32_bf16 a[180:183], a[116:119], v[76:79], a[180:183]
  ds_read_b128 a[112:115], v4 offset:256
  v_add_f32 v26, v26, v2
  v_mfma_f32_16x16x32_bf16 a[184:187], a[120:123], v[68:71], a[184:187]
  v_cvt_pk_bf16_f32 v59, v2, v3
  v_add_f32 v26, v26, v3
  v_mfma_f32_16x16x32_bf16 a[188:191], a[120:123], v[72:75], a[188:191]
  v_exp_f32 v96, v96
  v_mfma_f32_16x16x32_bf16 a[192:195], a[120:123], v[76:79], a[192:195]
  v_exp_f32 v97, v97
  v_mfma_f32_16x16x32_bf16 a[196:199], a[124:127], v[68:71], a[196:199]
  v_exp_f32 v98, v98
  v_mfma_f32_16x16x32_bf16 a[200:203], a[124:127], v[72:75], a[200:203]
  v_exp_f32 v99, v99
  v_mfma_f32_16x16x32_bf16 a[204:207], a[124:127], v[76:79], a[204:207]
  v_add_f32 v27, v27, v96
  v_cvt_pk_bf16_f32 v62, v96, v97
  v_add_f32 v27, v27, v97
  v_add_f32 v27, v27, v98
  v_cvt_pk_bf16_f32 v63, v98, v99
  v_add_f32 v27, v27, v99
  v_exp_f32 v108, v108
  v_exp_f32 v109, v109
  v_exp_f32 v110, v110
  v_exp_f32 v111, v111
  v_add_f32 v28, v28, v108
  v_cvt_pk_bf16_f32 v66, v108, v109
  v_add_f32 v28, v28, v109
  v_add_f32 v28, v28, v110
  v_cvt_pk_bf16_f32 v67, v110, v111
  v_add_f32 v28, v28, v111
  v_max3_f32 v29, v26, v27, v28
  v_cmp_lt_f32 vcc, 0x44800000, v29
  s_nop 0
  s_cbranch_vccz L_ok35
  s_swappc_b64 s[70:71], s[72:73]
L_ok35:
  v_add_f32 v20, v20, v26
  v_add_f32 v21, v21, v27
  v_add_f32 v22, v22, v28
  s_sub_u32 s60, s60, 1
  s_cmp_lg_u32 s60, 0
  s_cbranch_scc1 L_attA
L_preA:
  s_mul_i32 s64, s27, 28672
  s_mul_i32 s65, s52, 7168
  s_add_u32 s64, s64, s65
  s_mul_i32 s67, s26, 458752
  s_add_u32 s44, s22, s67
  s_addc_u32 s45, s23, 0
  s_and_b32 s45, s45, 0xffff
  s_mov_b32 s46, 458752
  s_mov_b32 s47, 0x20000
  s_waitcnt lgkmcnt(3)
  v_mfma_f32_16x16x32_bf16 v[32:35], a[96:99], a[0:3], 0
  ds_read_b128 a[116:119], v5 offset:256
  v_mfma_f32_16x16x32_bf16 v[36:39], a[96:99], a[4:7], 0
  ds_write_b128 v93, a[144:147] offset:0
  v_mfma_f32_16x16x32_bf16 v[40:43], a[96:99], a[8:11], 0
  ds_write_b128 v93, a[148:151] offset:1024
  v_mfma_f32_16x16x32_bf16 v[32:35], a[100:103], a[12:15], v[32:35]
  ds_read_b128 a[120:123], v6 offset:256
  v_mfma_f32_16x16x32_bf16 v[36:39], a[100:103], a[16:19], v[36:39]
  ds_write_b128 v93, a[152:155] offset:2048
  v_mfma_f32_16x16x32_bf16 v[40:43], a[100:103], a[20:23], v[40:43]
  s_waitcnt lgkmcnt(6)
  v_mfma_f32_16x16x32_bf16 v[32:35], a[104:107], a[24:27], v[32:35]
  ds_read_b128 a[124:127], v7 offset:256
  v_mfma_f32_16x16x32_bf16 v[36:39], a[104:107], a[28:31], v[36:39]
  ds_write_b128 v93, a[156:159] offset:3072
  v_mfma_f32_16x16x32_bf16 v[40:43], a[104:107], a[32:35], v[40:43]
  s_add_u32 s66, s64, 0
  buffer_load_dwordx4 a[128:131], v92, s[40:43], s66 offen
  v_mfma_f32_16x16x32_bf16 v[32:35], a[108:111], a[36:39], v[32:35]
  ds_read_b128 a[96:99], v4 offset:8192
  v_mfma_f32_16x16x32_bf16 v[36:39], a[108:111], a[40:43], v[36:39]
  v_mfma_f32_16x16x32_bf16 v[40:43], a[108:111], a[44:47], v[40:43]
  s_waitcnt lgkmcnt(7)
  v_mfma_f32_16x16x32_bf16 v[32:35], a[112:115], a[48:51], v[32:35]
  ds_read_b128 a[100:103], v5 offset:8192
  s_add_u32 s66, s64, 1024
  buffer_load_dwordx4 a[128:131], v92, s[40:43], s66 offen
  v_mfma_f32_16x16x32_bf16 v[36:39], a[112:115], a[52:55], v[36:39]
  v_mfma_f32_16x16x32_bf16 v[40:43], a[112:115], a[56:59], v[40:43]
  v_mfma_f32_16x16x32_bf16 v[32:35], a[116:119], a[60:63], v[32:35]
  ds_read_b128 a[104:107], v6 offset:8192
  v_mfma_f32_16x16x32_bf16 v[36:39], a[116:119], a[64:67], v[36:39]
  s_add_u32 s66, s64, 2048
  buffer_load_dwordx4 a[128:131], v92, s[40:43], s66 offen
  v_mfma_f32_16x16x32_bf16 v[40:43], a[116:119], a[68:71], v[40:43]
  s_waitcnt lgkmcnt(4)
  v_mfma_f32_16x16x32_bf16 v[32:35], a[120:123], a[72:75], v[32:35]
  ds_read_b128 a[108:111], v7 offset:8192
  v_mfma_f32_16x16x32_bf16 v[36:39], a[120:123], a[76:79], v[36:39]
  v_mfma_f32_16x16x32_bf16 v[40:43], a[120:123], a[80:83], v[40:43]
  s_add_u32 s66, s64, 3072
  buffer_load_dwordx4 a[128:131], v92, s[40:43], s66 offen
  v_mfma_f32_16x16x32_bf16 v[32:35], a[124:127], a[84:87], v[32:35]
  ds_read_b128 a[112:115], v4 offset:8448
  v_mfma_f32_16x16x32_bf16 v[36:39], a[124:127], a[88:91], v[36:39]
  v_mfma_f32_16x16x32_bf16 v[40:43], a[124:127], a[92:95], v[40:43]
  s_waitcnt lgkmcnt(3)
  v_mfma_f32_16x16x32_bf16 v[44:47], a[96:99], a[0:3], 0
  ds_read_b128 a[116:119], v5 offset:8448
  s_add_u32 s66, s64, 4096
  buffer_load_dwordx4 a[128:131], v92, s[40:43], s66 offen
  v_mfma_f32_16x16x32_bf16 v[48:51], a[96:99], a[4:7], 0
  v_mfma_f32_16x16x32_bf16 v[52:55], a[96:99], a[8:11], 0
  v_mfma_f32_16x16x32_bf16 v[44:47], a[100:103], a[12:15], v[44:47]
  ds_read_b128 a[120:123], v6 offset:8448
  v_fma_f32 v0, v32, s63, -v23
  v_mfma_f32_16x16x32_bf16 v[48:51], a[100:103], a[16:19], v[48:51]
  s_add_u32 s66, s64, 5120
  buffer_load_dwordx4 a[128:131], v92, s[40:43], s66 offen
  v_mfma_f32_16x16x32_bf16 v[52:55], a[100:103], a[20:23], v[52:55]
  v_fma_f32 v1, v33, s63, -v23
  s_waitcnt lgkmcnt(3)
  v_mfma_f32_16x16x32_bf16 v[44:47], a[104:107], a[24:27], v[44:47]
  ds_read_b128 a[124:127], v7 offset:8448
  v_fma_f32 v2, v34, s63, -v23
  v_mfma_f32_16x16x32_bf16 v[48:51], a[104:107], a[28:31], v[48:51]
  v_fma_f32 v3, v35, s63, -v23
  v_fma_f32 v96, v36, s63, -v24
  v_mfma_f32_16x16x32_bf16 v[52:55], a[104:107], a[32:35], v[52:55]
  s_add_u32 s66, s64, 6144
  buffer_load_dwordx4 a[128:131], v92, s[40:43], s66 offen
  v_mfma_f32_16x16x32_bf16 v[44:47], a[108:111], a[36:39], v[44:47]
  v_xor_b32 v4, 0x10000, v4
  v_xor_b32 v5, 0x10000, v5
  v_mfma_f32_16x16x32_bf16 v[48:51], a[108:111], a[40:43], v[48:51]
  v_xor_b32 v6, 0x10000, v6
  v_xor_b32 v7, 0x10000, v7
  v_mfma_f32_16x16x32_bf16 v[52:55], a[108:111], a[44:47], v[52:55]
  v_fma_f32 v97, v37, s63, -v24
  s_waitcnt lgkmcnt(2)
  v_mfma_f32_16x16x32_bf16 v[44:47], a[112:115], a[48:51], v[44:47]
  s_waitcnt vmcnt(7) lgkmcnt(0)
  s_barrier
  v_mfma_f32_16x16x32_bf16 v[48:51], a[112:115], a[52:55], v[48:51]
  ds_read_b64_tr_b16 a[96:97], v8 offset:0
  v_fma_f32 v98, v38, s63, -v24
  v_mfma_f32_16x16x32_bf16 v[52:55], a[112:115], a[56:59], v[52:55]
  ds_read_b64_tr_b16 a[98:99], v8 offset:8192
  v_fma_f32 v99, v39, s63, -v24
  v_mfma_f32_16x16x32_bf16 v[44:47], a[116:119], a[60:63], v[44:47]
  ds_read_b64_tr_b16 a[100:101], v9 offset:0
  v_fma_f32 v108, v40, s63, -v25
  v_mfma_f32_16x16x32_bf16 v[48:51], a[116:119], a[64:67], v[48:51]
  ds_read_b64_tr_b16 a[102:103], v9 offset:8192
  v_fma_f32 v109, v41, s63, -v25
  v_mfma_f32_16x16x32_bf16 v[52:55], a[116:119], a[68:71], v[52:55]
  ds_read_b64_tr_b16 a[104:105], v10 offset:0
  v_fma_f32 v110, v42, s63, -v25
  v_mfma_f32_16x16x32_bf16 v[44:47], a[120:123], a[72:75], v[44:47]
  ds_read_b64_tr_b16 a[106:107], v10 offset:8192
  v_fma_f32 v111, v43, s63, -v25
  v_mfma_f32_16x16x32_bf16 v[48:51], a[120:123], a[76:79], v[48:51]
  ds_read_b64_tr_b16 a[108:109], v11 offset:0
  v_mfma_f32_16x16x32_bf16 v[52:55], a[120:123], a[80:83], v[52:55]
  ds_read_b64_tr_b16 a[110:111], v11 offset:8192
  v_mfma_f32_16x16x32_bf16 v[44:47], a[124:127], a[84:87], v[44:47]
  ds_read_b64_tr_b16 a[112:113], v12 offset:0
  v_mfma_f32_16x16x32_bf16 v[48:51], a[124:127], a[88:91], v[48:51]
  ds_read_b64_tr_b16 a[114:115], v12 offset:8192
  v_mfma_f32_16x16x32_bf16 v[52:55], a[124:127], a[92:95], v[52:55]
  v_exp_f32 v0, v0
  v_exp_f32 v1, v1
  v_exp_f32 v2, v2
  v_exp_f32 v3, v3
  v_add_f32 v26, v0, v1
  v_cvt_pk_bf16_f32 v68, v0, v1
  v_add_f32 v26, v26, v2
  v_cvt_pk_bf16_f32 v69, v2, v3
  v_add_f32 v26, v26, v3
  v_exp_f32 v96, v96
  v_exp_f32 v97, v97
  v_exp_f32 v98, v98
  v_exp_f32 v99, v99
  v_add_f32 v27, v96, v97
  v_cvt_pk_bf16_f32 v72, v96, v97
  v_add_f32 v27, v27, v98
  v_cvt_pk_bf16_f32 v73, v98, v99
  v_add_f32 v27, v27, v99
  v_exp_f32 v108, v108
  v_exp_f32 v109, v109
  v_exp_f32 v110, v110
  v_exp_f32 v111, v111
  v_add_f32 v28, v108, v109
  v_cvt_pk_bf16_f32 v76, v108, v109
  v_add_f32 v28, v28, v110
  v_cvt_pk_bf16_f32 v77, v110, v111
  v_add_f32 v28, v28, v111
  s_waitcnt lgkmcnt(6)
  v_mfma_f32_16x16x32_bf16 v[112:115], a[96:99], v[56:59], v[112:115]
  ds_read_b64_tr_b16 a[116:117], v13 offset:0
  v_mfma_f32_16x16x32_bf16 v[116:119], a[96:99], v[60:63], v[116:119]
  ds_read_b64_tr_b16 a[118:119], v13 offset:8192
  v_mfma_f32_16x16x32_bf16 v[120:123], a[96:99], v[64:67], v[120:123]
  ds_write_b128 v93, a[208:211] offset:16384
  v_mfma_f32_16x16x32_bf16 v[124:127], a[100:103], v[56:59], v[124:127]
  ds_read_b64_tr_b16 a[120:121], v14 offset:0
  v_fma_f32 v0, v44, s63, -v23
  v_mfma_f32_16x16x32_bf16 v[128:131], a[100:103], v[60:63], v[128:131]
  ds_read_b64_tr_b16 a[122:123], v14 offset:8192
  v_fma_f32 v1, v45, s63, -v23
  v_mfma_f32_16x16x32_bf16 v[132:135], a[100:103], v[64:67], v[132:135]
  v_fma_f32 v2, v46, s63, -v23
  s_waitcnt lgkmcnt(7)
  v_mfma_f32_16x16x32_bf16 v[136:139], a[104:107], v[56:59], v[136:139]
  ds_read_b64_tr_b16 a[124:125], v15 offset:0
  v_fma_f32 v3, v47, s63, -v23
  v_mfma_f32_16x16x32_bf16 v[140:143], a[104:107], v[60:63], v[140:143]
  ds_read_b64_tr_b16 a[126:127], v15 offset:8192
  v_fma_f32 v96, v48, s63, -v24
  v_mfma_f32_16x16x32_bf16 v[144:147], a[104:107], v[64:67], v[144:147]
  ds_write_b128 v93, a[212:215] offset:17408
  v_mfma_f32_16x16x32_bf16 v[148:151], a[108:111], v[56:59], v[148:151]
  ds_read_b64_tr_b16 a[96:97], v8 offset:256
  v_fma_f32 v97, v49, s63, -v24
  v_mfma_f32_16x16x32_bf16 v[152:155], a[108:111], v[60:63], v[152:155]
  ds_read_b64_tr_b16 a[98:99], v8 offset:8448
  v_fma_f32 v98, v50, s63, -v24
  v_mfma_f32_16x16x32_bf16 v[156:159], a[108:111], v[64:67], v[156:159]
  v_fma_f32 v99, v51, s63, -v24
  s_waitcnt lgkmcnt(8)
  v_mfma_f32_16x16x32_bf16 v[160:163], a[112:115], v[56:59], v[160:163]
  ds_read_b64_tr_b16 a[100:101], v9 offset:256
  v_fma_f32 v108, v52, s63, -v25
  v_mfma_f32_16x16x32_bf16 v[164:167], a[112:115], v[60:63], v[164:167]
  ds_read_b64_tr_b16 a[102:103], v9 offset:8448
  v_fma_f32 v109, v53, s63, -v25
  v_mfma_f32_16x16x32_bf16 v[168:171], a[112:115], v[64:67], v[168:171]
  v_exp_f32 v0, v0
  v_mfma_f32_16x16x32_bf16 v[172:175], a[116:119], v[56:59], v[172:175]
  ds_read_b64_tr_b16 a[104:105], v10 offset:256
  v_fma_f32 v110, v54, s63, -v25
  v_mfma_f32_16x16x32_bf16 v[176:179], a[116:119], v[60:63], v[176:179]
  ds_read_b64_tr_b16 a[106:107], v10 offset:8448
  v_fma_f32 v111, v55, s63, -v25
  v_mfma_f32_16x16x32_bf16 v[180:183], a[116:119], v[64:67], v[180:183]
  s_waitcnt lgkmcnt(7)
  v_mfma_f32_16x16x32_bf16 v[184:187], a[120:123], v[56:59], v[184:187]
  ds_read_b64_tr_b16 a[108:109], v11 offset:256
  v_mfma_f32_16x16x32_bf16 v[188:191], a[120:123], v[60:63], v[188:191]
  ds_read_b64_tr_b16 a[110:111], v11 offset:8448
  v_mfma_f32_16x16x32_bf16 v[192:195], a[120:123], v[64:67], v[192:195]
  ds_write_b128 v93, a[216:219] offset:18432
  v_mfma_f32_16x16x32_bf16 v[196:199], a[124:127], v[56:59], v[196:199]
  ds_read_b64_tr_b16 a[112:113], v12 offset:256
  v_mfma_f32_16x16x32_bf16 v[200:203], a[124:127], v[60:63], v[200:203]
  ds_read_b64_tr_b16 a[114:115], v12 offset:8448
  v_mfma_f32_16x16x32_bf16 v[204:207], a[124:127], v[64:67], v[204:207]
  s_waitcnt lgkmcnt(7)
  v_mfma_f32_16x16x32_bf16 v[208:211], a[96:99], v[56:59], v[208:211]
  ds_read_b64_tr_b16 a[116:117], v13 offset:256
  v_mfma_f32_16x16x32_bf16 v[212:215], a[96:99], v[60:63], v[212:215]
  ds_read_b64_tr_b16 a[118:119], v13 offset:8448
  v_mfma_f32_16x16x32_bf16 v[216:219], a[96:99], v[64:67], v[216:219]
  ds_write_b128 v93, a[220:223] offset:19456
  v_mfma_f32_16x16x32_bf16 v[220:223], a[100:103], v[56:59], v[220:223]
  ds_read_b64_tr_b16 a[120:121], v14 offset:256
  s_add_u32 s66, s64, 0
  buffer_load_dwordx4 a[128:131], v92, s[44:47], s66 offen
  v_mfma_f32_16x16x32_bf16 v[224:227], a[100:103], v[60:63], v[224:227]
  ds_read_b64_tr_b16 a[122:123], v14 offset:8448
  v_mfma_f32_16x16x32_bf16 v[228:231], a[100:103], v[64:67], v[228:231]
  s_waitcnt lgkmcnt(8)
  v_mfma_f32_16x16x32_bf16 v[232:235], a[104:107], v[56:59], v[232:235]
  ds_read_b64_tr_b16 a[124:125], v15 offset:256
  v_mfma_f32_16x16x32_bf16 v[236:239], a[104:107], v[60:63], v[236:239]
  ds_read_b64_tr_b16 a[126:127], v15 offset:8448
  s_add_u32 s66, s64, 1024
  buffer_load_dwordx4 a[128:131], v92, s[44:47], s66 offen
  v_mfma_f32_16x16x32_bf16 v[240:243], a[104:107], v[64:67], v[240:243]
  v_exp_f32 v1, v1
  v_mfma_f32_16x16x32_bf16 v[244:247], a[108:111], v[56:59], v[244:247]
  v_xor_b32 v8, 0x18000, v8
  v_xor_b32 v9, 0x18000, v9
  v_mfma_f32_16x16x32_bf16 v[248:251], a[108:111], v[60:63], v[248:251]
  v_xor_b32 v10, 0x18000, v10
  v_xor_b32 v11, 0x18000, v11
  v_mfma_f32_16x16x32_bf16 v[252:255], a[108:111], v[64:67], v[252:255]
  s_add_u32 s66, s64, 2048
  buffer_load_dwordx4 a[128:131], v92, s[44:47], s66 offen
  s_waitcnt lgkmcnt(5)
  v_mfma_f32_16x16x32_bf16 a[160:163], a[112:115], v[56:59], a[160:163]
  s_add_u32 s66, s64, 3072
  buffer_load_dwordx4 a[128:131], v92, s[44:47], s66 offen
  s_add_u32 s66, s64, 4096
  buffer_load_dwordx4 a[128:131], v92, s[44:47], s66 offen
  s_add_u32 s66, s64, 5120
  buffer_load_dwordx4 a[128:131], v92, s[44:47], s66 offen
  s_add_u32 s66, s64, 6144
  buffer_load_dwordx4 a[128:131], v92, s[44:47], s66 offen
  v_xor_b32 v12, 0x18000, v12
  v_xor_b32 v13, 0x18000, v13
  v_xor_b32 v14, 0x18000, v14
  v_xor_b32 v15, 0x18000, v15
  s_waitcnt lgkmcnt(0)
  s_barrier
  v_mfma_f32_16x16x32_bf16 a[164:167], a[112:115], v[60:63], a[164:167]
  ds_read_b128 a[96:99], v4 offset:0
  v_mfma_f32_16x16x32_bf16 a[168:171], a[112:115], v[64:67], a[168:171]
  ds_read_b128 a[100:103], v5 offset:0
  v_mfma_f32_16x16x32_bf16 a[172:175], a[116:119], v[56:59], a[172:175]
  ds_read_b128 a[104:107], v6 offset:0
  v_mfma_f32_16x16x32_bf16 a[176:179], a[116:119], v[60:63], a[176:179]
  ds_read_b128 a[108:111], v7 offset:0
  v_mfma_f32_16x16x32_bf16 a[180:183], a[116:119], v[64:67], a[180:183]
  ds_read_b128 a[112:115], v4 offset:256
  v_mfma_f32_16x16x32_bf16 a[184:187], a[120:123], v[56:59], a[184:187]
  v_exp_f32 v2, v2
  v_mfma_f32_16x16x32_bf16 a[188:191], a[120:123], v[60:63], a[188:191]
  v_exp_f32 v3, v3
  v_mfma_f32_16x16x32_bf16 a[192:195], a[120:123], v[64:67], a[192:195]
  v_add_f32 v26, v26, v0
  v_cvt_pk_bf16_f32 v70, v0, v1
  v_mfma_f32_16x16x32_bf16 a[196:199], a[124:127], v[56:59], a[196:199]
  v_add_f32 v26, v26, v1
  v_add_f32 v26, v26, v2
  v_mfma_f32_16x16x32_bf16 a[200:203], a[124:127], v[60:63], a[200:203]
  v_cvt_pk_bf16_f32 v71, v2, v3
  v_add_f32 v26, v26, v3
  v_mfma_f32_16x16x32_bf16 a[204:207], a[124:127], v[64:67], a[204:207]
  v_exp_f32 v96, v96
  v_exp_f32 v97, v97
  v_exp_f32 v98, v98
  v_exp_f32 v99, v99
  v_add_f32 v27, v27, v96
  v_cvt_pk_bf16_f32 v74, v96, v97
  v_add_f32 v27, v27, v97
  v_add_f32 v27, v27, v98
  v_cvt_pk_bf16_f32 v75, v98, v99
  v_add_f32 v27, v27, v99
  v_exp_f32 v108, v108
  v_exp_f32 v109, v109
  v_exp_f32 v110, v110
  v_exp_f32 v111, v111
  v_add_f32 v28, v28, v108
  v_cvt_pk_bf16_f32 v78, v108, v109
  v_add_f32 v28, v28, v109
  v_add_f32 v28, v28, v110
  v_cvt_pk_bf16_f32 v79, v110, v111
  v_add_f32 v28, v28, v111
  v_max3_f32 v29, v26, v27, v28
  v_cmp_lt_f32 vcc, 0x44800000, v29
  s_nop 0
  s_cbranch_vccz L_ok36
  s_swappc_b64 s[70:71], s[74:75]
L_ok36:
  v_add_f32 v20, v20, v26
  v_add_f32 v21, v21, v27
  v_add_f32 v22, v22, v28
  s_waitcnt lgkmcnt(3)
  v_mfma_f32_16x16x32_bf16 v[32:35], a[96:99], a[0:3], 0
  ds_read_b128 a[116:119], v5 offset:256
  v_mfma_f32_16x16x32_bf16 v[36:39], a[96:99], a[4:7], 0
  ds_write_b128 v94, a[224:227] offset:0
  v_mfma_f32_16x16x32_bf16 v[40:43], a[96:99], a[8:11], 0
  ds_write_b128 v94, a[228:231] offset:1024
  v_mfma_f32_16x16x32_bf16 v[32:35], a[100:103], a[12:15], v[32:35]
  ds_read_b128 a[120:123], v6 offset:256
  v_mfma_f32_16x16x32_bf16 v[36:39], a[100:103], a[16:19], v[36:39]
  ds_write_b128 v94, a[232:235] offset:2048
  v_mfma_f32_16x16x32_bf16 v[40:43], a[100:103], a[20:23], v[40:43]
  s_waitcnt lgkmcnt(6)
  v_mfma_f32_16x16x32_bf16 v[32:35], a[104:107], a[24:27], v[32:35]
  ds_read_b128 a[124:127], v7 offset:256
  v_mfma_f32_16x16x32_bf16 v[36:39], a[104:107], a[28:31], v[36:39]
  ds_write_b128 v94, a[236:239] offset:3072
  v_mfma_f32_16x16x32_bf16 v[40:43], a[104:107], a[32:35], v[40:43]
  v_mfma_f32_16x16x32_bf16 v[32:35], a[108:111], a[36:39], v[32:35]
  ds_read_b128 a[96:99], v4 offset:8192
  v_mfma_f32_16x16x32_bf16 v[36:39], a[108:111], a[40:43], v[36:39]
  v_mfma_f32_16x16x32_bf16 v[40:43], a[108:111], a[44:47], v[40:43]
  s_waitcnt lgkmcnt(7)
  v_mfma_f32_16x16x32_bf16 v[32:35], a[112:115], a[48:51], v[32:35]
  ds_read_b128 a[100:103], v5 offset:8192
  v_mfma_f32_16x16x32_bf16 v[36:39], a[112:115], a[52:55], v[36:39]
  v_mfma_f32_16x16x32_bf16 v[40:43], a[112:115], a[56:59], v[40:43]
  v_mfma_f32_16x16x32_bf16 v[32:35], a[116:119], a[60:63], v[32:35]
  ds_read_b128 a[104:107], v6 offset:8192
  v_mfma_f32_16x16x32_bf16 v[36:39], a[116:119], a[64:67], v[36:39]
  v_mfma_f32_16x16x32_bf16 v[40:43], a[116:119], a[68:71], v[40:43]
  s_waitcnt lgkmcnt(4)
  v_mfma_f32_16x16x32_bf16 v[32:35], a[120:123], a[72:75], v[32:35]
  ds_read_b128 a[108:111], v7 offset:8192
  v_mfma_f32_16x16x32_bf16 v[36:39], a[120:123], a[76:79], v[36:39]
  v_mfma_f32_16x16x32_bf16 v[40:43], a[120:123], a[80:83], v[40:43]
  v_mfma_f32_16x16x32_bf16 v[32:35], a[124:127], a[84:87], v[32:35]
  ds_read_b128 a[112:115], v4 offset:8448
  v_mfma_f32_16x16x32_bf16 v[36:39], a[124:127], a[88:91], v[36:39]
  v_mfma_f32_16x16x32_bf16 v[40:43], a[124:127], a[92:95], v[40:43]
  s_waitcnt lgkmcnt(3)
  v_mfma_f32_16x16x32_bf16 v[44:47], a[96:99], a[0:3], 0
  ds_read_b128 a[116:119], v5 offset:8448
  v_mfma_f32_16x16x32_bf16 v[48:51], a[96:99], a[4:7], 0
  v_mfma_f32_16x16x32_bf16 v[52:55], a[96:99], a[8:11], 0
  v_mfma_f32_16x16x32_bf16 v[44:47], a[100:103], a[12:15], v[44:47]
  ds_read_b128 a[120:123], v6 offset:8448
  v_fma_f32 v0, v32, s63, -v23
  v_mfma_f32_16x16x32_bf16 v[48:51], a[100:103], a[16:19], v[48:51]
  v_fma_f32 v1, v33, s63, -v23
  v_fma_f32 v2, v34, s63, -v23
  v_mfma_f32_16x16x32_bf16 v[52:55], a[100:103], a[20:23], v[52:55]
  v_fma_f32 v3, v35, s63, -v23
  s_waitcnt lgkmcnt(3)
  v_mfma_f32_16x16x32_bf16 v[44:47], a[104:107], a[24:27], v[44:47]
  ds_read_b128 a[124:127], v7 offset:8448
  v_fma_f32 v96, v36, s63, -v24
  v_mfma_f32_16x16x32_bf16 v[48:51], a[104:107], a[28:31], v[48:51]
  v_exp_f32 v0, v0
  v_mfma_f32_16x16x32_bf16 v[52:55], a[104:107], a[32:35], v[52:55]
  v_exp_f32 v1, v1
  v_mfma_f32_16x16x32_bf16 v[44:47], a[108:111], a[36:39], v[44:47]
  v_xor_b32 v4, 0x18000, v4
  v_xor_b32 v5, 0x18000, v5
  v_mfma_f32_16x16x32_bf16 v[48:51], a[108:111], a[40:43], v[48:51]
  v_xor_b32 v6, 0x18000, v6
  v_xor_b32 v7, 0x18000, v7
  v_mfma_f32_16x16x32_bf16 v[52:55], a[108:111], a[44:47], v[52:55]
  v_fma_f32 v97, v37, s63, -v24
  s_waitcnt lgkmcnt(2)
  v_mfma_f32_16x16x32_bf16 v[44:47], a[112:115], a[48:51], v[44:47]
  s_waitcnt lgkmcnt(0)
  s_barrier
  v_mfma_f32_16x16x32_bf16 v[48:51], a[112:115], a[52:55], v[48:51]
  ds_read_b64_tr_b16 a[96:97], v8 offset:0
  v_fma_f32 v98, v38, s63, -v24
  v_mfma_f32_16x16x32_bf16 v[52:55], a[112:115], a[56:59], v[52:55]
  ds_read_b64_tr_b16 a[98:99], v8 offset:8192
  v_fma_f32 v99, v39, s63, -v24
  v_mfma_f32_16x16x32_bf16 v[44:47], a[116:119], a[60:63], v[44:47]
  ds_read_b64_tr_b16 a[100:101], v9 offset:0
  v_fma_f32 v108, v40, s63, -v25
  v_mfma_f32_16x16x32_bf16 v[48:51], a[116:119], a[64:67], v[48:51]
  ds_read_b64_tr_b16 a[102:103], v9 offset:8192
  v_fma_f32 v109, v41, s63, -v25
  v_mfma_f32_16x16x32_bf16 v[52:55], a[116:119], a[68:71], v[52:55]
  ds_read_b64_tr_b16 a[104:105], v10 offset:0
  v_fma_f32 v110, v42, s63, -v25
  v_mfma_f32_16x16x32_bf16 v[44:47], a[120:123], a[72:75], v[44:47]
  ds_read_b64_tr_b16 a[106:107], v10 offset:8192
  v_fma_f32 v111, v43, s63, -v25
  v_mfma_f32_16x16x32_bf16 v[48:51], a[120:123], a[76:79], v[48:51]
  ds_read_b64_tr_b16 a[108:109], v11 offset:0
  v_mfma_f32_16x16x32_bf16 v[52:55], a[120:123], a[80:83], v[52:55]
  ds_read_b64_tr_b16 a[110:111], v11 offset:8192
  v_mfma_f32_16x16x32_bf16 v[44:47], a[124:127], a[84:87], v[44:47]
  ds_read_b64_tr_b16 a[112:113], v12 offset:0
  v_mfma_f32_16x16x32_bf16 v[48:51], a[124:127], a[88:91], v[48:51]
  ds_read_b64_tr_b16 a[114:115], v12 offset:8192
  v_mfma_f32_16x16x32_bf16 v[52:55], a[124:127], a[92:95], v[52:55]
  v_exp_f32 v2, v2
  v_exp_f32 v3, v3
  v_add_f32 v26, v0, v1
  v_cvt_pk_bf16_f32 v56, v0, v1
  v_add_f32 v26, v26, v2
  v_cvt_pk_bf16_f32 v57, v2, v3
  v_add_f32 v26, v26, v3
  v_exp_f32 v96, v96
  v_exp_f32 v97, v97
  v_exp_f32 v98, v98
  v_exp_f32 v99, v99
  v_add_f32 v27, v96, v97
  v_cvt_pk_bf16_f32 v60, v96, v97
  v_add_f32 v27, v27, v98
  v_cvt_pk_bf16_f32 v61, v98, v99
  v_add_f32 v27, v27, v99
  v_exp_f32 v108, v108
  v_exp_f32 v109, v109
  v_exp_f32 v110, v110
  v_exp_f32 v111, v111
  v_add_f32 v28, v108, v109
  v_cvt_pk_bf16_f32 v64, v108, v109
  v_add_f32 v28, v28, v110
  v_cvt_pk_bf16_f32 v65, v110, v111
  v_add_f32 v28, v28, v111
  s_waitcnt lgkmcnt(6)
  v_mfma_f32_16x16x32_bf16 v[112:115], a[96:99], v[68:71], v[112:115]
  ds_read_b64_tr_b16 a[116:117], v13 offset:0
  v_mfma_f32_16x16x32_bf16 v[116:119], a[96:99], v[72:75], v[116:119]
  ds_read_b64_tr_b16 a[118:119], v13 offset:8192
  v_mfma_f32_16x16x32_bf16 v[120:123], a[96:99], v[76:79], v[120:123]
  v_mfma_f32_16x16x32_bf16 v[124:127], a[100:103], v[68:71], v[124:127]
  ds_read_b64_tr_b16 a[120:121], v14 offset:0
  v_fma_f32 v0, v44, s63, -v23
  v_mfma_f32_16x16x32_bf16 v[128:131], a[100:103], v[72:75], v[128:131]
  ds_read_b64_tr_b16 a[122:123], v14 offset:8192
  v_fma_f32 v1, v45, s63, -v23
  v_mfma_f32_16x16x32_bf16 v[132:135], a[100:103], v[76:79], v[132:135]
  v_fma_f32 v2, v46, s63, -v23
  s_waitcnt lgkmcnt(6)
  v_mfma_f32_16x16x32_bf16 v[136:139], a[104:107], v[68:71], v[136:139]
  ds_read_b64_tr_b16 a[124:125], v15 offset:0
  v_fma_f32 v3, v47, s63, -v23
  v_mfma_f32_16x16x32_bf16 v[140:143], a[104:107], v[72:75], v[140:143]
  ds_read_b64_tr_b16 a[126:127], v15 offset:8192
  v_fma_f32 v96, v48, s63, -v24
  v_mfma_f32_16x16x32_bf16 v[144:147], a[104:107], v[76:79], v[144:147]
  v_exp_f32 v0, v0
  v_mfma_f32_16x16x32_bf16 v[148:151], a[108:111], v[68:71], v[148:151]
  ds_read_b64_tr_b16 a[96:97], v8 offset:256
  v_fma_f32 v97, v49, s63, -v24
  v_mfma_f32_16x16x32_bf16 v[152:155], a[108:111], v[72:75], v[152:155]
  ds_read_b64_tr_b16 a[98:99], v8 offset:8448
  v_fma_f32 v98, v50, s63, -v24
  v_mfma_f32_16x16x32_bf16 v[156:159], a[108:111], v[76:79], v[156:159]
  v_fma_f32 v99, v51, s63, -v24
  s_waitcnt lgkmcnt(6)
  v_mfma_f32_16x16x32_bf16 v[160:163], a[112:115], v[68:71], v[160:163]
  ds_read_b64_tr_b16 a[100:101], v9 offset:256
  v_fma_f32 v108, v52, s63, -v25
  v_mfma_f32_16x16x32_bf16 v[164:167], a[112:115], v[72:75], v[164:167]
  ds_read_b64_tr_b16 a[102:103], v9 offset:8448
  v_fma_f32 v109, v53, s63, -v25
  v_mfma_f32_16x16x32_bf16 v[168:171], a[112:115], v[76:79], v[168:171]
  v_exp_f32 v1, v1
  v_mfma_f32_16x16x32_bf16 v[172:175], a[116:119], v[68:71], v[172:175]
  ds_read_b64_tr_b16 a[104:105], v10 offset:256
  v_fma_f32 v110, v54, s63, -v25
  v_mfma_f32_16x16x32_bf16 v[176:179], a[116:119], v[72:75], v[176:179]
  ds_read_b64_tr_b16 a[106:107], v10 offset:8448
  v_fma_f32 v111, v55, s63, -v25
  v_mfma_f32_16x16x32_bf16 v[180:183], a[116:119], v[76:79], v[180:183]
  s_waitcnt lgkmcnt(6)
  v_mfma_f32_16x16x32_bf16 v[184:187], a[120:123], v[68:71], v[184:187]
  ds_read_b64_tr_b16 a[108:109], v11 offset:256
  v_mfma_f32_16x16x32_bf16 v[188:191], a[120:123], v[72:75], v[188:191]
  ds_read_b64_tr_b16 a[110:111], v11 offset:8448
  v_mfma_f32_16x16x32_bf16 v[192:195], a[120:123], v[76:79], v[192:195]
  v_exp_f32 v2, v2
  v_mfma_f32_16x16x32_bf16 v[196:199], a[124:127], v[68:71], v[196:199]
  ds_read_b64_tr_b16 a[112:113], v12 offset:256
  v_mfma_f32_16x16x32_bf16 v[200:203], a[124:127], v[72:75], v[200:203]
  ds_read_b64_tr_b16 a[114:115], v12 offset:8448
  v_mfma_f32_16x16x32_bf16 v[204:207], a[124:127], v[76:79], v[204:207]
  s_waitcnt lgkmcnt(6)
  v_mfma_f32_16x16x32_bf16 v[208:211], a[96:99], v[68:71], v[208:211]
  ds_read_b64_tr_b16 a[116:117], v13 offset:256
  v_mfma_f32_16x16x32_bf16 v[212:215], a[96:99], v[72:75], v[212:215]
  ds_read_b64_tr_b16 a[118:119], v13 offset:8448
  v_mfma_f32_16x16x32_bf16 v[216:219], a[96:99], v[76:79], v[216:219]
  v_exp_f32 v3, v3
  v_mfma_f32_16x16x32_bf16 v[220:223], a[100:103], v[68:71], v[220:223]
  ds_read_b64_tr_b16 a[120:121], v14 offset:256
  v_add_f32 v26, v26, v0
  v_mfma_f32_16x16x32_bf16 v[224:227], a[100:103], v[72:75], v[224:227]
  ds_read_b64_tr_b16 a[122:123], v14 offset:8448
  v_cvt_pk_bf16_f32 v58, v0, v1
  v_mfma_f32_16x16x32_bf16 v[228:231], a[100:103], v[76:79], v[228:231]
  v_add_f32 v26, v26, v1
  s_waitcnt lgkmcnt(6)
  v_mfma_f32_16x16x32_bf16 v[232:235], a[104:107], v[68:71], v[232:235]
  ds_read_b64_tr_b16 a[124:125], v15 offset:256
  v_add_f32 v26, v26, v2
  v_mfma_f32_16x16x32_bf16 v[236:239], a[104:107], v[72:75], v[236:239]
  ds_read_b64_tr_b16 a[126:127], v15 offset:8448
  v_cvt_pk_bf16_f32 v59, v2, v3
  v_mfma_f32_16x16x32_bf16 v[240:243], a[104:107], v[76:79], v[240:243]
  v_add_f32 v26, v26, v3
  v_mfma_f32_16x16x32_bf16 v[244:247], a[108:111], v[68:71], v[244:247]
  v_xor_b32 v8, 0x28000, v8
  v_xor_b32 v9, 0x28000, v9
  v_mfma_f32_16x16x32_bf16 v[248:251], a[108:111], v[72:75], v[248:251]
  v_xor_b32 v10, 0x28000, v10
  v_xor_b32 v11, 0x28000, v11
  v_mfma_f32_16x16x32_bf16 v[252:255], a[108:111], v[76:79], v[252:255]
  v_xor_b32 v12, 0x28000, v12
  s_waitcnt lgkmcnt(4)
  v_mfma_f32_16x16x32_bf16 a[160:163], a[112:115], v[68:71], a[160:163]
  v_xor_b32 v13, 0x28000, v13
  v_xor_b32 v14, 0x28000, v14
  v_xor_b32 v15, 0x28000, v15
  s_waitcnt lgkmcnt(0)
  s_barrier
  v_mfma_f32_16x16x32_bf16 a[164:167], a[112:115], v[72:75], a[164:167]
  ds_read_b128 a[96:99], v4 offset:0
  v_mfma_f32_16x16x32_bf16 a[168:171], a[112:115], v[76:79], a[168:171]
  ds_read_b128 a[100:103], v5 offset:0
  v_mfma_f32_16x16x32_bf16 a[172:175], a[116:119], v[68:71], a[172:175]
  ds_read_b128 a[104:107], v6 offset:0
  v_mfma_f32_16x16x32_bf16 a[176:179], a[116:119], v[72:75], a[176:179]
  ds_read_b128 a[108:111], v7 offset:0
  v_mfma_f32_16x16x32_bf16 a[180:183], a[116:119], v[76:79], a[180:183]
  ds_read_b128 a[112:115], v4 offset:256
  v_mfma_f32_16x16x32_bf16 a[184:187], a[120:123], v[68:71], a[184:187]
  v_exp_f32 v96, v96
  v_mfma_f32_16x16x32_bf16 a[188:191], a[120:123], v[72:75], a[188:191]
  v_exp_f32 v97, v97
  v_mfma_f32_16x16x32_bf16 a[192:195], a[120:123], v[76:79], a[192:195]
  v_exp_f32 v98, v98
  v_mfma_f32_16x16x32_bf16 a[196:199], a[124:127], v[68:71], a[196:199]
  v_exp_f32 v99, v99
  v_mfma_f32_16x16x32_bf16 a[200:203], a[124:127], v[72:75], a[200:203]
  v_add_f32 v27, v27, v96
  v_cvt_pk_bf16_f32 v62, v96, v97
  v_mfma_f32_16x16x32_bf16 a[204:207], a[124:127], v[76:79], a[204:207]
  v_add_f32 v27, v27, v97
  v_add_f32 v27, v27, v98
  v_cvt_pk_bf16_f32 v63, v98, v99
  v_add_f32 v27, v27, v99
  v_exp_f32 v108, v108
  v_exp_f32 v109, v109
  v_exp_f32 v110, v110
  v_exp_f32 v111, v111
  v_add_f32 v28, v28, v108
  v_cvt_pk_bf16_f32 v66, v108, v109
  v_add_f32 v28, v28, v109
  v_add_f32 v28, v28, v110
  v_cvt_pk_bf16_f32 v67, v110, v111
  v_add_f32 v28, v28, v111
  v_max3_f32 v29, v26, v27, v28
  v_cmp_lt_f32 vcc, 0x44800000, v29
  s_nop 0
  s_cbranch_vccz L_ok37
  s_swappc_b64 s[70:71], s[72:73]
L_ok37:
  v_add_f32 v20, v20, v26
  v_add_f32 v21, v21, v27
  v_add_f32 v22, v22, v28
  s_waitcnt lgkmcnt(3)
  v_mfma_f32_16x16x32_bf16 v[32:35], a[96:99], a[0:3], 0
  ds_read_b128 a[116:119], v5 offset:256
  v_mfma_f32_16x16x32_bf16 v[36:39], a[96:99], a[4:7], 0
  ds_write_b128 v93, a[240:243] offset:32768
  v_mfma_f32_16x16x32_bf16 v[40:43], a[96:99], a[8:11], 0
  ds_write_b128 v93, a[244:247] offset:33792
  v_mfma_f32_16x16x32_bf16 v[32:35], a[100:103], a[12:15], v[32:35]
  ds_read_b128 a[120:123], v6 offset:256
  v_mfma_f32_16x16x32_bf16 v[36:39], a[100:103], a[16:19], v[36:39]
  ds_write_b128 v93, a[248:251] offset:34816
  v_mfma_f32_16x16x32_bf16 v[40:43], a[100:103], a[20:23], v[40:43]
  s_waitcnt lgkmcnt(6)
  v_mfma_f32_16x16x32_bf16 v[32:35], a[104:107], a[24:27], v[32:35]
  ds_read_b128 a[124:127], v7 offset:256
  v_mfma_f32_16x16x32_bf16 v[36:39], a[104:107], a[28:31], v[36:39]
  ds_write_b128 v93, a[252:255] offset:35840
  v_mfma_f32_16x16x32_bf16 v[40:43], a[104:107], a[32:35], v[40:43]
  v_mfma_f32_16x16x32_bf16 v[32:35], a[108:111], a[36:39], v[32:35]
  ds_read_b128 a[96:99], v4 offset:8192
  v_mfma_f32_16x16x32_bf16 v[36:39], a[108:111], a[40:43], v[36:39]
  v_mfma_f32_16x16x32_bf16 v[40:43], a[108:111], a[44:47], v[40:43]
  s_waitcnt lgkmcnt(7)
  v_mfma_f32_16x16x32_bf16 v[32:35], a[112:115], a[48:51], v[32:35]
  ds_read_b128 a[100:103], v5 offset:8192
  v_mfma_f32_16x16x32_bf16 v[36:39], a[112:115], a[52:55], v[36:39]
  v_mfma_f32_16x16x32_bf16 v[40:43], a[112:115], a[56:59], v[40:43]
  v_mfma_f32_16x16x32_bf16 v[32:35], a[116:119], a[60:63], v[32:35]
  ds_read_b128 a[104:107], v6 offset:8192
  v_mfma_f32_16x16x32_bf16 v[36:39], a[116:119], a[64:67], v[36:39]
  v_mfma_f32_16x16x32_bf16 v[40:43], a[116:119], a[68:71], v[40:43]
  s_waitcnt lgkmcnt(4)
  v_mfma_f32_16x16x32_bf16 v[32:35], a[120:123], a[72:75], v[32:35]
  ds_read_b128 a[108:111], v7 offset:8192
  v_mfma_f32_16x16x32_bf16 v[36:39], a[120:123], a[76:79], v[36:39]
  v_mfma_f32_16x16x32_bf16 v[40:43], a[120:123], a[80:83], v[40:43]
  v_mfma_f32_16x16x32_bf16 v[32:35], a[124:127], a[84:87], v[32:35]
  ds_read_b128 a[112:115], v4 offset:8448
  v_mfma_f32_16x16x32_bf16 v[36:39], a[124:127], a[88:91], v[36:39]
  v_mfma_f32_16x16x32_bf16 v[40:43], a[124:127], a[92:95], v[40:43]
  s_waitcnt lgkmcnt(3)
  v_mfma_f32_16x16x32_bf16 v[44:47], a[96:99], a[0:3], 0
  ds_read_b128 a[116:119], v5 offset:8448
  v_mfma_f32_16x16x32_bf16 v[48:51], a[96:99], a[4:7], 0
  v_mfma_f32_16x16x32_bf16 v[52:55], a[96:99], a[8:11], 0
  v_mfma_f32_16x16x32_bf16 v[44:47], a[100:103], a[12:15], v[44:47]
  ds_read_b128 a[120:123], v6 offset:8448
  v_fma_f32 v0, v32, s63, -v23
  v_mfma_f32_16x16x32_bf16 v[48:51], a[100:103], a[16:19], v[48:51]
  v_fma_f32 v1, v33, s63, -v23
  v_fma_f32 v2, v34, s63, -v23
  v_mfma_f32_16x16x32_bf16 v[52:55], a[100:103], a[20:23], v[52:55]
  v_fma_f32 v3, v35, s63, -v23
  s_waitcnt lgkmcnt(3)
  v_mfma_f32_16x16x32_bf16 v[44:47], a[104:107], a[24:27], v[44:47]
  ds_read_b128 a[124:127], v7 offset:8448
  v_fma_f32 v96, v36, s63, -v24
  v_mfma_f32_16x16x32_bf16 v[48:51], a[104:107], a[28:31], v[48:51]
  v_exp_f32 v0, v0
  v_mfma_f32_16x16x32_bf16 v[52:55], a[104:107], a[32:35], v[52:55]
  v_exp_f32 v1, v1
  v_mfma_f32_16x16x32_bf16 v[44:47], a[108:111], a[36:39], v[44:47]
  v_xor_b32 v4, 0x28000, v4
  v_xor_b32 v5, 0x28000, v5
  v_mfma_f32_16x16x32_bf16 v[48:51], a[108:111], a[40:43], v[48:51]
  v_xor_b32 v6, 0x28000, v6
  v_xor_b32 v7, 0x28000, v7
  v_mfma_f32_16x16x32_bf16 v[52:55], a[108:111], a[44:47], v[52:55]
  v_fma_f32 v97, v37, s63, -v24
  s_waitcnt lgkmcnt(2)
  v_mfma_f32_16x16x32_bf16 v[44:47], a[112:115], a[48:51], v[44:47]
  s_waitcnt lgkmcnt(0)
  s_barrier
  v_mfma_f32_16x16x32_bf16 v[48:51], a[112:115], a[52:55], v[48:51]
  ds_read_b64_tr_b16 a[96:97], v8 offset:0
  v_fma_f32 v98, v38, s63, -v24
  v_mfma_f32_16x16x32_bf16 v[52:55], a[112:115], a[56:59], v[52:55]
  ds_read_b64_tr_b16 a[98:99], v8 offset:8192
  v_fma_f32 v99, v39, s63, -v24
  v_mfma_f32_16x16x32_bf16 v[44:47], a[116:119], a[60:63], v[44:47]
  ds_read_b64_tr_b16 a[100:101], v9 offset:0
  v_fma_f32 v108, v40, s63, -v25
  v_mfma_f32_16x16x32_bf16 v[48:51], a[116:119], a[64:67], v[48:51]
  ds_read_b64_tr_b16 a[102:103], v9 offset:8192
  v_fma_f32 v109, v41, s63, -v25
  v_mfma_f32_16x16x32_bf16 v[52:55], a[116:119], a[68:71], v[52:55]
  ds_read_b64_tr_b16 a[104:105], v10 offset:0
  v_fma_f32 v110, v42, s63, -v25
  v_mfma_f32_16x16x32_bf16 v[44:47], a[120:123], a[72:75], v[44:47]
  ds_read_b64_tr_b16 a[106:107], v10 offset:8192
  v_fma_f32 v111, v43, s63, -v25
  v_mfma_f32_16x16x32_bf16 v[48:51], a[120:123], a[76:79], v[48:51]
  ds_read_b64_tr_b16 a[108:109], v11 offset:0
  v_mfma_f32_16x16x32_bf16 v[52:55], a[120:123], a[80:83], v[52:55]
  ds_read_b64_tr_b16 a[110:111], v11 offset:8192
  v_mfma_f32_16x16x32_bf16 v[44:47], a[124:127], a[84:87], v[44:47]
  ds_read_b64_tr_b16 a[112:113], v12 offset:0
  v_mfma_f32_16x16x32_bf16 v[48:51], a[124:127], a[88:91], v[48:51]
  ds_read_b64_tr_b16 a[114:115], v12 offset:8192
  v_mfma_f32_16x16x32_bf16 v[52:55], a[124:127], a[92:95], v[52:55]
  v_exp_f32 v2, v2
  v_exp_f32 v3, v3
  v_add_f32 v26, v0, v1
  v_cvt_pk_bf16_f32 v68, v0, v1
  v_add_f32 v26, v26, v2
  v_cvt_pk_bf16_f32 v69, v2, v3
  v_add_f32 v26, v26, v3
  v_exp_f32 v96, v96
  v_exp_f32 v97, v97
  v_exp_f32 v98, v98
  v_exp_f32 v99, v99
  v_add_f32 v27, v96, v97
  v_cvt_pk_bf16_f32 v72, v96, v97
  v_add_f32 v27, v27, v98
  v_cvt_pk_bf16_f32 v73, v98, v99
  v_add_f32 v27, v27, v99
  v_exp_f32 v108, v108
  v_exp_f32 v109, v109
  v_exp_f32 v110, v110
  v_exp_f32 v111, v111
  v_add_f32 v28, v108, v109
  v_cvt_pk_bf16_f32 v76, v108, v109
  v_add_f32 v28, v28, v110
  v_cvt_pk_bf16_f32 v77, v110, v111
  v_add_f32 v28, v28, v111
  s_waitcnt lgkmcnt(6)
  v_mfma_f32_16x16x32_bf16 v[112:115], a[96:99], v[56:59], v[112:115]
  ds_read_b64_tr_b16 a[116:117], v13 offset:0
  v_mfma_f32_16x16x32_bf16 v[116:119], a[96:99], v[60:63], v[116:119]
  ds_read_b64_tr_b16 a[118:119], v13 offset:8192
  v_mfma_f32_16x16x32_bf16 v[120:123], a[96:99], v[64:67], v[120:123]
  v_mfma_f32_16x16x32_bf16 v[124:127], a[100:103], v[56:59], v[124:127]
  ds_read_b64_tr_b16 a[120:121], v14 offset:0
  v_fma_f32 v0, v44, s63, -v23
  v_mfma_f32_16x16x32_bf16 v[128:131], a[100:103], v[60:63], v[128:131]
  ds_read_b64_tr_b16 a[122:123], v14 offset:8192
  v_fma_f32 v1, v45, s63, -v23
  v_mfma_f32_16x16x32_bf16 v[132:135], a[100:103], v[64:67], v[132:135]
  v_fma_f32 v2, v46, s63, -v23
  s_waitcnt lgkmcnt(6)
  v_mfma_f32_16x16x32_bf16 v[136:139], a[104:107], v[56:59], v[136:139]
  ds_read_b64_tr_b16 a[124:125], v15 offset:0
  v_fma_f32 v3, v47, s63, -v23
  v_mfma_f32_16x16x32_bf16 v[140:143], a[104:107], v[60:63], v[140:143]
  ds_read_b64_tr_b16 a[126:127], v15 offset:8192
  v_fma_f32 v96, v48, s63, -v24
  v_mfma_f32_16x16x32_bf16 v[144:147], a[104:107], v[64:67], v[144:147]
  v_exp_f32 v0, v0
  v_mfma_f32_16x16x32_bf16 v[148:151], a[108:111], v[56:59], v[148:151]
  ds_read_b64_tr_b16 a[96:97], v8 offset:256
  v_fma_f32 v97, v49, s63, -v24
  v_mfma_f32_16x16x32_bf16 v[152:155], a[108:111], v[60:63], v[152:155]
  ds_read_b64_tr_b16 a[98:99], v8 offset:8448
  v_fma_f32 v98, v50, s63, -v24
  v_mfma_f32_16x16x32_bf16 v[156:159], a[108:111], v[64:67], v[156:159]
  v_fma_f32 v99, v51, s63, -v24
  s_waitcnt lgkmcnt(6)
  v_mfma_f32_16x16x32_bf16 v[160:163], a[112:115], v[56:59], v[160:163]
  ds_read_b64_tr_b16 a[100:101], v9 offset:256
  v_fma_f32 v108, v52, s63, -v25
  v_mfma_f32_16x16x32_bf16 v[164:167], a[112:115], v[60:63], v[164:167]
  ds_read_b64_tr_b16 a[102:103], v9 offset:8448
  v_fma_f32 v109, v53, s63, -v25
  v_mfma_f32_16x16x32_bf16 v[168:171], a[112:115], v[64:67], v[168:171]
  v_exp_f32 v1, v1
  v_mfma_f32_16x16x32_bf16 v[172:175], a[116:119], v[56:59], v[172:175]
  ds_read_b64_tr_b16 a[104:105], v10 offset:256
  v_fma_f32 v110, v54, s63, -v25
  v_mfma_f32_16x16x32_bf16 v[176:179], a[116:119], v[60:63], v[176:179]
  ds_read_b64_tr_b16 a[106:107], v10 offset:8448
  v_fma_f32 v111, v55, s63, -v25
  v_mfma_f32_16x16x32_bf16 v[180:183], a[116:119], v[64:67], v[180:183]
  s_waitcnt lgkmcnt(6)
  v_mfma_f32_16x16x32_bf16 v[184:187], a[120:123], v[56:59], v[184:187]
  ds_read_b64_tr_b16 a[108:109], v11 offset:256
  v_mfma_f32_16x16x32_bf16 v[188:191], a[120:123], v[60:63], v[188:191]
  ds_read_b64_tr_b16 a[110:111], v11 offset:8448
  v_mfma_f32_16x16x32_bf16 v[192:195], a[120:123], v[64:67], v[192:195]
  v_exp_f32 v2, v2
  v_mfma_f32_16x16x32_bf16 v[196:199], a[124:127], v[56:59], v[196:199]
  ds_read_b64_tr_b16 a[112:113], v12 offset:256
  v_mfma_f32_16x16x32_bf16 v[200:203], a[124:127], v[60:63], v[200:203]
  ds_read_b64_tr_b16 a[114:115], v12 offset:8448
  v_mfma_f32_16x16x32_bf16 v[204:207], a[124:127], v[64:67], v[204:207]
  s_waitcnt lgkmcnt(6)
  v_mfma_f32_16x16x32_bf16 v[208:211], a[96:99], v[56:59], v[208:211]
  ds_read_b64_tr_b16 a[116:117], v13 offset:256
  v_mfma_f32_16x16x32_bf16 v[212:215], a[96:99], v[60:63], v[212:215]
  ds_read_b64_tr_b16 a[118:119], v13 offset:8448
  v_mfma_f32_16x16x32_bf16 v[216:219], a[96:99], v[64:67], v[216:219]
  v_exp_f32 v3, v3
  v_mfma_f32_16x16x32_bf16 v[220:223], a[100:103], v[56:59], v[220:223]
  ds_read_b64_tr_b16 a[120:121], v14 offset:256
  v_add_f32 v26, v26, v0
  v_mfma_f32_16x16x32_bf16 v[224:227], a[100:103], v[60:63], v[224:227]
  ds_read_b64_tr_b16 a[122:123], v14 offset:8448
  v_cvt_pk_bf16_f32 v70, v0, v1
  v_mfma_f32_16x16x32_bf16 v[228:231], a[100:103], v[64:67], v[228:231]
  v_add_f32 v26, v26, v1
  s_waitcnt lgkmcnt(6)
  v_mfma_f32_16x16x32_bf16 v[232:235], a[104:107], v[56:59], v[232:235]
  ds_read_b64_tr_b16 a[124:125], v15 offset:256
  v_add_f32 v26, v26, v2
  v_mfma_f32_16x16x32_bf16 v[236:239], a[104:107], v[60:63], v[236:239]
  ds_read_b64_tr_b16 a[126:127], v15 offset:8448
  v_cvt_pk_bf16_f32 v71, v2, v3
  v_mfma_f32_16x16x32_bf16 v[240:243], a[104:107], v[64:67], v[240:243]
  v_add_f32 v26, v26, v3
  v_mfma_f32_16x16x32_bf16 v[244:247], a[108:111], v[56:59], v[244:247]
  v_xor_b32 v8, 0x20000, v8
  v_xor_b32 v9, 0x20000, v9
  v_mfma_f32_16x16x32_bf16 v[248:251], a[108:111], v[60:63], v[248:251]
  v_xor_b32 v10, 0x20000, v10
  v_xor_b32 v11, 0x20000, v11
  v_mfma_f32_16x16x32_bf16 v[252:255], a[108:111], v[64:67], v[252:255]
  v_xor_b32 v12, 0x20000, v12
  s_waitcnt lgkmcnt(4)
  v_mfma_f32_16x16x32_bf16 a[160:163], a[112:115], v[56:59], a[160:163]
  v_xor_b32 v13, 0x20000, v13
  v_xor_b32 v14, 0x20000, v14
  v_xor_b32 v15, 0x20000, v15
  s_waitcnt lgkmcnt(0)
  s_barrier
  v_mfma_f32_16x16x32_bf16 a[164:167], a[112:115], v[60:63], a[164:167]
  ds_read_b128 a[96:99], v4 offset:0
  v_mfma_f32_16x16x32_bf16 a[168:171], a[112:115], v[64:67], a[168:171]
  ds_read_b128 a[100:103], v5 offset:0
  v_mfma_f32_16x16x32_bf16 a[172:175], a[116:119], v[56:59], a[172:175]
  ds_read_b128 a[104:107], v6 offset:0
  v_mfma_f32_16x16x32_bf16 a[176:179], a[116:119], v[60:63], a[176:179]
  ds_read_b128 a[108:111], v7 offset:0
  v_mfma_f32_16x16x32_bf16 a[180:183], a[116:119], v[64:67], a[180:183]
  ds_read_b128 a[112:115], v4 offset:256
  v_mfma_f32_16x16x32_bf16 a[184:187], a[120:123], v[56:59], a[184:187]
  v_exp_f32 v96, v96
  v_mfma_f32_16x16x32_bf16 a[188:191], a[120:123], v[60:63], a[188:191]
  v_exp_f32 v97, v97
  v_mfma_f32_16x16x32_bf16 a[192:195], a[120:123], v[64:67], a[192:195]
  v_exp_f32 v98, v98
  v_mfma_f32_16x16x32_bf16 a[196:199], a[124:127], v[56:59], a[196:199]
  v_exp_f32 v99, v99
  v_mfma_f32_16x16x32_bf16 a[200:203], a[124:127], v[60:63], a[200:203]
  v_add_f32 v27, v27, v96
  v_cvt_pk_bf16_f32 v74, v96, v97
  v_mfma_f32_16x16x32_bf16 a[204:207], a[124:127], v[64:67], a[204:207]
  v_add_f32 v27, v27, v97
  v_add_f32 v27, v27, v98
  v_cvt_pk_bf16_f32 v75, v98, v99
  v_add_f32 v27, v27, v99
  v_exp_f32 v108, v108
  v_exp_f32 v109, v109
  v_exp_f32 v110, v110
  v_exp_f32 v111, v111
  v_add_f32 v28, v28, v108
  v_cvt_pk_bf16_f32 v78, v108, v109
  v_add_f32 v28, v28, v109
  v_add_f32 v28, v28, v110
  v_cvt_pk_bf16_f32 v79, v110, v111
  v_add_f32 v28, v28, v111
  v_max3_f32 v29, v26, v27, v28
  v_cmp_lt_f32 vcc, 0x44800000, v29
  s_nop 0
  s_cbranch_vccz L_ok38
  s_swappc_b64 s[70:71], s[74:75]
L_ok38:
  v_add_f32 v20, v20, v26
  v_add_f32 v21, v21, v27
  v_add_f32 v22, v22, v28
  s_waitcnt lgkmcnt(3)
  v_mfma_f32_16x16x32_bf16 v[32:35], a[96:99], a[0:3], 0
  ds_read_b128 a[116:119], v5 offset:256
  v_mfma_f32_16x16x32_bf16 v[36:39], a[96:99], a[4:7], 0
  v_mfma_f32_16x16x32_bf16 v[40:43], a[96:99], a[8:11], 0
  v_mfma_f32_16x16x32_bf16 v[32:35], a[100:103], a[12:15], v[32:35]
  ds_read_b128 a[120:123], v6 offset:256
  v_mfma_f32_16x16x32_bf16 v[36:39], a[100:103], a[16:19], v[36:39]
  v_mfma_f32_16x16x32_bf16 v[40:43], a[100:103], a[20:23], v[40:43]
  s_waitcnt lgkmcnt(3)
  v_mfma_f32_16x16x32_bf16 v[32:35], a[104:107], a[24:27], v[32:35]
  ds_read_b128 a[124:127], v7 offset:256
  v_mfma_f32_16x16x32_bf16 v[36:39], a[104:107], a[28:31], v[36:39]
  v_mfma_f32_16x16x32_bf16 v[40:43], a[104:107], a[32:35], v[40:43]
  v_mfma_f32_16x16x32_bf16 v[32:35], a[108:111], a[36:39], v[32:35]
  ds_read_b128 a[96:99], v4 offset:8192
  v_mfma_f32_16x16x32_bf16 v[36:39], a[108:111], a[40:43], v[36:39]
  v_mfma_f32_16x16x32_bf16 v[40:43], a[108:111], a[44:47], v[40:43]
  s_waitcnt lgkmcnt(3)
  v_mfma_f32_16x16x32_bf16 v[32:35], a[112:115], a[48:51], v[32:35]
  ds_read_b128 a[100:103], v5 offset:8192
  v_mfma_f32_16x16x32_bf16 v[36:39], a[112:115], a[52:55], v[36:39]
  v_mfma_f32_16x16x32_bf16 v[40:43], a[112:115], a[56:59], v[40:43]
  v_mfma_f32_16x16x32_bf16 v[32:35], a[116:119], a[60:63], v[32:35]
  ds_read_b128 a[104:107], v6 offset:8192
  v_mfma_f32_16x16x32_bf16 v[36:39], a[116:119], a[64:67], v[36:39]
  v_mfma_f32_16x16x32_bf16 v[40:43], a[116:119], a[68:71], v[40:43]
  s_waitcnt lgkmcnt(3)
  v_mfma_f32_16x16x32_bf16 v[32:35], a[120:123], a[72:75], v[32:35]
  ds_read_b128 a[108:111], v7 offset:8192
  v_mfma_f32_16x16x32_bf16 v[36:39], a[120:123], a[76:79], v[36:39]
  v_mfma_f32_16x16x32_bf16 v[40:43], a[120:123], a[80:83], v[40:43]
  v_mfma_f32_16x16x32_bf16 v[32:35], a[124:127], a[84:87], v[32:35]
  ds_read_b128 a[112:115], v4 offset:8448
  v_mfma_f32_16x16x32_bf16 v[36:39], a[124:127], a[88:91], v[36:39]
  v_mfma_f32_16x16x32_bf16 v[40:43], a[124:127], a[92:95], v[40:43]
  s_waitcnt lgkmcnt(3)
  v_mfma_f32_16x16x32_bf16 v[44:47], a[96:99], a[0:3], 0
  ds_read_b128 a[116:119], v5 offset:8448
  v_mfma_f32_16x16x32_bf16 v[48:51], a[96:99], a[4:7], 0
  v_mfma_f32_16x16x32_bf16 v[52:55], a[96:99], a[8:11], 0
  v_mfma_f32_16x16x32_bf16 v[44:47], a[100:103], a[12:15], v[44:47]
  ds_read_b128 a[120:123], v6 offset:8448
  v_fma_f32 v0, v32, s63, -v23
  v_mfma_f32_16x16x32_bf16 v[48:51], a[100:103], a[16:19], v[48:51]
  v_fma_f32 v1, v33, s63, -v23
  v_fma_f32 v2, v34, s63, -v23
  v_mfma_f32_16x16x32_bf16 v[52:55], a[100:103], a[20:23], v[52:55]
  v_fma_f32 v3, v35, s63, -v23
  s_waitcnt lgkmcnt(3)
  v_mfma_f32_16x16x32_bf16 v[44:47], a[104:107], a[24:27], v[44:47]
  ds_read_b128 a[124:127], v7 offset:8448
  v_fma_f32 v96, v36, s63, -v24
  v_mfma_f32_16x16x32_bf16 v[48:51], a[104:107], a[28:31], v[48:51]
  v_exp_f32 v0, v0
  v_mfma_f32_16x16x32_bf16 v[52:55], a[104:107], a[32:35], v[52:55]
  v_exp_f32 v1, v1
  v_mfma_f32_16x16x32_bf16 v[44:47], a[108:111], a[36:39], v[44:47]
  v_xor_b32 v4, 0x20000, v4
  v_xor_b32 v5, 0x20000, v5
  v_mfma_f32_16x16x32_bf16 v[48:51], a[108:111], a[40:43], v[48:51]
  v_xor_b32 v6, 0x20000, v6
  v_xor_b32 v7, 0x20000, v7
  v_mfma_f32_16x16x32_bf16 v[52:55], a[108:111], a[44:47], v[52:55]
  v_fma_f32 v97, v37, s63, -v24
  s_waitcnt lgkmcnt(2)
  v_mfma_f32_16x16x32_bf16 v[44:47], a[112:115], a[48:51], v[44:47]
  s_waitcnt lgkmcnt(0)
  s_barrier
  v_mfma_f32_16x16x32_bf16 v[48:51], a[112:115], a[52:55], v[48:51]
  ds_read_b64_tr_b16 a[96:97], v8 offset:0
  v_fma_f32 v98, v38, s63, -v24
  v_mfma_f32_16x16x32_bf16 v[52:55], a[112:115], a[56:59], v[52:55]
  ds_read_b64_tr_b16 a[98:99], v8 offset:8192
  v_fma_f32 v99, v39, s63, -v24
  v_mfma_f32_16x16x32_bf16 v[44:47], a[116:119], a[60:63], v[44:47]
  ds_read_b64_tr_b16 a[100:101], v9 offset:0
  v_fma_f32 v108, v40, s63, -v25
  v_mfma_f32_16x16x32_bf16 v[48:51], a[116:119], a[64:67], v[48:51]
  ds_read_b64_tr_b16 a[102:103], v9 offset:8192
  v_fma_f32 v109, v41, s63, -v25
  v_mfma_f32_16x16x32_bf16 v[52:55], a[116:119], a[68:71], v[52:55]
  ds_read_b64_tr_b16 a[104:105], v10 offset:0
  v_fma_f32 v110, v42, s63, -v25
  v_mfma_f32_16x16x32_bf16 v[44:47], a[120:123], a[72:75], v[44:47]
  ds_read_b64_tr_b16 a[106:107], v10 offset:8192
  v_fma_f32 v111, v43, s63, -v25
  v_mfma_f32_16x16x32_bf16 v[48:51], a[120:123], a[76:79], v[48:51]
  ds_read_b64_tr_b16 a[108:109], v11 offset:0
  v_mfma_f32_16x16x32_bf16 v[52:55], a[120:123], a[80:83], v[52:55]
  ds_read_b64_tr_b16 a[110:111], v11 offset:8192
  v_mfma_f32_16x16x32_bf16 v[44:47], a[124:127], a[84:87], v[44:47]
  ds_read_b64_tr_b16 a[112:113], v12 offset:0
  v_mfma_f32_16x16x32_bf16 v[48:51], a[124:127], a[88:91], v[48:51]
  ds_read_b64_tr_b16 a[114:115], v12 offset:8192
  v_mfma_f32_16x16x32_bf16 v[52:55], a[124:127], a[92:95], v[52:55]
  v_exp_f32 v2, v2
  v_exp_f32 v3, v3
  v_add_f32 v26, v0, v1
  v_cvt_pk_bf16_f32 v56, v0, v1
  v_add_f32 v26, v26, v2
  v_cvt_pk_bf16_f32 v57, v2, v3
  v_add_f32 v26, v26, v3
  v_exp_f32 v96, v96
  v_exp_f32 v97, v97
  v_exp_f32 v98, v98
  v_exp_f32 v99, v99
  v_add_f32 v27, v96, v97
  v_cvt_pk_bf16_f32 v60, v96, v97
  v_add_f32 v27, v27, v98
  v_cvt_pk_bf16_f32 v61, v98, v99
  v_add_f32 v27, v27, v99
  v_exp_f32 v108, v108
  v_exp_f32 v109, v109
  v_exp_f32 v110, v110
  v_exp_f32 v111, v111
  v_add_f32 v28, v108, v109
  v_cvt_pk_bf16_f32 v64, v108, v109
  v_add_f32 v28, v28, v110
  v_cvt_pk_bf16_f32 v65, v110, v111
  v_add_f32 v28, v28, v111
  s_waitcnt lgkmcnt(6)
  v_mfma_f32_16x16x32_bf16 v[112:115], a[96:99], v[68:71], v[112:115]
  ds_read_b64_tr_b16 a[116:117], v13 offset:0
  v_mfma_f32_16x16x32_bf16 v[116:119], a[96:99], v[72:75], v[116:119]
  ds_read_b64_tr_b16 a[118:119], v13 offset:8192
  v_mfma_f32_16x16x32_bf16 v[120:123], a[96:99], v[76:79], v[120:123]
  v_mfma_f32_16x16x32_bf16 v[124:127], a[100:103], v[68:71], v[124:127]
  ds_read_b64_tr_b16 a[120:121], v14 offset:0
  v_fma_f32 v0, v44, s63, -v23
  v_mfma_f32_16x16x32_bf16 v[128:131], a[100:103], v[72:75], v[128:131]
  ds_read_b64_tr_b16 a[122:123], v14 offset:8192
  v_fma_f32 v1, v45, s63, -v23
  v_mfma_f32_16x16x32_bf16 v[132:135], a[100:103], v[76:79], v[132:135]
  v_fma_f32 v2, v46, s63, -v23
  s_waitcnt lgkmcnt(6)
  v_mfma_f32_16x16x32_bf16 v[136:139], a[104:107], v[68:71], v[136:139]
  ds_read_b64_tr_b16 a[124:125], v15 offset:0
  v_fma_f32 v3, v47, s63, -v23
  v_mfma_f32_16x16x32_bf16 v[140:143], a[104:107], v[72:75], v[140:143]
  ds_read_b64_tr_b16 a[126:127], v15 offset:8192
  v_fma_f32 v96, v48, s63, -v24
  v_mfma_f32_16x16x32_bf16 v[144:147], a[104:107], v[76:79], v[144:147]
  v_exp_f32 v0, v0
  v_mfma_f32_16x16x32_bf16 v[148:151], a[108:111], v[68:71], v[148:151]
  ds_read_b64_tr_b16 a[96:97], v8 offset:256
  v_fma_f32 v97, v49, s63, -v24
  v_mfma_f32_16x16x32_bf16 v[152:155], a[108:111], v[72:75], v[152:155]
  ds_read_b64_tr_b16 a[98:99], v8 offset:8448
  v_fma_f32 v98, v50, s63, -v24
  v_mfma_f32_16x16x32_bf16 v[156:159], a[108:111], v[76:79], v[156:159]
  v_fma_f32 v99, v51, s63, -v24
  s_waitcnt lgkmcnt(6)
  v_mfma_f32_16x16x32_bf16 v[160:163], a[112:115], v[68:71], v[160:163]
  ds_read_b64_tr_b16 a[100:101], v9 offset:256
  v_fma_f32 v108, v52, s63, -v25
  v_mfma_f32_16x16x32_bf16 v[164:167], a[112:115], v[72:75], v[164:167]
  ds_read_b64_tr_b16 a[102:103], v9 offset:8448
  v_fma_f32 v109, v53, s63, -v25
  v_mfma_f32_16x16x32_bf16 v[168:171], a[112:115], v[76:79], v[168:171]
  v_exp_f32 v1, v1
  v_mfma_f32_16x16x32_bf16 v[172:175], a[116:119], v[68:71], v[172:175]
  ds_read_b64_tr_b16 a[104:105], v10 offset:256
  v_fma_f32 v110, v54, s63, -v25
  v_mfma_f32_16x16x32_bf16 v[176:179], a[116:119], v[72:75], v[176:179]
  ds_read_b64_tr_b16 a[106:107], v10 offset:8448
  v_fma_f32 v111, v55, s63, -v25
  v_mfma_f32_16x16x32_bf16 v[180:183], a[116:119], v[76:79], v[180:183]
  s_waitcnt lgkmcnt(6)
  v_mfma_f32_16x16x32_bf16 v[184:187], a[120:123], v[68:71], v[184:187]
  ds_read_b64_tr_b16 a[108:109], v11 offset:256
  v_mfma_f32_16x16x32_bf16 v[188:191], a[120:123], v[72:75], v[188:191]
  ds_read_b64_tr_b16 a[110:111], v11 offset:8448
  v_mfma_f32_16x16x32_bf16 v[192:195], a[120:123], v[76:79], v[192:195]
  v_exp_f32 v2, v2
  v_mfma_f32_16x16x32_bf16 v[196:199], a[124:127], v[68:71], v[196:199]
  ds_read_b64_tr_b16 a[112:113], v12 offset:256
  v_mfma_f32_16x16x32_bf16 v[200:203], a[124:127], v[72:75], v[200:203]
  ds_read_b64_tr_b16 a[114:115], v12 offset:8448
  v_mfma_f32_16x16x32_bf16 v[204:207], a[124:127], v[76:79], v[204:207]
  s_waitcnt lgkmcnt(6)
  v_mfma_f32_16x16x32_bf16 v[208:211], a[96:99], v[68:71], v[208:211]
  ds_read_b64_tr_b16 a[116:117], v13 offset:256
  v_mfma_f32_16x16x32_bf16 v[212:215], a[96:99], v[72:75], v[212:215]
  ds_read_b64_tr_b16 a[118:119], v13 offset:8448
  v_mfma_f32_16x16x32_bf16 v[216:219], a[96:99], v[76:79], v[216:219]
  v_exp_f32 v3, v3
  v_mfma_f32_16x16x32_bf16 v[220:223], a[100:103], v[68:71], v[220:223]
  ds_read_b64_tr_b16 a[120:121], v14 offset:256
  v_add_f32 v26, v26, v0
  v_mfma_f32_16x16x32_bf16 v[224:227], a[100:103], v[72:75], v[224:227]
  ds_read_b64_tr_b16 a[122:123], v14 offset:8448
  v_cvt_pk_bf16_f32 v58, v0, v1
  v_mfma_f32_16x16x32_bf16 v[228:231], a[100:103], v[76:79], v[228:231]
  v_add_f32 v26, v26, v1
  s_waitcnt lgkmcnt(6)
  v_mfma_f32_16x16x32_bf16 v[232:235], a[104:107], v[68:71], v[232:235]
  ds_read_b64_tr_b16 a[124:125], v15 offset:256
  v_add_f32 v26, v26, v2
  v_mfma_f32_16x16x32_bf16 v[236:239], a[104:107], v[72:75], v[236:239]
  ds_read_b64_tr_b16 a[126:127], v15 offset:8448
  v_cvt_pk_bf16_f32 v59, v2, v3
  v_mfma_f32_16x16x32_bf16 v[240:243], a[104:107], v[76:79], v[240:243]
  v_add_f32 v26, v26, v3
  v_mfma_f32_16x16x32_bf16 v[244:247], a[108:111], v[68:71], v[244:247]
  v_xor_b32 v8, 0x10000, v8
  v_xor_b32 v9, 0x10000, v9
  v_mfma_f32_16x16x32_bf16 v[248:251], a[108:111], v[72:75], v[248:251]
  v_xor_b32 v10, 0x10000, v10
  v_xor_b32 v11, 0x10000, v11
  v_mfma_f32_16x16x32_bf16 v[252:255], a[108:111], v[76:79], v[252:255]
  v_xor_b32 v12, 0x10000, v12
  s_waitcnt lgkmcnt(4)
  v_mfma_f32_16x16x32_bf16 a[160:163], a[112:115], v[68:71], a[160:163]
  v_xor_b32 v13, 0x10000, v13
  v_xor_b32 v14, 0x10000, v14
  v_xor_b32 v15, 0x10000, v15
  s_waitcnt lgkmcnt(0)
  s_barrier
  v_mfma_f32_16x16x32_bf16 a[164:167], a[112:115], v[72:75], a[164:167]
  ds_read_b128 a[96:99], v4 offset:0
  v_mfma_f32_16x16x32_bf16 a[168:171], a[112:115], v[76:79], a[168:171]
  ds_read_b128 a[100:103], v5 offset:0
  v_mfma_f32_16x16x32_bf16 a[172:175], a[116:119], v[68:71], a[172:175]
  ds_read_b128 a[104:107], v6 offset:0
  v_mfma_f32_16x16x32_bf16 a[176:179], a[116:119], v[72:75], a[176:179]
  ds_read_b128 a[108:111], v7 offset:0
  v_mfma_f32_16x16x32_bf16 a[180:183], a[116:119], v[76:79], a[180:183]
  ds_read_b128 a[112:115], v4 offset:256
  v_mfma_f32_16x16x32_bf16 a[184:187], a[120:123], v[68:71], a[184:187]
  v_exp_f32 v96, v96
  v_mfma_f32_16x16x32_bf16 a[188:191], a[120:123], v[72:75], a[188:191]
  v_exp_f32 v97, v97
  v_mfma_f32_16x16x32_bf16 a[192:195], a[120:123], v[76:79], a[192:195]
  v_exp_f32 v98, v98
  v_mfma_f32_16x16x32_bf16 a[196:199], a[124:127], v[68:71], a[196:199]
  v_exp_f32 v99, v99
  v_mfma_f32_16x16x32_bf16 a[200:203], a[124:127], v[72:75], a[200:203]
  v_add_f32 v27, v27, v96
  v_cvt_pk_bf16_f32 v62, v96, v97
  v_mfma_f32_16x16x32_bf16 a[204:207], a[124:127], v[76:79], a[204:207]
  v_add_f32 v27, v27, v97
  v_add_f32 v27, v27, v98
  v_cvt_pk_bf16_f32 v63, v98, v99
  v_add_f32 v27, v27, v99
  v_exp_f32 v108, v108
  v_exp_f32 v109, v109
  v_exp_f32 v110, v110
  v_exp_f32 v111, v111
  v_add_f32 v28, v28, v108
  v_cvt_pk_bf16_f32 v66, v108, v109
  v_add_f32 v28, v28, v109
  v_add_f32 v28, v28, v110
  v_cvt_pk_bf16_f32 v67, v110, v111
  v_add_f32 v28, v28, v111
  v_max3_f32 v29, v26, v27, v28
  v_cmp_lt_f32 vcc, 0x44800000, v29
  s_nop 0
  s_cbranch_vccz L_ok39
  s_swappc_b64 s[70:71], s[72:73]
L_ok39:
  v_add_f32 v20, v20, v26
  v_add_f32 v21, v21, v27
  v_add_f32 v22, v22, v28
L_tailA:
  s_cmp_lg_u32 s52, 0
  s_cbranch_scc1 L_chkA
  s_lshr_b32 s64, s27, 1
  s_lshl_b32 s64, s64, 2
  v_mov_b32 v30, s64
  global_load_dword v95, v30, s[100:101] sc1
L_chkA:
  s_mov_b32 s77, 0
  s_lshl_b32 s61, s98, 7
  s_mov_b32 s62, s61
  s_mov_b32 s79, s98
  s_waitcnt lgkmcnt(3)
  v_mfma_f32_16x16x32_bf16 v[32:35], a[96:99], a[0:3], 0
  ds_read_b128 a[116:119], v5 offset:256
  v_mfma_f32_16x16x32_bf16 v[36:39], a[96:99], a[4:7], 0
  v_mfma_f32_16x16x32_bf16 v[40:43], a[96:99], a[8:11], 0
  v_mfma_f32_16x16x32_bf16 v[32:35], a[100:103], a[12:15], v[32:35]
  ds_read_b128 a[120:123], v6 offset:256
  v_mfma_f32_16x16x32_bf16 v[36:39], a[100:103], a[16:19], v[36:39]
  v_mfma_f32_16x16x32_bf16 v[40:43], a[100:103], a[20:23], v[40:43]
  s_waitcnt lgkmcnt(3)
  v_mfma_f32_16x16x32_bf16 v[32:35], a[104:107], a[24:27], v[32:35]
  ds_read_b128 a[124:127], v7 offset:256
  v_mfma_f32_16x16x32_bf16 v[36:39], a[104:107], a[28:31], v[36:39]
  v_mfma_f32_16x16x32_bf16 v[40:43], a[104:107], a[32:35], v[40:43]
  v_mfma_f32_16x16x32_bf16 v[32:35], a[108:111], a[36:39], v[32:35]
  ds_read_b128 a[96:99], v4 offset:8192
  v_mfma_f32_16x16x32_bf16 v[36:39], a[108:111], a[40:43], v[36:39]
  v_mfma_f32_16x16x32_bf16 v[40:43], a[108:111], a[44:47], v[40:43]
  s_waitcnt lgkmcnt(3)
  v_mfma_f32_16x16x32_bf16 v[32:35], a[112:115], a[48:51], v[32:35]
  ds_read_b128 a[100:103], v5 offset:8192
  v_mfma_f32_16x16x32_bf16 v[36:39], a[112:115], a[52:55], v[36:39]
  v_mfma_f32_16x16x32_bf16 v[40:43], a[112:115], a[56:59], v[40:43]
  v_mfma_f32_16x16x32_bf16 v[32:35], a[116:119], a[60:63], v[32:35]
  ds_read_b128 a[104:107], v6 offset:8192
  v_mfma_f32_16x16x32_bf16 v[36:39], a[116:119], a[64:67], v[36:39]
  v_mfma_f32_16x16x32_bf16 v[40:43], a[116:119], a[68:71], v[40:43]
  s_waitcnt lgkmcnt(3)
  v_mfma_f32_16x16x32_bf16 v[32:35], a[120:123], a[72:75], v[32:35]
  ds_read_b128 a[108:111], v7 offset:8192
  v_mfma_f32_16x16x32_bf16 v[36:39], a[120:123], a[76:79], v[36:39]
  v_mfma_f32_16x16x32_bf16 v[40:43], a[120:123], a[80:83], v[40:43]
  v_mfma_f32_16x16x32_bf16 v[32:35], a[124:127], a[84:87], v[32:35]
  ds_read_b128 a[112:115], v4 offset:8448
  v_mfma_f32_16x16x32_bf16 v[36:39], a[124:127], a[88:91], v[36:39]
  v_mfma_f32_16x16x32_bf16 v[40:43], a[124:127], a[92:95], v[40:43]
  s_waitcnt lgkmcnt(3)
  v_mfma_f32_16x16x32_bf16 v[44:47], a[96:99], a[0:3], 0
  ds_read_b128 a[116:119], v5 offset:8448
  v_mfma_f32_16x16x32_bf16 v[48:51], a[96:99], a[4:7], 0
  v_mfma_f32_16x16x32_bf16 v[52:55], a[96:99], a[8:11], 0
  v_mfma_f32_16x16x32_bf16 v[44:47], a[100:103], a[12:15], v[44:47]
  ds_read_b128 a[120:123], v6 offset:8448
  v_fma_f32 v0, v32, s63, -v23
  v_mfma_f32_16x16x32_bf16 v[48:51], a[100:103], a[16:19], v[48:51]
  v_fma_f32 v1, v33, s63, -v23
  v_fma_f32 v2, v34, s63, -v23
  v_mfma_f32_16x16x32_bf16 v[52:55], a[100:103], a[20:23], v[52:55]
  v_fma_f32 v3, v35, s63, -v23
  s_waitcnt lgkmcnt(3)
  v_mfma_f32_16x16x32_bf16 v[44:47], a[104:107], a[24:27], v[44:47]
  ds_read_b128 a[124:127], v7 offset:8448
  v_fma_f32 v96, v36, s63, -v24
  v_mfma_f32_16x16x32_bf16 v[48:51], a[104:107], a[28:31], v[48:51]
  v_exp_f32 v0, v0
  v_mfma_f32_16x16x32_bf16 v[52:55], a[104:107], a[32:35], v[52:55]
  v_exp_f32 v1, v1
  v_mfma_f32_16x16x32_bf16 v[44:47], a[108:111], a[36:39], v[44:47]
  v_xor_b32 v4, 0x10000, v4
  v_xor_b32 v5, 0x10000, v5
  v_mfma_f32_16x16x32_bf16 v[48:51], a[108:111], a[40:43], v[48:51]
  v_xor_b32 v6, 0x10000, v6
  v_xor_b32 v7, 0x10000, v7
  v_mfma_f32_16x16x32_bf16 v[52:55], a[108:111], a[44:47], v[52:55]
  v_fma_f32 v97, v37, s63, -v24
  s_waitcnt lgkmcnt(2)
  v_mfma_f32_16x16x32_bf16 v[44:47], a[112:115], a[48:51], v[44:47]
  s_waitcnt lgkmcnt(0)
  s_barrier
  v_mfma_f32_16x16x32_bf16 v[48:51], a[112:115], a[52:55], v[48:51]
  ds_read_b64_tr_b16 a[96:97], v8 offset:0
  v_fma_f32 v98, v38, s63, -v24
  v_mfma_f32_16x16x32_bf16 v[52:55], a[112:115], a[56:59], v[52:55]
  ds_read_b64_tr_b16 a[98:99], v8 offset:8192
  v_fma_f32 v99, v39, s63, -v24
  v_mfma_f32_16x16x32_bf16 v[44:47], a[116:119], a[60:63], v[44:47]
  ds_read_b64_tr_b16 a[100:101], v9 offset:0
  v_fma_f32 v108, v40, s63, -v25
  v_mfma_f32_16x16x32_bf16 v[48:51], a[116:119], a[64:67], v[48:51]
  ds_read_b64_tr_b16 a[102:103], v9 offset:8192
  v_fma_f32 v109, v41, s63, -v25
  v_mfma_f32_16x16x32_bf16 v[52:55], a[116:119], a[68:71], v[52:55]
  ds_read_b64_tr_b16 a[104:105], v10 offset:0
  v_fma_f32 v110, v42, s63, -v25
  v_mfma_f32_16x16x32_bf16 v[44:47], a[120:123], a[72:75], v[44:47]
  ds_read_b64_tr_b16 a[106:107], v10 offset:8192
  v_fma_f32 v111, v43, s63, -v25
  v_mfma_f32_16x16x32_bf16 v[48:51], a[120:123], a[76:79], v[48:51]
  ds_read_b64_tr_b16 a[108:109], v11 offset:0
  v_mfma_f32_16x16x32_bf16 v[52:55], a[120:123], a[80:83], v[52:55]
  ds_read_b64_tr_b16 a[110:111], v11 offset:8192
  v_mfma_f32_16x16x32_bf16 v[44:47], a[124:127], a[84:87], v[44:47]
  ds_read_b64_tr_b16 a[112:113], v12 offset:0
  v_mfma_f32_16x16x32_bf16 v[48:51], a[124:127], a[88:91], v[48:51]
  ds_read_b64_tr_b16 a[114:115], v12 offset:8192
  v_mfma_f32_16x16x32_bf16 v[52:55], a[124:127], a[92:95], v[52:55]
  v_exp_f32 v2, v2
  v_exp_f32 v3, v3
  v_add_f32 v26, v0, v1
  v_cvt_pk_bf16_f32 v68, v0, v1
  v_add_f32 v26, v26, v2
  v_cvt_pk_bf16_f32 v69, v2, v3
  v_add_f32 v26, v26, v3
  v_exp_f32 v96, v96
  v_exp_f32 v97, v97
  v_exp_f32 v98, v98
  v_exp_f32 v99, v99
  v_add_f32 v27, v96, v97
  v_cvt_pk_bf16_f32 v72, v96, v97
  v_add_f32 v27, v27, v98
  v_cvt_pk_bf16_f32 v73, v98, v99
  v_add_f32 v27, v27, v99
  v_exp_f32 v108, v108
  v_exp_f32 v109, v109
  v_exp_f32 v110, v110
  v_exp_f32 v111, v111
  v_add_f32 v28, v108, v109
  v_cvt_pk_bf16_f32 v76, v108, v109
  v_add_f32 v28, v28, v110
  v_cvt_pk_bf16_f32 v77, v110, v111
  v_add_f32 v28, v28, v111
  s_waitcnt lgkmcnt(6)
  v_mfma_f32_16x16x32_bf16 v[112:115], a[96:99], v[56:59], v[112:115]
  ds_read_b64_tr_b16 a[116:117], v13 offset:0
  s_add_u32 m0, s59, 16384
  v_mfma_f32_16x16x32_bf16 v[116:119], a[96:99], v[60:63], v[116:119]
  ds_read_b64_tr_b16 a[118:119], v13 offset:8192
  s_add_u32 s77, s77, 1
  v_mfma_f32_16x16x32_bf16 v[120:123], a[96:99], v[64:67], v[120:123]
  buffer_load_dwordx4 v80, s[40:43], s62 offen offset:0  lds
  v_mfma_f32_16x16x32_bf16 v[124:127], a[100:103], v[56:59], v[124:127]
  ds_read_b64_tr_b16 a[120:121], v14 offset:0
  v_fma_f32 v0, v44, s63, -v23
  v_mfma_f32_16x16x32_bf16 v[128:131], a[100:103], v[60:63], v[128:131]
  ds_read_b64_tr_b16 a[122:123], v14 offset:8192
  v_fma_f32 v1, v45, s63, -v23
  v_mfma_f32_16x16x32_bf16 v[132:135], a[100:103], v[64:67], v[132:135]
  v_fma_f32 v2, v46, s63, -v23
  s_waitcnt lgkmcnt(6)
  v_mfma_f32_16x16x32_bf16 v[136:139], a[104:107], v[56:59], v[136:139]
  ds_read_b64_tr_b16 a[124:125], v15 offset:0
  buffer_load_dwordx4 v81, s[40:43], s62 offen offset:1024  lds
  v_mfma_f32_16x16x32_bf16 v[140:143], a[104:107], v[60:63], v[140:143]
  ds_read_b64_tr_b16 a[126:127], v15 offset:8192
  v_fma_f32 v3, v47, s63, -v23
  v_mfma_f32_16x16x32_bf16 v[144:147], a[104:107], v[64:67], v[144:147]
  v_exp_f32 v0, v0
  v_mfma_f32_16x16x32_bf16 v[148:151], a[108:111], v[56:59], v[148:151]
  ds_read_b64_tr_b16 a[96:97], v8 offset:256
  v_fma_f32 v96, v48, s63, -v24
  v_mfma_f32_16x16x32_bf16 v[152:155], a[108:111], v[60:63], v[152:155]
  ds_read_b64_tr_b16 a[98:99], v8 offset:8448
  buffer_load_dwordx4 v82, s[40:43], s62 offen offset:2048  lds
  v_mfma_f32_16x16x32_bf16 v[156:159], a[108:111], v[64:67], v[156:159]
  v_fma_f32 v97, v49, s63, -v24
  s_waitcnt lgkmcnt(6)
  v_mfma_f32_16x16x32_bf16 v[160:163], a[112:115], v[56:59], v[160:163]
  ds_read_b64_tr_b16 a[100:101], v9 offset:256
  v_fma_f32 v98, v50, s63, -v24
  v_mfma_f32_16x16x32_bf16 v[164:167], a[112:115], v[60:63], v[164:167]
  ds_read_b64_tr_b16 a[102:103], v9 offset:8448
  v_fma_f32 v99, v51, s63, -v24
  v_mfma_f32_16x16x32_bf16 v[168:171], a[112:115], v[64:67], v[168:171]
  buffer_load_dwordx4 v83, s[40:43], s62 offen offset:3072  lds
  v_mfma_f32_16x16x32_bf16 v[172:175], a[116:119], v[56:59], v[172:175]
  ds_read_b64_tr_b16 a[104:105], v10 offset:256
  s_add_u32 m0, s59, 20480
  v_mfma_f32_16x16x32_bf16 v[176:179], a[116:119], v[60:63], v[176:179]
  ds_read_b64_tr_b16 a[106:107], v10 offset:8448
  s_add_u32 s61, s61, 229376
  v_mfma_f32_16x16x32_bf16 v[180:183], a[116:119], v[64:67], v[180:183]
  v_fma_f32 v108, v52, s63, -v25
  s_waitcnt lgkmcnt(6)
  v_mfma_f32_16x16x32_bf16 v[184:187], a[120:123], v[56:59], v[184:187]
  ds_read_b64_tr_b16 a[108:109], v11 offset:256
  buffer_load_dwordx4 v84, s[40:43], s62 offen offset:0  lds
  v_mfma_f32_16x16x32_bf16 v[188:191], a[120:123], v[60:63], v[188:191]
  ds_read_b64_tr_b16 a[110:111], v11 offset:8448
  v_fma_f32 v109, v53, s63, -v25
  v_mfma_f32_16x16x32_bf16 v[192:195], a[120:123], v[64:67], v[192:195]
  v_exp_f32 v1, v1
  v_mfma_f32_16x16x32_bf16 v[196:199], a[124:127], v[56:59], v[196:199]
  ds_read_b64_tr_b16 a[112:113], v12 offset:256
  v_fma_f32 v110, v54, s63, -v25
  v_mfma_f32_16x16x32_bf16 v[200:203], a[124:127], v[60:63], v[200:203]
  ds_read_b64_tr_b16 a[114:115], v12 offset:8448
  buffer_load_dwordx4 v85, s[40:43], s62 offen offset:1024  lds
  v_mfma_f32_16x16x32_bf16 v[204:207], a[124:127], v[64:67], v[204:207]
  v_fma_f32 v111, v55, s63, -v25
  s_waitcnt lgkmcnt(6)
  v_mfma_f32_16x16x32_bf16 v[208:211], a[96:99], v[56:59], v[208:211]
  ds_read_b64_tr_b16 a[116:117], v13 offset:256
  v_mfma_f32_16x16x32_bf16 v[212:215], a[96:99], v[60:63], v[212:215]
  ds_read_b64_tr_b16 a[118:119], v13 offset:8448
  v_mfma_f32_16x16x32_bf16 v[216:219], a[96:99], v[64:67], v[216:219]
  buffer_load_dwordx4 v86, s[40:43], s62 offen offset:2048  lds
  v_mfma_f32_16x16x32_bf16 v[220:223], a[100:103], v[56:59], v[220:223]
  ds_read_b64_tr_b16 a[120:121], v14 offset:256
  v_mfma_f32_16x16x32_bf16 v[224:227], a[100:103], v[60:63], v[224:227]
  ds_read_b64_tr_b16 a[122:123], v14 offset:8448
  v_mfma_f32_16x16x32_bf16 v[228:231], a[100:103], v[64:67], v[228:231]
  s_waitcnt lgkmcnt(6)
  v_mfma_f32_16x16x32_bf16 v[232:235], a[104:107], v[56:59], v[232:235]
  ds_read_b64_tr_b16 a[124:125], v15 offset:256
  buffer_load_dwordx4 v87, s[40:43], s62 offen offset:3072  lds
  v_mfma_f32_16x16x32_bf16 v[236:239], a[104:107], v[60:63], v[236:239]
  ds_read_b64_tr_b16 a[126:127], v15 offset:8448
  v_mfma_f32_16x16x32_bf16 v[240:243], a[104:107], v[64:67], v[240:243]
  s_cmp_ge_u32 s77, 14
  s_cselect_b32 s62, 458752, s61
  v_mfma_f32_16x16x32_bf16 v[244:247], a[108:111], v[56:59], v[244:247]
  v_xor_b32 v8, 0x18000, v8
  v_xor_b32 v9, 0x18000, v9
  v_mfma_f32_16x16x32_bf16 v[248:251], a[108:111], v[60:63], v[248:251]
  v_xor_b32 v10, 0x18000, v10
  v_xor_b32 v11, 0x18000, v11
  v_mfma_f32_16x16x32_bf16 v[252:255], a[108:111], v[64:67], v[252:255]
  v_xor_b32 v12, 0x18000, v12
  s_waitcnt lgkmcnt(4)
  v_mfma_f32_16x16x32_bf16 a[160:163], a[112:115], v[56:59], a[160:163]
  v_xor_b32 v13, 0x18000, v13
  v_xor_b32 v14, 0x18000, v14
  v_xor_b32 v15, 0x18000, v15
  s_waitcnt lgkmcnt(0)
  s_barrier
  v_mfma_f32_16x16x32_bf16 a[164:167], a[112:115], v[60:63], a[164:167]
  ds_read_b64_tr_b16 a[96:97], v8 offset:0
  v_mfma_f32_16x16x32_bf16 a[168:171], a[112:115], v[64:67], a[168:171]
  ds_read_b64_tr_b16 a[98:99], v8 offset:8192
  v_mfma_f32_16x16x32_bf16 a[172:175], a[116:119], v[56:59], a[172:175]
  ds_read_b64_tr_b16 a[100:101], v9 offset:0
  v_mfma_f32_16x16x32_bf16 a[176:179], a[116:119], v[60:63], a[176:179]
  ds_read_b64_tr_b16 a[102:103], v9 offset:8192
  v_mfma_f32_16x16x32_bf16 a[180:183], a[116:119], v[64:67], a[180:183]
  ds_read_b64_tr_b16 a[104:105], v10 offset:0
  v_mfma_f32_16x16x32_bf16 a[184:187], a[120:123], v[56:59], a[184:187]
  ds_read_b64_tr_b16 a[106:107], v10 offset:8192
  v_mfma_f32_16x16x32_bf16 a[188:191], a[120:123], v[60:63], a[188:191]
  ds_read_b64_tr_b16 a[108:109], v11 offset:0
  v_mfma_f32_16x16x32_bf16 a[192:195], a[120:123], v[64:67], a[192:195]
  ds_read_b64_tr_b16 a[110:111], v11 offset:8192
  v_mfma_f32_16x16x32_bf16 a[196:199], a[124:127], v[56:59], a[196:199]
  ds_read_b64_tr_b16 a[112:113], v12 offset:0
  v_mfma_f32_16x16x32_bf16 a[200:203], a[124:127], v[60:63], a[200:203]
  ds_read_b64_tr_b16 a[114:115], v12 offset:8192
  v_mfma_f32_16x16x32_bf16 a[204:207], a[124:127], v[64:67], a[204:207]
  v_exp_f32 v2, v2
  v_exp_f32 v3, v3
  v_add_f32 v26, v26, v0
  v_cvt_pk_bf16_f32 v70, v0, v1
  v_add_f32 v26, v26, v1
  v_add_f32 v26, v26, v2
  v_cvt_pk_bf16_f32 v71, v2, v3
  v_add_f32 v26, v26, v3
  v_exp_f32 v96, v96
  v_exp_f32 v97, v97
  v_exp_f32 v98, v98
  v_exp_f32 v99, v99
  v_add_f32 v27, v27, v96
  v_cvt_pk_bf16_f32 v74, v96, v97
  v_add_f32 v27, v27, v97
  v_add_f32 v27, v27, v98
  v_cvt_pk_bf16_f32 v75, v98, v99
  v_add_f32 v27, v27, v99
  v_exp_f32 v108, v108
  v_exp_f32 v109, v109
  v_exp_f32 v110, v110
  v_exp_f32 v111, v111
  v_add_f32 v28, v28, v108
  v_cvt_pk_bf16_f32 v78, v108, v109
  v_add_f32 v28, v28, v109
  v_add_f32 v28, v28, v110
  v_cvt_pk_bf16_f32 v79, v110, v111
  v_add_f32 v28, v28, v111
  v_max3_f32 v29, v26, v27, v28
  v_cmp_lt_f32 vcc, 0x44800000, v29
  s_nop 0
  s_cbranch_vccz L_ok40
  s_swappc_b64 s[70:71], s[74:75]
L_ok40:
  v_add_f32 v20, v20, v26
  v_add_f32 v21, v21, v27
  v_add_f32 v22, v22, v28
  s_waitcnt lgkmcnt(6)
  v_mfma_f32_16x16x32_bf16 v[112:115], a[96:99], v[68:71], v[112:115]
  ds_read_b64_tr_b16 a[116:117], v13 offset:0
  s_add_u32 m0, s59, 0
  v_mfma_f32_16x16x32_bf16 v[116:119], a[96:99], v[72:75], v[116:119]
  ds_read_b64_tr_b16 a[118:119], v13 offset:8192
  s_add_u32 s77, s77, 1
  v_mfma_f32_16x16x32_bf16 v[120:123], a[96:99], v[76:79], v[120:123]
  buffer_load_dwordx4 v80, s[40:43], s62 offen offset:0  lds
  v_mfma_f32_16x16x32_bf16 v[124:127], a[100:103], v[68:71], v[124:127]
  ds_read_b64_tr_b16 a[120:121], v14 offset:0
  v_mov_b32 v0, v20
  v_mfma_f32_16x16x32_bf16 v[128:131], a[100:103], v[72:75], v[128:131]
  ds_read_b64_tr_b16 a[122:123], v14 offset:8192
  s_nop 1
  v_mfma_f32_16x16x32_bf16 v[132:135], a[100:103], v[76:79], v[132:135]
  v_permlane32_swap_b32 v20, v0
  s_waitcnt lgkmcnt(6)
  v_mfma_f32_16x16x32_bf16 v[136:139], a[104:107], v[68:71], v[136:139]
  ds_read_b64_tr_b16 a[124:125], v15 offset:0
  buffer_load_dwordx4 v81, s[40:43], s62 offen offset:1024  lds
  v_mfma_f32_16x16x32_bf16 v[140:143], a[104:107], v[72:75], v[140:143]
  ds_read_b64_tr_b16 a[126:127], v15 offset:8192
  v_add_f32 v20, v20, v0
  v_mfma_f32_16x16x32_bf16 v[144:147], a[104:107], v[76:79], v[144:147]
  v_mov_b32 v0, v20
  s_nop 1
  v_mfma_f32_16x16x32_bf16 v[148:151], a[108:111], v[68:71], v[148:151]
  ds_read_b64_tr_b16 a[96:97], v8 offset:256
  v_permlane16_swap_b32 v20, v0
  v_mfma_f32_16x16x32_bf16 v[152:155], a[108:111], v[72:75], v[152:155]
  ds_read_b64_tr_b16 a[98:99], v8 offset:8448
  buffer_load_dwordx4 v82, s[40:43], s62 offen offset:2048  lds
  v_mfma_f32_16x16x32_bf16 v[156:159], a[108:111], v[76:79], v[156:159]
  v_add_f32 v20, v20, v0
  s_waitcnt lgkmcnt(6)
  v_mfma_f32_16x16x32_bf16 v[160:163], a[112:115], v[68:71], v[160:163]
  ds_read_b64_tr_b16 a[100:101], v9 offset:256
  v_rcp_f32 v26, v20
  v_mfma_f32_16x16x32_bf16 v[164:167], a[112:115], v[72:75], v[164:167]
  ds_read_b64_tr_b16 a[102:103], v9 offset:8448
  v_mov_b32 v96, v21
  v_mfma_f32_16x16x32_bf16 v[168:171], a[112:115], v[76:79], v[168:171]
  buffer_load_dwordx4 v83, s[40:43], s62 offen offset:3072  lds
  v_mfma_f32_16x16x32_bf16 v[172:175], a[116:119], v[68:71], v[172:175]
  ds_read_b64_tr_b16 a[104:105], v10 offset:256
  s_add_u32 m0, s59, 4096
  v_mfma_f32_16x16x32_bf16 v[176:179], a[116:119], v[72:75], v[176:179]
  ds_read_b64_tr_b16 a[106:107], v10 offset:8448
  s_sub_u32 s61, s61, 229248
  v_mfma_f32_16x16x32_bf16 v[180:183], a[116:119], v[76:79], v[180:183]
  s_nop 1
  s_waitcnt lgkmcnt(6)
  v_mfma_f32_16x16x32_bf16 v[184:187], a[120:123], v[68:71], v[184:187]
  ds_read_b64_tr_b16 a[108:109], v11 offset:256
  buffer_load_dwordx4 v84, s[40:43], s62 offen offset:0  lds
  v_mfma_f32_16x16x32_bf16 v[188:191], a[120:123], v[72:75], v[188:191]
  ds_read_b64_tr_b16 a[110:111], v11 offset:8448
  v_permlane32_swap_b32 v21, v96
  v_mfma_f32_16x16x32_bf16 v[192:195], a[120:123], v[76:79], v[192:195]
  v_add_f32 v21, v21, v96
  v_mov_b32 v96, v21
  v_mfma_f32_16x16x32_bf16 v[196:199], a[124:127], v[68:71], v[196:199]
  ds_read_b64_tr_b16 a[112:113], v12 offset:256
  s_nop 1
  v_mfma_f32_16x16x32_bf16 v[200:203], a[124:127], v[72:75], v[200:203]
  ds_read_b64_tr_b16 a[114:115], v12 offset:8448
  buffer_load_dwordx4 v85, s[40:43], s62 offen offset:1024  lds
  v_mfma_f32_16x16x32_bf16 v[204:207], a[124:127], v[76:79], v[204:207]
  v_permlane16_swap_b32 v21, v96
  s_waitcnt lgkmcnt(6)
  v_mfma_f32_16x16x32_bf16 v[208:211], a[96:99], v[68:71], v[208:211]
  ds_read_b64_tr_b16 a[116:117], v13 offset:256
  v_add_f32 v21, v21, v96
  v_mfma_f32_16x16x32_bf16 v[212:215], a[96:99], v[72:75], v[212:215]
  ds_read_b64_tr_b16 a[118:119], v13 offset:8448
  v_rcp_f32 v28, v21
  v_mfma_f32_16x16x32_bf16 v[216:219], a[96:99], v[76:79], v[216:219]
  buffer_load_dwordx4 v86, s[40:43], s62 offen offset:2048  lds
  v_mfma_f32_16x16x32_bf16 v[220:223], a[100:103], v[68:71], v[220:223]
  ds_read_b64_tr_b16 a[120:121], v14 offset:256
  v_mov_b32 v108, v22
  v_mfma_f32_16x16x32_bf16 v[224:227], a[100:103], v[72:75], v[224:227]
  ds_read_b64_tr_b16 a[122:123], v14 offset:8448
  s_nop 1
  v_mfma_f32_16x16x32_bf16 v[228:231], a[100:103], v[76:79], v[228:231]
  v_permlane32_swap_b32 v22, v108
  s_waitcnt lgkmcnt(6)
  v_mfma_f32_16x16x32_bf16 v[232:235], a[104:107], v[68:71], v[232:235]
  ds_read_b64_tr_b16 a[124:125], v15 offset:256
  buffer_load_dwordx4 v87, s[40:43], s62 offen offset:3072  lds
  v_mfma_f32_16x16x32_bf16 v[236:239], a[104:107], v[72:75], v[236:239]
  ds_read_b64_tr_b16 a[126:127], v15 offset:8448
  v_add_f32 v22, v22, v108
  v_mfma_f32_16x16x32_bf16 v[240:243], a[104:107], v[76:79], v[240:243]
  s_cmp_eq_u32 s61, 896
  s_cselect_b32 s61, 0, s61
  v_mfma_f32_16x16x32_bf16 v[244:247], a[108:111], v[68:71], v[244:247]
  s_cmp_ge_u32 s77, 14
  s_cselect_b32 s62, 458752, s61
  v_mfma_f32_16x16x32_bf16 v[248:251], a[108:111], v[72:75], v[248:251]
  v_mov_b32 v108, v22
  s_nop 1
  v_mfma_f32_16x16x32_bf16 v[252:255], a[108:111], v[76:79], v[252:255]
  v_permlane16_swap_b32 v22, v108
  s_waitcnt lgkmcnt(4)
  v_mfma_f32_16x16x32_bf16 a[160:163], a[112:115], v[68:71], a[160:163]
  s_waitcnt vmcnt(8) lgkmcnt(0)
  s_barrier
  v_mfma_f32_16x16x32_bf16 a[164:167], a[112:115], v[72:75], a[164:167]
  ds_read_b64_tr_b16 a[96:97], v88 offset:16384
  v_add_f32 v22, v22, v108
  v_mfma_f32_16x16x32_bf16 a[168:171], a[112:115], v[76:79], a[168:171]
  ds_read_b64_tr_b16 a[98:99], v88 offset:18432
  v_rcp_f32 v30, v22
  v_mfma_f32_16x16x32_bf16 a[172:175], a[116:119], v[68:71], a[172:175]
  ds_read_b64_tr_b16 a[100:101], v88 offset:20480
  v_add_u32 v104, s59, v92
  v_mfma_f32_16x16x32_bf16 a[176:179], a[116:119], v[72:75], a[176:179]
  ds_read_b64_tr_b16 a[102:103], v88 offset:22528
  v_xor_b32 v106, 0x10000, v104
  v_mfma_f32_16x16x32_bf16 a[180:183], a[116:119], v[76:79], a[180:183]
  ds_read_b64_tr_b16 a[104:105], v88 offset:24576
  s_lshl_b32 s64, s52, 13
  v_mfma_f32_16x16x32_bf16 a[184:187], a[120:123], v[68:71], a[184:187]
  ds_read_b64_tr_b16 a[106:107], v88 offset:26624
  s_add_u32 s64, s64, 131072
  v_mfma_f32_16x16x32_bf16 a[188:191], a[120:123], v[72:75], a[188:191]
  ds_read_b64_tr_b16 a[108:109], v88 offset:28672
  v_add_u32 v105, s64, v92
  v_mfma_f32_16x16x32_bf16 a[192:195], a[120:123], v[76:79], a[192:195]
  ds_read_b64_tr_b16 a[110:111], v88 offset:30720
  v_xor_b32 v107, 0x4000, v105
  v_mfma_f32_16x16x32_bf16 a[196:199], a[124:127], v[68:71], a[196:199]
  ds_read_b64_tr_b16 a[112:113], v89 offset:16384
  v_mfma_f32_16x16x32_bf16 a[200:203], a[124:127], v[72:75], a[200:203]
  ds_read_b64_tr_b16 a[114:115], v89 offset:18432
  v_mfma_f32_16x16x32_bf16 a[204:207], a[124:127], v[76:79], a[204:207]
  s_nop 7
  v_pk_mul_f32 v[112:113], v[112:113], v[26:27] op_sel_hi:[1,0]
  v_pk_mul_f32 v[114:115], v[114:115], v[26:27] op_sel_hi:[1,0]
  v_cvt_pk_bf16_f32 v112, v112, v113
  v_cvt_pk_bf16_f32 v113, v114, v115
  v_pk_mul_f32 v[124:125], v[124:125], v[26:27] op_sel_hi:[1,0]
  v_pk_mul_f32 v[126:127], v[126:127], v[26:27] op_sel_hi:[1,0]
  v_cvt_pk_bf16_f32 v114, v124, v125
  v_cvt_pk_bf16_f32 v115, v126, v127
  ds_write_b128 v104, v[112:115] offset:49152
  v_pk_mul_f32 v[116:117], v[116:117], v[28:29] op_sel_hi:[1,0]
  v_pk_mul_f32 v[118:119], v[118:119], v[28:29] op_sel_hi:[1,0]
  v_cvt_pk_bf16_f32 v116, v116, v117
  v_cvt_pk_bf16_f32 v117, v118, v119
  v_pk_mul_f32 v[128:129], v[128:129], v[28:29] op_sel_hi:[1,0]
  v_pk_mul_f32 v[130:131], v[130:131], v[28:29] op_sel_hi:[1,0]
  v_cvt_pk_bf16_f32 v118, v128, v129
  v_cvt_pk_bf16_f32 v119, v130, v131
  ds_write_b128 v104, v[116:119] offset:50176
  v_pk_mul_f32 v[120:121], v[120:121], v[30:31] op_sel_hi:[1,0]
  v_pk_mul_f32 v[122:123], v[122:123], v[30:31] op_sel_hi:[1,0]
  v_cvt_pk_bf16_f32 v120, v120, v121
  v_cvt_pk_bf16_f32 v121, v122, v123
  v_pk_mul_f32 v[132:133], v[132:133], v[30:31] op_sel_hi:[1,0]
  v_pk_mul_f32 v[134:135], v[134:135], v[30:31] op_sel_hi:[1,0]
  v_cvt_pk_bf16_f32 v122, v132, v133
  v_cvt_pk_bf16_f32 v123, v134, v135
  ds_write_b128 v104, v[120:123] offset:51200
  v_pk_mul_f32 v[136:137], v[136:137], v[26:27] op_sel_hi:[1,0]
  v_pk_mul_f32 v[138:139], v[138:139], v[26:27] op_sel_hi:[1,0]
  v_cvt_pk_bf16_f32 v124, v136, v137
  v_cvt_pk_bf16_f32 v125, v138, v139
  v_pk_mul_f32 v[148:149], v[148:149], v[26:27] op_sel_hi:[1,0]
  v_pk_mul_f32 v[150:151], v[150:151], v[26:27] op_sel_hi:[1,0]
  v_cvt_pk_bf16_f32 v126, v148, v149
  v_cvt_pk_bf16_f32 v127, v150, v151
  ds_write_b128 v104, v[124:127] offset:52224
  v_pk_mul_f32 v[140:141], v[140:141], v[28:29] op_sel_hi:[1,0]
  v_pk_mul_f32 v[142:143], v[142:143], v[28:29] op_sel_hi:[1,0]
  v_cvt_pk_bf16_f32 v128, v140, v141
  v_cvt_pk_bf16_f32 v129, v142, v143
  v_pk_mul_f32 v[152:153], v[152:153], v[28:29] op_sel_hi:[1,0]
  v_pk_mul_f32 v[154:155], v[154:155], v[28:29] op_sel_hi:[1,0]
  v_cvt_pk_bf16_f32 v130, v152, v153
  v_cvt_pk_bf16_f32 v131, v154, v155
  s_waitcnt lgkmcnt(6)
  ds_write_b128 v104, v[128:131] offset:53248
  v_pk_mul_f32 v[144:145], v[144:145], v[30:31] op_sel_hi:[1,0]
  v_pk_mul_f32 v[146:147], v[146:147], v[30:31] op_sel_hi:[1,0]
  v_cvt_pk_bf16_f32 v132, v144, v145
  v_cvt_pk_bf16_f32 v133, v146, v147
  v_pk_mul_f32 v[156:157], v[156:157], v[30:31] op_sel_hi:[1,0]
  v_pk_mul_f32 v[158:159], v[158:159], v[30:31] op_sel_hi:[1,0]
  v_cvt_pk_bf16_f32 v134, v156, v157
  v_cvt_pk_bf16_f32 v135, v158, v159
  ds_write_b128 v104, v[132:135] offset:54272
  v_pk_mul_f32 v[160:161], v[160:161], v[26:27] op_sel_hi:[1,0]
  v_pk_mul_f32 v[162:163], v[162:163], v[26:27] op_sel_hi:[1,0]
  v_cvt_pk_bf16_f32 v136, v160, v161
  v_cvt_pk_bf16_f32 v137, v162, v163
  v_pk_mul_f32 v[172:173], v[172:173], v[26:27] op_sel_hi:[1,0]
  v_pk_mul_f32 v[174:175], v[174:175], v[26:27] op_sel_hi:[1,0]
  v_cvt_pk_bf16_f32 v138, v172, v173
  v_cvt_pk_bf16_f32 v139, v174, v175
  ds_write_b128 v104, v[136:139] offset:55296
  v_pk_mul_f32 v[164:165], v[164:165], v[28:29] op_sel_hi:[1,0]
  v_pk_mul_f32 v[166:167], v[166:167], v[28:29] op_sel_hi:[1,0]
  v_cvt_pk_bf16_f32 v140, v164, v165
  v_cvt_pk_bf16_f32 v141, v166, v167
  v_pk_mul_f32 v[176:177], v[176:177], v[28:29] op_sel_hi:[1,0]
  v_pk_mul_f32 v[178:179], v[178:179], v[28:29] op_sel_hi:[1,0]
  v_cvt_pk_bf16_f32 v142, v176, v177
  v_cvt_pk_bf16_f32 v143, v178, v179
  ds_write_b128 v104, v[140:143] offset:56320
  v_pk_mul_f32 v[168:169], v[168:169], v[30:31] op_sel_hi:[1,0]
  v_pk_mul_f32 v[170:171], v[170:171], v[30:31] op_sel_hi:[1,0]
  v_cvt_pk_bf16_f32 v144, v168, v169
  v_cvt_pk_bf16_f32 v145, v170, v171
  v_pk_mul_f32 v[180:181], v[180:181], v[30:31] op_sel_hi:[1,0]
  v_pk_mul_f32 v[182:183], v[182:183], v[30:31] op_sel_hi:[1,0]
  v_cvt_pk_bf16_f32 v146, v180, v181
  v_cvt_pk_bf16_f32 v147, v182, v183
  ds_write_b128 v105, v[144:147] offset:0
  v_pk_mul_f32 v[184:185], v[184:185], v[26:27] op_sel_hi:[1,0]
  v_pk_mul_f32 v[186:187], v[186:187], v[26:27] op_sel_hi:[1,0]
  v_cvt_pk_bf16_f32 v148, v184, v185
  v_cvt_pk_bf16_f32 v149, v186, v187
  v_pk_mul_f32 v[196:197], v[196:197], v[26:27] op_sel_hi:[1,0]
  v_pk_mul_f32 v[198:199], v[198:199], v[26:27] op_sel_hi:[1,0]
  v_cvt_pk_bf16_f32 v150, v196, v197
  v_cvt_pk_bf16_f32 v151, v198, v199
  ds_write_b128 v105, v[148:151] offset:1024
  v_pk_mul_f32 v[188:189], v[188:189], v[28:29] op_sel_hi:[1,0]
  v_pk_mul_f32 v[190:191], v[190:191], v[28:29] op_sel_hi:[1,0]
  v_cvt_pk_bf16_f32 v152, v188, v189
  v_cvt_pk_bf16_f32 v153, v190, v191
  v_pk_mul_f32 v[200:201], v[200:201], v[28:29] op_sel_hi:[1,0]
  v_pk_mul_f32 v[202:203], v[202:203], v[28:29] op_sel_hi:[1,0]
  v_cvt_pk_bf16_f32 v154, v200, v201
  v_cvt_pk_bf16_f32 v155, v202, v203
  ds_write_b128 v105, v[152:155] offset:2048
  v_pk_mul_f32 v[192:193], v[192:193], v[30:31] op_sel_hi:[1,0]
  v_pk_mul_f32 v[194:195], v[194:195], v[30:31] op_sel_hi:[1,0]
  v_cvt_pk_bf16_f32 v156, v192, v193
  v_cvt_pk_bf16_f32 v157, v194, v195
  v_pk_mul_f32 v[204:205], v[204:205], v[30:31] op_sel_hi:[1,0]
  v_pk_mul_f32 v[206:207], v[206:207], v[30:31] op_sel_hi:[1,0]
  v_cvt_pk_bf16_f32 v158, v204, v205
  v_cvt_pk_bf16_f32 v159, v206, v207
  ds_write_b128 v105, v[156:159] offset:3072
  v_pk_mul_f32 v[208:209], v[208:209], v[26:27] op_sel_hi:[1,0]
  v_pk_mul_f32 v[210:211], v[210:211], v[26:27] op_sel_hi:[1,0]
  v_cvt_pk_bf16_f32 v160, v208, v209
  v_cvt_pk_bf16_f32 v161, v210, v211
  v_pk_mul_f32 v[220:221], v[220:221], v[26:27] op_sel_hi:[1,0]
  v_pk_mul_f32 v[222:223], v[222:223], v[26:27] op_sel_hi:[1,0]
  v_cvt_pk_bf16_f32 v162, v220, v221
  v_cvt_pk_bf16_f32 v163, v222, v223
  s_waitcnt lgkmcnt(6)
  ds_write_b128 v105, v[160:163] offset:4096
  v_pk_mul_f32 v[212:213], v[212:213], v[28:29] op_sel_hi:[1,0]
  v_pk_mul_f32 v[214:215], v[214:215], v[28:29] op_sel_hi:[1,0]
  v_cvt_pk_bf16_f32 v164, v212, v213
  v_cvt_pk_bf16_f32 v165, v214, v215
  v_pk_mul_f32 v[224:225], v[224:225], v[28:29] op_sel_hi:[1,0]
  v_pk_mul_f32 v[226:227], v[226:227], v[28:29] op_sel_hi:[1,0]
  v_cvt_pk_bf16_f32 v166, v224, v225
  v_cvt_pk_bf16_f32 v167, v226, v227
  ds_write_b128 v105, v[164:167] offset:5120
  v_pk_mul_f32 v[216:217], v[216:217], v[30:31] op_sel_hi:[1,0]
  v_pk_mul_f32 v[218:219], v[218:219], v[30:31] op_sel_hi:[1,0]
  v_cvt_pk_bf16_f32 v168, v216, v217
  v_cvt_pk_bf16_f32 v169, v218, v219
  v_pk_mul_f32 v[228:229], v[228:229], v[30:31] op_sel_hi:[1,0]
  v_pk_mul_f32 v[230:231], v[230:231], v[30:31] op_sel_hi:[1,0]
  v_cvt_pk_bf16_f32 v170, v228, v229
  v_cvt_pk_bf16_f32 v171, v230, v231
  ds_write_b128 v105, v[168:171] offset:6144
  v_pk_mul_f32 v[232:233], v[232:233], v[26:27] op_sel_hi:[1,0]
  v_pk_mul_f32 v[234:235], v[234:235], v[26:27] op_sel_hi:[1,0]
  v_cvt_pk_bf16_f32 v172, v232, v233
  v_cvt_pk_bf16_f32 v173, v234, v235
  v_pk_mul_f32 v[244:245], v[244:245], v[26:27] op_sel_hi:[1,0]
  v_pk_mul_f32 v[246:247], v[246:247], v[26:27] op_sel_hi:[1,0]
  v_cvt_pk_bf16_f32 v174, v244, v245
  v_cvt_pk_bf16_f32 v175, v246, v247
  ds_write_b128 v105, v[172:175] offset:7168
  v_pk_mul_f32 v[236:237], v[236:237], v[28:29] op_sel_hi:[1,0]
  v_pk_mul_f32 v[238:239], v[238:239], v[28:29] op_sel_hi:[1,0]
  v_cvt_pk_bf16_f32 v176, v236, v237
  v_cvt_pk_bf16_f32 v177, v238, v239
  v_pk_mul_f32 v[248:249], v[248:249], v[28:29] op_sel_hi:[1,0]
  v_pk_mul_f32 v[250:251], v[250:251], v[28:29] op_sel_hi:[1,0]
  v_cvt_pk_bf16_f32 v178, v248, v249
  v_cvt_pk_bf16_f32 v179, v250, v251
  ds_write_b128 v104, v[176:179] offset:32768
  v_pk_mul_f32 v[240:241], v[240:241], v[30:31] op_sel_hi:[1,0]
  v_pk_mul_f32 v[242:243], v[242:243], v[30:31] op_sel_hi:[1,0]
  v_cvt_pk_bf16_f32 v180, v240, v241
  v_cvt_pk_bf16_f32 v181, v242, v243
  v_pk_mul_f32 v[252:253], v[252:253], v[30:31] op_sel_hi:[1,0]
  v_pk_mul_f32 v[254:255], v[254:255], v[30:31] op_sel_hi:[1,0]
  v_cvt_pk_bf16_f32 v182, v252, v253
  v_cvt_pk_bf16_f32 v183, v254, v255
  ds_write_b128 v104, v[180:183] offset:33792
  v_accvgpr_read_b32 v0, a160
  v_accvgpr_read_b32 v1, a161
  v_accvgpr_read_b32 v2, a162
  v_accvgpr_read_b32 v3, a163
  v_pk_mul_f32 v[0:1], v[0:1], v[26:27] op_sel_hi:[1,0]
  v_pk_mul_f32 v[2:3], v[2:3], v[26:27] op_sel_hi:[1,0]
  v_cvt_pk_bf16_f32 v184, v0, v1
  v_cvt_pk_bf16_f32 v185, v2, v3
  v_accvgpr_read_b32 v96, a172
  v_accvgpr_read_b32 v97, a173
  v_accvgpr_read_b32 v98, a174
  v_accvgpr_read_b32 v99, a175
  v_pk_mul_f32 v[96:97], v[96:97], v[26:27] op_sel_hi:[1,0]
  v_pk_mul_f32 v[98:99], v[98:99], v[26:27] op_sel_hi:[1,0]
  v_cvt_pk_bf16_f32 v186, v96, v97
  v_cvt_pk_bf16_f32 v187, v98, v99
  ds_write_b128 v104, v[184:187] offset:34816
  v_accvgpr_read_b32 v0, a164
  v_accvgpr_read_b32 v1, a165
  v_accvgpr_read_b32 v2, a166
  v_accvgpr_read_b32 v3, a167
  v_pk_mul_f32 v[0:1], v[0:1], v[28:29] op_sel_hi:[1,0]
  v_pk_mul_f32 v[2:3], v[2:3], v[28:29] op_sel_hi:[1,0]
  v_cvt_pk_bf16_f32 v188, v0, v1
  v_cvt_pk_bf16_f32 v189, v2, v3
  v_accvgpr_read_b32 v96, a176
  v_accvgpr_read_b32 v97, a177
  v_accvgpr_read_b32 v98, a178
  v_accvgpr_read_b32 v99, a179
  v_pk_mul_f32 v[96:97], v[96:97], v[28:29] op_sel_hi:[1,0]
  v_pk_mul_f32 v[98:99], v[98:99], v[28:29] op_sel_hi:[1,0]
  v_cvt_pk_bf16_f32 v190, v96, v97
  v_cvt_pk_bf16_f32 v191, v98, v99
  ds_write_b128 v104, v[188:191] offset:35840
  v_accvgpr_read_b32 v0, a168
  v_accvgpr_read_b32 v1, a169
  v_accvgpr_read_b32 v2, a170
  v_accvgpr_read_b32 v3, a171
  v_pk_mul_f32 v[0:1], v[0:1], v[30:31] op_sel_hi:[1,0]
  v_pk_mul_f32 v[2:3], v[2:3], v[30:31] op_sel_hi:[1,0]
  v_cvt_pk_bf16_f32 v192, v0, v1
  v_cvt_pk_bf16_f32 v193, v2, v3
  v_accvgpr_read_b32 v96, a180
  v_accvgpr_read_b32 v97, a181
  v_accvgpr_read_b32 v98, a182
  v_accvgpr_read_b32 v99, a183
  v_pk_mul_f32 v[96:97], v[96:97], v[30:31] op_sel_hi:[1,0]
  v_pk_mul_f32 v[98:99], v[98:99], v[30:31] op_sel_hi:[1,0]
  v_cvt_pk_bf16_f32 v194, v96, v97
  v_cvt_pk_bf16_f32 v195, v98, v99
  s_waitcnt lgkmcnt(6)
  ds_write_b128 v104, v[192:195] offset:36864
  v_accvgpr_read_b32 v0, a184
  v_accvgpr_read_b32 v1, a185
  v_accvgpr_read_b32 v2, a186
  v_accvgpr_read_b32 v3, a187
  v_pk_mul_f32 v[0:1], v[0:1], v[26:27] op_sel_hi:[1,0]
  v_pk_mul_f32 v[2:3], v[2:3], v[26:27] op_sel_hi:[1,0]
  v_cvt_pk_bf16_f32 v196, v0, v1
  v_cvt_pk_bf16_f32 v197, v2, v3
  v_accvgpr_read_b32 v96, a196
  v_accvgpr_read_b32 v97, a197
  v_accvgpr_read_b32 v98, a198
  v_accvgpr_read_b32 v99, a199
  v_pk_mul_f32 v[96:97], v[96:97], v[26:27] op_sel_hi:[1,0]
  v_pk_mul_f32 v[98:99], v[98:99], v[26:27] op_sel_hi:[1,0]
  v_cvt_pk_bf16_f32 v198, v96, v97
  v_cvt_pk_bf16_f32 v199, v98, v99
  ds_write_b128 v104, v[196:199] offset:37888
  v_accvgpr_read_b32 v0, a188
  v_accvgpr_read_b32 v1, a189
  v_accvgpr_read_b32 v2, a190
  v_accvgpr_read_b32 v3, a191
  v_pk_mul_f32 v[0:1], v[0:1], v[28:29] op_sel_hi:[1,0]
  v_pk_mul_f32 v[2:3], v[2:3], v[28:29] op_sel_hi:[1,0]
  v_cvt_pk_bf16_f32 v200, v0, v1
  v_cvt_pk_bf16_f32 v201, v2, v3
  v_accvgpr_read_b32 v96, a200
  v_accvgpr_read_b32 v97, a201
  v_accvgpr_read_b32 v98, a202
  v_accvgpr_read_b32 v99, a203
  v_pk_mul_f32 v[96:97], v[96:97], v[28:29] op_sel_hi:[1,0]
  v_pk_mul_f32 v[98:99], v[98:99], v[28:29] op_sel_hi:[1,0]
  v_cvt_pk_bf16_f32 v202, v96, v97
  v_cvt_pk_bf16_f32 v203, v98, v99
  ds_write_b128 v104, v[200:203] offset:38912
  v_accvgpr_read_b32 v0, a192
  v_accvgpr_read_b32 v1, a193
  v_accvgpr_read_b32 v2, a194
  v_accvgpr_read_b32 v3, a195
  v_pk_mul_f32 v[0:1], v[0:1], v[30:31] op_sel_hi:[1,0]
  v_pk_mul_f32 v[2:3], v[2:3], v[30:31] op_sel_hi:[1,0]
  v_cvt_pk_bf16_f32 v204, v0, v1
  v_cvt_pk_bf16_f32 v205, v2, v3
  v_accvgpr_read_b32 v96, a204
  v_accvgpr_read_b32 v97, a205
  v_accvgpr_read_b32 v98, a206
  v_accvgpr_read_b32 v99, a207
  v_pk_mul_f32 v[96:97], v[96:97], v[30:31] op_sel_hi:[1,0]
  v_pk_mul_f32 v[98:99], v[98:99], v[30:31] op_sel_hi:[1,0]
  v_cvt_pk_bf16_f32 v206, v96, v97
  v_cvt_pk_bf16_f32 v207, v98, v99
  ds_write_b128 v104, v[204:207] offset:39936
  s_waitcnt lgkmcnt(0)
  s_barrier
  ds_read_b128 a[0:3], v106 offset:49152
  ds_read_b128 a[4:7], v106 offset:50176
  ds_read_b128 a[8:11], v106 offset:51200
  ds_read_b128 a[12:15], v106 offset:52224
  ds_read_b128 a[16:19], v106 offset:53248
  ds_read_b128 a[20:23], v106 offset:54272
  ds_read_b128 a[24:27], v106 offset:55296
  ds_read_b128 a[28:31], v106 offset:56320
  ds_read_b128 a[32:35], v107 offset:0
  ds_read_b128 a[36:39], v107 offset:1024
  ds_read_b128 a[40:43], v107 offset:2048
  ds_read_b128 a[44:47], v107 offset:3072
  ds_read_b128 a[48:51], v107 offset:4096
  ds_read_b128 a[52:55], v107 offset:5120
  s_waitcnt lgkmcnt(6)
  ds_read_b128 a[56:59], v107 offset:6144
  ds_read_b128 a[60:63], v107 offset:7168
  ds_read_b128 a[64:67], v106 offset:32768
  ds_read_b128 a[68:71], v106 offset:33792
  ds_read_b128 a[72:75], v106 offset:34816
  ds_read_b128 a[76:79], v106 offset:35840
  ds_read_b128 a[80:83], v106 offset:36864
  ds_read_b128 a[84:87], v106 offset:37888
  s_waitcnt lgkmcnt(6)
  ds_read_b128 a[88:91], v106 offset:38912
  ds_read_b128 a[92:95], v106 offset:39936
  s_mov_b32 s78, 21504
  s_waitcnt lgkmcnt(0)
  s_barrier
  s_cmp_lg_u32 s53, 0
  s_cbranch_scc1 L_opYA
  s_mov_b32 s60, 7
.p2align 3
L_opA0:
  s_waitcnt lgkmcnt(6)
  v_mfma_f32_16x16x32_bf16 v[208:211], a[96:99], v[112:115], 0
  ds_read_b64_tr_b16 a[116:117], v89 offset:20480
  s_xor_b32 s59, s59, 0x8000
  v_mfma_f32_16x16x32_bf16 v[212:215], a[96:99], v[116:119], 0
  ds_read_b64_tr_b16 a[118:119], v89 offset:22528
  s_add_u32 m0, s59, 16384
  v_mfma_f32_16x16x32_bf16 v[216:219], a[96:99], v[120:123], 0
  s_add_u32 s77, s77, 1
  buffer_load_dwordx4 v80, s[40:43], s62 offen offset:0  lds
  v_mfma_f32_16x16x32_bf16 v[208:211], a[100:103], v[124:127], v[208:211]
  ds_read_b64_tr_b16 a[120:121], v89 offset:24576
  v_cvt_pk_bf16_f32 v234, v220, v221
  v_mfma_f32_16x16x32_bf16 v[212:215], a[100:103], v[128:131], v[212:215]
  ds_read_b64_tr_b16 a[122:123], v89 offset:26624
  v_cvt_pk_bf16_f32 v235, v222, v223
  v_mfma_f32_16x16x32_bf16 v[216:219], a[100:103], v[132:135], v[216:219]
  v_cvt_pk_bf16_f32 v238, v224, v225
  s_waitcnt lgkmcnt(6)
  v_mfma_f32_16x16x32_bf16 v[208:211], a[104:107], v[136:139], v[208:211]
  ds_read_b64_tr_b16 a[124:125], v89 offset:28672
  v_cvt_pk_bf16_f32 v239, v226, v227
  v_mfma_f32_16x16x32_bf16 v[212:215], a[104:107], v[140:143], v[212:215]
  ds_read_b64_tr_b16 a[126:127], v89 offset:30720
  v_cvt_pk_bf16_f32 v242, v228, v229
  v_mfma_f32_16x16x32_bf16 v[216:219], a[104:107], v[144:147], v[216:219]
  v_cvt_pk_bf16_f32 v243, v230, v231
  buffer_load_dwordx4 v81, s[40:43], s62 offen offset:1024  lds
  v_mfma_f32_16x16x32_bf16 v[208:211], a[108:111], v[148:151], v[208:211]
  ds_read_b64_tr_b16 a[96:97], v90 offset:16384
  v_mfma_f32_16x16x32_bf16 v[212:215], a[108:111], v[152:155], v[212:215]
  ds_read_b64_tr_b16 a[98:99], v90 offset:18432
  v_mfma_f32_16x16x32_bf16 v[216:219], a[108:111], v[156:159], v[216:219]
  s_waitcnt lgkmcnt(6)
  v_mfma_f32_16x16x32_bf16 v[208:211], a[112:115], v[160:163], v[208:211]
  ds_read_b64_tr_b16 a[100:101], v90 offset:20480
  buffer_load_dwordx4 v82, s[40:43], s62 offen offset:2048  lds
  v_mfma_f32_16x16x32_bf16 v[212:215], a[112:115], v[164:167], v[212:215]
  ds_read_b64_tr_b16 a[102:103], v90 offset:22528
  v_mfma_f32_16x16x32_bf16 v[216:219], a[112:115], v[168:171], v[216:219]
  v_mfma_f32_16x16x32_bf16 v[208:211], a[116:119], v[172:175], v[208:211]
  ds_read_b64_tr_b16 a[104:105], v90 offset:24576
  v_mfma_f32_16x16x32_bf16 v[212:215], a[116:119], v[176:179], v[212:215]
  ds_read_b64_tr_b16 a[106:107], v90 offset:26624
  buffer_load_dwordx4 v83, s[40:43], s62 offen offset:3072  lds
  v_mfma_f32_16x16x32_bf16 v[216:219], a[116:119], v[180:183], v[216:219]
  s_add_u32 m0, s59, 20480
  s_waitcnt lgkmcnt(6)
  v_mfma_f32_16x16x32_bf16 v[208:211], a[120:123], v[184:187], v[208:211]
  ds_read_b64_tr_b16 a[108:109], v90 offset:28672
  s_add_u32 s61, s61, 229376
  v_mfma_f32_16x16x32_bf16 v[212:215], a[120:123], v[188:191], v[212:215]
  ds_read_b64_tr_b16 a[110:111], v90 offset:30720
  v_mfma_f32_16x16x32_bf16 v[216:219], a[120:123], v[192:195], v[216:219]
  buffer_load_dwordx4 v84, s[40:43], s62 offen offset:0  lds
  v_mfma_f32_16x16x32_bf16 v[208:211], a[124:127], v[196:199], v[208:211]
  ds_read_b64_tr_b16 a[112:113], v91 offset:16384
  v_mfma_f32_16x16x32_bf16 v[212:215], a[124:127], v[200:203], v[212:215]
  ds_read_b64_tr_b16 a[114:115], v91 offset:18432
  v_mfma_f32_16x16x32_bf16 v[216:219], a[124:127], v[204:207], v[216:219]
  s_waitcnt lgkmcnt(6)
  v_mfma_f32_16x16x32_bf16 v[220:223], a[96:99], v[112:115], 0
  ds_read_b64_tr_b16 a[116:117], v91 offset:20480
  buffer_load_dwordx4 v85, s[40:43], s62 offen offset:1024  lds
  v_mfma_f32_16x16x32_bf16 v[224:227], a[96:99], v[116:119], 0
  ds_read_b64_tr_b16 a[118:119], v91 offset:22528
  v_mfma_f32_16x16x32_bf16 v[228:231], a[96:99], v[120:123], 0
  v_mfma_f32_16x16x32_bf16 v[220:223], a[100:103], v[124:127], v[220:223]
  ds_read_b64_tr_b16 a[120:121], v91 offset:24576
  v_mfma_f32_16x16x32_bf16 v[224:227], a[100:103], v[128:131], v[224:227]
  ds_read_b64_tr_b16 a[122:123], v91 offset:26624
  buffer_load_dwordx4 v86, s[40:43], s62 offen offset:2048  lds
  v_mfma_f32_16x16x32_bf16 v[228:231], a[100:103], v[132:135], v[228:231]
  s_waitcnt lgkmcnt(6)
  v_mfma_f32_16x16x32_bf16 v[220:223], a[104:107], v[136:139], v[220:223]
  ds_read_b64_tr_b16 a[124:125], v91 offset:28672
  v_mfma_f32_16x16x32_bf16 v[224:227], a[104:107], v[140:143], v[224:227]
  ds_read_b64_tr_b16 a[126:127], v91 offset:30720
  v_mfma_f32_16x16x32_bf16 v[228:231], a[104:107], v[144:147], v[228:231]
  buffer_load_dwordx4 v87, s[40:43], s62 offen offset:3072  lds
  v_mfma_f32_16x16x32_bf16 v[220:223], a[108:111], v[148:151], v[220:223]
  s_cmp_ge_u32 s77, 14
  s_cselect_b32 s62, 458752, s61
  v_mfma_f32_16x16x32_bf16 v[224:227], a[108:111], v[152:155], v[224:227]
  v_mfma_f32_16x16x32_bf16 v[228:231], a[108:111], v[156:159], v[228:231]
  s_waitcnt lgkmcnt(4)
  v_mfma_f32_16x16x32_bf16 v[220:223], a[112:115], v[160:163], v[220:223]
  s_waitcnt vmcnt(8) lgkmcnt(0)
  s_barrier
  v_mfma_f32_16x16x32_bf16 v[224:227], a[112:115], v[164:167], v[224:227]
  ds_read_b64_tr_b16 a[96:97], v88 offset:0
  v_mfma_f32_16x16x32_bf16 v[228:231], a[112:115], v[168:171], v[228:231]
  ds_read_b64_tr_b16 a[98:99], v88 offset:2048
  v_mfma_f32_16x16x32_bf16 v[220:223], a[116:119], v[172:175], v[220:223]
  ds_read_b64_tr_b16 a[100:101], v88 offset:4096
  buffer_store_dwordx4 v[232:235], v92, s[48:51], s78 offen offset:0 sc1
  v_mfma_f32_16x16x32_bf16 v[224:227], a[116:119], v[176:179], v[224:227]
  ds_read_b64_tr_b16 a[102:103], v88 offset:6144
  v_mfma_f32_16x16x32_bf16 v[228:231], a[116:119], v[180:183], v[228:231]
  ds_read_b64_tr_b16 a[104:105], v88 offset:8192
  v_mfma_f32_16x16x32_bf16 v[220:223], a[120:123], v[184:187], v[220:223]
  ds_read_b64_tr_b16 a[106:107], v88 offset:10240
  v_mfma_f32_16x16x32_bf16 v[224:227], a[120:123], v[188:191], v[224:227]
  ds_read_b64_tr_b16 a[108:109], v88 offset:12288
  v_mfma_f32_16x16x32_bf16 v[228:231], a[120:123], v[192:195], v[228:231]
  ds_read_b64_tr_b16 a[110:111], v88 offset:14336
  v_mfma_f32_16x16x32_bf16 v[220:223], a[124:127], v[196:199], v[220:223]
  ds_read_b64_tr_b16 a[112:113], v89 offset:0
  v_mfma_f32_16x16x32_bf16 v[224:227], a[124:127], v[200:203], v[224:227]
  ds_read_b64_tr_b16 a[114:115], v89 offset:2048
  buffer_store_dwordx4 v[236:239], v92, s[48:51], s78 offen offset:1024 sc1
  v_mfma_f32_16x16x32_bf16 v[228:231], a[124:127], v[204:207], v[228:231]
  buffer_store_dwordx4 v[240:243], v92, s[48:51], s78 offen offset:2048 sc1
  s_mul_i32 s78, s79, 3072
  s_add_u32 s79, s79, 1
  s_cmp_eq_u32 s79, 7
  s_cselect_b32 s79, 0, s79
  s_waitcnt lgkmcnt(6)
  v_mfma_f32_16x16x32_bf16 v[208:211], a[96:99], a[0:3], v[208:211]
  ds_read_b64_tr_b16 a[116:117], v89 offset:4096
  s_add_u32 m0, s59, 0
  v_mfma_f32_16x16x32_bf16 v[212:215], a[96:99], a[4:7], v[212:215]
  ds_read_b64_tr_b16 a[118:119], v89 offset:6144
  s_add_u32 s77, s77, 1
  v_mfma_f32_16x16x32_bf16 v[216:219], a[96:99], a[8:11], v[216:219]
  buffer_load_dwordx4 v80, s[40:43], s62 offen offset:0  lds
  v_mfma_f32_16x16x32_bf16 v[208:211], a[100:103], a[12:15], v[208:211]
  ds_read_b64_tr_b16 a[120:121], v89 offset:8192
  v_mfma_f32_16x16x32_bf16 v[212:215], a[100:103], a[16:19], v[212:215]
  ds_read_b64_tr_b16 a[122:123], v89 offset:10240
  v_mfma_f32_16x16x32_bf16 v[216:219], a[100:103], a[20:23], v[216:219]
  s_waitcnt lgkmcnt(6)
  v_mfma_f32_16x16x32_bf16 v[208:211], a[104:107], a[24:27], v[208:211]
  ds_read_b64_tr_b16 a[124:125], v89 offset:12288
  buffer_load_dwordx4 v81, s[40:43], s62 offen offset:1024  lds
  v_mfma_f32_16x16x32_bf16 v[212:215], a[104:107], a[28:31], v[212:215]
  ds_read_b64_tr_b16 a[126:127], v89 offset:14336
  v_mfma_f32_16x16x32_bf16 v[216:219], a[104:107], a[32:35], v[216:219]
  v_mfma_f32_16x16x32_bf16 v[208:211], a[108:111], a[36:39], v[208:211]
  ds_read_b64_tr_b16 a[96:97], v90 offset:0
  v_mfma_f32_16x16x32_bf16 v[212:215], a[108:111], a[40:43], v[212:215]
  ds_read_b64_tr_b16 a[98:99], v90 offset:2048
  buffer_load_dwordx4 v82, s[40:43], s62 offen offset:2048  lds
  v_mfma_f32_16x16x32_bf16 v[216:219], a[108:111], a[44:47], v[216:219]
  s_waitcnt lgkmcnt(6)
  v_mfma_f32_16x16x32_bf16 v[208:211], a[112:115], a[48:51], v[208:211]
  ds_read_b64_tr_b16 a[100:101], v90 offset:4096
  v_mfma_f32_16x16x32_bf16 v[212:215], a[112:115], a[52:55], v[212:215]
  ds_read_b64_tr_b16 a[102:103], v90 offset:6144
  v_mfma_f32_16x16x32_bf16 v[216:219], a[112:115], a[56:59], v[216:219]
  buffer_load_dwordx4 v83, s[40:43], s62 offen offset:3072  lds
  v_mfma_f32_16x16x32_bf16 v[208:211], a[116:119], a[60:63], v[208:211]
  ds_read_b64_tr_b16 a[104:105], v90 offset:8192
  s_add_u32 m0, s59, 4096
  v_mfma_f32_16x16x32_bf16 v[212:215], a[116:119], a[64:67], v[212:215]
  ds_read_b64_tr_b16 a[106:107], v90 offset:10240
  s_sub_u32 s61, s61, 229248
  v_mfma_f32_16x16x32_bf16 v[216:219], a[116:119], a[68:71], v[216:219]
  s_waitcnt lgkmcnt(6)
  v_mfma_f32_16x16x32_bf16 v[208:211], a[120:123], a[72:75], v[208:211]
  ds_read_b64_tr_b16 a[108:109], v90 offset:12288
  buffer_load_dwordx4 v84, s[40:43], s62 offen offset:0  lds
  v_mfma_f32_16x16x32_bf16 v[212:215], a[120:123], a[76:79], v[212:215]
  ds_read_b64_tr_b16 a[110:111], v90 offset:14336
  v_mfma_f32_16x16x32_bf16 v[216:219], a[120:123], a[80:83], v[216:219]
  v_mfma_f32_16x16x32_bf16 v[208:211], a[124:127], a[84:87], v[208:211]
  ds_read_b64_tr_b16 a[112:113], v91 offset:0
  v_mfma_f32_16x16x32_bf16 v[212:215], a[124:127], a[88:91], v[212:215]
  ds_read_b64_tr_b16 a[114:115], v91 offset:2048
  buffer_load_dwordx4 v85, s[40:43], s62 offen offset:1024  lds
  v_mfma_f32_16x16x32_bf16 v[216:219], a[124:127], a[92:95], v[216:219]
  s_waitcnt lgkmcnt(6)
  v_mfma_f32_16x16x32_bf16 v[220:223], a[96:99], a[0:3], v[220:223]
  ds_read_b64_tr_b16 a[116:117], v91 offset:4096
  v_mfma_f32_16x16x32_bf16 v[224:227], a[96:99], a[4:7], v[224:227]
  ds_read_b64_tr_b16 a[118:119], v91 offset:6144
  v_mfma_f32_16x16x32_bf16 v[228:231], a[96:99], a[8:11], v[228:231]
  buffer_load_dwordx4 v86, s[40:43], s62 offen offset:2048  lds
  v_mfma_f32_16x16x32_bf16 v[220:223], a[100:103], a[12:15], v[220:223]
  ds_read_b64_tr_b16 a[120:121], v91 offset:8192
  v_cvt_pk_bf16_f32 v232, v208, v209
  v_mfma_f32_16x16x32_bf16 v[224:227], a[100:103], a[16:19], v[224:227]
  ds_read_b64_tr_b16 a[122:123], v91 offset:10240
  v_cvt_pk_bf16_f32 v233, v210, v211
  v_mfma_f32_16x16x32_bf16 v[228:231], a[100:103], a[20:23], v[228:231]
  v_cvt_pk_bf16_f32 v236, v212, v213
  s_waitcnt lgkmcnt(6)
  v_mfma_f32_16x16x32_bf16 v[220:223], a[104:107], a[24:27], v[220:223]
  ds_read_b64_tr_b16 a[124:125], v91 offset:12288
  buffer_load_dwordx4 v87, s[40:43], s62 offen offset:3072  lds
  v_mfma_f32_16x16x32_bf16 v[224:227], a[104:107], a[28:31], v[224:227]
  ds_read_b64_tr_b16 a[126:127], v91 offset:14336
  v_cvt_pk_bf16_f32 v237, v214, v215
  v_mfma_f32_16x16x32_bf16 v[228:231], a[104:107], a[32:35], v[228:231]
  s_cmp_eq_u32 s61, 896
  s_cselect_b32 s61, 0, s61
  v_mfma_f32_16x16x32_bf16 v[220:223], a[108:111], a[36:39], v[220:223]
  s_cmp_ge_u32 s77, 14
  s_cselect_b32 s62, 458752, s61
  v_mfma_f32_16x16x32_bf16 v[224:227], a[108:111], a[40:43], v[224:227]
  v_xor_b32 v88, 0x8000, v88
  v_xor_b32 v89, 0x8000, v89
  v_mfma_f32_16x16x32_bf16 v[228:231], a[108:111], a[44:47], v[228:231]
  v_xor_b32 v90, 0x8000, v90
  s_waitcnt lgkmcnt(4)
  v_mfma_f32_16x16x32_bf16 v[220:223], a[112:115], a[48:51], v[220:223]
  v_xor_b32 v91, 0x8000, v91
  s_waitcnt vmcnt(11) lgkmcnt(0)
  s_barrier
  v_mfma_f32_16x16x32_bf16 v[224:227], a[112:115], a[52:55], v[224:227]
  ds_read_b64_tr_b16 a[96:97], v88 offset:16384
  v_cvt_pk_bf16_f32 v240, v216, v217
  v_mfma_f32_16x16x32_bf16 v[228:231], a[112:115], a[56:59], v[228:231]
  ds_read_b64_tr_b16 a[98:99], v88 offset:18432
  v_cvt_pk_bf16_f32 v241, v218, v219
  v_mfma_f32_16x16x32_bf16 v[220:223], a[116:119], a[60:63], v[220:223]
  ds_read_b64_tr_b16 a[100:101], v88 offset:20480
  v_mfma_f32_16x16x32_bf16 v[224:227], a[116:119], a[64:67], v[224:227]
  ds_read_b64_tr_b16 a[102:103], v88 offset:22528
  v_mfma_f32_16x16x32_bf16 v[228:231], a[116:119], a[68:71], v[228:231]
  ds_read_b64_tr_b16 a[104:105], v88 offset:24576
  v_mfma_f32_16x16x32_bf16 v[220:223], a[120:123], a[72:75], v[220:223]
  ds_read_b64_tr_b16 a[106:107], v88 offset:26624
  v_mfma_f32_16x16x32_bf16 v[224:227], a[120:123], a[76:79], v[224:227]
  ds_read_b64_tr_b16 a[108:109], v88 offset:28672
  v_mfma_f32_16x16x32_bf16 v[228:231], a[120:123], a[80:83], v[228:231]
  ds_read_b64_tr_b16 a[110:111], v88 offset:30720
  v_mfma_f32_16x16x32_bf16 v[220:223], a[124:127], a[84:87], v[220:223]
  ds_read_b64_tr_b16 a[112:113], v89 offset:16384
  v_mfma_f32_16x16x32_bf16 v[224:227], a[124:127], a[88:91], v[224:227]
  ds_read_b64_tr_b16 a[114:115], v89 offset:18432
  v_mfma_f32_16x16x32_bf16 v[228:231], a[124:127], a[92:95], v[228:231]
  s_sub_u32 s60, s60, 1
  s_cmp_lg_u32 s60, 0
  s_cbranch_scc1 L_opA0
  s_branch L_opendA
L_opYA:
  s_mov_b32 s60, 7
.p2align 3
L_opA1:
  s_waitcnt lgkmcnt(6)
  v_mfma_f32_16x16x32_bf16 v[208:211], a[96:99], a[0:3], 0
  ds_read_b64_tr_b16 a[116:117], v89 offset:20480
  s_xor_b32 s59, s59, 0x8000
  v_mfma_f32_16x16x32_bf16 v[212:215], a[96:99], a[4:7], 0
  ds_read_b64_tr_b16 a[118:119], v89 offset:22528
  s_add_u32 m0, s59, 16384
  v_mfma_f32_16x16x32_bf16 v[216:219], a[96:99], a[8:11], 0
  s_add_u32 s77, s77, 1
  buffer_load_dwordx4 v80, s[40:43], s62 offen offset:0  lds
  v_mfma_f32_16x16x32_bf16 v[208:211], a[100:103], a[12:15], v[208:211]
  ds_read_b64_tr_b16 a[120:121], v89 offset:24576
  v_cvt_pk_bf16_f32 v234, v220, v221
  v_mfma_f32_16x16x32_bf16 v[212:215], a[100:103], a[16:19], v[212:215]
  ds_read_b64_tr_b16 a[122:123], v89 offset:26624
  v_cvt_pk_bf16_f32 v235, v222, v223
  v_mfma_f32_16x16x32_bf16 v[216:219], a[100:103], a[20:23], v[216:219]
  v_cvt_pk_bf16_f32 v238, v224, v225
  s_waitcnt lgkmcnt(6)
  v_mfma_f32_16x16x32_bf16 v[208:211], a[104:107], a[24:27], v[208:211]
  ds_read_b64_tr_b16 a[124:125], v89 offset:28672
  v_cvt_pk_bf16_f32 v239, v226, v227
  v_mfma_f32_16x16x32_bf16 v[212:215], a[104:107], a[28:31], v[212:215]
  ds_read_b64_tr_b16 a[126:127], v89 offset:30720
  v_cvt_pk_bf16_f32 v242, v228, v229
  v_mfma_f32_16x16x32_bf16 v[216:219], a[104:107], a[32:35], v[216:219]
  v_cvt_pk_bf16_f32 v243, v230, v231
  buffer_load_dwordx4 v81, s[40:43], s62 offen offset:1024  lds
  v_mfma_f32_16x16x32_bf16 v[208:211], a[108:111], a[36:39], v[208:211]
  ds_read_b64_tr_b16 a[96:97], v90 offset:16384
  v_mfma_f32_16x16x32_bf16 v[212:215], a[108:111], a[40:43], v[212:215]
  ds_read_b64_tr_b16 a[98:99], v90 offset:18432
  v_mfma_f32_16x16x32_bf16 v[216:219], a[108:111], a[44:47], v[216:219]
  s_waitcnt lgkmcnt(6)
  v_mfma_f32_16x16x32_bf16 v[208:211], a[112:115], a[48:51], v[208:211]
  ds_read_b64_tr_b16 a[100:101], v90 offset:20480
  buffer_load_dwordx4 v82, s[40:43], s62 offen offset:2048  lds
  v_mfma_f32_16x16x32_bf16 v[212:215], a[112:115], a[52:55], v[212:215]
  ds_read_b64_tr_b16 a[102:103], v90 offset:22528
  v_mfma_f32_16x16x32_bf16 v[216:219], a[112:115], a[56:59], v[216:219]
  v_mfma_f32_16x16x32_bf16 v[208:211], a[116:119], a[60:63], v[208:211]
  ds_read_b64_tr_b16 a[104:105], v90 offset:24576
  v_mfma_f32_16x16x32_bf16 v[212:215], a[116:119], a[64:67], v[212:215]
  ds_read_b64_tr_b16 a[106:107], v90 offset:26624
  buffer_load_dwordx4 v83, s[40:43], s62 offen offset:3072  lds
  v_mfma_f32_16x16x32_bf16 v[216:219], a[116:119], a[68:71], v[216:219]
  s_add_u32 m0, s59, 20480
  s_waitcnt lgkmcnt(6)
  v_mfma_f32_16x16x32_bf16 v[208:211], a[120:123], a[72:75], v[208:211]
  ds_read_b64_tr_b16 a[108:109], v90 offset:28672
  s_add_u32 s61, s61, 229376
  v_mfma_f32_16x16x32_bf16 v[212:215], a[120:123], a[76:79], v[212:215]
  ds_read_b64_tr_b16 a[110:111], v90 offset:30720
  v_mfma_f32_16x16x32_bf16 v[216:219], a[120:123], a[80:83], v[216:219]
  buffer_load_dwordx4 v84, s[40:43], s62 offen offset:0  lds
  v_mfma_f32_16x16x32_bf16 v[208:211], a[124:127], a[84:87], v[208:211]
  ds_read_b64_tr_b16 a[112:113], v91 offset:16384
  v_mfma_f32_16x16x32_bf16 v[212:215], a[124:127], a[88:91], v[212:215]
  ds_read_b64_tr_b16 a[114:115], v91 offset:18432
  v_mfma_f32_16x16x32_bf16 v[216:219], a[124:127], a[92:95], v[216:219]
  s_waitcnt lgkmcnt(6)
  v_mfma_f32_16x16x32_bf16 v[220:223], a[96:99], a[0:3], 0
  ds_read_b64_tr_b16 a[116:117], v91 offset:20480
  buffer_load_dwordx4 v85, s[40:43], s62 offen offset:1024  lds
  v_mfma_f32_16x16x32_bf16 v[224:227], a[96:99], a[4:7], 0
  ds_read_b64_tr_b16 a[118:119], v91 offset:22528
  v_mfma_f32_16x16x32_bf16 v[228:231], a[96:99], a[8:11], 0
  v_mfma_f32_16x16x32_bf16 v[220:223], a[100:103], a[12:15], v[220:223]
  ds_read_b64_tr_b16 a[120:121], v91 offset:24576
  v_mfma_f32_16x16x32_bf16 v[224:227], a[100:103], a[16:19], v[224:227]
  ds_read_b64_tr_b16 a[122:123], v91 offset:26624
  buffer_load_dwordx4 v86, s[40:43], s62 offen offset:2048  lds
  v_mfma_f32_16x16x32_bf16 v[228:231], a[100:103], a[20:23], v[228:231]
  s_waitcnt lgkmcnt(6)
  v_mfma_f32_16x16x32_bf16 v[220:223], a[104:107], a[24:27], v[220:223]
  ds_read_b64_tr_b16 a[124:125], v91 offset:28672
  v_mfma_f32_16x16x32_bf16 v[224:227], a[104:107], a[28:31], v[224:227]
  ds_read_b64_tr_b16 a[126:127], v91 offset:30720
  v_mfma_f32_16x16x32_bf16 v[228:231], a[104:107], a[32:35], v[228:231]
  buffer_load_dwordx4 v87, s[40:43], s62 offen offset:3072  lds
  v_mfma_f32_16x16x32_bf16 v[220:223], a[108:111], a[36:39], v[220:223]
  s_cmp_ge_u32 s77, 14
  s_cselect_b32 s62, 458752, s61
  v_mfma_f32_16x16x32_bf16 v[224:227], a[108:111], a[40:43], v[224:227]
  v_mfma_f32_16x16x32_bf16 v[228:231], a[108:111], a[44:47], v[228:231]
  s_waitcnt lgkmcnt(4)
  v_mfma_f32_16x16x32_bf16 v[220:223], a[112:115], a[48:51], v[220:223]
  s_waitcnt vmcnt(8) lgkmcnt(0)
  s_barrier
  v_mfma_f32_16x16x32_bf16 v[224:227], a[112:115], a[52:55], v[224:227]
  ds_read_b64_tr_b16 a[96:97], v88 offset:0
  v_mfma_f32_16x16x32_bf16 v[228:231], a[112:115], a[56:59], v[228:231]
  ds_read_b64_tr_b16 a[98:99], v88 offset:2048
  v_mfma_f32_16x16x32_bf16 v[220:223], a[116:119], a[60:63], v[220:223]
  ds_read_b64_tr_b16 a[100:101], v88 offset:4096
  buffer_store_dwordx4 v[232:235], v92, s[48:51], s78 offen offset:0 sc1
  v_mfma_f32_16x16x32_bf16 v[224:227], a[116:119], a[64:67], v[224:227]
  ds_read_b64_tr_b16 a[102:103], v88 offset:6144
  v_mfma_f32_16x16x32_bf16 v[228:231], a[116:119], a[68:71], v[228:231]
  ds_read_b64_tr_b16 a[104:105], v88 offset:8192
  v_mfma_f32_16x16x32_bf16 v[220:223], a[120:123], a[72:75], v[220:223]
  ds_read_b64_tr_b16 a[106:107], v88 offset:10240
  v_mfma_f32_16x16x32_bf16 v[224:227], a[120:123], a[76:79], v[224:227]
  ds_read_b64_tr_b16 a[108:109], v88 offset:12288
  v_mfma_f32_16x16x32_bf16 v[228:231], a[120:123], a[80:83], v[228:231]
  ds_read_b64_tr_b16 a[110:111], v88 offset:14336
  v_mfma_f32_16x16x32_bf16 v[220:223], a[124:127], a[84:87], v[220:223]
  ds_read_b64_tr_b16 a[112:113], v89 offset:0
  v_mfma_f32_16x16x32_bf16 v[224:227], a[124:127], a[88:91], v[224:227]
  ds_read_b64_tr_b16 a[114:115], v89 offset:2048
  buffer_store_dwordx4 v[236:239], v92, s[48:51], s78 offen offset:1024 sc1
  v_mfma_f32_16x16x32_bf16 v[228:231], a[124:127], a[92:95], v[228:231]
  buffer_store_dwordx4 v[240:243], v92, s[48:51], s78 offen offset:2048 sc1
  s_mul_i32 s78, s79, 3072
  s_add_u32 s79, s79, 1
  s_cmp_eq_u32 s79, 7
  s_cselect_b32 s79, 0, s79
  s_waitcnt lgkmcnt(6)
  v_mfma_f32_16x16x32_bf16 v[208:211], a[96:99], v[112:115], v[208:211]
  ds_read_b64_tr_b16 a[116:117], v89 offset:4096
  s_add_u32 m0, s59, 0
  v_mfma_f32_16x16x32_bf16 v[212:215], a[96:99], v[116:119], v[212:215]
  ds_read_b64_tr_b16 a[118:119], v89 offset:6144
  s_add_u32 s77, s77, 1
  v_mfma_f32_16x16x32_bf16 v[216:219], a[96:99], v[120:123], v[216:219]
  buffer_load_dwordx4 v80, s[40:43], s62 offen offset:0  lds
  v_mfma_f32_16x16x32_bf16 v[208:211], a[100:103], v[124:127], v[208:211]
  ds_read_b64_tr_b16 a[120:121], v89 offset:8192
  v_mfma_f32_16x16x32_bf16 v[212:215], a[100:103], v[128:131], v[212:215]
  ds_read_b64_tr_b16 a[122:123], v89 offset:10240
  v_mfma_f32_16x16x32_bf16 v[216:219], a[100:103], v[132:135], v[216:219]
  s_waitcnt lgkmcnt(6)
  v_mfma_f32_16x16x32_bf16 v[208:211], a[104:107], v[136:139], v[208:211]
  ds_read_b64_tr_b16 a[124:125], v89 offset:12288
  buffer_load_dwordx4 v81, s[40:43], s62 offen offset:1024  lds
  v_mfma_f32_16x16x32_bf16 v[212:215], a[104:107], v[140:143], v[212:215]
  ds_read_b64_tr_b16 a[126:127], v89 offset:14336
  v_mfma_f32_16x16x32_bf16 v[216:219], a[104:107], v[144:147], v[216:219]
  v_mfma_f32_16x16x32_bf16 v[208:211], a[108:111], v[148:151], v[208:211]
  ds_read_b64_tr_b16 a[96:97], v90 offset:0
  v_mfma_f32_16x16x32_bf16 v[212:215], a[108:111], v[152:155], v[212:215]
  ds_read_b64_tr_b16 a[98:99], v90 offset:2048
  buffer_load_dwordx4 v82, s[40:43], s62 offen offset:2048  lds
  v_mfma_f32_16x16x32_bf16 v[216:219], a[108:111], v[156:159], v[216:219]
  s_waitcnt lgkmcnt(6)
  v_mfma_f32_16x16x32_bf16 v[208:211], a[112:115], v[160:163], v[208:211]
  ds_read_b64_tr_b16 a[100:101], v90 offset:4096
  v_mfma_f32_16x16x32_bf16 v[212:215], a[112:115], v[164:167], v[212:215]
  ds_read_b64_tr_b16 a[102:103], v90 offset:6144
  v_mfma_f32_16x16x32_bf16 v[216:219], a[112:115], v[168:171], v[216:219]
  buffer_load_dwordx4 v83, s[40:43], s62 offen offset:3072  lds
  v_mfma_f32_16x16x32_bf16 v[208:211], a[116:119], v[172:175], v[208:211]
  ds_read_b64_tr_b16 a[104:105], v90 offset:8192
  s_add_u32 m0, s59, 4096
  v_mfma_f32_16x16x32_bf16 v[212:215], a[116:119], v[176:179], v[212:215]
  ds_read_b64_tr_b16 a[106:107], v90 offset:10240
  s_sub_u32 s61, s61, 229248
  v_mfma_f32_16x16x32_bf16 v[216:219], a[116:119], v[180:183], v[216:219]
  s_waitcnt lgkmcnt(6)
  v_mfma_f32_16x16x32_bf16 v[208:211], a[120:123], v[184:187], v[208:211]
  ds_read_b64_tr_b16 a[108:109], v90 offset:12288
  buffer_load_dwordx4 v84, s[40:43], s62 offen offset:0  lds
  v_mfma_f32_16x16x32_bf16 v[212:215], a[120:123], v[188:191], v[212:215]
  ds_read_b64_tr_b16 a[110:111], v90 offset:14336
  v_mfma_f32_16x16x32_bf16 v[216:219], a[120:123], v[192:195], v[216:219]
  v_mfma_f32_16x16x32_bf16 v[208:211], a[124:127], v[196:199], v[208:211]
  ds_read_b64_tr_b16 a[112:113], v91 offset:0
  v_mfma_f32_16x16x32_bf16 v[212:215], a[124:127], v[200:203], v[212:215]
  ds_read_b64_tr_b16 a[114:115], v91 offset:2048
  buffer_load_dwordx4 v85, s[40:43], s62 offen offset:1024  lds
  v_mfma_f32_16x16x32_bf16 v[216:219], a[124:127], v[204:207], v[216:219]
  s_waitcnt lgkmcnt(6)
  v_mfma_f32_16x16x32_bf16 v[220:223], a[96:99], v[112:115], v[220:223]
  ds_read_b64_tr_b16 a[116:117], v91 offset:4096
  v_mfma_f32_16x16x32_bf16 v[224:227], a[96:99], v[116:119], v[224:227]
  ds_read_b64_tr_b16 a[118:119], v91 offset:6144
  v_mfma_f32_16x16x32_bf16 v[228:231], a[96:99], v[120:123], v[228:231]
  buffer_load_dwordx4 v86, s[40:43], s62 offen offset:2048  lds
  v_mfma_f32_16x16x32_bf16 v[220:223], a[100:103], v[124:127], v[220:223]
  ds_read_b64_tr_b16 a[120:121], v91 offset:8192
  v_cvt_pk_bf16_f32 v232, v208, v209
  v_mfma_f32_16x16x32_bf16 v[224:227], a[100:103], v[128:131], v[224:227]
  ds_read_b64_tr_b16 a[122:123], v91 offset:10240
  v_cvt_pk_bf16_f32 v233, v210, v211
  v_mfma_f32_16x16x32_bf16 v[228:231], a[100:103], v[132:135], v[228:231]
  v_cvt_pk_bf16_f32 v236, v212, v213
  s_waitcnt lgkmcnt(6)
  v_mfma_f32_16x16x32_bf16 v[220:223], a[104:107], v[136:139], v[220:223]
  ds_read_b64_tr_b16 a[124:125], v91 offset:12288
  buffer_load_dwordx4 v87, s[40:43], s62 offen offset:3072  lds
  v_mfma_f32_16x16x32_bf16 v[224:227], a[104:107], v[140:143], v[224:227]
  ds_read_b64_tr_b16 a[126:127], v91 offset:14336
  v_cvt_pk_bf16_f32 v237, v214, v215
  v_mfma_f32_16x16x32_bf16 v[228:231], a[104:107], v[144:147], v[228:231]
  s_cmp_eq_u32 s61, 896
  s_cselect_b32 s61, 0, s61
  v_mfma_f32_16x16x32_bf16 v[220:223], a[108:111], v[148:151], v[220:223]
  s_cmp_ge_u32 s77, 14
  s_cselect_b32 s62, 458752, s61
  v_mfma_f32_16x16x32_bf16 v[224:227], a[108:111], v[152:155], v[224:227]
  v_xor_b32 v88, 0x8000, v88
  v_xor_b32 v89, 0x8000, v89
  v_mfma_f32_16x16x32_bf16 v[228:231], a[108:111], v[156:159], v[228:231]
  v_xor_b32 v90, 0x8000, v90
  s_waitcnt lgkmcnt(4)
  v_mfma_f32_16x16x32_bf16 v[220:223], a[112:115], v[160:163], v[220:223]
  v_xor_b32 v91, 0x8000, v91
  s_waitcnt vmcnt(11) lgkmcnt(0)
  s_barrier
  v_mfma_f32_16x16x32_bf16 v[224:227], a[112:115], v[164:167], v[224:227]
  ds_read_b64_tr_b16 a[96:97], v88 offset:16384
  v_cvt_pk_bf16_f32 v240, v216, v217
  v_mfma_f32_16x16x32_bf16 v[228:231], a[112:115], v[168:171], v[228:231]
  ds_read_b64_tr_b16 a[98:99], v88 offset:18432
  v_cvt_pk_bf16_f32 v241, v218, v219
  v_mfma_f32_16x16x32_bf16 v[220:223], a[116:119], v[172:175], v[220:223]
  ds_read_b64_tr_b16 a[100:101], v88 offset:20480
  v_mfma_f32_16x16x32_bf16 v[224:227], a[116:119], v[176:179], v[224:227]
  ds_read_b64_tr_b16 a[102:103], v88 offset:22528
  v_mfma_f32_16x16x32_bf16 v[228:231], a[116:119], v[180:183], v[228:231]
  ds_read_b64_tr_b16 a[104:105], v88 offset:24576
  v_mfma_f32_16x16x32_bf16 v[220:223], a[120:123], v[184:187], v[220:223]
  ds_read_b64_tr_b16 a[106:107], v88 offset:26624
  v_mfma_f32_16x16x32_bf16 v[224:227], a[120:123], v[188:191], v[224:227]
  ds_read_b64_tr_b16 a[108:109], v88 offset:28672
  v_mfma_f32_16x16x32_bf16 v[228:231], a[120:123], v[192:195], v[228:231]
  ds_read_b64_tr_b16 a[110:111], v88 offset:30720
  v_mfma_f32_16x16x32_bf16 v[220:223], a[124:127], v[196:199], v[220:223]
  ds_read_b64_tr_b16 a[112:113], v89 offset:16384
  v_mfma_f32_16x16x32_bf16 v[224:227], a[124:127], v[200:203], v[224:227]
  ds_read_b64_tr_b16 a[114:115], v89 offset:18432
  v_mfma_f32_16x16x32_bf16 v[228:231], a[124:127], v[204:207], v[228:231]
  s_sub_u32 s60, s60, 1
  s_cmp_lg_u32 s60, 0
  s_cbranch_scc1 L_opA1
L_opendA:
  s_nop 7
  v_cvt_pk_bf16_f32 v234, v220, v221
  v_cvt_pk_bf16_f32 v235, v222, v223
  v_cvt_pk_bf16_f32 v238, v224, v225
  v_cvt_pk_bf16_f32 v239, v226, v227
  v_cvt_pk_bf16_f32 v242, v228, v229
  v_cvt_pk_bf16_f32 v243, v230, v231
  buffer_store_dwordx4 v[232:235], v92, s[48:51], s78 offen offset:0 sc1
  buffer_store_dwordx4 v[236:239], v92, s[48:51], s78 offen offset:1024 sc1
  buffer_store_dwordx4 v[240:243], v92, s[48:51], s78 offen offset:2048 sc1
  s_branch L_red
L_iniA:
  s_cmp_lg_u32 s52, 0
  s_cbranch_scc1 L_iniretA
  s_lshr_b32 s64, s27, 1
  s_lshl_b32 s64, s64, 2
  v_mov_b32 v30, s64
  v_mov_b32 v31, 1
  s_mov_b64 exec, 1
  global_atomic_add v30, v31, s[100:101] sc1
  s_mov_b64 exec, -1
  s_branch L_iniretA
L_warmA:
  s_getpc_b64 s[66:67]
L_cw2A:
  s_add_u32 s66, s66, L_preA-L_cw2A
  s_addc_u32 s67, s67, -1
  s_lshl_b32 s64, s27, 2
  s_add_u32 s64, s64, s52
  s_lshl_b32 s64, s64, 9
  v_lshlrev_b32 v30, 3, v92
  v_add_u32 v30, s64, v30
  v_min_u32 v30, L_codeend-L_preA, v30
  v_mov_b32 v31, s67
  v_add_co_u32 v30, vcc, s66, v30
  s_nop 1
  v_addc_co_u32 v31, vcc, 0, v31, vcc
  s_mov_b64 exec, 0xf
  global_load_dword v100, v[30:31], off
  s_mov_b64 exec, -1
  s_mul_i32 s64, s27, 28672
  s_mul_i32 s65, s52, 7168
  s_add_u32 s64, s64, s65
  s_add_u32 s65, s65, 131072
  s_branch L_warmretA
L_red:
  s_load_dwordx2 s[4:5], s[0:1], 80
  v_mbcnt_lo_u32_b32 v7, -1, 0
  v_mbcnt_hi_u32_b32 v7, -1, v7
  s_add_u32 s30, s24, 33554432
  s_addc_u32 s31, s25, 0
  s_lshr_b32 s16, s27, 1
  s_and_b32 s22, s27, 1
  s_lshl_b32 s22, s22, 3
  s_add_u32 s22, s22, s26
  s_xor_b32 s23, s3, 1
  s_lshl_b32 s23, s23, 4
  s_add_u32 s22, s22, s23
  s_lshl_b32 s22, s22, 2
  s_lshl_b32 s23, s16, 5
  s_add_u32 s23, s23, 64
  s_lshl_b32 s23, s23, 8
  s_add_u32 s22, s22, s23
  v_and_b32 v8, 31, v7
  v_lshl_add_u32 v2, v8, 8, s22
  v_mov_b32 v4, 1
  s_lshl_b32 s22, s16, 2
  v_mov_b32 v9, s22
  v_add_u32 v3, 128, v9
  s_mov_b32 s29, 0x100000
  s_add_u32 s22, s2, 64
  s_lshl_b32 s22, s22, 8
  v_lshl_add_u32 v6, v8, 2, s22
  s_waitcnt vmcnt(0)
  s_barrier
  s_cmp_lg_u32 s52, 0
  s_cbranch_scc1 L_sg
L_ic:
  v_readfirstlane_b32 s23, v95
  s_cmp_ge_u32 s23, 32
  s_cbranch_scc0 L_icw
L_icx:
  s_mov_b32 exec_hi, 0
  global_store_dword v2, v4, s[30:31] sc1
  s_mov_b64 exec, 1
  global_atomic_add v5, v3, v4, s[100:101] sc0 sc1
  s_mov_b64 exec, -1
  s_waitcnt vmcnt(0)
  v_mov_b32 v3, 0
  s_mov_b64 exec, 1
  ds_write_b32 v3, v5 offset:4
  s_mov_b64 exec, -1
  s_waitcnt lgkmcnt(0)
L_sg:
  v_lshlrev_b32 v0, 4, v7
  v_and_b32 v4, 15, v7
  v_mul_u32_u24 v4, 1792, v4
  v_lshrrev_b32 v5, 4, v7
  v_lshl_add_u32 v1, v5, 4, v4
  s_mov_b32 s8, s24
  s_and_b32 s9, s25, 0xffff
  s_mov_b32 s10, 33030144
  s_mov_b32 s11, 0x20000
  v_mov_b32 v224, 0
  v_mov_b32 v225, 0
  v_mov_b32 v226, 0
  v_mov_b32 v227, 0
  v_mov_b32 v228, 0
  v_mov_b32 v229, 0
  v_mov_b32 v230, 0
  v_mov_b32 v231, 0
  v_mov_b32 v232, 0
  v_mov_b32 v233, 0
  v_mov_b32 v234, 0
  v_mov_b32 v235, 0
  v_mov_b32 v236, 0
  v_mov_b32 v237, 0
  v_mov_b32 v238, 0
  v_mov_b32 v239, 0
  v_mov_b32 v240, 0
  v_mov_b32 v241, 0
  v_mov_b32 v242, 0
  v_mov_b32 v243, 0
  v_mov_b32 v244, 0
  v_mov_b32 v245, 0
  v_mov_b32 v246, 0
  v_mov_b32 v247, 0
  v_mov_b32 v248, 0
  v_mov_b32 v249, 0
  v_mov_b32 v250, 0
  v_mov_b32 v251, 0
  v_mov_b32 v252, 0
  v_mov_b32 v253, 0
  v_mov_b32 v254, 0
  v_mov_b32 v255, 0
  s_barrier
  v_mov_b32 v3, 0
  ds_read_b32 v3, v3 offset:4
  s_waitcnt lgkmcnt(0)
  v_readfirstlane_b32 s17, v3
  s_mov_b32 s12, s4
  s_and_b32 s13, s5, 0xffff
  s_mov_b32 s14, 2752512
  s_mov_b32 s15, 0x20000
  s_and_b32 s17, s17, 31
  s_mul_i32 s18, s17, 2
  s_add_u32 s18, s18, 32
  s_cmp_ge_u32 s52, 2
  s_cselect_b32 s18, 84, s18
  s_cmp_lt_u32 s17, 16
  s_cselect_b32 s19, 1, 0
  s_lshl_b32 s17, s17, 2
  s_cmp_eq_u32 s19, 1
  s_cselect_b32 s17, s17, s18
  s_add_u32 s17, s17, s52
  s_cmp_ge_u32 s17, 84
  s_cbranch_scc1 L_done
  s_and_b32 s18, s17, 1
  s_lshr_b32 s17, s17, 1
  s_cmp_ge_u32 s17, 21
  s_cselect_b32 s19, 1, 0
  s_mul_i32 s34, s19, 21
  s_sub_u32 s17, s17, s34
  s_mul_i32 s20, s17, 43
  s_lshr_b32 s20, s20, 7
  s_mul_i32 s21, s20, 3
  s_sub_u32 s21, s17, s21
  s_lshl_b32 s36, s16, 6
  s_add_u32 s36, s36, s19
  s_mul_i32 s36, s36, 43008
  s_mul_i32 s34, s20, 6144
  s_add_u32 s36, s36, s34
  s_mul_i32 s34, s18, 3072
  s_add_u32 s36, s36, s34
  s_lshl_b32 s34, s21, 10
  s_add_u32 s36, s36, s34
  s_add_u32 s36, s36, 11010048
  s_lshl_b32 s37, s16, 6
  s_lshl_b32 s34, s18, 1
  s_add_u32 s37, s37, s34
  s_add_u32 s37, s37, s19
  s_mul_i32 s37, s37, 21504
  s_lshl_b32 s34, s17, 10
  s_add_u32 s37, s37, s34
  s_add_u32 s38, s37, 688128
  s_mul_i32 s42, s16, 12
  s_mul_i32 s34, s19, 3
  s_add_u32 s42, s42, s34
  s_add_u32 s42, s42, s21
  s_mul_i32 s42, s42, 28672
  s_lshl_b32 s34, s20, 7
  s_add_u32 s42, s42, s34
  s_lshl_b32 s34, s18, 6
  s_add_u32 s42, s42, s34
  s_add_u32 s43, s42, 172032
  s_add_u32 s40, s42, 896
  s_add_u32 s41, s43, 896
  s_mov_b32 s33, 0
  s_mov_b32 s28, -1
  s_mov_b32 s29, 0x200000
  s_cmp_lg_u32 s52, 0
  s_cbranch_scc1 L_ps_w
L_ps_p:
  global_load_dword v4, v6, s[30:31] sc1
  s_waitcnt vmcnt(0)
L_ps:
  v_cmp_eq_u32 vcc, 1, v4
  s_mov_b32 s22, vcc_lo
  s_sub_u32 s29, s29, 1
  s_cmp_eq_u32 s29, 0
  s_cselect_b32 s22, -1, s22
  s_cmp_eq_u32 s22, -1
  s_cbranch_scc1 L_ps_x
  s_andn2_b32 s23, s22, s33
  s_bcnt1_i32_b32 s23, s23
  s_cmp_ge_u32 s23, 2
  s_cbranch_scc1 L_ps_x
  s_sleep 2
  s_branch L_ps_p
L_ps_x:
  v_mov_b32 v5, s22
  v_mov_b32 v3, 0
  ds_write_b32 v3, v5
  s_waitcnt lgkmcnt(0)
L_ps_w:
  s_barrier
  v_mov_b32 v3, 0
  ds_read_b32 v3, v3
  s_waitcnt lgkmcnt(0)
  v_readfirstlane_b32 s22, v3
  s_barrier
  s_andn2_b32 s23, s22, s33
  s_and_b32 s23, s23, s28
  s_bfe_u32 s17, s23, 0x100000
  s_bcnt1_i32_b32 s18, s17
  s_ff1_i32_b32 s34, s17
  s_cmp_eq_u32 s17, 0
  s_cbranch_scc1 L_plB
  s_bitset0_b32 s17, s34
  s_mul_i32 s34, s34, 172032
  s_add_u32 s34, s34, s36
  s_add_u32 s35, s34, 86016
  buffer_load_dwordx4 v[32:35], v0, s[8:11], s34 offen sc1 nt
  buffer_load_dwordx4 v[36:39], v0, s[8:11], s35 offen sc1 nt
  s_ff1_i32_b32 s34, s17
  s_cmp_eq_u32 s17, 0
  s_cbranch_scc1 L_plB
  s_bitset0_b32 s17, s34
  s_mul_i32 s34, s34, 172032
  s_add_u32 s34, s34, s36
  s_add_u32 s35, s34, 86016
  buffer_load_dwordx4 v[40:43], v0, s[8:11], s34 offen sc1 nt
  buffer_load_dwordx4 v[44:47], v0, s[8:11], s35 offen sc1 nt
  s_ff1_i32_b32 s34, s17
  s_cmp_eq_u32 s17, 0
  s_cbranch_scc1 L_plB
  s_bitset0_b32 s17, s34
  s_mul_i32 s34, s34, 172032
  s_add_u32 s34, s34, s36
  s_add_u32 s35, s34, 86016
  buffer_load_dwordx4 v[48:51], v0, s[8:11], s34 offen sc1 nt
  buffer_load_dwordx4 v[52:55], v0, s[8:11], s35 offen sc1 nt
  s_ff1_i32_b32 s34, s17
  s_cmp_eq_u32 s17, 0
  s_cbranch_scc1 L_plB
  s_bitset0_b32 s17, s34
  s_mul_i32 s34, s34, 172032
  s_add_u32 s34, s34, s36
  s_add_u32 s35, s34, 86016
  buffer_load_dwordx4 v[56:59], v0, s[8:11], s34 offen sc1 nt
  buffer_load_dwordx4 v[60:63], v0, s[8:11], s35 offen sc1 nt
  s_ff1_i32_b32 s34, s17
  s_cmp_eq_u32 s17, 0
  s_cbranch_scc1 L_plB
  s_bitset0_b32 s17, s34
  s_mul_i32 s34, s34, 172032
  s_add_u32 s34, s34, s36
  s_add_u32 s35, s34, 86016
  buffer_load_dwordx4 v[64:67], v0, s[8:11], s34 offen sc1 nt
  buffer_load_dwordx4 v[68:71], v0, s[8:11], s35 offen sc1 nt
  s_ff1_i32_b32 s34, s17
  s_cmp_eq_u32 s17, 0
  s_cbranch_scc1 L_plB
  s_bitset0_b32 s17, s34
  s_mul_i32 s34, s34, 172032
  s_add_u32 s34, s34, s36
  s_add_u32 s35, s34, 86016
  buffer_load_dwordx4 v[72:75], v0, s[8:11], s34 offen sc1 nt
  buffer_load_dwordx4 v[76:79], v0, s[8:11], s35 offen sc1 nt
  s_ff1_i32_b32 s34, s17
  s_cmp_eq_u32 s17, 0
  s_cbranch_scc1 L_plB
  s_bitset0_b32 s17, s34
  s_mul_i32 s34, s34, 172032
  s_add_u32 s34, s34, s36
  s_add_u32 s35, s34, 86016
  buffer_load_dwordx4 v[80:83], v0, s[8:11], s34 offen sc1 nt
  buffer_load_dwordx4 v[84:87], v0, s[8:11], s35 offen sc1 nt
  s_ff1_i32_b32 s34, s17
  s_cmp_eq_u32 s17, 0
  s_cbranch_scc1 L_plB
  s_bitset0_b32 s17, s34
  s_mul_i32 s34, s34, 172032
  s_add_u32 s34, s34, s36
  s_add_u32 s35, s34, 86016
  buffer_load_dwordx4 v[88:91], v0, s[8:11], s34 offen sc1 nt
  buffer_load_dwordx4 v[92:95], v0, s[8:11], s35 offen sc1 nt
  s_ff1_i32_b32 s34, s17
  s_cmp_eq_u32 s17, 0
  s_cbranch_scc1 L_plB
  s_bitset0_b32 s17, s34
  s_mul_i32 s34, s34, 172032
  s_add_u32 s34, s34, s36
  s_add_u32 s35, s34, 86016
  buffer_load_dwordx4 v[96:99], v0, s[8:11], s34 offen sc1 nt
  buffer_load_dwordx4 v[100:103], v0, s[8:11], s35 offen sc1 nt
  s_ff1_i32_b32 s34, s17
  s_cmp_eq_u32 s17, 0
  s_cbranch_scc1 L_plB
  s_bitset0_b32 s17, s34
  s_mul_i32 s34, s34, 172032
  s_add_u32 s34, s34, s36
  s_add_u32 s35, s34, 86016
  buffer_load_dwordx4 v[104:107], v0, s[8:11], s34 offen sc1 nt
  buffer_load_dwordx4 v[108:111], v0, s[8:11], s35 offen sc1 nt
  s_ff1_i32_b32 s34, s17
  s_cmp_eq_u32 s17, 0
  s_cbranch_scc1 L_plB
  s_bitset0_b32 s17, s34
  s_mul_i32 s34, s34, 172032
  s_add_u32 s34, s34, s36
  s_add_u32 s35, s34, 86016
  buffer_load_dwordx4 v[112:115], v0, s[8:11], s34 offen sc1 nt
  buffer_load_dwordx4 v[116:119], v0, s[8:11], s35 offen sc1 nt
  s_ff1_i32_b32 s34, s17
  s_cmp_eq_u32 s17, 0
  s_cbranch_scc1 L_plB
  s_bitset0_b32 s17, s34
  s_mul_i32 s34, s34, 172032
  s_add_u32 s34, s34, s36
  s_add_u32 s35, s34, 86016
  buffer_load_dwordx4 v[120:123], v0, s[8:11], s34 offen sc1 nt
  buffer_load_dwordx4 v[124:127], v0, s[8:11], s35 offen sc1 nt
  s_ff1_i32_b32 s34, s17
  s_cmp_eq_u32 s17, 0
  s_cbranch_scc1 L_plB
  s_bitset0_b32 s17, s34
  s_mul_i32 s34, s34, 172032
  s_add_u32 s34, s34, s36
  s_add_u32 s35, s34, 86016
  buffer_load_dwordx4 v[128:131], v0, s[8:11], s34 offen sc1 nt
  buffer_load_dwordx4 v[132:135], v0, s[8:11], s35 offen sc1 nt
  s_ff1_i32_b32 s34, s17
  s_cmp_eq_u32 s17, 0
  s_cbranch_scc1 L_plB
  s_bitset0_b32 s17, s34
  s_mul_i32 s34, s34, 172032
  s_add_u32 s34, s34, s36
  s_add_u32 s35, s34, 86016
  buffer_load_dwordx4 v[136:139], v0, s[8:11], s34 offen sc1 nt
  buffer_load_dwordx4 v[140:143], v0, s[8:11], s35 offen sc1 nt
  s_ff1_i32_b32 s34, s17
  s_cmp_eq_u32 s17, 0
  s_cbranch_scc1 L_plB
  s_bitset0_b32 s17, s34
  s_mul_i32 s34, s34, 172032
  s_add_u32 s34, s34, s36
  s_add_u32 s35, s34, 86016
  buffer_load_dwordx4 v[144:147], v0, s[8:11], s34 offen sc1 nt
  buffer_load_dwordx4 v[148:151], v0, s[8:11], s35 offen sc1 nt
  s_ff1_i32_b32 s34, s17
  s_cmp_eq_u32 s17, 0
  s_cbranch_scc1 L_plB
  s_bitset0_b32 s17, s34
  s_mul_i32 s34, s34, 172032
  s_add_u32 s34, s34, s36
  s_add_u32 s35, s34, 86016
  buffer_load_dwordx4 v[152:155], v0, s[8:11], s34 offen sc1 nt
  buffer_load_dwordx4 v[156:159], v0, s[8:11], s35 offen sc1 nt
L_plB:
  s_bfe_u32 s17, s23, 0x80010
  s_bcnt1_i32_b32 s19, s17
  s_ff1_i32_b32 s34, s17
  s_cmp_eq_u32 s17, 0
  s_cbranch_scc1 L_plA0
  s_bitset0_b32 s17, s34
  s_mul_i32 s34, s34, 86016
  s_add_u32 s34, s34, s37
  buffer_load_dwordx4 v[160:163], v0, s[8:11], s34 offen sc1 nt
  s_ff1_i32_b32 s34, s17
  s_cmp_eq_u32 s17, 0
  s_cbranch_scc1 L_plA0
  s_bitset0_b32 s17, s34
  s_mul_i32 s34, s34, 86016
  s_add_u32 s34, s34, s37
  buffer_load_dwordx4 v[164:167], v0, s[8:11], s34 offen sc1 nt
  s_ff1_i32_b32 s34, s17
  s_cmp_eq_u32 s17, 0
  s_cbranch_scc1 L_plA0
  s_bitset0_b32 s17, s34
  s_mul_i32 s34, s34, 86016
  s_add_u32 s34, s34, s37
  buffer_load_dwordx4 v[168:171], v0, s[8:11], s34 offen sc1 nt
  s_ff1_i32_b32 s34, s17
  s_cmp_eq_u32 s17, 0
  s_cbranch_scc1 L_plA0
  s_bitset0_b32 s17, s34
  s_mul_i32 s34, s34, 86016
  s_add_u32 s34, s34, s37
  buffer_load_dwordx4 v[172:175], v0, s[8:11], s34 offen sc1 nt
  s_ff1_i32_b32 s34, s17
  s_cmp_eq_u32 s17, 0
  s_cbranch_scc1 L_plA0
  s_bitset0_b32 s17, s34
  s_mul_i32 s34, s34, 86016
  s_add_u32 s34, s34, s37
  buffer_load_dwordx4 v[176:179], v0, s[8:11], s34 offen sc1 nt
  s_ff1_i32_b32 s34, s17
  s_cmp_eq_u32 s17, 0
  s_cbranch_scc1 L_plA0
  s_bitset0_b32 s17, s34
  s_mul_i32 s34, s34, 86016
  s_add_u32 s34, s34, s37
  buffer_load_dwordx4 v[180:183], v0, s[8:11], s34 offen sc1 nt
  s_ff1_i32_b32 s34, s17
  s_cmp_eq_u32 s17, 0
  s_cbranch_scc1 L_plA0
  s_bitset0_b32 s17, s34
  s_mul_i32 s34, s34, 86016
  s_add_u32 s34, s34, s37
  buffer_load_dwordx4 v[184:187], v0, s[8:11], s34 offen sc1 nt
  s_ff1_i32_b32 s34, s17
  s_cmp_eq_u32 s17, 0
  s_cbranch_scc1 L_plA0
  s_bitset0_b32 s17, s34
  s_mul_i32 s34, s34, 86016
  s_add_u32 s34, s34, s37
  buffer_load_dwordx4 v[188:191], v0, s[8:11], s34 offen sc1 nt
L_plA0:
  s_bfe_u32 s17, s23, 0x80018
  s_bcnt1_i32_b32 s20, s17
  s_ff1_i32_b32 s34, s17
  s_cmp_eq_u32 s17, 0
  s_cbranch_scc1 L_plA1
  s_bitset0_b32 s17, s34
  s_mul_i32 s34, s34, 86016
  s_add_u32 s34, s34, s38
  buffer_load_dwordx4 v[192:195], v0, s[8:11], s34 offen sc1 nt
  s_ff1_i32_b32 s34, s17
  s_cmp_eq_u32 s17, 0
  s_cbranch_scc1 L_plA1
  s_bitset0_b32 s17, s34
  s_mul_i32 s34, s34, 86016
  s_add_u32 s34, s34, s38
  buffer_load_dwordx4 v[196:199], v0, s[8:11], s34 offen sc1 nt
  s_ff1_i32_b32 s34, s17
  s_cmp_eq_u32 s17, 0
  s_cbranch_scc1 L_plA1
  s_bitset0_b32 s17, s34
  s_mul_i32 s34, s34, 86016
  s_add_u32 s34, s34, s38
  buffer_load_dwordx4 v[200:203], v0, s[8:11], s34 offen sc1 nt
  s_ff1_i32_b32 s34, s17
  s_cmp_eq_u32 s17, 0
  s_cbranch_scc1 L_plA1
  s_bitset0_b32 s17, s34
  s_mul_i32 s34, s34, 86016
  s_add_u32 s34, s34, s38
  buffer_load_dwordx4 v[204:207], v0, s[8:11], s34 offen sc1 nt
  s_ff1_i32_b32 s34, s17
  s_cmp_eq_u32 s17, 0
  s_cbranch_scc1 L_plA1
  s_bitset0_b32 s17, s34
  s_mul_i32 s34, s34, 86016
  s_add_u32 s34, s34, s38
  buffer_load_dwordx4 v[208:211], v0, s[8:11], s34 offen sc1 nt
  s_ff1_i32_b32 s34, s17
  s_cmp_eq_u32 s17, 0
  s_cbranch_scc1 L_plA1
  s_bitset0_b32 s17, s34
  s_mul_i32 s34, s34, 86016
  s_add_u32 s34, s34, s38
  buffer_load_dwordx4 v[212:215], v0, s[8:11], s34 offen sc1 nt
  s_ff1_i32_b32 s34, s17
  s_cmp_eq_u32 s17, 0
  s_cbranch_scc1 L_plA1
  s_bitset0_b32 s17, s34
  s_mul_i32 s34, s34, 86016
  s_add_u32 s34, s34, s38
  buffer_load_dwordx4 v[216:219], v0, s[8:11], s34 offen sc1 nt
  s_ff1_i32_b32 s34, s17
  s_cmp_eq_u32 s17, 0
  s_cbranch_scc1 L_plA1
  s_bitset0_b32 s17, s34
  s_mul_i32 s34, s34, 86016
  s_add_u32 s34, s34, s38
  buffer_load_dwordx4 v[220:223], v0, s[8:11], s34 offen sc1 nt
L_plA1:
  s_cmp_lg_u32 s52, 0
  s_cbranch_scc1 L_np
  global_load_dword v4, v6, s[30:31] sc1
L_np:
  s_mov_b32 s34, 0x3f80
  s_mov_b32 s35, 0x3f800000
  s_waitcnt vmcnt(0)
  s_cmp_eq_u32 s18, 0
  s_cbranch_scc1 L_paB
  v_dot2c_f32_bf16 v224, s34, v32
  v_dot2c_f32_bf16 v225, s35, v32
  v_dot2c_f32_bf16 v226, s34, v33
  v_dot2c_f32_bf16 v227, s35, v33
  v_dot2c_f32_bf16 v228, s34, v34
  v_dot2c_f32_bf16 v229, s35, v34
  v_dot2c_f32_bf16 v230, s34, v35
  v_dot2c_f32_bf16 v231, s35, v35
  v_dot2c_f32_bf16 v232, s34, v36
  v_dot2c_f32_bf16 v233, s35, v36
  v_dot2c_f32_bf16 v234, s34, v37
  v_dot2c_f32_bf16 v235, s35, v37
  v_dot2c_f32_bf16 v236, s34, v38
  v_dot2c_f32_bf16 v237, s35, v38
  v_dot2c_f32_bf16 v238, s34, v39
  v_dot2c_f32_bf16 v239, s35, v39
  s_cmp_eq_u32 s18, 1
  s_cbranch_scc1 L_paB
  v_dot2c_f32_bf16 v224, s34, v40
  v_dot2c_f32_bf16 v225, s35, v40
  v_dot2c_f32_bf16 v226, s34, v41
  v_dot2c_f32_bf16 v227, s35, v41
  v_dot2c_f32_bf16 v228, s34, v42
  v_dot2c_f32_bf16 v229, s35, v42
  v_dot2c_f32_bf16 v230, s34, v43
  v_dot2c_f32_bf16 v231, s35, v43
  v_dot2c_f32_bf16 v232, s34, v44
  v_dot2c_f32_bf16 v233, s35, v44
  v_dot2c_f32_bf16 v234, s34, v45
  v_dot2c_f32_bf16 v235, s35, v45
  v_dot2c_f32_bf16 v236, s34, v46
  v_dot2c_f32_bf16 v237, s35, v46
  v_dot2c_f32_bf16 v238, s34, v47
  v_dot2c_f32_bf16 v239, s35, v47
  s_cmp_eq_u32 s18, 2
  s_cbranch_scc1 L_paB
  v_dot2c_f32_bf16 v224, s34, v48
  v_dot2c_f32_bf16 v225, s35, v48
  v_dot2c_f32_bf16 v226, s34, v49
  v_dot2c_f32_bf16 v227, s35, v49
  v_dot2c_f32_bf16 v228, s34, v50
  v_dot2c_f32_bf16 v229, s35, v50
  v_dot2c_f32_bf16 v230, s34, v51
  v_dot2c_f32_bf16 v231, s35, v51
  v_dot2c_f32_bf16 v232, s34, v52
  v_dot2c_f32_bf16 v233, s35, v52
  v_dot2c_f32_bf16 v234, s34, v53
  v_dot2c_f32_bf16 v235, s35, v53
  v_dot2c_f32_bf16 v236, s34, v54
  v_dot2c_f32_bf16 v237, s35, v54
  v_dot2c_f32_bf16 v238, s34, v55
  v_dot2c_f32_bf16 v239, s35, v55
  s_cmp_eq_u32 s18, 3
  s_cbranch_scc1 L_paB
  v_dot2c_f32_bf16 v224, s34, v56
  v_dot2c_f32_bf16 v225, s35, v56
  v_dot2c_f32_bf16 v226, s34, v57
  v_dot2c_f32_bf16 v227, s35, v57
  v_dot2c_f32_bf16 v228, s34, v58
  v_dot2c_f32_bf16 v229, s35, v58
  v_dot2c_f32_bf16 v230, s34, v59
  v_dot2c_f32_bf16 v231, s35, v59
  v_dot2c_f32_bf16 v232, s34, v60
  v_dot2c_f32_bf16 v233, s35, v60
  v_dot2c_f32_bf16 v234, s34, v61
  v_dot2c_f32_bf16 v235, s35, v61
  v_dot2c_f32_bf16 v236, s34, v62
  v_dot2c_f32_bf16 v237, s35, v62
  v_dot2c_f32_bf16 v238, s34, v63
  v_dot2c_f32_bf16 v239, s35, v63
  s_cmp_eq_u32 s18, 4
  s_cbranch_scc1 L_paB
  v_dot2c_f32_bf16 v224, s34, v64
  v_dot2c_f32_bf16 v225, s35, v64
  v_dot2c_f32_bf16 v226, s34, v65
  v_dot2c_f32_bf16 v227, s35, v65
  v_dot2c_f32_bf16 v228, s34, v66
  v_dot2c_f32_bf16 v229, s35, v66
  v_dot2c_f32_bf16 v230, s34, v67
  v_dot2c_f32_bf16 v231, s35, v67
  v_dot2c_f32_bf16 v232, s34, v68
  v_dot2c_f32_bf16 v233, s35, v68
  v_dot2c_f32_bf16 v234, s34, v69
  v_dot2c_f32_bf16 v235, s35, v69
  v_dot2c_f32_bf16 v236, s34, v70
  v_dot2c_f32_bf16 v237, s35, v70
  v_dot2c_f32_bf16 v238, s34, v71
  v_dot2c_f32_bf16 v239, s35, v71
  s_cmp_eq_u32 s18, 5
  s_cbranch_scc1 L_paB
  v_dot2c_f32_bf16 v224, s34, v72
  v_dot2c_f32_bf16 v225, s35, v72
  v_dot2c_f32_bf16 v226, s34, v73
  v_dot2c_f32_bf16 v227, s35, v73
  v_dot2c_f32_bf16 v228, s34, v74
  v_dot2c_f32_bf16 v229, s35, v74
  v_dot2c_f32_bf16 v230, s34, v75
  v_dot2c_f32_bf16 v231, s35, v75
  v_dot2c_f32_bf16 v232, s34, v76
  v_dot2c_f32_bf16 v233, s35, v76
  v_dot2c_f32_bf16 v234, s34, v77
  v_dot2c_f32_bf16 v235, s35, v77
  v_dot2c_f32_bf16 v236, s34, v78
  v_dot2c_f32_bf16 v237, s35, v78
  v_dot2c_f32_bf16 v238, s34, v79
  v_dot2c_f32_bf16 v239, s35, v79
  s_cmp_eq_u32 s18, 6
  s_cbranch_scc1 L_paB
  v_dot2c_f32_bf16 v224, s34, v80
  v_dot2c_f32_bf16 v225, s35, v80
  v_dot2c_f32_bf16 v226, s34, v81
  v_dot2c_f32_bf16 v227, s35, v81
  v_dot2c_f32_bf16 v228, s34, v82
  v_dot2c_f32_bf16 v229, s35, v82
  v_dot2c_f32_bf16 v230, s34, v83
  v_dot2c_f32_bf16 v231, s35, v83
  v_dot2c_f32_bf16 v232, s34, v84
  v_dot2c_f32_bf16 v233, s35, v84
  v_dot2c_f32_bf16 v234, s34, v85
  v_dot2c_f32_bf16 v235, s35, v85
  v_dot2c_f32_bf16 v236, s34, v86
  v_dot2c_f32_bf16 v237, s35, v86
  v_dot2c_f32_bf16 v238, s34, v87
  v_dot2c_f32_bf16 v239, s35, v87
  s_cmp_eq_u32 s18, 7
  s_cbranch_scc1 L_paB
  v_dot2c_f32_bf16 v224, s34, v88
  v_dot2c_f32_bf16 v225, s35, v88
  v_dot2c_f32_bf16 v226, s34, v89
  v_dot2c_f32_bf16 v227, s35, v89
  v_dot2c_f32_bf16 v228, s34, v90
  v_dot2c_f32_bf16 v229, s35, v90
  v_dot2c_f32_bf16 v230, s34, v91
  v_dot2c_f32_bf16 v231, s35, v91
  v_dot2c_f32_bf16 v232, s34, v92
  v_dot2c_f32_bf16 v233, s35, v92
  v_dot2c_f32_bf16 v234, s34, v93
  v_dot2c_f32_bf16 v235, s35, v93
  v_dot2c_f32_bf16 v236, s34, v94
  v_dot2c_f32_bf16 v237, s35, v94
  v_dot2c_f32_bf16 v238, s34, v95
  v_dot2c_f32_bf16 v239, s35, v95
  s_cmp_eq_u32 s18, 8
  s_cbranch_scc1 L_paB
  v_dot2c_f32_bf16 v224, s34, v96
  v_dot2c_f32_bf16 v225, s35, v96
  v_dot2c_f32_bf16 v226, s34, v97
  v_dot2c_f32_bf16 v227, s35, v97
  v_dot2c_f32_bf16 v228, s34, v98
  v_dot2c_f32_bf16 v229, s35, v98
  v_dot2c_f32_bf16 v230, s34, v99
  v_dot2c_f32_bf16 v231, s35, v99
  v_dot2c_f32_bf16 v232, s34, v100
  v_dot2c_f32_bf16 v233, s35, v100
  v_dot2c_f32_bf16 v234, s34, v101
  v_dot2c_f32_bf16 v235, s35, v101
  v_dot2c_f32_bf16 v236, s34, v102
  v_dot2c_f32_bf16 v237, s35, v102
  v_dot2c_f32_bf16 v238, s34, v103
  v_dot2c_f32_bf16 v239, s35, v103
  s_cmp_eq_u32 s18, 9
  s_cbranch_scc1 L_paB
  v_dot2c_f32_bf16 v224, s34, v104
  v_dot2c_f32_bf16 v225, s35, v104
  v_dot2c_f32_bf16 v226, s34, v105
  v_dot2c_f32_bf16 v227, s35, v105
  v_dot2c_f32_bf16 v228, s34, v106
  v_dot2c_f32_bf16 v229, s35, v106
  v_dot2c_f32_bf16 v230, s34, v107
  v_dot2c_f32_bf16 v231, s35, v107
  v_dot2c_f32_bf16 v232, s34, v108
  v_dot2c_f32_bf16 v233, s35, v108
  v_dot2c_f32_bf16 v234, s34, v109
  v_dot2c_f32_bf16 v235, s35, v109
  v_dot2c_f32_bf16 v236, s34, v110
  v_dot2c_f32_bf16 v237, s35, v110
  v_dot2c_f32_bf16 v238, s34, v111
  v_dot2c_f32_bf16 v239, s35, v111
  s_cmp_eq_u32 s18, 10
  s_cbranch_scc1 L_paB
  v_dot2c_f32_bf16 v224, s34, v112
  v_dot2c_f32_bf16 v225, s35, v112
  v_dot2c_f32_bf16 v226, s34, v113
  v_dot2c_f32_bf16 v227, s35, v113
  v_dot2c_f32_bf16 v228, s34, v114
  v_dot2c_f32_bf16 v229, s35, v114
  v_dot2c_f32_bf16 v230, s34, v115
  v_dot2c_f32_bf16 v231, s35, v115
  v_dot2c_f32_bf16 v232, s34, v116
  v_dot2c_f32_bf16 v233, s35, v116
  v_dot2c_f32_bf16 v234, s34, v117
  v_dot2c_f32_bf16 v235, s35, v117
  v_dot2c_f32_bf16 v236, s34, v118
  v_dot2c_f32_bf16 v237, s35, v118
  v_dot2c_f32_bf16 v238, s34, v119
  v_dot2c_f32_bf16 v239, s35, v119
  s_cmp_eq_u32 s18, 11
  s_cbranch_scc1 L_paB
  v_dot2c_f32_bf16 v224, s34, v120
  v_dot2c_f32_bf16 v225, s35, v120
  v_dot2c_f32_bf16 v226, s34, v121
  v_dot2c_f32_bf16 v227, s35, v121
  v_dot2c_f32_bf16 v228, s34, v122
  v_dot2c_f32_bf16 v229, s35, v122
  v_dot2c_f32_bf16 v230, s34, v123
  v_dot2c_f32_bf16 v231, s35, v123
  v_dot2c_f32_bf16 v232, s34, v124
  v_dot2c_f32_bf16 v233, s35, v124
  v_dot2c_f32_bf16 v234, s34, v125
  v_dot2c_f32_bf16 v235, s35, v125
  v_dot2c_f32_bf16 v236, s34, v126
  v_dot2c_f32_bf16 v237, s35, v126
  v_dot2c_f32_bf16 v238, s34, v127
  v_dot2c_f32_bf16 v239, s35, v127
  s_cmp_eq_u32 s18, 12
  s_cbranch_scc1 L_paB
  v_dot2c_f32_bf16 v224, s34, v128
  v_dot2c_f32_bf16 v225, s35, v128
  v_dot2c_f32_bf16 v226, s34, v129
  v_dot2c_f32_bf16 v227, s35, v129
  v_dot2c_f32_bf16 v228, s34, v130
  v_dot2c_f32_bf16 v229, s35, v130
  v_dot2c_f32_bf16 v230, s34, v131
  v_dot2c_f32_bf16 v231, s35, v131
  v_dot2c_f32_bf16 v232, s34, v132
  v_dot2c_f32_bf16 v233, s35, v132
  v_dot2c_f32_bf16 v234, s34, v133
  v_dot2c_f32_bf16 v235, s35, v133
  v_dot2c_f32_bf16 v236, s34, v134
  v_dot2c_f32_bf16 v237, s35, v134
  v_dot2c_f32_bf16 v238, s34, v135
  v_dot2c_f32_bf16 v239, s35, v135
  s_cmp_eq_u32 s18, 13
  s_cbranch_scc1 L_paB
  v_dot2c_f32_bf16 v224, s34, v136
  v_dot2c_f32_bf16 v225, s35, v136
  v_dot2c_f32_bf16 v226, s34, v137
  v_dot2c_f32_bf16 v227, s35, v137
  v_dot2c_f32_bf16 v228, s34, v138
  v_dot2c_f32_bf16 v229, s35, v138
  v_dot2c_f32_bf16 v230, s34, v139
  v_dot2c_f32_bf16 v231, s35, v139
  v_dot2c_f32_bf16 v232, s34, v140
  v_dot2c_f32_bf16 v233, s35, v140
  v_dot2c_f32_bf16 v234, s34, v141
  v_dot2c_f32_bf16 v235, s35, v141
  v_dot2c_f32_bf16 v236, s34, v142
  v_dot2c_f32_bf16 v237, s35, v142
  v_dot2c_f32_bf16 v238, s34, v143
  v_dot2c_f32_bf16 v239, s35, v143
  s_cmp_eq_u32 s18, 14
  s_cbranch_scc1 L_paB
  v_dot2c_f32_bf16 v224, s34, v144
  v_dot2c_f32_bf16 v225, s35, v144
  v_dot2c_f32_bf16 v226, s34, v145
  v_dot2c_f32_bf16 v227, s35, v145
  v_dot2c_f32_bf16 v228, s34, v146
  v_dot2c_f32_bf16 v229, s35, v146
  v_dot2c_f32_bf16 v230, s34, v147
  v_dot2c_f32_bf16 v231, s35, v147
  v_dot2c_f32_bf16 v232, s34, v148
  v_dot2c_f32_bf16 v233, s35, v148
  v_dot2c_f32_bf16 v234, s34, v149
  v_dot2c_f32_bf16 v235, s35, v149
  v_dot2c_f32_bf16 v236, s34, v150
  v_dot2c_f32_bf16 v237, s35, v150
  v_dot2c_f32_bf16 v238, s34, v151
  v_dot2c_f32_bf16 v239, s35, v151
  s_cmp_eq_u32 s18, 15
  s_cbranch_scc1 L_paB
  v_dot2c_f32_bf16 v224, s34, v152
  v_dot2c_f32_bf16 v225, s35, v152
  v_dot2c_f32_bf16 v226, s34, v153
  v_dot2c_f32_bf16 v227, s35, v153
  v_dot2c_f32_bf16 v228, s34, v154
  v_dot2c_f32_bf16 v229, s35, v154
  v_dot2c_f32_bf16 v230, s34, v155
  v_dot2c_f32_bf16 v231, s35, v155
  v_dot2c_f32_bf16 v232, s34, v156
  v_dot2c_f32_bf16 v233, s35, v156
  v_dot2c_f32_bf16 v234, s34, v157
  v_dot2c_f32_bf16 v235, s35, v157
  v_dot2c_f32_bf16 v236, s34, v158
  v_dot2c_f32_bf16 v237, s35, v158
  v_dot2c_f32_bf16 v238, s34, v159
  v_dot2c_f32_bf16 v239, s35, v159
L_paB:
  s_cmp_eq_u32 s19, 0
  s_cbranch_scc1 L_paA0
  v_dot2c_f32_bf16 v240, s34, v160
  v_dot2c_f32_bf16 v241, s35, v160
  v_dot2c_f32_bf16 v242, s34, v161
  v_dot2c_f32_bf16 v243, s35, v161
  v_dot2c_f32_bf16 v244, s34, v162
  v_dot2c_f32_bf16 v245, s35, v162
  v_dot2c_f32_bf16 v246, s34, v163
  v_dot2c_f32_bf16 v247, s35, v163
  s_cmp_eq_u32 s19, 1
  s_cbranch_scc1 L_paA0
  v_dot2c_f32_bf16 v240, s34, v164
  v_dot2c_f32_bf16 v241, s35, v164
  v_dot2c_f32_bf16 v242, s34, v165
  v_dot2c_f32_bf16 v243, s35, v165
  v_dot2c_f32_bf16 v244, s34, v166
  v_dot2c_f32_bf16 v245, s35, v166
  v_dot2c_f32_bf16 v246, s34, v167
  v_dot2c_f32_bf16 v247, s35, v167
  s_cmp_eq_u32 s19, 2
  s_cbranch_scc1 L_paA0
  v_dot2c_f32_bf16 v240, s34, v168
  v_dot2c_f32_bf16 v241, s35, v168
  v_dot2c_f32_bf16 v242, s34, v169
  v_dot2c_f32_bf16 v243, s35, v169
  v_dot2c_f32_bf16 v244, s34, v170
  v_dot2c_f32_bf16 v245, s35, v170
  v_dot2c_f32_bf16 v246, s34, v171
  v_dot2c_f32_bf16 v247, s35, v171
  s_cmp_eq_u32 s19, 3
  s_cbranch_scc1 L_paA0
  v_dot2c_f32_bf16 v240, s34, v172
  v_dot2c_f32_bf16 v241, s35, v172
  v_dot2c_f32_bf16 v242, s34, v173
  v_dot2c_f32_bf16 v243, s35, v173
  v_dot2c_f32_bf16 v244, s34, v174
  v_dot2c_f32_bf16 v245, s35, v174
  v_dot2c_f32_bf16 v246, s34, v175
  v_dot2c_f32_bf16 v247, s35, v175
  s_cmp_eq_u32 s19, 4
  s_cbranch_scc1 L_paA0
  v_dot2c_f32_bf16 v240, s34, v176
  v_dot2c_f32_bf16 v241, s35, v176
  v_dot2c_f32_bf16 v242, s34, v177
  v_dot2c_f32_bf16 v243, s35, v177
  v_dot2c_f32_bf16 v244, s34, v178
  v_dot2c_f32_bf16 v245, s35, v178
  v_dot2c_f32_bf16 v246, s34, v179
  v_dot2c_f32_bf16 v247, s35, v179
  s_cmp_eq_u32 s19, 5
  s_cbranch_scc1 L_paA0
  v_dot2c_f32_bf16 v240, s34, v180
  v_dot2c_f32_bf16 v241, s35, v180
  v_dot2c_f32_bf16 v242, s34, v181
  v_dot2c_f32_bf16 v243, s35, v181
  v_dot2c_f32_bf16 v244, s34, v182
  v_dot2c_f32_bf16 v245, s35, v182
  v_dot2c_f32_bf16 v246, s34, v183
  v_dot2c_f32_bf16 v247, s35, v183
  s_cmp_eq_u32 s19, 6
  s_cbranch_scc1 L_paA0
  v_dot2c_f32_bf16 v240, s34, v184
  v_dot2c_f32_bf16 v241, s35, v184
  v_dot2c_f32_bf16 v242, s34, v185
  v_dot2c_f32_bf16 v243, s35, v185
  v_dot2c_f32_bf16 v244, s34, v186
  v_dot2c_f32_bf16 v245, s35, v186
  v_dot2c_f32_bf16 v246, s34, v187
  v_dot2c_f32_bf16 v247, s35, v187
  s_cmp_eq_u32 s19, 7
  s_cbranch_scc1 L_paA0
  v_dot2c_f32_bf16 v240, s34, v188
  v_dot2c_f32_bf16 v241, s35, v188
  v_dot2c_f32_bf16 v242, s34, v189
  v_dot2c_f32_bf16 v243, s35, v189
  v_dot2c_f32_bf16 v244, s34, v190
  v_dot2c_f32_bf16 v245, s35, v190
  v_dot2c_f32_bf16 v246, s34, v191
  v_dot2c_f32_bf16 v247, s35, v191
L_paA0:
  s_cmp_eq_u32 s20, 0
  s_cbranch_scc1 L_paA1
  v_dot2c_f32_bf16 v248, s34, v192
  v_dot2c_f32_bf16 v249, s35, v192
  v_dot2c_f32_bf16 v250, s34, v193
  v_dot2c_f32_bf16 v251, s35, v193
  v_dot2c_f32_bf16 v252, s34, v194
  v_dot2c_f32_bf16 v253, s35, v194
  v_dot2c_f32_bf16 v254, s34, v195
  v_dot2c_f32_bf16 v255, s35, v195
  s_cmp_eq_u32 s20, 1
  s_cbranch_scc1 L_paA1
  v_dot2c_f32_bf16 v248, s34, v196
  v_dot2c_f32_bf16 v249, s35, v196
  v_dot2c_f32_bf16 v250, s34, v197
  v_dot2c_f32_bf16 v251, s35, v197
  v_dot2c_f32_bf16 v252, s34, v198
  v_dot2c_f32_bf16 v253, s35, v198
  v_dot2c_f32_bf16 v254, s34, v199
  v_dot2c_f32_bf16 v255, s35, v199
  s_cmp_eq_u32 s20, 2
  s_cbranch_scc1 L_paA1
  v_dot2c_f32_bf16 v248, s34, v200
  v_dot2c_f32_bf16 v249, s35, v200
  v_dot2c_f32_bf16 v250, s34, v201
  v_dot2c_f32_bf16 v251, s35, v201
  v_dot2c_f32_bf16 v252, s34, v202
  v_dot2c_f32_bf16 v253, s35, v202
  v_dot2c_f32_bf16 v254, s34, v203
  v_dot2c_f32_bf16 v255, s35, v203
  s_cmp_eq_u32 s20, 3
  s_cbranch_scc1 L_paA1
  v_dot2c_f32_bf16 v248, s34, v204
  v_dot2c_f32_bf16 v249, s35, v204
  v_dot2c_f32_bf16 v250, s34, v205
  v_dot2c_f32_bf16 v251, s35, v205
  v_dot2c_f32_bf16 v252, s34, v206
  v_dot2c_f32_bf16 v253, s35, v206
  v_dot2c_f32_bf16 v254, s34, v207
  v_dot2c_f32_bf16 v255, s35, v207
  s_cmp_eq_u32 s20, 4
  s_cbranch_scc1 L_paA1
  v_dot2c_f32_bf16 v248, s34, v208
  v_dot2c_f32_bf16 v249, s35, v208
  v_dot2c_f32_bf16 v250, s34, v209
  v_dot2c_f32_bf16 v251, s35, v209
  v_dot2c_f32_bf16 v252, s34, v210
  v_dot2c_f32_bf16 v253, s35, v210
  v_dot2c_f32_bf16 v254, s34, v211
  v_dot2c_f32_bf16 v255, s35, v211
  s_cmp_eq_u32 s20, 5
  s_cbranch_scc1 L_paA1
  v_dot2c_f32_bf16 v248, s34, v212
  v_dot2c_f32_bf16 v249, s35, v212
  v_dot2c_f32_bf16 v250, s34, v213
  v_dot2c_f32_bf16 v251, s35, v213
  v_dot2c_f32_bf16 v252, s34, v214
  v_dot2c_f32_bf16 v253, s35, v214
  v_dot2c_f32_bf16 v254, s34, v215
  v_dot2c_f32_bf16 v255, s35, v215
  s_cmp_eq_u32 s20, 6
  s_cbranch_scc1 L_paA1
  v_dot2c_f32_bf16 v248, s34, v216
  v_dot2c_f32_bf16 v249, s35, v216
  v_dot2c_f32_bf16 v250, s34, v217
  v_dot2c_f32_bf16 v251, s35, v217
  v_dot2c_f32_bf16 v252, s34, v218
  v_dot2c_f32_bf16 v253, s35, v218
  v_dot2c_f32_bf16 v254, s34, v219
  v_dot2c_f32_bf16 v255, s35, v219
  s_cmp_eq_u32 s20, 7
  s_cbranch_scc1 L_paA1
  v_dot2c_f32_bf16 v248, s34, v220
  v_dot2c_f32_bf16 v249, s35, v220
  v_dot2c_f32_bf16 v250, s34, v221
  v_dot2c_f32_bf16 v251, s35, v221
  v_dot2c_f32_bf16 v252, s34, v222
  v_dot2c_f32_bf16 v253, s35, v222
  v_dot2c_f32_bf16 v254, s34, v223
  v_dot2c_f32_bf16 v255, s35, v223
L_paA1:
  s_mov_b32 s33, s22
  s_cmp_eq_u32 s33, -1
  s_cbranch_scc1 L_pe
  s_cmp_lg_u32 s52, 0
  s_cbranch_scc1 L_ps_w
  s_branch L_ps
L_pe:
  s_nop 2
  v_cvt_pk_bf16_f32 v16, v224, v225
  v_cvt_pk_bf16_f32 v17, v226, v227
  v_cvt_pk_bf16_f32 v18, v228, v229
  v_cvt_pk_bf16_f32 v19, v230, v231
  v_cvt_pk_bf16_f32 v20, v232, v233
  v_cvt_pk_bf16_f32 v21, v234, v235
  v_cvt_pk_bf16_f32 v22, v236, v237
  v_cvt_pk_bf16_f32 v23, v238, v239
  v_cvt_pk_bf16_f32 v24, v240, v241
  v_cvt_pk_bf16_f32 v25, v242, v243
  v_cvt_pk_bf16_f32 v26, v244, v245
  v_cvt_pk_bf16_f32 v27, v246, v247
  v_cvt_pk_bf16_f32 v28, v248, v249
  v_cvt_pk_bf16_f32 v29, v250, v251
  v_cvt_pk_bf16_f32 v30, v252, v253
  v_cvt_pk_bf16_f32 v31, v254, v255
  v_permlane32_swap_b32 v16, v18
  v_permlane32_swap_b32 v17, v19
  v_permlane32_swap_b32 v20, v22
  v_permlane32_swap_b32 v21, v23
  v_permlane32_swap_b32 v24, v26
  v_permlane32_swap_b32 v25, v27
  v_permlane32_swap_b32 v28, v30
  v_permlane32_swap_b32 v29, v31
  v_permlane16_swap_b32 v16, v18
  v_permlane16_swap_b32 v17, v19
  v_permlane16_swap_b32 v20, v22
  v_permlane16_swap_b32 v21, v23
  v_permlane16_swap_b32 v24, v26
  v_permlane16_swap_b32 v25, v27
  v_permlane16_swap_b32 v28, v30
  v_permlane16_swap_b32 v29, v31
  buffer_store_dwordx4 v[16:19], v1, s[12:15], s40 offen sc1
  buffer_store_dwordx4 v[20:23], v1, s[12:15], s41 offen sc1
  buffer_store_dwordx4 v[24:27], v1, s[12:15], s42 offen sc1
  buffer_store_dwordx4 v[28:31], v1, s[12:15], s43 offen sc1
  s_waitcnt vmcnt(0)
  s_branch L_done
L_icw:
  s_sub_u32 s29, s29, 1
  s_cmp_eq_u32 s29, 0
  s_cbranch_scc1 L_icx
  global_load_dword v95, v9, s[100:101] sc1
  s_waitcnt vmcnt(0)
  s_branch L_ic
L_done:
L_end:
  s_endpgm
L_codeend:
L_slow0:
  s_nop 15
  v_max3_f32 v29, v32, v33, v34
  v_max3_f32 v29, v29, v35, v44
  v_max3_f32 v29, v29, v45, v46
  v_max_f32 v29, v29, v47
  v_mov_b32 v30, v29
  s_nop 1
  v_permlane32_swap_b32 v29, v30
  v_max_f32 v29, v29, v30
  v_mov_b32 v30, v29
  s_nop 1
  v_permlane16_swap_b32 v29, v30
  v_max_f32 v29, v29, v30
  v_mul_f32 v104, s63, v29
  v_max3_f32 v29, v36, v37, v38
  v_max3_f32 v29, v29, v39, v48
  v_max3_f32 v29, v29, v49, v50
  v_max_f32 v29, v29, v51
  v_mov_b32 v30, v29
  s_nop 1
  v_permlane32_swap_b32 v29, v30
  v_max_f32 v29, v29, v30
  v_mov_b32 v30, v29
  s_nop 1
  v_permlane16_swap_b32 v29, v30
  v_max_f32 v29, v29, v30
  v_mul_f32 v105, s63, v29
  v_max3_f32 v29, v40, v41, v42
  v_max3_f32 v29, v29, v43, v52
  v_max3_f32 v29, v29, v53, v54
  v_max_f32 v29, v29, v55
  v_mov_b32 v30, v29
  s_nop 1
  v_permlane32_swap_b32 v29, v30
  v_max_f32 v29, v29, v30
  v_mov_b32 v30, v29
  s_nop 1
  v_permlane16_swap_b32 v29, v30
  v_max_f32 v29, v29, v30
  v_mul_f32 v106, s63, v29
  s_cmp_lg_u32 s76, 0
  s_cbranch_scc1 L_slowfirst0
  v_max_f32 v29, v104, v23
  v_sub_f32 v104, v23, v29
  v_exp_f32 v104, v104
  v_mov_b32 v23, v29
  v_mul_f32 v20, v20, v104
  v_max_f32 v29, v105, v24
  v_sub_f32 v105, v24, v29
  v_exp_f32 v105, v105
  v_mov_b32 v24, v29
  v_mul_f32 v21, v21, v105
  v_max_f32 v29, v106, v25
  v_sub_f32 v106, v25, v29
  v_exp_f32 v106, v106
  v_mov_b32 v25, v29
  v_mul_f32 v22, v22, v106
  v_mul_f32 v112, v112, v104
  v_mul_f32 v113, v113, v104
  v_mul_f32 v114, v114, v104
  v_mul_f32 v115, v115, v104
  v_mul_f32 v116, v116, v105
  v_mul_f32 v117, v117, v105
  v_mul_f32 v118, v118, v105
  v_mul_f32 v119, v119, v105
  v_mul_f32 v120, v120, v106
  v_mul_f32 v121, v121, v106
  v_mul_f32 v122, v122, v106
  v_mul_f32 v123, v123, v106
  v_mul_f32 v124, v124, v104
  v_mul_f32 v125, v125, v104
  v_mul_f32 v126, v126, v104
  v_mul_f32 v127, v127, v104
  v_mul_f32 v128, v128, v105
  v_mul_f32 v129, v129, v105
  v_mul_f32 v130, v130, v105
  v_mul_f32 v131, v131, v105
  v_mul_f32 v132, v132, v106
  v_mul_f32 v133, v133, v106
  v_mul_f32 v134, v134, v106
  v_mul_f32 v135, v135, v106
  v_mul_f32 v136, v136, v104
  v_mul_f32 v137, v137, v104
  v_mul_f32 v138, v138, v104
  v_mul_f32 v139, v139, v104
  v_mul_f32 v140, v140, v105
  v_mul_f32 v141, v141, v105
  v_mul_f32 v142, v142, v105
  v_mul_f32 v143, v143, v105
  v_mul_f32 v144, v144, v106
  v_mul_f32 v145, v145, v106
  v_mul_f32 v146, v146, v106
  v_mul_f32 v147, v147, v106
  v_mul_f32 v148, v148, v104
  v_mul_f32 v149, v149, v104
  v_mul_f32 v150, v150, v104
  v_mul_f32 v151, v151, v104
  v_mul_f32 v152, v152, v105
  v_mul_f32 v153, v153, v105
  v_mul_f32 v154, v154, v105
  v_mul_f32 v155, v155, v105
  v_mul_f32 v156, v156, v106
  v_mul_f32 v157, v157, v106
  v_mul_f32 v158, v158, v106
  v_mul_f32 v159, v159, v106
  v_mul_f32 v160, v160, v104
  v_mul_f32 v161, v161, v104
  v_mul_f32 v162, v162, v104
  v_mul_f32 v163, v163, v104
  v_mul_f32 v164, v164, v105
  v_mul_f32 v165, v165, v105
  v_mul_f32 v166, v166, v105
  v_mul_f32 v167, v167, v105
  v_mul_f32 v168, v168, v106
  v_mul_f32 v169, v169, v106
  v_mul_f32 v170, v170, v106
  v_mul_f32 v171, v171, v106
  v_mul_f32 v172, v172, v104
  v_mul_f32 v173, v173, v104
  v_mul_f32 v174, v174, v104
  v_mul_f32 v175, v175, v104
  v_mul_f32 v176, v176, v105
  v_mul_f32 v177, v177, v105
  v_mul_f32 v178, v178, v105
  v_mul_f32 v179, v179, v105
  v_mul_f32 v180, v180, v106
  v_mul_f32 v181, v181, v106
  v_mul_f32 v182, v182, v106
  v_mul_f32 v183, v183, v106
  v_mul_f32 v184, v184, v104
  v_mul_f32 v185, v185, v104
  v_mul_f32 v186, v186, v104
  v_mul_f32 v187, v187, v104
  v_mul_f32 v188, v188, v105
  v_mul_f32 v189, v189, v105
  v_mul_f32 v190, v190, v105
  v_mul_f32 v191, v191, v105
  v_mul_f32 v192, v192, v106
  v_mul_f32 v193, v193, v106
  v_mul_f32 v194, v194, v106
  v_mul_f32 v195, v195, v106
  v_mul_f32 v196, v196, v104
  v_mul_f32 v197, v197, v104
  v_mul_f32 v198, v198, v104
  v_mul_f32 v199, v199, v104
  v_mul_f32 v200, v200, v105
  v_mul_f32 v201, v201, v105
  v_mul_f32 v202, v202, v105
  v_mul_f32 v203, v203, v105
  v_mul_f32 v204, v204, v106
  v_mul_f32 v205, v205, v106
  v_mul_f32 v206, v206, v106
  v_mul_f32 v207, v207, v106
  v_mul_f32 v208, v208, v104
  v_mul_f32 v209, v209, v104
  v_mul_f32 v210, v210, v104
  v_mul_f32 v211, v211, v104
  v_mul_f32 v212, v212, v105
  v_mul_f32 v213, v213, v105
  v_mul_f32 v214, v214, v105
  v_mul_f32 v215, v215, v105
  v_mul_f32 v216, v216, v106
  v_mul_f32 v217, v217, v106
  v_mul_f32 v218, v218, v106
  v_mul_f32 v219, v219, v106
  v_mul_f32 v220, v220, v104
  v_mul_f32 v221, v221, v104
  v_mul_f32 v222, v222, v104
  v_mul_f32 v223, v223, v104
  v_mul_f32 v224, v224, v105
  v_mul_f32 v225, v225, v105
  v_mul_f32 v226, v226, v105
  v_mul_f32 v227, v227, v105
  v_mul_f32 v228, v228, v106
  v_mul_f32 v229, v229, v106
  v_mul_f32 v230, v230, v106
  v_mul_f32 v231, v231, v106
  v_mul_f32 v232, v232, v104
  v_mul_f32 v233, v233, v104
  v_mul_f32 v234, v234, v104
  v_mul_f32 v235, v235, v104
  v_mul_f32 v236, v236, v105
  v_mul_f32 v237, v237, v105
  v_mul_f32 v238, v238, v105
  v_mul_f32 v239, v239, v105
  v_mul_f32 v240, v240, v106
  v_mul_f32 v241, v241, v106
  v_mul_f32 v242, v242, v106
  v_mul_f32 v243, v243, v106
  v_mul_f32 v244, v244, v104
  v_mul_f32 v245, v245, v104
  v_mul_f32 v246, v246, v104
  v_mul_f32 v247, v247, v104
  v_mul_f32 v248, v248, v105
  v_mul_f32 v249, v249, v105
  v_mul_f32 v250, v250, v105
  v_mul_f32 v251, v251, v105
  v_mul_f32 v252, v252, v106
  v_mul_f32 v253, v253, v106
  v_mul_f32 v254, v254, v106
  v_mul_f32 v255, v255, v106
  v_accvgpr_read_b32 v29, a160
  v_mul_f32 v29, v29, v104
  v_accvgpr_write_b32 a160, v29
  v_accvgpr_read_b32 v29, a161
  v_mul_f32 v29, v29, v104
  v_accvgpr_write_b32 a161, v29
  v_accvgpr_read_b32 v29, a162
  v_mul_f32 v29, v29, v104
  v_accvgpr_write_b32 a162, v29
  v_accvgpr_read_b32 v29, a163
  v_mul_f32 v29, v29, v104
  v_accvgpr_write_b32 a163, v29
  v_accvgpr_read_b32 v29, a164
  v_mul_f32 v29, v29, v105
  v_accvgpr_write_b32 a164, v29
  v_accvgpr_read_b32 v29, a165
  v_mul_f32 v29, v29, v105
  v_accvgpr_write_b32 a165, v29
  v_accvgpr_read_b32 v29, a166
  v_mul_f32 v29, v29, v105
  v_accvgpr_write_b32 a166, v29
  v_accvgpr_read_b32 v29, a167
  v_mul_f32 v29, v29, v105
  v_accvgpr_write_b32 a167, v29
  v_accvgpr_read_b32 v29, a168
  v_mul_f32 v29, v29, v106
  v_accvgpr_write_b32 a168, v29
  v_accvgpr_read_b32 v29, a169
  v_mul_f32 v29, v29, v106
  v_accvgpr_write_b32 a169, v29
  v_accvgpr_read_b32 v29, a170
  v_mul_f32 v29, v29, v106
  v_accvgpr_write_b32 a170, v29
  v_accvgpr_read_b32 v29, a171
  v_mul_f32 v29, v29, v106
  v_accvgpr_write_b32 a171, v29
  v_accvgpr_read_b32 v29, a172
  v_mul_f32 v29, v29, v104
  v_accvgpr_write_b32 a172, v29
  v_accvgpr_read_b32 v29, a173
  v_mul_f32 v29, v29, v104
  v_accvgpr_write_b32 a173, v29
  v_accvgpr_read_b32 v29, a174
  v_mul_f32 v29, v29, v104
  v_accvgpr_write_b32 a174, v29
  v_accvgpr_read_b32 v29, a175
  v_mul_f32 v29, v29, v104
  v_accvgpr_write_b32 a175, v29
  v_accvgpr_read_b32 v29, a176
  v_mul_f32 v29, v29, v105
  v_accvgpr_write_b32 a176, v29
  v_accvgpr_read_b32 v29, a177
  v_mul_f32 v29, v29, v105
  v_accvgpr_write_b32 a177, v29
  v_accvgpr_read_b32 v29, a178
  v_mul_f32 v29, v29, v105
  v_accvgpr_write_b32 a178, v29
  v_accvgpr_read_b32 v29, a179
  v_mul_f32 v29, v29, v105
  v_accvgpr_write_b32 a179, v29
  v_accvgpr_read_b32 v29, a180
  v_mul_f32 v29, v29, v106
  v_accvgpr_write_b32 a180, v29
  v_accvgpr_read_b32 v29, a181
  v_mul_f32 v29, v29, v106
  v_accvgpr_write_b32 a181, v29
  v_accvgpr_read_b32 v29, a182
  v_mul_f32 v29, v29, v106
  v_accvgpr_write_b32 a182, v29
  v_accvgpr_read_b32 v29, a183
  v_mul_f32 v29, v29, v106
  v_accvgpr_write_b32 a183, v29
  v_accvgpr_read_b32 v29, a184
  v_mul_f32 v29, v29, v104
  v_accvgpr_write_b32 a184, v29
  v_accvgpr_read_b32 v29, a185
  v_mul_f32 v29, v29, v104
  v_accvgpr_write_b32 a185, v29
  v_accvgpr_read_b32 v29, a186
  v_mul_f32 v29, v29, v104
  v_accvgpr_write_b32 a186, v29
  v_accvgpr_read_b32 v29, a187
  v_mul_f32 v29, v29, v104
  v_accvgpr_write_b32 a187, v29
  v_accvgpr_read_b32 v29, a188
  v_mul_f32 v29, v29, v105
  v_accvgpr_write_b32 a188, v29
  v_accvgpr_read_b32 v29, a189
  v_mul_f32 v29, v29, v105
  v_accvgpr_write_b32 a189, v29
  v_accvgpr_read_b32 v29, a190
  v_mul_f32 v29, v29, v105
  v_accvgpr_write_b32 a190, v29
  v_accvgpr_read_b32 v29, a191
  v_mul_f32 v29, v29, v105
  v_accvgpr_write_b32 a191, v29
  v_accvgpr_read_b32 v29, a192
  v_mul_f32 v29, v29, v106
  v_accvgpr_write_b32 a192, v29
  v_accvgpr_read_b32 v29, a193
  v_mul_f32 v29, v29, v106
  v_accvgpr_write_b32 a193, v29
  v_accvgpr_read_b32 v29, a194
  v_mul_f32 v29, v29, v106
  v_accvgpr_write_b32 a194, v29
  v_accvgpr_read_b32 v29, a195
  v_mul_f32 v29, v29, v106
  v_accvgpr_write_b32 a195, v29
  v_accvgpr_read_b32 v29, a196
  v_mul_f32 v29, v29, v104
  v_accvgpr_write_b32 a196, v29
  v_accvgpr_read_b32 v29, a197
  v_mul_f32 v29, v29, v104
  v_accvgpr_write_b32 a197, v29
  v_accvgpr_read_b32 v29, a198
  v_mul_f32 v29, v29, v104
  v_accvgpr_write_b32 a198, v29
  v_accvgpr_read_b32 v29, a199
  v_mul_f32 v29, v29, v104
  v_accvgpr_write_b32 a199, v29
  v_accvgpr_read_b32 v29, a200
  v_mul_f32 v29, v29, v105
  v_accvgpr_write_b32 a200, v29
  v_accvgpr_read_b32 v29, a201
  v_mul_f32 v29, v29, v105
  v_accvgpr_write_b32 a201, v29
  v_accvgpr_read_b32 v29, a202
  v_mul_f32 v29, v29, v105
  v_accvgpr_write_b32 a202, v29
  v_accvgpr_read_b32 v29, a203
  v_mul_f32 v29, v29, v105
  v_accvgpr_write_b32 a203, v29
  v_accvgpr_read_b32 v29, a204
  v_mul_f32 v29, v29, v106
  v_accvgpr_write_b32 a204, v29
  v_accvgpr_read_b32 v29, a205
  v_mul_f32 v29, v29, v106
  v_accvgpr_write_b32 a205, v29
  v_accvgpr_read_b32 v29, a206
  v_mul_f32 v29, v29, v106
  v_accvgpr_write_b32 a206, v29
  v_accvgpr_read_b32 v29, a207
  v_mul_f32 v29, v29, v106
  v_accvgpr_write_b32 a207, v29
  s_branch L_slowp0
L_slowfirst0:
  v_mov_b32 v23, v104
  v_mov_b32 v20, 0
  v_mov_b32 v24, v105
  v_mov_b32 v21, 0
  v_mov_b32 v25, v106
  v_mov_b32 v22, 0
  s_mov_b32 s76, 0
L_slowp0:
  v_fma_f32 v0, v32, s63, -v23
  v_fma_f32 v1, v33, s63, -v23
  v_fma_f32 v2, v34, s63, -v23
  v_fma_f32 v3, v35, s63, -v23
  v_exp_f32 v0, v0
  v_exp_f32 v1, v1
  v_exp_f32 v2, v2
  v_exp_f32 v3, v3
  v_add_f32 v26, v0, v1
  v_cvt_pk_bf16_f32 v56, v0, v1
  v_add_f32 v26, v26, v2
  v_cvt_pk_bf16_f32 v57, v2, v3
  v_add_f32 v26, v26, v3
  v_fma_f32 v96, v36, s63, -v24
  v_fma_f32 v97, v37, s63, -v24
  v_fma_f32 v98, v38, s63, -v24
  v_fma_f32 v99, v39, s63, -v24
  v_exp_f32 v96, v96
  v_exp_f32 v97, v97
  v_exp_f32 v98, v98
  v_exp_f32 v99, v99
  v_add_f32 v27, v96, v97
  v_cvt_pk_bf16_f32 v60, v96, v97
  v_add_f32 v27, v27, v98
  v_cvt_pk_bf16_f32 v61, v98, v99
  v_add_f32 v27, v27, v99
  v_fma_f32 v108, v40, s63, -v25
  v_fma_f32 v109, v41, s63, -v25
  v_fma_f32 v110, v42, s63, -v25
  v_fma_f32 v111, v43, s63, -v25
  v_exp_f32 v108, v108
  v_exp_f32 v109, v109
  v_exp_f32 v110, v110
  v_exp_f32 v111, v111
  v_add_f32 v28, v108, v109
  v_cvt_pk_bf16_f32 v64, v108, v109
  v_add_f32 v28, v28, v110
  v_cvt_pk_bf16_f32 v65, v110, v111
  v_add_f32 v28, v28, v111
  v_fma_f32 v0, v44, s63, -v23
  v_fma_f32 v1, v45, s63, -v23
  v_fma_f32 v2, v46, s63, -v23
  v_fma_f32 v3, v47, s63, -v23
  v_exp_f32 v0, v0
  v_exp_f32 v1, v1
  v_exp_f32 v2, v2
  v_exp_f32 v3, v3
  v_add_f32 v26, v26, v0
  v_cvt_pk_bf16_f32 v58, v0, v1
  v_add_f32 v26, v26, v1
  v_add_f32 v26, v26, v2
  v_cvt_pk_bf16_f32 v59, v2, v3
  v_add_f32 v26, v26, v3
  v_fma_f32 v96, v48, s63, -v24
  v_fma_f32 v97, v49, s63, -v24
  v_fma_f32 v98, v50, s63, -v24
  v_fma_f32 v99, v51, s63, -v24
  v_exp_f32 v96, v96
  v_exp_f32 v97, v97
  v_exp_f32 v98, v98
  v_exp_f32 v99, v99
  v_add_f32 v27, v27, v96
  v_cvt_pk_bf16_f32 v62, v96, v97
  v_add_f32 v27, v27, v97
  v_add_f32 v27, v27, v98
  v_cvt_pk_bf16_f32 v63, v98, v99
  v_add_f32 v27, v27, v99
  v_fma_f32 v108, v52, s63, -v25
  v_fma_f32 v109, v53, s63, -v25
  v_fma_f32 v110, v54, s63, -v25
  v_fma_f32 v111, v55, s63, -v25
  v_exp_f32 v108, v108
  v_exp_f32 v109, v109
  v_exp_f32 v110, v110
  v_exp_f32 v111, v111
  v_add_f32 v28, v28, v108
  v_cvt_pk_bf16_f32 v66, v108, v109
  v_add_f32 v28, v28, v109
  v_add_f32 v28, v28, v110
  v_cvt_pk_bf16_f32 v67, v110, v111
  v_add_f32 v28, v28, v111
  s_nop 1
  s_setpc_b64 s[70:71]
L_slow1:
  s_nop 15
  v_max3_f32 v29, v32, v33, v34
  v_max3_f32 v29, v29, v35, v44
  v_max3_f32 v29, v29, v45, v46
  v_max_f32 v29, v29, v47
  v_mov_b32 v30, v29
  s_nop 1
  v_permlane32_swap_b32 v29, v30
  v_max_f32 v29, v29, v30
  v_mov_b32 v30, v29
  s_nop 1
  v_permlane16_swap_b32 v29, v30
  v_max_f32 v29, v29, v30
  v_mul_f32 v104, s63, v29
  v_max3_f32 v29, v36, v37, v38
  v_max3_f32 v29, v29, v39, v48
  v_max3_f32 v29, v29, v49, v50
  v_max_f32 v29, v29, v51
  v_mov_b32 v30, v29
  s_nop 1
  v_permlane32_swap_b32 v29, v30
  v_max_f32 v29, v29, v30
  v_mov_b32 v30, v29
  s_nop 1
  v_permlane16_swap_b32 v29, v30
  v_max_f32 v29, v29, v30
  v_mul_f32 v105, s63, v29
  v_max3_f32 v29, v40, v41, v42
  v_max3_f32 v29, v29, v43, v52
  v_max3_f32 v29, v29, v53, v54
  v_max_f32 v29, v29, v55
  v_mov_b32 v30, v29
  s_nop 1
  v_permlane32_swap_b32 v29, v30
  v_max_f32 v29, v29, v30
  v_mov_b32 v30, v29
  s_nop 1
  v_permlane16_swap_b32 v29, v30
  v_max_f32 v29, v29, v30
  v_mul_f32 v106, s63, v29
  s_cmp_lg_u32 s76, 0
  s_cbranch_scc1 L_slowfirst1
  v_max_f32 v29, v104, v23
  v_sub_f32 v104, v23, v29
  v_exp_f32 v104, v104
  v_mov_b32 v23, v29
  v_mul_f32 v20, v20, v104
  v_max_f32 v29, v105, v24
  v_sub_f32 v105, v24, v29
  v_exp_f32 v105, v105
  v_mov_b32 v24, v29
  v_mul_f32 v21, v21, v105
  v_max_f32 v29, v106, v25
  v_sub_f32 v106, v25, v29
  v_exp_f32 v106, v106
  v_mov_b32 v25, v29
  v_mul_f32 v22, v22, v106
  v_mul_f32 v112, v112, v104
  v_mul_f32 v113, v113, v104
  v_mul_f32 v114, v114, v104
  v_mul_f32 v115, v115, v104
  v_mul_f32 v116, v116, v105
  v_mul_f32 v117, v117, v105
  v_mul_f32 v118, v118, v105
  v_mul_f32 v119, v119, v105
  v_mul_f32 v120, v120, v106
  v_mul_f32 v121, v121, v106
  v_mul_f32 v122, v122, v106
  v_mul_f32 v123, v123, v106
  v_mul_f32 v124, v124, v104
  v_mul_f32 v125, v125, v104
  v_mul_f32 v126, v126, v104
  v_mul_f32 v127, v127, v104
  v_mul_f32 v128, v128, v105
  v_mul_f32 v129, v129, v105
  v_mul_f32 v130, v130, v105
  v_mul_f32 v131, v131, v105
  v_mul_f32 v132, v132, v106
  v_mul_f32 v133, v133, v106
  v_mul_f32 v134, v134, v106
  v_mul_f32 v135, v135, v106
  v_mul_f32 v136, v136, v104
  v_mul_f32 v137, v137, v104
  v_mul_f32 v138, v138, v104
  v_mul_f32 v139, v139, v104
  v_mul_f32 v140, v140, v105
  v_mul_f32 v141, v141, v105
  v_mul_f32 v142, v142, v105
  v_mul_f32 v143, v143, v105
  v_mul_f32 v144, v144, v106
  v_mul_f32 v145, v145, v106
  v_mul_f32 v146, v146, v106
  v_mul_f32 v147, v147, v106
  v_mul_f32 v148, v148, v104
  v_mul_f32 v149, v149, v104
  v_mul_f32 v150, v150, v104
  v_mul_f32 v151, v151, v104
  v_mul_f32 v152, v152, v105
  v_mul_f32 v153, v153, v105
  v_mul_f32 v154, v154, v105
  v_mul_f32 v155, v155, v105
  v_mul_f32 v156, v156, v106
  v_mul_f32 v157, v157, v106
  v_mul_f32 v158, v158, v106
  v_mul_f32 v159, v159, v106
  v_mul_f32 v160, v160, v104
  v_mul_f32 v161, v161, v104
  v_mul_f32 v162, v162, v104
  v_mul_f32 v163, v163, v104
  v_mul_f32 v164, v164, v105
  v_mul_f32 v165, v165, v105
  v_mul_f32 v166, v166, v105
  v_mul_f32 v167, v167, v105
  v_mul_f32 v168, v168, v106
  v_mul_f32 v169, v169, v106
  v_mul_f32 v170, v170, v106
  v_mul_f32 v171, v171, v106
  v_mul_f32 v172, v172, v104
  v_mul_f32 v173, v173, v104
  v_mul_f32 v174, v174, v104
  v_mul_f32 v175, v175, v104
  v_mul_f32 v176, v176, v105
  v_mul_f32 v177, v177, v105
  v_mul_f32 v178, v178, v105
  v_mul_f32 v179, v179, v105
  v_mul_f32 v180, v180, v106
  v_mul_f32 v181, v181, v106
  v_mul_f32 v182, v182, v106
  v_mul_f32 v183, v183, v106
  v_mul_f32 v184, v184, v104
  v_mul_f32 v185, v185, v104
  v_mul_f32 v186, v186, v104
  v_mul_f32 v187, v187, v104
  v_mul_f32 v188, v188, v105
  v_mul_f32 v189, v189, v105
  v_mul_f32 v190, v190, v105
  v_mul_f32 v191, v191, v105
  v_mul_f32 v192, v192, v106
  v_mul_f32 v193, v193, v106
  v_mul_f32 v194, v194, v106
  v_mul_f32 v195, v195, v106
  v_mul_f32 v196, v196, v104
  v_mul_f32 v197, v197, v104
  v_mul_f32 v198, v198, v104
  v_mul_f32 v199, v199, v104
  v_mul_f32 v200, v200, v105
  v_mul_f32 v201, v201, v105
  v_mul_f32 v202, v202, v105
  v_mul_f32 v203, v203, v105
  v_mul_f32 v204, v204, v106
  v_mul_f32 v205, v205, v106
  v_mul_f32 v206, v206, v106
  v_mul_f32 v207, v207, v106
  v_mul_f32 v208, v208, v104
  v_mul_f32 v209, v209, v104
  v_mul_f32 v210, v210, v104
  v_mul_f32 v211, v211, v104
  v_mul_f32 v212, v212, v105
  v_mul_f32 v213, v213, v105
  v_mul_f32 v214, v214, v105
  v_mul_f32 v215, v215, v105
  v_mul_f32 v216, v216, v106
  v_mul_f32 v217, v217, v106
  v_mul_f32 v218, v218, v106
  v_mul_f32 v219, v219, v106
  v_mul_f32 v220, v220, v104
  v_mul_f32 v221, v221, v104
  v_mul_f32 v222, v222, v104
  v_mul_f32 v223, v223, v104
  v_mul_f32 v224, v224, v105
  v_mul_f32 v225, v225, v105
  v_mul_f32 v226, v226, v105
  v_mul_f32 v227, v227, v105
  v_mul_f32 v228, v228, v106
  v_mul_f32 v229, v229, v106
  v_mul_f32 v230, v230, v106
  v_mul_f32 v231, v231, v106
  v_mul_f32 v232, v232, v104
  v_mul_f32 v233, v233, v104
  v_mul_f32 v234, v234, v104
  v_mul_f32 v235, v235, v104
  v_mul_f32 v236, v236, v105
  v_mul_f32 v237, v237, v105
  v_mul_f32 v238, v238, v105
  v_mul_f32 v239, v239, v105
  v_mul_f32 v240, v240, v106
  v_mul_f32 v241, v241, v106
  v_mul_f32 v242, v242, v106
  v_mul_f32 v243, v243, v106
  v_mul_f32 v244, v244, v104
  v_mul_f32 v245, v245, v104
  v_mul_f32 v246, v246, v104
  v_mul_f32 v247, v247, v104
  v_mul_f32 v248, v248, v105
  v_mul_f32 v249, v249, v105
  v_mul_f32 v250, v250, v105
  v_mul_f32 v251, v251, v105
  v_mul_f32 v252, v252, v106
  v_mul_f32 v253, v253, v106
  v_mul_f32 v254, v254, v106
  v_mul_f32 v255, v255, v106
  v_accvgpr_read_b32 v29, a160
  v_mul_f32 v29, v29, v104
  v_accvgpr_write_b32 a160, v29
  v_accvgpr_read_b32 v29, a161
  v_mul_f32 v29, v29, v104
  v_accvgpr_write_b32 a161, v29
  v_accvgpr_read_b32 v29, a162
  v_mul_f32 v29, v29, v104
  v_accvgpr_write_b32 a162, v29
  v_accvgpr_read_b32 v29, a163
  v_mul_f32 v29, v29, v104
  v_accvgpr_write_b32 a163, v29
  v_accvgpr_read_b32 v29, a164
  v_mul_f32 v29, v29, v105
  v_accvgpr_write_b32 a164, v29
  v_accvgpr_read_b32 v29, a165
  v_mul_f32 v29, v29, v105
  v_accvgpr_write_b32 a165, v29
  v_accvgpr_read_b32 v29, a166
  v_mul_f32 v29, v29, v105
  v_accvgpr_write_b32 a166, v29
  v_accvgpr_read_b32 v29, a167
  v_mul_f32 v29, v29, v105
  v_accvgpr_write_b32 a167, v29
  v_accvgpr_read_b32 v29, a168
  v_mul_f32 v29, v29, v106
  v_accvgpr_write_b32 a168, v29
  v_accvgpr_read_b32 v29, a169
  v_mul_f32 v29, v29, v106
  v_accvgpr_write_b32 a169, v29
  v_accvgpr_read_b32 v29, a170
  v_mul_f32 v29, v29, v106
  v_accvgpr_write_b32 a170, v29
  v_accvgpr_read_b32 v29, a171
  v_mul_f32 v29, v29, v106
  v_accvgpr_write_b32 a171, v29
  v_accvgpr_read_b32 v29, a172
  v_mul_f32 v29, v29, v104
  v_accvgpr_write_b32 a172, v29
  v_accvgpr_read_b32 v29, a173
  v_mul_f32 v29, v29, v104
  v_accvgpr_write_b32 a173, v29
  v_accvgpr_read_b32 v29, a174
  v_mul_f32 v29, v29, v104
  v_accvgpr_write_b32 a174, v29
  v_accvgpr_read_b32 v29, a175
  v_mul_f32 v29, v29, v104
  v_accvgpr_write_b32 a175, v29
  v_accvgpr_read_b32 v29, a176
  v_mul_f32 v29, v29, v105
  v_accvgpr_write_b32 a176, v29
  v_accvgpr_read_b32 v29, a177
  v_mul_f32 v29, v29, v105
  v_accvgpr_write_b32 a177, v29
  v_accvgpr_read_b32 v29, a178
  v_mul_f32 v29, v29, v105
  v_accvgpr_write_b32 a178, v29
  v_accvgpr_read_b32 v29, a179
  v_mul_f32 v29, v29, v105
  v_accvgpr_write_b32 a179, v29
  v_accvgpr_read_b32 v29, a180
  v_mul_f32 v29, v29, v106
  v_accvgpr_write_b32 a180, v29
  v_accvgpr_read_b32 v29, a181
  v_mul_f32 v29, v29, v106
  v_accvgpr_write_b32 a181, v29
  v_accvgpr_read_b32 v29, a182
  v_mul_f32 v29, v29, v106
  v_accvgpr_write_b32 a182, v29
  v_accvgpr_read_b32 v29, a183
  v_mul_f32 v29, v29, v106
  v_accvgpr_write_b32 a183, v29
  v_accvgpr_read_b32 v29, a184
  v_mul_f32 v29, v29, v104
  v_accvgpr_write_b32 a184, v29
  v_accvgpr_read_b32 v29, a185
  v_mul_f32 v29, v29, v104
  v_accvgpr_write_b32 a185, v29
  v_accvgpr_read_b32 v29, a186
  v_mul_f32 v29, v29, v104
  v_accvgpr_write_b32 a186, v29
  v_accvgpr_read_b32 v29, a187
  v_mul_f32 v29, v29, v104
  v_accvgpr_write_b32 a187, v29
  v_accvgpr_read_b32 v29, a188
  v_mul_f32 v29, v29, v105
  v_accvgpr_write_b32 a188, v29
  v_accvgpr_read_b32 v29, a189
  v_mul_f32 v29, v29, v105
  v_accvgpr_write_b32 a189, v29
  v_accvgpr_read_b32 v29, a190
  v_mul_f32 v29, v29, v105
  v_accvgpr_write_b32 a190, v29
  v_accvgpr_read_b32 v29, a191
  v_mul_f32 v29, v29, v105
  v_accvgpr_write_b32 a191, v29
  v_accvgpr_read_b32 v29, a192
  v_mul_f32 v29, v29, v106
  v_accvgpr_write_b32 a192, v29
  v_accvgpr_read_b32 v29, a193
  v_mul_f32 v29, v29, v106
  v_accvgpr_write_b32 a193, v29
  v_accvgpr_read_b32 v29, a194
  v_mul_f32 v29, v29, v106
  v_accvgpr_write_b32 a194, v29
  v_accvgpr_read_b32 v29, a195
  v_mul_f32 v29, v29, v106
  v_accvgpr_write_b32 a195, v29
  v_accvgpr_read_b32 v29, a196
  v_mul_f32 v29, v29, v104
  v_accvgpr_write_b32 a196, v29
  v_accvgpr_read_b32 v29, a197
  v_mul_f32 v29, v29, v104
  v_accvgpr_write_b32 a197, v29
  v_accvgpr_read_b32 v29, a198
  v_mul_f32 v29, v29, v104
  v_accvgpr_write_b32 a198, v29
  v_accvgpr_read_b32 v29, a199
  v_mul_f32 v29, v29, v104
  v_accvgpr_write_b32 a199, v29
  v_accvgpr_read_b32 v29, a200
  v_mul_f32 v29, v29, v105
  v_accvgpr_write_b32 a200, v29
  v_accvgpr_read_b32 v29, a201
  v_mul_f32 v29, v29, v105
  v_accvgpr_write_b32 a201, v29
  v_accvgpr_read_b32 v29, a202
  v_mul_f32 v29, v29, v105
  v_accvgpr_write_b32 a202, v29
  v_accvgpr_read_b32 v29, a203
  v_mul_f32 v29, v29, v105
  v_accvgpr_write_b32 a203, v29
  v_accvgpr_read_b32 v29, a204
  v_mul_f32 v29, v29, v106
  v_accvgpr_write_b32 a204, v29
  v_accvgpr_read_b32 v29, a205
  v_mul_f32 v29, v29, v106
  v_accvgpr_write_b32 a205, v29
  v_accvgpr_read_b32 v29, a206
  v_mul_f32 v29, v29, v106
  v_accvgpr_write_b32 a206, v29
  v_accvgpr_read_b32 v29, a207
  v_mul_f32 v29, v29, v106
  v_accvgpr_write_b32 a207, v29
  s_branch L_slowp1
L_slowfirst1:
  v_mov_b32 v23, v104
  v_mov_b32 v20, 0
  v_mov_b32 v24, v105
  v_mov_b32 v21, 0
  v_mov_b32 v25, v106
  v_mov_b32 v22, 0
  s_mov_b32 s76, 0
L_slowp1:
  v_fma_f32 v0, v32, s63, -v23
  v_fma_f32 v1, v33, s63, -v23
  v_fma_f32 v2, v34, s63, -v23
  v_fma_f32 v3, v35, s63, -v23
  v_exp_f32 v0, v0
  v_exp_f32 v1, v1
  v_exp_f32 v2, v2
  v_exp_f32 v3, v3
  v_add_f32 v26, v0, v1
  v_cvt_pk_bf16_f32 v68, v0, v1
  v_add_f32 v26, v26, v2
  v_cvt_pk_bf16_f32 v69, v2, v3
  v_add_f32 v26, v26, v3
  v_fma_f32 v96, v36, s63, -v24
  v_fma_f32 v97, v37, s63, -v24
  v_fma_f32 v98, v38, s63, -v24
  v_fma_f32 v99, v39, s63, -v24
  v_exp_f32 v96, v96
  v_exp_f32 v97, v97
  v_exp_f32 v98, v98
  v_exp_f32 v99, v99
  v_add_f32 v27, v96, v97
  v_cvt_pk_bf16_f32 v72, v96, v97
  v_add_f32 v27, v27, v98
  v_cvt_pk_bf16_f32 v73, v98, v99
  v_add_f32 v27, v27, v99
  v_fma_f32 v108, v40, s63, -v25
  v_fma_f32 v109, v41, s63, -v25
  v_fma_f32 v110, v42, s63, -v25
  v_fma_f32 v111, v43, s63, -v25
  v_exp_f32 v108, v108
  v_exp_f32 v109, v109
  v_exp_f32 v110, v110
  v_exp_f32 v111, v111
  v_add_f32 v28, v108, v109
  v_cvt_pk_bf16_f32 v76, v108, v109
  v_add_f32 v28, v28, v110
  v_cvt_pk_bf16_f32 v77, v110, v111
  v_add_f32 v28, v28, v111
  v_fma_f32 v0, v44, s63, -v23
  v_fma_f32 v1, v45, s63, -v23
  v_fma_f32 v2, v46, s63, -v23
  v_fma_f32 v3, v47, s63, -v23
  v_exp_f32 v0, v0
  v_exp_f32 v1, v1
  v_exp_f32 v2, v2
  v_exp_f32 v3, v3
  v_add_f32 v26, v26, v0
  v_cvt_pk_bf16_f32 v70, v0, v1
  v_add_f32 v26, v26, v1
  v_add_f32 v26, v26, v2
  v_cvt_pk_bf16_f32 v71, v2, v3
  v_add_f32 v26, v26, v3
  v_fma_f32 v96, v48, s63, -v24
  v_fma_f32 v97, v49, s63, -v24
  v_fma_f32 v98, v50, s63, -v24
  v_fma_f32 v99, v51, s63, -v24
  v_exp_f32 v96, v96
  v_exp_f32 v97, v97
  v_exp_f32 v98, v98
  v_exp_f32 v99, v99
  v_add_f32 v27, v27, v96
  v_cvt_pk_bf16_f32 v74, v96, v97
  v_add_f32 v27, v27, v97
  v_add_f32 v27, v27, v98
  v_cvt_pk_bf16_f32 v75, v98, v99
  v_add_f32 v27, v27, v99
  v_fma_f32 v108, v52, s63, -v25
  v_fma_f32 v109, v53, s63, -v25
  v_fma_f32 v110, v54, s63, -v25
  v_fma_f32 v111, v55, s63, -v25
  v_exp_f32 v108, v108
  v_exp_f32 v109, v109
  v_exp_f32 v110, v110
  v_exp_f32 v111, v111
  v_add_f32 v28, v28, v108
  v_cvt_pk_bf16_f32 v78, v108, v109
  v_add_f32 v28, v28, v109
  v_add_f32 v28, v28, v110
  v_cvt_pk_bf16_f32 v79, v110, v111
  v_add_f32 v28, v28, v111
  s_nop 1
  s_setpc_b64 s[70:71]
.section .rodata,"a"
.p2align 6
.amdhsa_kernel concat_heads__gqa_block_cached__mha_block_cached__near_ridge_kernel
  .amdhsa_next_free_vgpr 512
  .amdhsa_next_free_sgpr 102
  .amdhsa_accum_offset 256
  .amdhsa_group_segment_fixed_size 0
  .amdhsa_kernarg_size 104
  .amdhsa_user_sgpr_count 2
  .amdhsa_user_sgpr_kernarg_segment_ptr 1
  .amdhsa_system_sgpr_workgroup_id_x 1
  .amdhsa_float_denorm_mode_32 3
.end_amdhsa_kernel
```
